```python
import torch

def _softmax(x, axis=-1):
    return torch.softmax(x, dim=axis)

def _gelu(x):
    return torch.nn.functional.gelu(x, approximate='tanh')

def _silu(x):
    return torch.nn.functional.silu(x)

def _sigmoid(x):
    return torch.sigmoid(x)

def _layernorm(x, axis=-1, eps=1e-05):
    m = x.mean(dim=axis, keepdim=True)
    v = x.var(dim=axis, keepdim=True, unbiased=False)
    return (x - m) / torch.sqrt(v + eps)

def _scatter_add(tgt, idx, src, axis=0):
    return tgt.clone().index_add_(axis, idx, src)

def _segment_sum(src, seg, n):
    out = torch.zeros((n,) + src.shape[1:], dtype=src.dtype)
    return out.index_add_(0, seg, src)

def _pad(x, pw):
    flat = tuple((v for pair in reversed(pw) for v in pair))
    return torch.nn.functional.pad(x, flat)
kernel_name = 'gated_mix__memory_aug_recurrent_mem_tr__dense_activation_relu__prompt'

def setup_inputs():

    _w = lambda a: (lambda t: t.to(torch.bfloat16) if t.is_floating_point() else t)(torch.as_tensor(a))

    def _A_setup():
        B, S, Dm = (1, 2048, 512)
        H, Dh = (32, 128)
        M, seg = (8, 32)
        seg = min(seg, S)
        S = S // seg * seg
        return {'x': _w((lambda *s: torch.randn(*s, dtype=torch.bfloat16) * 0.05)(B, S, Dm)), 'mem0': _w((lambda *s: torch.randn(*s, dtype=torch.bfloat16) * 1.6)(B, M, Dm)), 'Wq': _w((lambda *s: torch.randn(*s, dtype=torch.bfloat16) * 0.8)(Dm, H, Dh) * Dm ** (-0.5)), 'Wk': _w((lambda *s: torch.randn(*s, dtype=torch.bfloat16) * 0.8)(Dm, H, Dh) * Dm ** (-0.5)), 'Wv': _w((lambda *s: torch.randn(*s, dtype=torch.bfloat16) * 1.6)(Dm, H, Dh) * Dm ** (-0.5)), 'Wo': _w((lambda *s: torch.randn(*s, dtype=torch.bfloat16) * 1.6)(H, Dh, Dm) * (H * Dh) ** (-0.5)), 'seg_len': seg}
    _A_in = _A_setup()

    def _B_setup():
        B, S, D, Dff = (1, 2048, 512, 1792)
        return {'x': _w((lambda *s: torch.randn(*s, dtype=torch.bfloat16) * 0.05)(B, S, D)), 'w1': _w((lambda *s: torch.randn(*s, dtype=torch.bfloat16) * 0.1)(D, Dff)), 'w2': _w((lambda *s: torch.randn(*s, dtype=torch.bfloat16) * 0.1)(Dff, D))}
    _B_in = _B_setup()
    return {'A_x': _A_in['x'], 'A_mem0': _A_in['mem0'], 'A_Wq': _A_in['Wq'], 'A_Wk': _A_in['Wk'], 'A_Wv': _A_in['Wv'], 'A_Wo': _A_in['Wo'], 'A_seg_len': _A_in['seg_len'], 'B_x': _B_in['x'], 'B_w1': _B_in['w1'], 'B_w2': _B_in['w2'], 'gate_w': _w((lambda *s: torch.randn(*s, dtype=torch.bfloat16) * 0.05)(512) * 16.0)}

def reference(A_x, A_mem0, A_Wq, A_Wk, A_Wv, A_Wo, A_seg_len, B_x, B_w1, B_w2, gate_w):

    def _A_ref(x, mem0, Wq, Wk, Wv, Wo, seg_len):
        B, S, Dm = x.shape
        H, Dh = (Wq.shape[1], Wq.shape[2])
        M = mem0.shape[1]
        scale = Dh ** (-0.5)
        n_seg = S // seg_len
        L = M + seg_len
        idx = torch.arange(L)
        mask = (idx[:, None] < M) | (idx[:, None] >= idx[None, :])
        mem = mem0
        outs = []
        for s in range(n_seg):
            xs = x[:, s * seg_len:(s + 1) * seg_len, :].clone()
            h = torch.concatenate([mem, xs], axis=1)
            q = torch.einsum('btd,dhe->bhte', h, Wq)
            k = torch.einsum('btd,dhe->bhte', h, Wk)
            v = torch.einsum('btd,dhe->bhte', h, Wv)
            scores = torch.einsum('bhqe,bhke->bhqk', q, k) * scale
            scores = torch.where(mask[None, None], scores, -1000000000.0)
            p = _softmax(scores, axis=-1)
            o = torch.einsum('bhqk,bhke->bhqe', p, v)
            o = torch.einsum('bhte,hed->btd', o, Wo)
            mem = o[:, :M, :].clone()
            outs.append(o[:, M:, :])
        return torch.concatenate(outs, axis=1)

    def _B_ref(x, w1, w2):
        h = torch.einsum('bsd,df->bsf', x, w1)
        zero = torch.zeros_like(h)
        h = torch.maximum(h, zero)
        return torch.einsum('bsf,fd->bsd', h, w2)
    x = A_x
    g = _sigmoid((x * gate_w).sum(-1, keepdims=True))
    a = _A_ref(x, A_mem0, A_Wq, A_Wk, A_Wv, A_Wo, A_seg_len)
    b = _B_ref(x, B_w1, B_w2)
    return g * a + (1 - g) * b
```

```asm
; @launch grid=(256,1,1) block=(256,1,1) lds=163840
.amdgcn_target "amdgcn-amd-amdhsa--gfx950"
.text
.globl gated_mix__memory_aug_recurrent_mem_tr__dense_activation_relu__prompt_kernel
.p2align 8
.type gated_mix__memory_aug_recurrent_mem_tr__dense_activation_relu__prompt_kernel,@function
gated_mix__memory_aug_recurrent_mem_tr__dense_activation_relu__prompt_kernel:
    s_cmp_ge_u32 s2, 256
    s_cbranch_scc1 L_done
    s_load_dwordx2 s[32:33], s[0:1], 104
    s_load_dwordx2 s[6:7], s[0:1], 96
    s_getreg_b32 s20, hwreg(HW_REG_XCC_ID, 0, 4)
    v_lshrrev_b32 v2, 6, v0
    s_waitcnt lgkmcnt(0)
    v_readfirstlane_b32 s22, v2
    s_mov_b32 s99, 0
    s_sub_u32 s56, s20, 1
    s_cmp_lt_u32 s56, 7
    s_cselect_b32 s56, s56, 0
    s_mov_b32 s57, 0
    s_mov_b32 s55, 0
    s_mov_b32 s63, 0
    s_mov_b32 s45, 0
    s_mov_b32 s64, 0
    s_add_u32 s66, s32, 89141248
    s_addc_u32 s67, s33, 0
    s_cmp_eq_u32 s2, 0
    s_cbranch_scc0 L_noinit
    s_cmp_lt_u32 s22, 2
    s_cbranch_scc0 L_init_b
    v_lshlrev_b32 v10, 7, v0
    v_mov_b32 v11, 0
    s_add_u32 s68, s32, 89128960
    s_addc_u32 s69, s33, 0
    global_store_dword v10, v11, s[68:69] sc1
    s_waitcnt vmcnt(0)
L_init_b:
    s_barrier
    s_cmp_eq_u32 s22, 0
    s_cbranch_scc0 L_noinit
    v_mov_b32 v10, 200
    v_mov_b32 v11, 1
    global_store_dword v10, v11, s[6:7] sc1
L_noinit:
    v_cmp_eq_u32 vcc, 0, v0
    s_and_saveexec_b64 s[12:13], vcc
    s_cbranch_execz L_tot
    v_mov_b32 v10, 192
    v_mov_b32 v11, 1
    global_atomic_add v10, v11, s[6:7]
L_tot:
    s_mov_b64 exec, s[12:13]
    s_cmp_eq_u32 s20, 0
    s_cbranch_scc0 L_task
    v_cmp_eq_u32 vcc, 0, v0
    s_and_saveexec_b64 s[12:13], vcc
    s_cbranch_execz L_ba_t
    v_mov_b32 v3, 0
    v_mov_b32 v4, 1
    global_atomic_add v5, v3, v4, s[6:7] sc0
    s_waitcnt vmcnt(0)
    v_mov_b32 v6, 0
    ds_write_b32 v6, v5
    s_waitcnt lgkmcnt(0)
L_ba_t:
    s_mov_b64 exec, s[12:13]
    s_barrier
    v_mov_b32 v6, 0
    ds_read_b32 v5, v6
    s_waitcnt lgkmcnt(0)
    v_readfirstlane_b32 s34, v5
    s_barrier
    s_cmp_lt_u32 s34, 32
    s_cbranch_scc1 L_chain
L_task:
    s_lshl_b32 s38, s56, 2
    s_add_u32 s38, s38, 4
    v_cmp_eq_u32 vcc, 0, v0
    s_and_saveexec_b64 s[12:13], vcc
    s_cbranch_execz L_ba_q
    v_mov_b32 v3, s38
    v_mov_b32 v4, 1
    global_atomic_add v5, v3, v4, s[6:7] sc0
    s_waitcnt vmcnt(0)
    v_mov_b32 v6, 0
    ds_write_b32 v6, v5
    s_waitcnt lgkmcnt(0)
L_ba_q:
    s_mov_b64 exec, s[12:13]
    s_barrier
    v_mov_b32 v6, 0
    ds_read_b32 v5, v6
    s_waitcnt lgkmcnt(0)
    v_readfirstlane_b32 s34, v5
    s_barrier
    s_cmp_lt_u32 s56, 4
    s_cselect_b32 s58, 5, 4
    s_cmp_lt_u32 s56, 2
    s_cselect_b32 s59, 3, 2
    s_cmp_eq_u32 s56, 0
    s_cselect_b32 s60, 2, 1
    s_cmp_eq_u32 s56, 0
    s_cselect_b32 s61, 10, 9
    s_cmp_lt_u32 s34, s61
    s_cbranch_scc1 L_dec_n
    s_sub_u32 s34, s34, s61
    s_cmp_lt_u32 s34, s58
    s_cbranch_scc1 L_dec_kvA
    s_sub_u32 s34, s34, s58
    s_cmp_eq_u32 s55, 7
    s_cbranch_scc0 L_gate_open
    s_mov_b32 s37, 0
    s_mov_b32 s62, s34
    s_cmp_eq_u32 s64, 1
    s_cbranch_scc1 L_ei_wkv0
    s_mov_b32 s65, 200
    s_cmp_eq_u32 s22, 0
    s_cbranch_scc0 L_wfd_eiwkv0
    v_mov_b32 v3, s65
    s_mov_b32 s14, 0
L_wf_eiwkv0:
    global_load_dword v4, v3, s[6:7] sc1
    s_waitcnt vmcnt(0)
    v_readfirstlane_b32 s15, v4
    s_add_u32 s14, s14, 1
    s_cmp_gt_u32 s14, 400000
    s_cbranch_scc1 L_wfd_eiwkv0
    s_cmp_ge_u32 s15, 1
    s_cbranch_scc1 L_wfd_eiwkv0
    s_sleep 4
    s_branch L_wf_eiwkv0
L_wfd_eiwkv0:
    s_barrier
    s_mov_b32 s64, 1
L_ei_wkv0:
    s_cmp_eq_u32 s22, 0
    s_cbranch_scc0 L_wfd_kv0
    v_mov_b32 v3, s37
    s_mov_b32 s14, 0
L_wf_kv0:
    global_load_dword v4, v3, s[66:67] sc1
    s_waitcnt vmcnt(0)
    v_readfirstlane_b32 s15, v4
    s_add_u32 s14, s14, 1
    s_cmp_gt_u32 s14, 400000
    s_cbranch_scc1 L_wfd_kv0
    s_cmp_eq_u32 s15, 64
    s_cbranch_scc1 L_wfd_kv0
    s_sleep 32
    s_branch L_wf_kv0
L_wfd_kv0:
    s_barrier
    s_mov_b32 s34, s62
    s_mov_b32 s55, 1
L_gate_open:
    s_cmp_lt_u32 s34, 8
    s_cbranch_scc1 L_dec_f1
    s_sub_u32 s34, s34, 8
    s_mul_i32 s61, s58, 6
    s_cmp_lt_u32 s34, s61
    s_cbranch_scc1 L_dec_kvC
    s_sub_u32 s34, s34, s61
    s_cmp_lt_u32 s34, s60
    s_cbranch_scc1 L_dec_g
    s_sub_u32 s34, s34, s60
    s_cmp_lt_u32 s34, s58
    s_cbranch_scc1 L_dec_qE
    s_sub_u32 s34, s34, s58
    s_lshl_b32 s61, s60, 3
    s_cmp_lt_u32 s34, s61
    s_cbranch_scc1 L_dec_f2
    s_sub_u32 s34, s34, s61
    s_mul_i32 s61, s58, 7
    s_cmp_lt_u32 s34, s61
    s_cbranch_scc1 L_dec_qG
    s_cmp_eq_u32 s22, 0
    s_cbranch_scc0 L_steal_b
    v_and_b32 v3, 63, v0
    v_lshlrev_b32 v4, 2, v3
    v_add_u32 v4, 4, v4
    s_mov_b64 exec, 0x7f
    global_load_dword v5, v4, s[6:7] sc1
    v_mov_b32 v6, 86
    v_mov_b32 v7, 101
    v_cmp_gt_u32 vcc, 4, v3
    s_nop 1
    v_cndmask_b32 v6, v6, v7, vcc
    v_mov_b32 v7, 111
    v_cmp_eq_u32 vcc, 0, v3
    s_nop 1
    v_cndmask_b32 v6, v6, v7, vcc
    s_waitcnt vmcnt(0)
    v_cmp_lt_u32 vcc, v5, v6
    s_nop 3
    s_mov_b32 s14, vcc_lo
    s_mov_b64 exec, -1
    v_mov_b32 v3, 4
    v_mov_b32 v4, s14
    ds_write_b32 v3, v4
    s_waitcnt lgkmcnt(0)
L_steal_b:
    s_barrier
    v_mov_b32 v3, 4
    ds_read_b32 v4, v3
    s_waitcnt lgkmcnt(0)
    v_readfirstlane_b32 s14, v4
    s_barrier
    s_and_b32 s14, s14, 0x7f
    s_cmp_eq_u32 s14, 0
    s_cbranch_scc1 L_phase2
    s_add_u32 s15, s56, 1
    s_lshr_b32 s16, s14, s15
    s_cmp_lg_u32 s16, 0
    s_cbranch_scc0 L_steal_wrap
    s_ff1_i32_b32 s16, s16
    s_add_u32 s56, s15, s16
    s_branch L_task
L_steal_wrap:
    s_ff1_i32_b32 s56, s14
    s_branch L_task
L_dec_n:
    s_mul_i32 s34, s34, 7
    s_add_u32 s34, s34, s56
    s_lshr_b32 s36, s34, 5
    s_add_u32 s36, s36, 6
    s_and_b32 s37, s34, 31
    s_mov_b32 s35, 0
    s_branch L_dec_done
L_dec_kvA:
    s_mov_b32 s35, 1
    s_branch L_dec_kvj
L_dec_kvC:
    s_mov_b32 s35, 2
L_dec_kvl:
    s_cmp_lt_u32 s34, s58
    s_cbranch_scc1 L_dec_kvj
    s_sub_u32 s34, s34, s58
    s_add_u32 s35, s35, 1
    s_branch L_dec_kvl
L_dec_kvj:
    s_mul_i32 s34, s34, 7
    s_add_u32 s34, s34, s56
    s_lshr_b32 s36, s34, 4
    s_and_b32 s37, s34, 15
    s_branch L_dec_done
L_dec_qE:
    s_mov_b32 s35, 0
    s_branch L_dec_qj
L_dec_qG:
    s_mov_b32 s35, 1
L_dec_ql:
    s_cmp_lt_u32 s34, s58
    s_cbranch_scc1 L_dec_qj
    s_sub_u32 s34, s34, s58
    s_add_u32 s35, s35, 1
    s_branch L_dec_ql
L_dec_qj:
    s_mul_i32 s37, s34, 7
    s_add_u32 s37, s37, s56
    s_mov_b32 s36, 8
    s_branch L_dec_done
L_dec_g:
    s_mul_i32 s35, s34, 7
    s_add_u32 s35, s35, s56
    s_mov_b32 s36, 5
    s_branch L_dec_done
L_dec_f1:
    s_mov_b32 s35, s34
    s_mov_b32 s37, s56
    s_mov_b32 s36, 3
    s_branch L_dec_done
L_dec_f2:
    s_lshr_b32 s35, s34, 3
    s_mul_i32 s35, s35, 7
    s_add_u32 s35, s35, s56
    s_and_b32 s37, s34, 1
    s_bfe_u32 s53, s34, 0x20001
    s_mov_b32 s36, 4
L_dec_done:
    v_and_b32 v1, 63, v0
    s_load_dwordx2 s[30:31], s[0:1], 0
    s_lshl_b32 s51, s35, 9
    s_cmp_ge_u32 s36, 6
    s_cbranch_scc1 L_t_n
    s_cmp_eq_u32 s36, 5
    s_cbranch_scc1 L_t_g
    s_cmp_eq_u32 s36, 4
    s_cbranch_scc1 L_t_f2
    s_cmp_eq_u32 s36, 3
    s_cbranch_scc1 L_t_f1
    s_cmp_eq_u32 s36, 0
    s_cselect_b32 s38, 24, 32
    s_cmp_eq_u32 s36, 2
    s_cselect_b32 s38, 16, s38
    s_load_dwordx2 s[40:41], s[0:1], s38
    s_mov_b32 s18, 1024
    s_mov_b32 s19, 8192
    s_mov_b32 s20, 16
    s_mov_b32 s27, 64
    s_mov_b32 s28, 262144
    s_waitcnt lgkmcnt(0)
    s_mov_b32 s8, s30
    s_mov_b32 s9, s31
    s_mov_b32 s10, 2097152
    s_mov_b32 s11, 0x00020000
    s_mov_b32 s12, s40
    s_mov_b32 s13, s41
    s_mov_b32 s14, 4194304
    s_mov_b32 s15, 0x00020000
    s_lshl_b32 s16, s35, 18
    s_lshl_b32 s17, s37, 9
    v_lshrrev_b32 v88, 2, v1
    s_lshl_b32 s23, s22, 6
    v_add_u32 v88, s23, v88
    v_mul_lo_u32 v88, v88, s18
    v_and_b32 v89, 3, v1
    v_bfe_u32 v90, v1, 4, 2
    v_xor_b32 v89, v89, v90
    v_lshl_add_u32 v2, v89, 4, v88
    s_lshl_b32 s23, s18, 4
    v_add_u32 v3, s23, v2
    v_add_u32 v4, s23, v3
    v_add_u32 v5, s23, v4
    v_lshrrev_b32 v88, 5, v1
    v_add_u32 v88, 0, v88
    v_and_b32 v89, 3, v88
    v_lshlrev_b32 v89, 2, v89
    v_and_b32 v90, 31, v1
    v_xor_b32 v89, v89, v90
    s_lshl_b32 s23, s22, 3
    v_add_u32 v88, s23, v88
    v_mul_lo_u32 v88, v88, s19
    v_lshl_add_u32 v6, v89, 4, v88
    v_lshrrev_b32 v88, 5, v1
    v_add_u32 v88, 2, v88
    v_and_b32 v89, 3, v88
    v_lshlrev_b32 v89, 2, v89
    v_and_b32 v90, 31, v1
    v_xor_b32 v89, v89, v90
    s_lshl_b32 s23, s22, 3
    v_add_u32 v88, s23, v88
    v_mul_lo_u32 v88, v88, s19
    v_lshl_add_u32 v7, v89, 4, v88
    v_lshrrev_b32 v88, 5, v1
    v_add_u32 v88, 4, v88
    v_and_b32 v89, 3, v88
    v_lshlrev_b32 v89, 2, v89
    v_and_b32 v90, 31, v1
    v_xor_b32 v89, v89, v90
    s_lshl_b32 s23, s22, 3
    v_add_u32 v88, s23, v88
    v_mul_lo_u32 v88, v88, s19
    v_lshl_add_u32 v8, v89, 4, v88
    v_lshrrev_b32 v88, 5, v1
    v_add_u32 v88, 6, v88
    v_and_b32 v89, 3, v88
    v_lshlrev_b32 v89, 2, v89
    v_and_b32 v90, 31, v1
    v_xor_b32 v89, v89, v90
    s_lshl_b32 s23, s22, 3
    v_add_u32 v88, s23, v88
    v_mul_lo_u32 v88, v88, s19
    v_lshl_add_u32 v9, v89, 4, v88
    v_and_b32 v88, 31, v1
    s_lshr_b32 s23, s22, 1
    s_lshl_b32 s23, s23, 7
    v_add_u32 v89, s23, v88
    v_lshlrev_b32 v89, 6, v89
    v_bfe_u32 v88, v1, 2, 2
    v_lshrrev_b32 v90, 5, v1
    v_add_u32 v90, 0, v90
    v_xor_b32 v90, v90, v88
    v_lshl_add_u32 v10, v90, 4, v89
    v_add_u32 v12, 65536, v10
    v_and_b32 v88, 31, v1
    s_lshr_b32 s23, s22, 1
    s_lshl_b32 s23, s23, 7
    v_add_u32 v89, s23, v88
    v_lshlrev_b32 v89, 6, v89
    v_bfe_u32 v88, v1, 2, 2
    v_lshrrev_b32 v90, 5, v1
    v_add_u32 v90, 2, v90
    v_xor_b32 v90, v90, v88
    v_lshl_add_u32 v11, v90, 4, v89
    v_add_u32 v13, 65536, v11
    v_bfe_u32 v88, v1, 2, 2
    v_lshrrev_b32 v89, 5, v1
    v_lshl_add_u32 v89, v89, 3, v88
    v_lshlrev_b32 v89, 9, v89
    v_xor_b32 v88, 0, v88
    v_lshlrev_b32 v88, 2, v88
    v_bfe_u32 v90, v1, 4, 1
    v_lshl_add_u32 v88, v90, 1, v88
    v_bfe_u32 v90, v1, 1, 1
    v_add_u32 v88, v88, v90
    s_and_b32 s23, s22, 1
    s_lshl_b32 s23, s23, 4
    v_add_u32 v88, s23, v88
    v_lshl_add_u32 v89, v88, 4, v89
    v_and_b32 v90, 1, v1
    v_lshl_add_u32 v89, v90, 3, v89
    v_add_u32 v14, 16384, v89
    v_add_u32 v18, 65536, v14
    v_bfe_u32 v88, v1, 2, 2
    v_lshrrev_b32 v89, 5, v1
    v_lshl_add_u32 v89, v89, 3, v88
    v_lshlrev_b32 v89, 9, v89
    v_xor_b32 v88, 1, v88
    v_lshlrev_b32 v88, 2, v88
    v_bfe_u32 v90, v1, 4, 1
    v_lshl_add_u32 v88, v90, 1, v88
    v_bfe_u32 v90, v1, 1, 1
    v_add_u32 v88, v88, v90
    s_and_b32 s23, s22, 1
    s_lshl_b32 s23, s23, 4
    v_add_u32 v88, s23, v88
    v_lshl_add_u32 v89, v88, 4, v89
    v_and_b32 v90, 1, v1
    v_lshl_add_u32 v89, v90, 3, v89
    v_add_u32 v15, 16384, v89
    v_add_u32 v19, 65536, v15
    v_bfe_u32 v88, v1, 2, 2
    v_lshrrev_b32 v89, 5, v1
    v_lshl_add_u32 v89, v89, 3, v88
    v_lshlrev_b32 v89, 9, v89
    v_xor_b32 v88, 2, v88
    v_lshlrev_b32 v88, 2, v88
    v_bfe_u32 v90, v1, 4, 1
    v_lshl_add_u32 v88, v90, 1, v88
    v_bfe_u32 v90, v1, 1, 1
    v_add_u32 v88, v88, v90
    s_and_b32 s23, s22, 1
    s_lshl_b32 s23, s23, 4
    v_add_u32 v88, s23, v88
    v_lshl_add_u32 v89, v88, 4, v89
    v_and_b32 v90, 1, v1
    v_lshl_add_u32 v89, v90, 3, v89
    v_add_u32 v16, 16384, v89
    v_add_u32 v20, 65536, v16
    v_bfe_u32 v88, v1, 2, 2
    v_lshrrev_b32 v89, 5, v1
    v_lshl_add_u32 v89, v89, 3, v88
    v_lshlrev_b32 v89, 9, v89
    v_xor_b32 v88, 3, v88
    v_lshlrev_b32 v88, 2, v88
    v_bfe_u32 v90, v1, 4, 1
    v_lshl_add_u32 v88, v90, 1, v88
    v_bfe_u32 v90, v1, 1, 1
    v_add_u32 v88, v88, v90
    s_and_b32 s23, s22, 1
    s_lshl_b32 s23, s23, 4
    v_add_u32 v88, s23, v88
    v_lshl_add_u32 v89, v88, 4, v89
    v_and_b32 v90, 1, v1
    v_lshl_add_u32 v89, v90, 3, v89
    v_add_u32 v17, 16384, v89
    v_add_u32 v21, 65536, v17
    s_cmp_eq_u32 s36, 1
    s_cbranch_scc1 L_t_v
    s_lshl_b32 s25, s22, 12
    s_add_u32 s26, s25, 0
    s_add_u32 m0, s26, 0
    s_nop 0
    buffer_load_dwordx4 v2, s[8:11], s16 offen lds
    s_add_u32 m0, s26, 1024
    s_nop 0
    buffer_load_dwordx4 v3, s[8:11], s16 offen lds
    s_add_u32 m0, s26, 2048
    s_nop 0
    buffer_load_dwordx4 v4, s[8:11], s16 offen lds
    s_add_u32 m0, s26, 3072
    s_nop 0
    buffer_load_dwordx4 v5, s[8:11], s16 offen lds
    s_add_u32 m0, s26, 16384
    s_nop 0
    buffer_load_dwordx4 v6, s[12:15], s17 offen lds
    s_add_u32 m0, s26, 17408
    s_nop 0
    buffer_load_dwordx4 v7, s[12:15], s17 offen lds
    s_add_u32 m0, s26, 18432
    s_nop 0
    buffer_load_dwordx4 v8, s[12:15], s17 offen lds
    s_add_u32 m0, s26, 19456
    s_nop 0
    buffer_load_dwordx4 v9, s[12:15], s17 offen lds
    s_add_u32 s16, s16, s27
    s_add_u32 s17, s17, s28
    s_add_u32 s26, s25, 32768
    s_add_u32 m0, s26, 0
    s_nop 0
    buffer_load_dwordx4 v2, s[8:11], s16 offen lds
    s_add_u32 m0, s26, 1024
    s_nop 0
    buffer_load_dwordx4 v3, s[8:11], s16 offen lds
    s_add_u32 m0, s26, 2048
    s_nop 0
    buffer_load_dwordx4 v4, s[8:11], s16 offen lds
    s_add_u32 m0, s26, 3072
    s_nop 0
    buffer_load_dwordx4 v5, s[8:11], s16 offen lds
    s_add_u32 m0, s26, 16384
    s_nop 0
    buffer_load_dwordx4 v6, s[12:15], s17 offen lds
    s_add_u32 m0, s26, 17408
    s_nop 0
    buffer_load_dwordx4 v7, s[12:15], s17 offen lds
    s_add_u32 m0, s26, 18432
    s_nop 0
    buffer_load_dwordx4 v8, s[12:15], s17 offen lds
    s_add_u32 m0, s26, 19456
    s_nop 0
    buffer_load_dwordx4 v9, s[12:15], s17 offen lds
    s_add_u32 s16, s16, s27
    s_add_u32 s17, s17, s28
    s_add_u32 s26, s25, 65536
    s_add_u32 m0, s26, 0
    s_nop 0
    buffer_load_dwordx4 v2, s[8:11], s16 offen lds
    s_add_u32 m0, s26, 1024
    s_nop 0
    buffer_load_dwordx4 v3, s[8:11], s16 offen lds
    s_add_u32 m0, s26, 2048
    s_nop 0
    buffer_load_dwordx4 v4, s[8:11], s16 offen lds
    s_add_u32 m0, s26, 3072
    s_nop 0
    buffer_load_dwordx4 v5, s[8:11], s16 offen lds
    s_add_u32 m0, s26, 16384
    s_nop 0
    buffer_load_dwordx4 v6, s[12:15], s17 offen lds
    s_add_u32 m0, s26, 17408
    s_nop 0
    buffer_load_dwordx4 v7, s[12:15], s17 offen lds
    s_add_u32 m0, s26, 18432
    s_nop 0
    buffer_load_dwordx4 v8, s[12:15], s17 offen lds
    s_add_u32 m0, s26, 19456
    s_nop 0
    buffer_load_dwordx4 v9, s[12:15], s17 offen lds
    s_add_u32 s16, s16, s27
    s_add_u32 s17, s17, s28
    s_waitcnt vmcnt(16)
    s_barrier
    ds_read_b128 v[24:27], v10 offset:0
    ds_read_b128 v[28:31], v10 offset:2048
    ds_read_b128 v[32:35], v10 offset:4096
    ds_read_b128 v[36:39], v10 offset:6144
    ds_read_b64_tr_b16 v[40:41], v14 offset:0
    ds_read_b64_tr_b16 v[42:43], v14 offset:2048
    ds_read_b64_tr_b16 v[44:45], v15 offset:0
    ds_read_b64_tr_b16 v[46:47], v15 offset:2048
    ds_read_b64_tr_b16 v[48:49], v16 offset:0
    ds_read_b64_tr_b16 v[50:51], v16 offset:2048
    ds_read_b64_tr_b16 v[52:53], v17 offset:0
    ds_read_b64_tr_b16 v[54:55], v17 offset:2048
    s_mov_b32 s21, 0
    v_accvgpr_write_b32 a0, 0
    v_accvgpr_write_b32 a1, 0
    v_accvgpr_write_b32 a2, 0
    v_accvgpr_write_b32 a3, 0
    v_accvgpr_write_b32 a4, 0
    v_accvgpr_write_b32 a5, 0
    v_accvgpr_write_b32 a6, 0
    v_accvgpr_write_b32 a7, 0
    v_accvgpr_write_b32 a8, 0
    v_accvgpr_write_b32 a9, 0
    v_accvgpr_write_b32 a10, 0
    v_accvgpr_write_b32 a11, 0
    v_accvgpr_write_b32 a12, 0
    v_accvgpr_write_b32 a13, 0
    v_accvgpr_write_b32 a14, 0
    v_accvgpr_write_b32 a15, 0
    v_accvgpr_write_b32 a16, 0
    v_accvgpr_write_b32 a17, 0
    v_accvgpr_write_b32 a18, 0
    v_accvgpr_write_b32 a19, 0
    v_accvgpr_write_b32 a20, 0
    v_accvgpr_write_b32 a21, 0
    v_accvgpr_write_b32 a22, 0
    v_accvgpr_write_b32 a23, 0
    v_accvgpr_write_b32 a24, 0
    v_accvgpr_write_b32 a25, 0
    v_accvgpr_write_b32 a26, 0
    v_accvgpr_write_b32 a27, 0
    v_accvgpr_write_b32 a28, 0
    v_accvgpr_write_b32 a29, 0
    v_accvgpr_write_b32 a30, 0
    v_accvgpr_write_b32 a31, 0
    v_accvgpr_write_b32 a32, 0
    v_accvgpr_write_b32 a33, 0
    v_accvgpr_write_b32 a34, 0
    v_accvgpr_write_b32 a35, 0
    v_accvgpr_write_b32 a36, 0
    v_accvgpr_write_b32 a37, 0
    v_accvgpr_write_b32 a38, 0
    v_accvgpr_write_b32 a39, 0
    v_accvgpr_write_b32 a40, 0
    v_accvgpr_write_b32 a41, 0
    v_accvgpr_write_b32 a42, 0
    v_accvgpr_write_b32 a43, 0
    v_accvgpr_write_b32 a44, 0
    v_accvgpr_write_b32 a45, 0
    v_accvgpr_write_b32 a46, 0
    v_accvgpr_write_b32 a47, 0
    v_accvgpr_write_b32 a48, 0
    v_accvgpr_write_b32 a49, 0
    v_accvgpr_write_b32 a50, 0
    v_accvgpr_write_b32 a51, 0
    v_accvgpr_write_b32 a52, 0
    v_accvgpr_write_b32 a53, 0
    v_accvgpr_write_b32 a54, 0
    v_accvgpr_write_b32 a55, 0
    v_accvgpr_write_b32 a56, 0
    v_accvgpr_write_b32 a57, 0
    v_accvgpr_write_b32 a58, 0
    v_accvgpr_write_b32 a59, 0
    v_accvgpr_write_b32 a60, 0
    v_accvgpr_write_b32 a61, 0
    v_accvgpr_write_b32 a62, 0
    v_accvgpr_write_b32 a63, 0
    v_accvgpr_write_b32 a64, 0
    v_accvgpr_write_b32 a65, 0
    v_accvgpr_write_b32 a66, 0
    v_accvgpr_write_b32 a67, 0
    v_accvgpr_write_b32 a68, 0
    v_accvgpr_write_b32 a69, 0
    v_accvgpr_write_b32 a70, 0
    v_accvgpr_write_b32 a71, 0
    v_accvgpr_write_b32 a72, 0
    v_accvgpr_write_b32 a73, 0
    v_accvgpr_write_b32 a74, 0
    v_accvgpr_write_b32 a75, 0
    v_accvgpr_write_b32 a76, 0
    v_accvgpr_write_b32 a77, 0
    v_accvgpr_write_b32 a78, 0
    v_accvgpr_write_b32 a79, 0
    v_accvgpr_write_b32 a80, 0
    v_accvgpr_write_b32 a81, 0
    v_accvgpr_write_b32 a82, 0
    v_accvgpr_write_b32 a83, 0
    v_accvgpr_write_b32 a84, 0
    v_accvgpr_write_b32 a85, 0
    v_accvgpr_write_b32 a86, 0
    v_accvgpr_write_b32 a87, 0
    v_accvgpr_write_b32 a88, 0
    v_accvgpr_write_b32 a89, 0
    v_accvgpr_write_b32 a90, 0
    v_accvgpr_write_b32 a91, 0
    v_accvgpr_write_b32 a92, 0
    v_accvgpr_write_b32 a93, 0
    v_accvgpr_write_b32 a94, 0
    v_accvgpr_write_b32 a95, 0
    v_accvgpr_write_b32 a96, 0
    v_accvgpr_write_b32 a97, 0
    v_accvgpr_write_b32 a98, 0
    v_accvgpr_write_b32 a99, 0
    v_accvgpr_write_b32 a100, 0
    v_accvgpr_write_b32 a101, 0
    v_accvgpr_write_b32 a102, 0
    v_accvgpr_write_b32 a103, 0
    v_accvgpr_write_b32 a104, 0
    v_accvgpr_write_b32 a105, 0
    v_accvgpr_write_b32 a106, 0
    v_accvgpr_write_b32 a107, 0
    v_accvgpr_write_b32 a108, 0
    v_accvgpr_write_b32 a109, 0
    v_accvgpr_write_b32 a110, 0
    v_accvgpr_write_b32 a111, 0
    v_accvgpr_write_b32 a112, 0
    v_accvgpr_write_b32 a113, 0
    v_accvgpr_write_b32 a114, 0
    v_accvgpr_write_b32 a115, 0
    v_accvgpr_write_b32 a116, 0
    v_accvgpr_write_b32 a117, 0
    v_accvgpr_write_b32 a118, 0
    v_accvgpr_write_b32 a119, 0
    v_accvgpr_write_b32 a120, 0
    v_accvgpr_write_b32 a121, 0
    v_accvgpr_write_b32 a122, 0
    v_accvgpr_write_b32 a123, 0
    v_accvgpr_write_b32 a124, 0
    v_accvgpr_write_b32 a125, 0
    v_accvgpr_write_b32 a126, 0
    v_accvgpr_write_b32 a127, 0
    v_accvgpr_write_b32 a128, 0
    v_accvgpr_write_b32 a129, 0
    v_accvgpr_write_b32 a130, 0
    v_accvgpr_write_b32 a131, 0
    v_accvgpr_write_b32 a132, 0
    v_accvgpr_write_b32 a133, 0
    v_accvgpr_write_b32 a134, 0
    v_accvgpr_write_b32 a135, 0
    v_accvgpr_write_b32 a136, 0
    v_accvgpr_write_b32 a137, 0
    v_accvgpr_write_b32 a138, 0
    v_accvgpr_write_b32 a139, 0
    v_accvgpr_write_b32 a140, 0
    v_accvgpr_write_b32 a141, 0
    v_accvgpr_write_b32 a142, 0
    v_accvgpr_write_b32 a143, 0
    v_accvgpr_write_b32 a144, 0
    v_accvgpr_write_b32 a145, 0
    v_accvgpr_write_b32 a146, 0
    v_accvgpr_write_b32 a147, 0
    v_accvgpr_write_b32 a148, 0
    v_accvgpr_write_b32 a149, 0
    v_accvgpr_write_b32 a150, 0
    v_accvgpr_write_b32 a151, 0
    v_accvgpr_write_b32 a152, 0
    v_accvgpr_write_b32 a153, 0
    v_accvgpr_write_b32 a154, 0
    v_accvgpr_write_b32 a155, 0
    v_accvgpr_write_b32 a156, 0
    v_accvgpr_write_b32 a157, 0
    v_accvgpr_write_b32 a158, 0
    v_accvgpr_write_b32 a159, 0
    v_accvgpr_write_b32 a160, 0
    v_accvgpr_write_b32 a161, 0
    v_accvgpr_write_b32 a162, 0
    v_accvgpr_write_b32 a163, 0
    v_accvgpr_write_b32 a164, 0
    v_accvgpr_write_b32 a165, 0
    v_accvgpr_write_b32 a166, 0
    v_accvgpr_write_b32 a167, 0
    v_accvgpr_write_b32 a168, 0
    v_accvgpr_write_b32 a169, 0
    v_accvgpr_write_b32 a170, 0
    v_accvgpr_write_b32 a171, 0
    v_accvgpr_write_b32 a172, 0
    v_accvgpr_write_b32 a173, 0
    v_accvgpr_write_b32 a174, 0
    v_accvgpr_write_b32 a175, 0
    v_accvgpr_write_b32 a176, 0
    v_accvgpr_write_b32 a177, 0
    v_accvgpr_write_b32 a178, 0
    v_accvgpr_write_b32 a179, 0
    v_accvgpr_write_b32 a180, 0
    v_accvgpr_write_b32 a181, 0
    v_accvgpr_write_b32 a182, 0
    v_accvgpr_write_b32 a183, 0
    v_accvgpr_write_b32 a184, 0
    v_accvgpr_write_b32 a185, 0
    v_accvgpr_write_b32 a186, 0
    v_accvgpr_write_b32 a187, 0
    v_accvgpr_write_b32 a188, 0
    v_accvgpr_write_b32 a189, 0
    v_accvgpr_write_b32 a190, 0
    v_accvgpr_write_b32 a191, 0
    v_accvgpr_write_b32 a192, 0
    v_accvgpr_write_b32 a193, 0
    v_accvgpr_write_b32 a194, 0
    v_accvgpr_write_b32 a195, 0
    v_accvgpr_write_b32 a196, 0
    v_accvgpr_write_b32 a197, 0
    v_accvgpr_write_b32 a198, 0
    v_accvgpr_write_b32 a199, 0
    v_accvgpr_write_b32 a200, 0
    v_accvgpr_write_b32 a201, 0
    v_accvgpr_write_b32 a202, 0
    v_accvgpr_write_b32 a203, 0
    v_accvgpr_write_b32 a204, 0
    v_accvgpr_write_b32 a205, 0
    v_accvgpr_write_b32 a206, 0
    v_accvgpr_write_b32 a207, 0
    v_accvgpr_write_b32 a208, 0
    v_accvgpr_write_b32 a209, 0
    v_accvgpr_write_b32 a210, 0
    v_accvgpr_write_b32 a211, 0
    v_accvgpr_write_b32 a212, 0
    v_accvgpr_write_b32 a213, 0
    v_accvgpr_write_b32 a214, 0
    v_accvgpr_write_b32 a215, 0
    v_accvgpr_write_b32 a216, 0
    v_accvgpr_write_b32 a217, 0
    v_accvgpr_write_b32 a218, 0
    v_accvgpr_write_b32 a219, 0
    v_accvgpr_write_b32 a220, 0
    v_accvgpr_write_b32 a221, 0
    v_accvgpr_write_b32 a222, 0
    v_accvgpr_write_b32 a223, 0
    v_accvgpr_write_b32 a224, 0
    v_accvgpr_write_b32 a225, 0
    v_accvgpr_write_b32 a226, 0
    v_accvgpr_write_b32 a227, 0
    v_accvgpr_write_b32 a228, 0
    v_accvgpr_write_b32 a229, 0
    v_accvgpr_write_b32 a230, 0
    v_accvgpr_write_b32 a231, 0
    v_accvgpr_write_b32 a232, 0
    v_accvgpr_write_b32 a233, 0
    v_accvgpr_write_b32 a234, 0
    v_accvgpr_write_b32 a235, 0
    v_accvgpr_write_b32 a236, 0
    v_accvgpr_write_b32 a237, 0
    v_accvgpr_write_b32 a238, 0
    v_accvgpr_write_b32 a239, 0
    v_accvgpr_write_b32 a240, 0
    v_accvgpr_write_b32 a241, 0
    v_accvgpr_write_b32 a242, 0
    v_accvgpr_write_b32 a243, 0
    v_accvgpr_write_b32 a244, 0
    v_accvgpr_write_b32 a245, 0
    v_accvgpr_write_b32 a246, 0
    v_accvgpr_write_b32 a247, 0
    v_accvgpr_write_b32 a248, 0
    v_accvgpr_write_b32 a249, 0
    v_accvgpr_write_b32 a250, 0
    v_accvgpr_write_b32 a251, 0
    v_accvgpr_write_b32 a252, 0
    v_accvgpr_write_b32 a253, 0
    v_accvgpr_write_b32 a254, 0
    v_accvgpr_write_b32 a255, 0
.p2align 6
L_gemm_qk:
    s_waitcnt lgkmcnt(0)
    v_mfma_f32_32x32x16_bf16 a[0:15], v[40:43], v[24:27], a[0:15]
    ds_read_b128 v[56:59], v11 offset:0
    v_mfma_f32_32x32x16_bf16 a[16:31], v[44:47], v[24:27], a[16:31]
    ds_read_b128 v[60:63], v11 offset:2048
    v_mfma_f32_32x32x16_bf16 a[32:47], v[48:51], v[24:27], a[32:47]
    ds_read_b128 v[64:67], v11 offset:4096
    v_mfma_f32_32x32x16_bf16 a[48:63], v[52:55], v[24:27], a[48:63]
    ds_read_b128 v[68:71], v11 offset:6144
    v_mfma_f32_32x32x16_bf16 a[64:79], v[40:43], v[28:31], a[64:79]
    ds_read_b64_tr_b16 v[72:73], v14 offset:8192
    v_mfma_f32_32x32x16_bf16 a[80:95], v[44:47], v[28:31], a[80:95]
    ds_read_b64_tr_b16 v[74:75], v14 offset:10240
    v_mfma_f32_32x32x16_bf16 a[96:111], v[48:51], v[28:31], a[96:111]
    ds_read_b64_tr_b16 v[76:77], v15 offset:8192
    v_mfma_f32_32x32x16_bf16 a[112:127], v[52:55], v[28:31], a[112:127]
    ds_read_b64_tr_b16 v[78:79], v15 offset:10240
    v_mfma_f32_32x32x16_bf16 a[128:143], v[40:43], v[32:35], a[128:143]
    ds_read_b64_tr_b16 v[80:81], v16 offset:8192
    v_mfma_f32_32x32x16_bf16 a[144:159], v[44:47], v[32:35], a[144:159]
    ds_read_b64_tr_b16 v[82:83], v16 offset:10240
    v_mfma_f32_32x32x16_bf16 a[160:175], v[48:51], v[32:35], a[160:175]
    ds_read_b64_tr_b16 v[84:85], v17 offset:8192
    v_mfma_f32_32x32x16_bf16 a[176:191], v[52:55], v[32:35], a[176:191]
    ds_read_b64_tr_b16 v[86:87], v17 offset:10240
    v_mfma_f32_32x32x16_bf16 a[192:207], v[40:43], v[36:39], a[192:207]
    v_mfma_f32_32x32x16_bf16 a[208:223], v[44:47], v[36:39], a[208:223]
    v_mfma_f32_32x32x16_bf16 a[224:239], v[48:51], v[36:39], a[224:239]
    v_mfma_f32_32x32x16_bf16 a[240:255], v[52:55], v[36:39], a[240:255]
    s_waitcnt vmcnt(8)
    s_waitcnt lgkmcnt(0)
    s_barrier
    s_add_u32 s26, s25, 98304
    v_mfma_f32_32x32x16_bf16 a[0:15], v[72:75], v[56:59], a[0:15]
    ds_read_b128 v[24:27], v10 offset:32768
    v_mfma_f32_32x32x16_bf16 a[16:31], v[76:79], v[56:59], a[16:31]
    ds_read_b128 v[28:31], v10 offset:34816
    v_mfma_f32_32x32x16_bf16 a[32:47], v[80:83], v[56:59], a[32:47]
    ds_read_b128 v[32:35], v10 offset:36864
    s_add_u32 m0, s26, 0
    s_nop 0
    v_mfma_f32_32x32x16_bf16 a[48:63], v[84:87], v[56:59], a[48:63]
    ds_read_b128 v[36:39], v10 offset:38912
    buffer_load_dwordx4 v2, s[8:11], s16 offen lds
    s_add_u32 m0, s26, 1024
    v_mfma_f32_32x32x16_bf16 a[64:79], v[72:75], v[60:63], a[64:79]
    ds_read_b64_tr_b16 v[40:41], v14 offset:32768
    s_nop 0
    buffer_load_dwordx4 v3, s[8:11], s16 offen lds
    v_mfma_f32_32x32x16_bf16 a[80:95], v[76:79], v[60:63], a[80:95]
    ds_read_b64_tr_b16 v[42:43], v14 offset:34816
    s_add_u32 m0, s26, 2048
    s_nop 0
    v_mfma_f32_32x32x16_bf16 a[96:111], v[80:83], v[60:63], a[96:111]
    ds_read_b64_tr_b16 v[44:45], v15 offset:32768
    buffer_load_dwordx4 v4, s[8:11], s16 offen lds
    s_add_u32 m0, s26, 3072
    v_mfma_f32_32x32x16_bf16 a[112:127], v[84:87], v[60:63], a[112:127]
    ds_read_b64_tr_b16 v[46:47], v15 offset:34816
    s_nop 0
    buffer_load_dwordx4 v5, s[8:11], s16 offen lds
    v_mfma_f32_32x32x16_bf16 a[128:143], v[72:75], v[64:67], a[128:143]
    ds_read_b64_tr_b16 v[48:49], v16 offset:32768
    s_add_u32 m0, s26, 16384
    s_nop 0
    v_mfma_f32_32x32x16_bf16 a[144:159], v[76:79], v[64:67], a[144:159]
    ds_read_b64_tr_b16 v[50:51], v16 offset:34816
    buffer_load_dwordx4 v6, s[12:15], s17 offen lds
    s_add_u32 m0, s26, 17408
    v_mfma_f32_32x32x16_bf16 a[160:175], v[80:83], v[64:67], a[160:175]
    ds_read_b64_tr_b16 v[52:53], v17 offset:32768
    s_nop 0
    buffer_load_dwordx4 v7, s[12:15], s17 offen lds
    v_mfma_f32_32x32x16_bf16 a[176:191], v[84:87], v[64:67], a[176:191]
    ds_read_b64_tr_b16 v[54:55], v17 offset:34816
    s_add_u32 m0, s26, 18432
    s_nop 0
    v_mfma_f32_32x32x16_bf16 a[192:207], v[72:75], v[68:71], a[192:207]
    buffer_load_dwordx4 v8, s[12:15], s17 offen lds
    s_add_u32 m0, s26, 19456
    v_mfma_f32_32x32x16_bf16 a[208:223], v[76:79], v[68:71], a[208:223]
    s_nop 0
    buffer_load_dwordx4 v9, s[12:15], s17 offen lds
    v_mfma_f32_32x32x16_bf16 a[224:239], v[80:83], v[68:71], a[224:239]
    s_add_u32 s16, s16, s27
    s_add_u32 s17, s17, s28
    v_mfma_f32_32x32x16_bf16 a[240:255], v[84:87], v[68:71], a[240:255]
    s_waitcnt lgkmcnt(0)
    v_mfma_f32_32x32x16_bf16 a[0:15], v[40:43], v[24:27], a[0:15]
    ds_read_b128 v[56:59], v11 offset:32768
    v_mfma_f32_32x32x16_bf16 a[16:31], v[44:47], v[24:27], a[16:31]
    ds_read_b128 v[60:63], v11 offset:34816
    v_mfma_f32_32x32x16_bf16 a[32:47], v[48:51], v[24:27], a[32:47]
    ds_read_b128 v[64:67], v11 offset:36864
    v_mfma_f32_32x32x16_bf16 a[48:63], v[52:55], v[24:27], a[48:63]
    ds_read_b128 v[68:71], v11 offset:38912
    v_mfma_f32_32x32x16_bf16 a[64:79], v[40:43], v[28:31], a[64:79]
    ds_read_b64_tr_b16 v[72:73], v14 offset:40960
    v_mfma_f32_32x32x16_bf16 a[80:95], v[44:47], v[28:31], a[80:95]
    ds_read_b64_tr_b16 v[74:75], v14 offset:43008
    v_mfma_f32_32x32x16_bf16 a[96:111], v[48:51], v[28:31], a[96:111]
    ds_read_b64_tr_b16 v[76:77], v15 offset:40960
    v_mfma_f32_32x32x16_bf16 a[112:127], v[52:55], v[28:31], a[112:127]
    ds_read_b64_tr_b16 v[78:79], v15 offset:43008
    v_mfma_f32_32x32x16_bf16 a[128:143], v[40:43], v[32:35], a[128:143]
    ds_read_b64_tr_b16 v[80:81], v16 offset:40960
    v_mfma_f32_32x32x16_bf16 a[144:159], v[44:47], v[32:35], a[144:159]
    ds_read_b64_tr_b16 v[82:83], v16 offset:43008
    v_mfma_f32_32x32x16_bf16 a[160:175], v[48:51], v[32:35], a[160:175]
    ds_read_b64_tr_b16 v[84:85], v17 offset:40960
    v_mfma_f32_32x32x16_bf16 a[176:191], v[52:55], v[32:35], a[176:191]
    ds_read_b64_tr_b16 v[86:87], v17 offset:43008
    v_mfma_f32_32x32x16_bf16 a[192:207], v[40:43], v[36:39], a[192:207]
    v_mfma_f32_32x32x16_bf16 a[208:223], v[44:47], v[36:39], a[208:223]
    v_mfma_f32_32x32x16_bf16 a[224:239], v[48:51], v[36:39], a[224:239]
    v_mfma_f32_32x32x16_bf16 a[240:255], v[52:55], v[36:39], a[240:255]
    s_waitcnt vmcnt(8)
    s_waitcnt lgkmcnt(0)
    s_barrier
    s_add_u32 s26, s25, 0
    v_mfma_f32_32x32x16_bf16 a[0:15], v[72:75], v[56:59], a[0:15]
    ds_read_b128 v[24:27], v12 offset:0
    v_mfma_f32_32x32x16_bf16 a[16:31], v[76:79], v[56:59], a[16:31]
    ds_read_b128 v[28:31], v12 offset:2048
    v_mfma_f32_32x32x16_bf16 a[32:47], v[80:83], v[56:59], a[32:47]
    ds_read_b128 v[32:35], v12 offset:4096
    s_add_u32 m0, s26, 0
    s_nop 0
    v_mfma_f32_32x32x16_bf16 a[48:63], v[84:87], v[56:59], a[48:63]
    ds_read_b128 v[36:39], v12 offset:6144
    buffer_load_dwordx4 v2, s[8:11], s16 offen lds
    s_add_u32 m0, s26, 1024
    v_mfma_f32_32x32x16_bf16 a[64:79], v[72:75], v[60:63], a[64:79]
    ds_read_b64_tr_b16 v[40:41], v18 offset:0
    s_nop 0
    buffer_load_dwordx4 v3, s[8:11], s16 offen lds
    v_mfma_f32_32x32x16_bf16 a[80:95], v[76:79], v[60:63], a[80:95]
    ds_read_b64_tr_b16 v[42:43], v18 offset:2048
    s_add_u32 m0, s26, 2048
    s_nop 0
    v_mfma_f32_32x32x16_bf16 a[96:111], v[80:83], v[60:63], a[96:111]
    ds_read_b64_tr_b16 v[44:45], v19 offset:0
    buffer_load_dwordx4 v4, s[8:11], s16 offen lds
    s_add_u32 m0, s26, 3072
    v_mfma_f32_32x32x16_bf16 a[112:127], v[84:87], v[60:63], a[112:127]
    ds_read_b64_tr_b16 v[46:47], v19 offset:2048
    s_nop 0
    buffer_load_dwordx4 v5, s[8:11], s16 offen lds
    v_mfma_f32_32x32x16_bf16 a[128:143], v[72:75], v[64:67], a[128:143]
    ds_read_b64_tr_b16 v[48:49], v20 offset:0
    s_add_u32 m0, s26, 16384
    s_nop 0
    v_mfma_f32_32x32x16_bf16 a[144:159], v[76:79], v[64:67], a[144:159]
    ds_read_b64_tr_b16 v[50:51], v20 offset:2048
    buffer_load_dwordx4 v6, s[12:15], s17 offen lds
    s_add_u32 m0, s26, 17408
    v_mfma_f32_32x32x16_bf16 a[160:175], v[80:83], v[64:67], a[160:175]
    ds_read_b64_tr_b16 v[52:53], v21 offset:0
    s_nop 0
    buffer_load_dwordx4 v7, s[12:15], s17 offen lds
    v_mfma_f32_32x32x16_bf16 a[176:191], v[84:87], v[64:67], a[176:191]
    ds_read_b64_tr_b16 v[54:55], v21 offset:2048
    s_add_u32 m0, s26, 18432
    s_nop 0
    v_mfma_f32_32x32x16_bf16 a[192:207], v[72:75], v[68:71], a[192:207]
    buffer_load_dwordx4 v8, s[12:15], s17 offen lds
    s_add_u32 m0, s26, 19456
    v_mfma_f32_32x32x16_bf16 a[208:223], v[76:79], v[68:71], a[208:223]
    s_nop 0
    buffer_load_dwordx4 v9, s[12:15], s17 offen lds
    v_mfma_f32_32x32x16_bf16 a[224:239], v[80:83], v[68:71], a[224:239]
    s_add_u32 s16, s16, s27
    s_add_u32 s17, s17, s28
    v_mfma_f32_32x32x16_bf16 a[240:255], v[84:87], v[68:71], a[240:255]
    s_waitcnt lgkmcnt(0)
    v_mfma_f32_32x32x16_bf16 a[0:15], v[40:43], v[24:27], a[0:15]
    ds_read_b128 v[56:59], v13 offset:0
    v_mfma_f32_32x32x16_bf16 a[16:31], v[44:47], v[24:27], a[16:31]
    ds_read_b128 v[60:63], v13 offset:2048
    v_mfma_f32_32x32x16_bf16 a[32:47], v[48:51], v[24:27], a[32:47]
    ds_read_b128 v[64:67], v13 offset:4096
    v_mfma_f32_32x32x16_bf16 a[48:63], v[52:55], v[24:27], a[48:63]
    ds_read_b128 v[68:71], v13 offset:6144
    v_mfma_f32_32x32x16_bf16 a[64:79], v[40:43], v[28:31], a[64:79]
    ds_read_b64_tr_b16 v[72:73], v18 offset:8192
    v_mfma_f32_32x32x16_bf16 a[80:95], v[44:47], v[28:31], a[80:95]
    ds_read_b64_tr_b16 v[74:75], v18 offset:10240
    v_mfma_f32_32x32x16_bf16 a[96:111], v[48:51], v[28:31], a[96:111]
    ds_read_b64_tr_b16 v[76:77], v19 offset:8192
    v_mfma_f32_32x32x16_bf16 a[112:127], v[52:55], v[28:31], a[112:127]
    ds_read_b64_tr_b16 v[78:79], v19 offset:10240
    v_mfma_f32_32x32x16_bf16 a[128:143], v[40:43], v[32:35], a[128:143]
    ds_read_b64_tr_b16 v[80:81], v20 offset:8192
    v_mfma_f32_32x32x16_bf16 a[144:159], v[44:47], v[32:35], a[144:159]
    ds_read_b64_tr_b16 v[82:83], v20 offset:10240
    v_mfma_f32_32x32x16_bf16 a[160:175], v[48:51], v[32:35], a[160:175]
    ds_read_b64_tr_b16 v[84:85], v21 offset:8192
    v_mfma_f32_32x32x16_bf16 a[176:191], v[52:55], v[32:35], a[176:191]
    ds_read_b64_tr_b16 v[86:87], v21 offset:10240
    v_mfma_f32_32x32x16_bf16 a[192:207], v[40:43], v[36:39], a[192:207]
    v_mfma_f32_32x32x16_bf16 a[208:223], v[44:47], v[36:39], a[208:223]
    v_mfma_f32_32x32x16_bf16 a[224:239], v[48:51], v[36:39], a[224:239]
    v_mfma_f32_32x32x16_bf16 a[240:255], v[52:55], v[36:39], a[240:255]
    s_waitcnt vmcnt(8)
    s_waitcnt lgkmcnt(0)
    s_barrier
    s_add_u32 s26, s25, 32768
    v_mfma_f32_32x32x16_bf16 a[0:15], v[72:75], v[56:59], a[0:15]
    ds_read_b128 v[24:27], v12 offset:32768
    v_mfma_f32_32x32x16_bf16 a[16:31], v[76:79], v[56:59], a[16:31]
    ds_read_b128 v[28:31], v12 offset:34816
    v_mfma_f32_32x32x16_bf16 a[32:47], v[80:83], v[56:59], a[32:47]
    ds_read_b128 v[32:35], v12 offset:36864
    s_add_u32 m0, s26, 0
    s_nop 0
    v_mfma_f32_32x32x16_bf16 a[48:63], v[84:87], v[56:59], a[48:63]
    ds_read_b128 v[36:39], v12 offset:38912
    buffer_load_dwordx4 v2, s[8:11], s16 offen lds
    s_add_u32 m0, s26, 1024
    v_mfma_f32_32x32x16_bf16 a[64:79], v[72:75], v[60:63], a[64:79]
    ds_read_b64_tr_b16 v[40:41], v18 offset:32768
    s_nop 0
    buffer_load_dwordx4 v3, s[8:11], s16 offen lds
    v_mfma_f32_32x32x16_bf16 a[80:95], v[76:79], v[60:63], a[80:95]
    ds_read_b64_tr_b16 v[42:43], v18 offset:34816
    s_add_u32 m0, s26, 2048
    s_nop 0
    v_mfma_f32_32x32x16_bf16 a[96:111], v[80:83], v[60:63], a[96:111]
    ds_read_b64_tr_b16 v[44:45], v19 offset:32768
    buffer_load_dwordx4 v4, s[8:11], s16 offen lds
    s_add_u32 m0, s26, 3072
    v_mfma_f32_32x32x16_bf16 a[112:127], v[84:87], v[60:63], a[112:127]
    ds_read_b64_tr_b16 v[46:47], v19 offset:34816
    s_nop 0
    buffer_load_dwordx4 v5, s[8:11], s16 offen lds
    v_mfma_f32_32x32x16_bf16 a[128:143], v[72:75], v[64:67], a[128:143]
    ds_read_b64_tr_b16 v[48:49], v20 offset:32768
    s_add_u32 m0, s26, 16384
    s_nop 0
    v_mfma_f32_32x32x16_bf16 a[144:159], v[76:79], v[64:67], a[144:159]
    ds_read_b64_tr_b16 v[50:51], v20 offset:34816
    buffer_load_dwordx4 v6, s[12:15], s17 offen lds
    s_add_u32 m0, s26, 17408
    v_mfma_f32_32x32x16_bf16 a[160:175], v[80:83], v[64:67], a[160:175]
    ds_read_b64_tr_b16 v[52:53], v21 offset:32768
    s_nop 0
    buffer_load_dwordx4 v7, s[12:15], s17 offen lds
    v_mfma_f32_32x32x16_bf16 a[176:191], v[84:87], v[64:67], a[176:191]
    ds_read_b64_tr_b16 v[54:55], v21 offset:34816
    s_add_u32 m0, s26, 18432
    s_nop 0
    v_mfma_f32_32x32x16_bf16 a[192:207], v[72:75], v[68:71], a[192:207]
    buffer_load_dwordx4 v8, s[12:15], s17 offen lds
    s_add_u32 m0, s26, 19456
    v_mfma_f32_32x32x16_bf16 a[208:223], v[76:79], v[68:71], a[208:223]
    s_nop 0
    buffer_load_dwordx4 v9, s[12:15], s17 offen lds
    v_mfma_f32_32x32x16_bf16 a[224:239], v[80:83], v[68:71], a[224:239]
    s_add_u32 s16, s16, s27
    s_add_u32 s17, s17, s28
    v_mfma_f32_32x32x16_bf16 a[240:255], v[84:87], v[68:71], a[240:255]
    s_waitcnt lgkmcnt(0)
    v_mfma_f32_32x32x16_bf16 a[0:15], v[40:43], v[24:27], a[0:15]
    ds_read_b128 v[56:59], v13 offset:32768
    v_mfma_f32_32x32x16_bf16 a[16:31], v[44:47], v[24:27], a[16:31]
    ds_read_b128 v[60:63], v13 offset:34816
    v_mfma_f32_32x32x16_bf16 a[32:47], v[48:51], v[24:27], a[32:47]
    ds_read_b128 v[64:67], v13 offset:36864
    v_mfma_f32_32x32x16_bf16 a[48:63], v[52:55], v[24:27], a[48:63]
    ds_read_b128 v[68:71], v13 offset:38912
    v_mfma_f32_32x32x16_bf16 a[64:79], v[40:43], v[28:31], a[64:79]
    ds_read_b64_tr_b16 v[72:73], v18 offset:40960
    v_mfma_f32_32x32x16_bf16 a[80:95], v[44:47], v[28:31], a[80:95]
    ds_read_b64_tr_b16 v[74:75], v18 offset:43008
    v_mfma_f32_32x32x16_bf16 a[96:111], v[48:51], v[28:31], a[96:111]
    ds_read_b64_tr_b16 v[76:77], v19 offset:40960
    v_mfma_f32_32x32x16_bf16 a[112:127], v[52:55], v[28:31], a[112:127]
    ds_read_b64_tr_b16 v[78:79], v19 offset:43008
    v_mfma_f32_32x32x16_bf16 a[128:143], v[40:43], v[32:35], a[128:143]
    ds_read_b64_tr_b16 v[80:81], v20 offset:40960
    v_mfma_f32_32x32x16_bf16 a[144:159], v[44:47], v[32:35], a[144:159]
    ds_read_b64_tr_b16 v[82:83], v20 offset:43008
    v_mfma_f32_32x32x16_bf16 a[160:175], v[48:51], v[32:35], a[160:175]
    ds_read_b64_tr_b16 v[84:85], v21 offset:40960
    v_mfma_f32_32x32x16_bf16 a[176:191], v[52:55], v[32:35], a[176:191]
    ds_read_b64_tr_b16 v[86:87], v21 offset:43008
    v_mfma_f32_32x32x16_bf16 a[192:207], v[40:43], v[36:39], a[192:207]
    v_mfma_f32_32x32x16_bf16 a[208:223], v[44:47], v[36:39], a[208:223]
    v_mfma_f32_32x32x16_bf16 a[224:239], v[48:51], v[36:39], a[224:239]
    v_mfma_f32_32x32x16_bf16 a[240:255], v[52:55], v[36:39], a[240:255]
    s_waitcnt vmcnt(8)
    s_waitcnt lgkmcnt(0)
    s_barrier
    s_add_u32 s26, s25, 65536
    v_mfma_f32_32x32x16_bf16 a[0:15], v[72:75], v[56:59], a[0:15]
    ds_read_b128 v[24:27], v10 offset:0
    v_mfma_f32_32x32x16_bf16 a[16:31], v[76:79], v[56:59], a[16:31]
    ds_read_b128 v[28:31], v10 offset:2048
    v_mfma_f32_32x32x16_bf16 a[32:47], v[80:83], v[56:59], a[32:47]
    ds_read_b128 v[32:35], v10 offset:4096
    s_add_u32 m0, s26, 0
    s_nop 0
    v_mfma_f32_32x32x16_bf16 a[48:63], v[84:87], v[56:59], a[48:63]
    ds_read_b128 v[36:39], v10 offset:6144
    buffer_load_dwordx4 v2, s[8:11], s16 offen lds
    s_add_u32 m0, s26, 1024
    v_mfma_f32_32x32x16_bf16 a[64:79], v[72:75], v[60:63], a[64:79]
    ds_read_b64_tr_b16 v[40:41], v14 offset:0
    s_nop 0
    buffer_load_dwordx4 v3, s[8:11], s16 offen lds
    v_mfma_f32_32x32x16_bf16 a[80:95], v[76:79], v[60:63], a[80:95]
    ds_read_b64_tr_b16 v[42:43], v14 offset:2048
    s_add_u32 m0, s26, 2048
    s_nop 0
    v_mfma_f32_32x32x16_bf16 a[96:111], v[80:83], v[60:63], a[96:111]
    ds_read_b64_tr_b16 v[44:45], v15 offset:0
    buffer_load_dwordx4 v4, s[8:11], s16 offen lds
    s_add_u32 m0, s26, 3072
    v_mfma_f32_32x32x16_bf16 a[112:127], v[84:87], v[60:63], a[112:127]
    ds_read_b64_tr_b16 v[46:47], v15 offset:2048
    s_nop 0
    buffer_load_dwordx4 v5, s[8:11], s16 offen lds
    v_mfma_f32_32x32x16_bf16 a[128:143], v[72:75], v[64:67], a[128:143]
    ds_read_b64_tr_b16 v[48:49], v16 offset:0
    s_add_u32 m0, s26, 16384
    s_nop 0
    v_mfma_f32_32x32x16_bf16 a[144:159], v[76:79], v[64:67], a[144:159]
    ds_read_b64_tr_b16 v[50:51], v16 offset:2048
    buffer_load_dwordx4 v6, s[12:15], s17 offen lds
    s_add_u32 m0, s26, 17408
    v_mfma_f32_32x32x16_bf16 a[160:175], v[80:83], v[64:67], a[160:175]
    ds_read_b64_tr_b16 v[52:53], v17 offset:0
    s_nop 0
    buffer_load_dwordx4 v7, s[12:15], s17 offen lds
    v_mfma_f32_32x32x16_bf16 a[176:191], v[84:87], v[64:67], a[176:191]
    ds_read_b64_tr_b16 v[54:55], v17 offset:2048
    s_add_u32 m0, s26, 18432
    s_nop 0
    v_mfma_f32_32x32x16_bf16 a[192:207], v[72:75], v[68:71], a[192:207]
    buffer_load_dwordx4 v8, s[12:15], s17 offen lds
    s_add_u32 m0, s26, 19456
    v_mfma_f32_32x32x16_bf16 a[208:223], v[76:79], v[68:71], a[208:223]
    s_nop 0
    buffer_load_dwordx4 v9, s[12:15], s17 offen lds
    v_mfma_f32_32x32x16_bf16 a[224:239], v[80:83], v[68:71], a[224:239]
    s_add_u32 s16, s16, s27
    s_add_u32 s17, s17, s28
    v_mfma_f32_32x32x16_bf16 a[240:255], v[84:87], v[68:71], a[240:255]
    s_add_u32 s21, s21, 4
    s_cmp_lt_u32 s21, s20
    s_cbranch_scc1 L_gemm_qk
    s_waitcnt vmcnt(0) lgkmcnt(0)
    s_nop 15
    s_barrier
    s_cmp_eq_u32 s36, 0
    s_cselect_b32 s38, 16777216, 0
    s_lshl_b32 s39, s35, 21
    s_add_u32 s38, s38, s39
    s_lshl_b32 s39, s37, 14
    s_add_u32 s38, s38, s39
    s_add_u32 s42, s32, s38
    s_addc_u32 s43, s33, 0
    s_lshl_b32 s25, s22, 15
    v_and_b32 v88, 31, v1
    v_lshlrev_b32 v90, 8, v88
    v_add_u32 v90, s25, v90
    v_and_b32 v89, 15, v88
    v_lshrrev_b32 v88, 5, v1
    v_xor_b32 v89, v89, v88
    v_xor_b32 v93, 0, v89
    v_lshl_add_u32 v93, v93, 4, v90
    v_xor_b32 v94, 2, v89
    v_lshl_add_u32 v94, v94, 4, v90
    v_xor_b32 v95, 4, v89
    v_lshl_add_u32 v95, v95, 4, v90
    v_xor_b32 v96, 6, v89
    v_lshl_add_u32 v96, v96, 4, v90
    v_xor_b32 v97, 8, v89
    v_lshl_add_u32 v97, v97, 4, v90
    v_xor_b32 v98, 10, v89
    v_lshl_add_u32 v98, v98, 4, v90
    v_xor_b32 v99, 12, v89
    v_lshl_add_u32 v99, v99, 4, v90
    v_xor_b32 v100, 14, v89
    v_lshl_add_u32 v100, v100, 4, v90
    v_accvgpr_read_b32 v24, a0
    v_accvgpr_read_b32 v25, a1
    v_accvgpr_read_b32 v26, a2
    v_accvgpr_read_b32 v27, a3
    v_accvgpr_read_b32 v28, a4
    v_accvgpr_read_b32 v29, a5
    v_accvgpr_read_b32 v30, a6
    v_accvgpr_read_b32 v31, a7
    v_accvgpr_read_b32 v32, a8
    v_accvgpr_read_b32 v33, a9
    v_accvgpr_read_b32 v34, a10
    v_accvgpr_read_b32 v35, a11
    v_accvgpr_read_b32 v36, a12
    v_accvgpr_read_b32 v37, a13
    v_accvgpr_read_b32 v38, a14
    v_accvgpr_read_b32 v39, a15
    v_cvt_pk_bf16_f32 v40, v24, v25
    v_cvt_pk_bf16_f32 v41, v26, v27
    v_cvt_pk_bf16_f32 v42, v28, v29
    v_cvt_pk_bf16_f32 v43, v30, v31
    v_cvt_pk_bf16_f32 v44, v32, v33
    v_cvt_pk_bf16_f32 v45, v34, v35
    v_cvt_pk_bf16_f32 v46, v36, v37
    v_cvt_pk_bf16_f32 v47, v38, v39
    s_nop 1
    v_permlane32_swap_b32 v40, v42
    v_permlane32_swap_b32 v41, v43
    v_permlane32_swap_b32 v44, v46
    v_permlane32_swap_b32 v45, v47
    ds_write_b128 v93, v[40:43] offset:0
    ds_write_b128 v94, v[44:47] offset:0
    v_accvgpr_read_b32 v48, a16
    v_accvgpr_read_b32 v49, a17
    v_accvgpr_read_b32 v50, a18
    v_accvgpr_read_b32 v51, a19
    v_accvgpr_read_b32 v52, a20
    v_accvgpr_read_b32 v53, a21
    v_accvgpr_read_b32 v54, a22
    v_accvgpr_read_b32 v55, a23
    v_accvgpr_read_b32 v56, a24
    v_accvgpr_read_b32 v57, a25
    v_accvgpr_read_b32 v58, a26
    v_accvgpr_read_b32 v59, a27
    v_accvgpr_read_b32 v60, a28
    v_accvgpr_read_b32 v61, a29
    v_accvgpr_read_b32 v62, a30
    v_accvgpr_read_b32 v63, a31
    v_cvt_pk_bf16_f32 v64, v48, v49
    v_cvt_pk_bf16_f32 v65, v50, v51
    v_cvt_pk_bf16_f32 v66, v52, v53
    v_cvt_pk_bf16_f32 v67, v54, v55
    v_cvt_pk_bf16_f32 v68, v56, v57
    v_cvt_pk_bf16_f32 v69, v58, v59
    v_cvt_pk_bf16_f32 v70, v60, v61
    v_cvt_pk_bf16_f32 v71, v62, v63
    s_nop 1
    v_permlane32_swap_b32 v64, v66
    v_permlane32_swap_b32 v65, v67
    v_permlane32_swap_b32 v68, v70
    v_permlane32_swap_b32 v69, v71
    ds_write_b128 v95, v[64:67] offset:0
    ds_write_b128 v96, v[68:71] offset:0
    v_accvgpr_read_b32 v24, a32
    v_accvgpr_read_b32 v25, a33
    v_accvgpr_read_b32 v26, a34
    v_accvgpr_read_b32 v27, a35
    v_accvgpr_read_b32 v28, a36
    v_accvgpr_read_b32 v29, a37
    v_accvgpr_read_b32 v30, a38
    v_accvgpr_read_b32 v31, a39
    v_accvgpr_read_b32 v32, a40
    v_accvgpr_read_b32 v33, a41
    v_accvgpr_read_b32 v34, a42
    v_accvgpr_read_b32 v35, a43
    v_accvgpr_read_b32 v36, a44
    v_accvgpr_read_b32 v37, a45
    v_accvgpr_read_b32 v38, a46
    v_accvgpr_read_b32 v39, a47
    v_cvt_pk_bf16_f32 v40, v24, v25
    v_cvt_pk_bf16_f32 v41, v26, v27
    v_cvt_pk_bf16_f32 v42, v28, v29
    v_cvt_pk_bf16_f32 v43, v30, v31
    v_cvt_pk_bf16_f32 v44, v32, v33
    v_cvt_pk_bf16_f32 v45, v34, v35
    v_cvt_pk_bf16_f32 v46, v36, v37
    v_cvt_pk_bf16_f32 v47, v38, v39
    s_nop 1
    v_permlane32_swap_b32 v40, v42
    v_permlane32_swap_b32 v41, v43
    v_permlane32_swap_b32 v44, v46
    v_permlane32_swap_b32 v45, v47
    ds_write_b128 v97, v[40:43] offset:0
    ds_write_b128 v98, v[44:47] offset:0
    v_accvgpr_read_b32 v48, a48
    v_accvgpr_read_b32 v49, a49
    v_accvgpr_read_b32 v50, a50
    v_accvgpr_read_b32 v51, a51
    v_accvgpr_read_b32 v52, a52
    v_accvgpr_read_b32 v53, a53
    v_accvgpr_read_b32 v54, a54
    v_accvgpr_read_b32 v55, a55
    v_accvgpr_read_b32 v56, a56
    v_accvgpr_read_b32 v57, a57
    v_accvgpr_read_b32 v58, a58
    v_accvgpr_read_b32 v59, a59
    v_accvgpr_read_b32 v60, a60
    v_accvgpr_read_b32 v61, a61
    v_accvgpr_read_b32 v62, a62
    v_accvgpr_read_b32 v63, a63
    v_cvt_pk_bf16_f32 v64, v48, v49
    v_cvt_pk_bf16_f32 v65, v50, v51
    v_cvt_pk_bf16_f32 v66, v52, v53
    v_cvt_pk_bf16_f32 v67, v54, v55
    v_cvt_pk_bf16_f32 v68, v56, v57
    v_cvt_pk_bf16_f32 v69, v58, v59
    v_cvt_pk_bf16_f32 v70, v60, v61
    v_cvt_pk_bf16_f32 v71, v62, v63
    s_nop 1
    v_permlane32_swap_b32 v64, v66
    v_permlane32_swap_b32 v65, v67
    v_permlane32_swap_b32 v68, v70
    v_permlane32_swap_b32 v69, v71
    ds_write_b128 v99, v[64:67] offset:0
    ds_write_b128 v100, v[68:71] offset:0
    v_accvgpr_read_b32 v24, a64
    v_accvgpr_read_b32 v25, a65
    v_accvgpr_read_b32 v26, a66
    v_accvgpr_read_b32 v27, a67
    v_accvgpr_read_b32 v28, a68
    v_accvgpr_read_b32 v29, a69
    v_accvgpr_read_b32 v30, a70
    v_accvgpr_read_b32 v31, a71
    v_accvgpr_read_b32 v32, a72
    v_accvgpr_read_b32 v33, a73
    v_accvgpr_read_b32 v34, a74
    v_accvgpr_read_b32 v35, a75
    v_accvgpr_read_b32 v36, a76
    v_accvgpr_read_b32 v37, a77
    v_accvgpr_read_b32 v38, a78
    v_accvgpr_read_b32 v39, a79
    v_cvt_pk_bf16_f32 v40, v24, v25
    v_cvt_pk_bf16_f32 v41, v26, v27
    v_cvt_pk_bf16_f32 v42, v28, v29
    v_cvt_pk_bf16_f32 v43, v30, v31
    v_cvt_pk_bf16_f32 v44, v32, v33
    v_cvt_pk_bf16_f32 v45, v34, v35
    v_cvt_pk_bf16_f32 v46, v36, v37
    v_cvt_pk_bf16_f32 v47, v38, v39
    s_nop 1
    v_permlane32_swap_b32 v40, v42
    v_permlane32_swap_b32 v41, v43
    v_permlane32_swap_b32 v44, v46
    v_permlane32_swap_b32 v45, v47
    ds_write_b128 v93, v[40:43] offset:8192
    ds_write_b128 v94, v[44:47] offset:8192
    v_accvgpr_read_b32 v48, a80
    v_accvgpr_read_b32 v49, a81
    v_accvgpr_read_b32 v50, a82
    v_accvgpr_read_b32 v51, a83
    v_accvgpr_read_b32 v52, a84
    v_accvgpr_read_b32 v53, a85
    v_accvgpr_read_b32 v54, a86
    v_accvgpr_read_b32 v55, a87
    v_accvgpr_read_b32 v56, a88
    v_accvgpr_read_b32 v57, a89
    v_accvgpr_read_b32 v58, a90
    v_accvgpr_read_b32 v59, a91
    v_accvgpr_read_b32 v60, a92
    v_accvgpr_read_b32 v61, a93
    v_accvgpr_read_b32 v62, a94
    v_accvgpr_read_b32 v63, a95
    v_cvt_pk_bf16_f32 v64, v48, v49
    v_cvt_pk_bf16_f32 v65, v50, v51
    v_cvt_pk_bf16_f32 v66, v52, v53
    v_cvt_pk_bf16_f32 v67, v54, v55
    v_cvt_pk_bf16_f32 v68, v56, v57
    v_cvt_pk_bf16_f32 v69, v58, v59
    v_cvt_pk_bf16_f32 v70, v60, v61
    v_cvt_pk_bf16_f32 v71, v62, v63
    s_nop 1
    v_permlane32_swap_b32 v64, v66
    v_permlane32_swap_b32 v65, v67
    v_permlane32_swap_b32 v68, v70
    v_permlane32_swap_b32 v69, v71
    ds_write_b128 v95, v[64:67] offset:8192
    ds_write_b128 v96, v[68:71] offset:8192
    v_accvgpr_read_b32 v24, a96
    v_accvgpr_read_b32 v25, a97
    v_accvgpr_read_b32 v26, a98
    v_accvgpr_read_b32 v27, a99
    v_accvgpr_read_b32 v28, a100
    v_accvgpr_read_b32 v29, a101
    v_accvgpr_read_b32 v30, a102
    v_accvgpr_read_b32 v31, a103
    v_accvgpr_read_b32 v32, a104
    v_accvgpr_read_b32 v33, a105
    v_accvgpr_read_b32 v34, a106
    v_accvgpr_read_b32 v35, a107
    v_accvgpr_read_b32 v36, a108
    v_accvgpr_read_b32 v37, a109
    v_accvgpr_read_b32 v38, a110
    v_accvgpr_read_b32 v39, a111
    v_cvt_pk_bf16_f32 v40, v24, v25
    v_cvt_pk_bf16_f32 v41, v26, v27
    v_cvt_pk_bf16_f32 v42, v28, v29
    v_cvt_pk_bf16_f32 v43, v30, v31
    v_cvt_pk_bf16_f32 v44, v32, v33
    v_cvt_pk_bf16_f32 v45, v34, v35
    v_cvt_pk_bf16_f32 v46, v36, v37
    v_cvt_pk_bf16_f32 v47, v38, v39
    s_nop 1
    v_permlane32_swap_b32 v40, v42
    v_permlane32_swap_b32 v41, v43
    v_permlane32_swap_b32 v44, v46
    v_permlane32_swap_b32 v45, v47
    ds_write_b128 v97, v[40:43] offset:8192
    ds_write_b128 v98, v[44:47] offset:8192
    v_accvgpr_read_b32 v48, a112
    v_accvgpr_read_b32 v49, a113
    v_accvgpr_read_b32 v50, a114
    v_accvgpr_read_b32 v51, a115
    v_accvgpr_read_b32 v52, a116
    v_accvgpr_read_b32 v53, a117
    v_accvgpr_read_b32 v54, a118
    v_accvgpr_read_b32 v55, a119
    v_accvgpr_read_b32 v56, a120
    v_accvgpr_read_b32 v57, a121
    v_accvgpr_read_b32 v58, a122
    v_accvgpr_read_b32 v59, a123
    v_accvgpr_read_b32 v60, a124
    v_accvgpr_read_b32 v61, a125
    v_accvgpr_read_b32 v62, a126
    v_accvgpr_read_b32 v63, a127
    v_cvt_pk_bf16_f32 v64, v48, v49
    v_cvt_pk_bf16_f32 v65, v50, v51
    v_cvt_pk_bf16_f32 v66, v52, v53
    v_cvt_pk_bf16_f32 v67, v54, v55
    v_cvt_pk_bf16_f32 v68, v56, v57
    v_cvt_pk_bf16_f32 v69, v58, v59
    v_cvt_pk_bf16_f32 v70, v60, v61
    v_cvt_pk_bf16_f32 v71, v62, v63
    s_nop 1
    v_permlane32_swap_b32 v64, v66
    v_permlane32_swap_b32 v65, v67
    v_permlane32_swap_b32 v68, v70
    v_permlane32_swap_b32 v69, v71
    ds_write_b128 v99, v[64:67] offset:8192
    ds_write_b128 v100, v[68:71] offset:8192
    v_accvgpr_read_b32 v24, a128
    v_accvgpr_read_b32 v25, a129
    v_accvgpr_read_b32 v26, a130
    v_accvgpr_read_b32 v27, a131
    v_accvgpr_read_b32 v28, a132
    v_accvgpr_read_b32 v29, a133
    v_accvgpr_read_b32 v30, a134
    v_accvgpr_read_b32 v31, a135
    v_accvgpr_read_b32 v32, a136
    v_accvgpr_read_b32 v33, a137
    v_accvgpr_read_b32 v34, a138
    v_accvgpr_read_b32 v35, a139
    v_accvgpr_read_b32 v36, a140
    v_accvgpr_read_b32 v37, a141
    v_accvgpr_read_b32 v38, a142
    v_accvgpr_read_b32 v39, a143
    v_cvt_pk_bf16_f32 v40, v24, v25
    v_cvt_pk_bf16_f32 v41, v26, v27
    v_cvt_pk_bf16_f32 v42, v28, v29
    v_cvt_pk_bf16_f32 v43, v30, v31
    v_cvt_pk_bf16_f32 v44, v32, v33
    v_cvt_pk_bf16_f32 v45, v34, v35
    v_cvt_pk_bf16_f32 v46, v36, v37
    v_cvt_pk_bf16_f32 v47, v38, v39
    s_nop 1
    v_permlane32_swap_b32 v40, v42
    v_permlane32_swap_b32 v41, v43
    v_permlane32_swap_b32 v44, v46
    v_permlane32_swap_b32 v45, v47
    ds_write_b128 v93, v[40:43] offset:16384
    ds_write_b128 v94, v[44:47] offset:16384
    v_accvgpr_read_b32 v48, a144
    v_accvgpr_read_b32 v49, a145
    v_accvgpr_read_b32 v50, a146
    v_accvgpr_read_b32 v51, a147
    v_accvgpr_read_b32 v52, a148
    v_accvgpr_read_b32 v53, a149
    v_accvgpr_read_b32 v54, a150
    v_accvgpr_read_b32 v55, a151
    v_accvgpr_read_b32 v56, a152
    v_accvgpr_read_b32 v57, a153
    v_accvgpr_read_b32 v58, a154
    v_accvgpr_read_b32 v59, a155
    v_accvgpr_read_b32 v60, a156
    v_accvgpr_read_b32 v61, a157
    v_accvgpr_read_b32 v62, a158
    v_accvgpr_read_b32 v63, a159
    v_cvt_pk_bf16_f32 v64, v48, v49
    v_cvt_pk_bf16_f32 v65, v50, v51
    v_cvt_pk_bf16_f32 v66, v52, v53
    v_cvt_pk_bf16_f32 v67, v54, v55
    v_cvt_pk_bf16_f32 v68, v56, v57
    v_cvt_pk_bf16_f32 v69, v58, v59
    v_cvt_pk_bf16_f32 v70, v60, v61
    v_cvt_pk_bf16_f32 v71, v62, v63
    s_nop 1
    v_permlane32_swap_b32 v64, v66
    v_permlane32_swap_b32 v65, v67
    v_permlane32_swap_b32 v68, v70
    v_permlane32_swap_b32 v69, v71
    ds_write_b128 v95, v[64:67] offset:16384
    ds_write_b128 v96, v[68:71] offset:16384
    v_accvgpr_read_b32 v24, a160
    v_accvgpr_read_b32 v25, a161
    v_accvgpr_read_b32 v26, a162
    v_accvgpr_read_b32 v27, a163
    v_accvgpr_read_b32 v28, a164
    v_accvgpr_read_b32 v29, a165
    v_accvgpr_read_b32 v30, a166
    v_accvgpr_read_b32 v31, a167
    v_accvgpr_read_b32 v32, a168
    v_accvgpr_read_b32 v33, a169
    v_accvgpr_read_b32 v34, a170
    v_accvgpr_read_b32 v35, a171
    v_accvgpr_read_b32 v36, a172
    v_accvgpr_read_b32 v37, a173
    v_accvgpr_read_b32 v38, a174
    v_accvgpr_read_b32 v39, a175
    v_cvt_pk_bf16_f32 v40, v24, v25
    v_cvt_pk_bf16_f32 v41, v26, v27
    v_cvt_pk_bf16_f32 v42, v28, v29
    v_cvt_pk_bf16_f32 v43, v30, v31
    v_cvt_pk_bf16_f32 v44, v32, v33
    v_cvt_pk_bf16_f32 v45, v34, v35
    v_cvt_pk_bf16_f32 v46, v36, v37
    v_cvt_pk_bf16_f32 v47, v38, v39
    s_nop 1
    v_permlane32_swap_b32 v40, v42
    v_permlane32_swap_b32 v41, v43
    v_permlane32_swap_b32 v44, v46
    v_permlane32_swap_b32 v45, v47
    ds_write_b128 v97, v[40:43] offset:16384
    ds_write_b128 v98, v[44:47] offset:16384
    v_accvgpr_read_b32 v48, a176
    v_accvgpr_read_b32 v49, a177
    v_accvgpr_read_b32 v50, a178
    v_accvgpr_read_b32 v51, a179
    v_accvgpr_read_b32 v52, a180
    v_accvgpr_read_b32 v53, a181
    v_accvgpr_read_b32 v54, a182
    v_accvgpr_read_b32 v55, a183
    v_accvgpr_read_b32 v56, a184
    v_accvgpr_read_b32 v57, a185
    v_accvgpr_read_b32 v58, a186
    v_accvgpr_read_b32 v59, a187
    v_accvgpr_read_b32 v60, a188
    v_accvgpr_read_b32 v61, a189
    v_accvgpr_read_b32 v62, a190
    v_accvgpr_read_b32 v63, a191
    v_cvt_pk_bf16_f32 v64, v48, v49
    v_cvt_pk_bf16_f32 v65, v50, v51
    v_cvt_pk_bf16_f32 v66, v52, v53
    v_cvt_pk_bf16_f32 v67, v54, v55
    v_cvt_pk_bf16_f32 v68, v56, v57
    v_cvt_pk_bf16_f32 v69, v58, v59
    v_cvt_pk_bf16_f32 v70, v60, v61
    v_cvt_pk_bf16_f32 v71, v62, v63
    s_nop 1
    v_permlane32_swap_b32 v64, v66
    v_permlane32_swap_b32 v65, v67
    v_permlane32_swap_b32 v68, v70
    v_permlane32_swap_b32 v69, v71
    ds_write_b128 v99, v[64:67] offset:16384
    ds_write_b128 v100, v[68:71] offset:16384
    v_accvgpr_read_b32 v24, a192
    v_accvgpr_read_b32 v25, a193
    v_accvgpr_read_b32 v26, a194
    v_accvgpr_read_b32 v27, a195
    v_accvgpr_read_b32 v28, a196
    v_accvgpr_read_b32 v29, a197
    v_accvgpr_read_b32 v30, a198
    v_accvgpr_read_b32 v31, a199
    v_accvgpr_read_b32 v32, a200
    v_accvgpr_read_b32 v33, a201
    v_accvgpr_read_b32 v34, a202
    v_accvgpr_read_b32 v35, a203
    v_accvgpr_read_b32 v36, a204
    v_accvgpr_read_b32 v37, a205
    v_accvgpr_read_b32 v38, a206
    v_accvgpr_read_b32 v39, a207
    v_cvt_pk_bf16_f32 v40, v24, v25
    v_cvt_pk_bf16_f32 v41, v26, v27
    v_cvt_pk_bf16_f32 v42, v28, v29
    v_cvt_pk_bf16_f32 v43, v30, v31
    v_cvt_pk_bf16_f32 v44, v32, v33
    v_cvt_pk_bf16_f32 v45, v34, v35
    v_cvt_pk_bf16_f32 v46, v36, v37
    v_cvt_pk_bf16_f32 v47, v38, v39
    s_nop 1
    v_permlane32_swap_b32 v40, v42
    v_permlane32_swap_b32 v41, v43
    v_permlane32_swap_b32 v44, v46
    v_permlane32_swap_b32 v45, v47
    ds_write_b128 v93, v[40:43] offset:24576
    ds_write_b128 v94, v[44:47] offset:24576
    v_accvgpr_read_b32 v48, a208
    v_accvgpr_read_b32 v49, a209
    v_accvgpr_read_b32 v50, a210
    v_accvgpr_read_b32 v51, a211
    v_accvgpr_read_b32 v52, a212
    v_accvgpr_read_b32 v53, a213
    v_accvgpr_read_b32 v54, a214
    v_accvgpr_read_b32 v55, a215
    v_accvgpr_read_b32 v56, a216
    v_accvgpr_read_b32 v57, a217
    v_accvgpr_read_b32 v58, a218
    v_accvgpr_read_b32 v59, a219
    v_accvgpr_read_b32 v60, a220
    v_accvgpr_read_b32 v61, a221
    v_accvgpr_read_b32 v62, a222
    v_accvgpr_read_b32 v63, a223
    v_cvt_pk_bf16_f32 v64, v48, v49
    v_cvt_pk_bf16_f32 v65, v50, v51
    v_cvt_pk_bf16_f32 v66, v52, v53
    v_cvt_pk_bf16_f32 v67, v54, v55
    v_cvt_pk_bf16_f32 v68, v56, v57
    v_cvt_pk_bf16_f32 v69, v58, v59
    v_cvt_pk_bf16_f32 v70, v60, v61
    v_cvt_pk_bf16_f32 v71, v62, v63
    s_nop 1
    v_permlane32_swap_b32 v64, v66
    v_permlane32_swap_b32 v65, v67
    v_permlane32_swap_b32 v68, v70
    v_permlane32_swap_b32 v69, v71
    ds_write_b128 v95, v[64:67] offset:24576
    ds_write_b128 v96, v[68:71] offset:24576
    v_accvgpr_read_b32 v24, a224
    v_accvgpr_read_b32 v25, a225
    v_accvgpr_read_b32 v26, a226
    v_accvgpr_read_b32 v27, a227
    v_accvgpr_read_b32 v28, a228
    v_accvgpr_read_b32 v29, a229
    v_accvgpr_read_b32 v30, a230
    v_accvgpr_read_b32 v31, a231
    v_accvgpr_read_b32 v32, a232
    v_accvgpr_read_b32 v33, a233
    v_accvgpr_read_b32 v34, a234
    v_accvgpr_read_b32 v35, a235
    v_accvgpr_read_b32 v36, a236
    v_accvgpr_read_b32 v37, a237
    v_accvgpr_read_b32 v38, a238
    v_accvgpr_read_b32 v39, a239
    v_cvt_pk_bf16_f32 v40, v24, v25
    v_cvt_pk_bf16_f32 v41, v26, v27
    v_cvt_pk_bf16_f32 v42, v28, v29
    v_cvt_pk_bf16_f32 v43, v30, v31
    v_cvt_pk_bf16_f32 v44, v32, v33
    v_cvt_pk_bf16_f32 v45, v34, v35
    v_cvt_pk_bf16_f32 v46, v36, v37
    v_cvt_pk_bf16_f32 v47, v38, v39
    s_nop 1
    v_permlane32_swap_b32 v40, v42
    v_permlane32_swap_b32 v41, v43
    v_permlane32_swap_b32 v44, v46
    v_permlane32_swap_b32 v45, v47
    ds_write_b128 v97, v[40:43] offset:24576
    ds_write_b128 v98, v[44:47] offset:24576
    v_accvgpr_read_b32 v48, a240
    v_accvgpr_read_b32 v49, a241
    v_accvgpr_read_b32 v50, a242
    v_accvgpr_read_b32 v51, a243
    v_accvgpr_read_b32 v52, a244
    v_accvgpr_read_b32 v53, a245
    v_accvgpr_read_b32 v54, a246
    v_accvgpr_read_b32 v55, a247
    v_accvgpr_read_b32 v56, a248
    v_accvgpr_read_b32 v57, a249
    v_accvgpr_read_b32 v58, a250
    v_accvgpr_read_b32 v59, a251
    v_accvgpr_read_b32 v60, a252
    v_accvgpr_read_b32 v61, a253
    v_accvgpr_read_b32 v62, a254
    v_accvgpr_read_b32 v63, a255
    v_cvt_pk_bf16_f32 v64, v48, v49
    v_cvt_pk_bf16_f32 v65, v50, v51
    v_cvt_pk_bf16_f32 v66, v52, v53
    v_cvt_pk_bf16_f32 v67, v54, v55
    v_cvt_pk_bf16_f32 v68, v56, v57
    v_cvt_pk_bf16_f32 v69, v58, v59
    v_cvt_pk_bf16_f32 v70, v60, v61
    v_cvt_pk_bf16_f32 v71, v62, v63
    s_nop 1
    v_permlane32_swap_b32 v64, v66
    v_permlane32_swap_b32 v65, v67
    v_permlane32_swap_b32 v68, v70
    v_permlane32_swap_b32 v69, v71
    ds_write_b128 v99, v[64:67] offset:24576
    ds_write_b128 v100, v[68:71] offset:24576
    v_and_b32 v88, 15, v1
    v_lshrrev_b32 v89, 4, v1
    v_xor_b32 v89, v89, v88
    v_lshlrev_b32 v91, 8, v88
    v_add_u32 v91, s25, v91
    v_lshlrev_b32 v92, 4, v1
    s_lshr_b32 s23, s22, 1
    s_lshl_b32 s23, s23, 20
    s_and_b32 s24, s22, 1
    s_lshl_b32 s24, s24, 13
    s_add_u32 s23, s23, s24
    v_add_u32 v92, s23, v92
    v_add_u32 v101, 4096, v92
    v_xor_b32 v93, 0, v89
    v_lshl_add_u32 v93, v93, 4, v91
    v_xor_b32 v94, 4, v89
    v_lshl_add_u32 v94, v94, 4, v91
    v_xor_b32 v95, 8, v89
    v_lshl_add_u32 v95, v95, 4, v91
    v_xor_b32 v96, 12, v89
    v_lshl_add_u32 v96, v96, 4, v91
    s_waitcnt lgkmcnt(0)
    ds_read_b128 v[24:27], v93 offset:0
    ds_read_b128 v[28:31], v94 offset:0
    ds_read_b128 v[32:35], v95 offset:0
    ds_read_b128 v[36:39], v96 offset:0
    s_waitcnt lgkmcnt(0)
    global_store_dwordx4 v92, v[24:27], s[42:43] offset:0 sc1
    global_store_dwordx4 v92, v[28:31], s[42:43] offset:1024 sc1
    global_store_dwordx4 v92, v[32:35], s[42:43] offset:2048 sc1
    global_store_dwordx4 v92, v[36:39], s[42:43] offset:3072 sc1
    ds_read_b128 v[40:43], v93 offset:4096
    ds_read_b128 v[44:47], v94 offset:4096
    ds_read_b128 v[48:51], v95 offset:4096
    ds_read_b128 v[52:55], v96 offset:4096
    s_waitcnt lgkmcnt(0)
    global_store_dwordx4 v101, v[40:43], s[42:43] offset:0 sc1
    global_store_dwordx4 v101, v[44:47], s[42:43] offset:1024 sc1
    global_store_dwordx4 v101, v[48:51], s[42:43] offset:2048 sc1
    global_store_dwordx4 v101, v[52:55], s[42:43] offset:3072 sc1
    v_add_u32 v92, 262144, v92
    v_add_u32 v101, 262144, v101
    ds_read_b128 v[24:27], v93 offset:8192
    ds_read_b128 v[28:31], v94 offset:8192
    ds_read_b128 v[32:35], v95 offset:8192
    ds_read_b128 v[36:39], v96 offset:8192
    s_waitcnt lgkmcnt(0)
    global_store_dwordx4 v92, v[24:27], s[42:43] offset:0 sc1
    global_store_dwordx4 v92, v[28:31], s[42:43] offset:1024 sc1
    global_store_dwordx4 v92, v[32:35], s[42:43] offset:2048 sc1
    global_store_dwordx4 v92, v[36:39], s[42:43] offset:3072 sc1
    ds_read_b128 v[40:43], v93 offset:12288
    ds_read_b128 v[44:47], v94 offset:12288
    ds_read_b128 v[48:51], v95 offset:12288
    ds_read_b128 v[52:55], v96 offset:12288
    s_waitcnt lgkmcnt(0)
    global_store_dwordx4 v101, v[40:43], s[42:43] offset:0 sc1
    global_store_dwordx4 v101, v[44:47], s[42:43] offset:1024 sc1
    global_store_dwordx4 v101, v[48:51], s[42:43] offset:2048 sc1
    global_store_dwordx4 v101, v[52:55], s[42:43] offset:3072 sc1
    v_add_u32 v92, 262144, v92
    v_add_u32 v101, 262144, v101
    ds_read_b128 v[24:27], v93 offset:16384
    ds_read_b128 v[28:31], v94 offset:16384
    ds_read_b128 v[32:35], v95 offset:16384
    ds_read_b128 v[36:39], v96 offset:16384
    s_waitcnt lgkmcnt(0)
    global_store_dwordx4 v92, v[24:27], s[42:43] offset:0 sc1
    global_store_dwordx4 v92, v[28:31], s[42:43] offset:1024 sc1
    global_store_dwordx4 v92, v[32:35], s[42:43] offset:2048 sc1
    global_store_dwordx4 v92, v[36:39], s[42:43] offset:3072 sc1
    ds_read_b128 v[40:43], v93 offset:20480
    ds_read_b128 v[44:47], v94 offset:20480
    ds_read_b128 v[48:51], v95 offset:20480
    ds_read_b128 v[52:55], v96 offset:20480
    s_waitcnt lgkmcnt(0)
    global_store_dwordx4 v101, v[40:43], s[42:43] offset:0 sc1
    global_store_dwordx4 v101, v[44:47], s[42:43] offset:1024 sc1
    global_store_dwordx4 v101, v[48:51], s[42:43] offset:2048 sc1
    global_store_dwordx4 v101, v[52:55], s[42:43] offset:3072 sc1
    v_add_u32 v92, 262144, v92
    v_add_u32 v101, 262144, v101
    ds_read_b128 v[24:27], v93 offset:24576
    ds_read_b128 v[28:31], v94 offset:24576
    ds_read_b128 v[32:35], v95 offset:24576
    ds_read_b128 v[36:39], v96 offset:24576
    s_waitcnt lgkmcnt(0)
    global_store_dwordx4 v92, v[24:27], s[42:43] offset:0 sc1
    global_store_dwordx4 v92, v[28:31], s[42:43] offset:1024 sc1
    global_store_dwordx4 v92, v[32:35], s[42:43] offset:2048 sc1
    global_store_dwordx4 v92, v[36:39], s[42:43] offset:3072 sc1
    ds_read_b128 v[40:43], v93 offset:28672
    ds_read_b128 v[44:47], v94 offset:28672
    ds_read_b128 v[48:51], v95 offset:28672
    ds_read_b128 v[52:55], v96 offset:28672
    s_waitcnt lgkmcnt(0)
    global_store_dwordx4 v101, v[40:43], s[42:43] offset:0 sc1
    global_store_dwordx4 v101, v[44:47], s[42:43] offset:1024 sc1
    global_store_dwordx4 v101, v[48:51], s[42:43] offset:2048 sc1
    global_store_dwordx4 v101, v[52:55], s[42:43] offset:3072 sc1
    s_cmp_eq_u32 s36, 0
    s_cbranch_scc1 L_sig_kv
    s_add_u32 s51, s51, 128
    s_cmp_eq_u32 s64, 1
    s_cbranch_scc1 L_ei_sq
    s_mov_b32 s65, 200
    s_cmp_eq_u32 s22, 0
    s_cbranch_scc0 L_wfd_eisq
    v_mov_b32 v3, s65
    s_mov_b32 s14, 0
L_wf_eisq:
    global_load_dword v4, v3, s[6:7] sc1
    s_waitcnt vmcnt(0)
    v_readfirstlane_b32 s15, v4
    s_add_u32 s14, s14, 1
    s_cmp_gt_u32 s14, 400000
    s_cbranch_scc1 L_wfd_eisq
    s_cmp_ge_u32 s15, 1
    s_cbranch_scc1 L_wfd_eisq
    s_sleep 4
    s_branch L_wf_eisq
L_wfd_eisq:
    s_barrier
    s_mov_b32 s64, 1
L_ei_sq:
    s_waitcnt vmcnt(0)
    s_barrier
    v_cmp_eq_u32 vcc, 0, v0
    s_and_saveexec_b64 s[12:13], vcc
    s_cbranch_execz L_sg_q
    v_mov_b32 v3, s51
    v_mov_b32 v4, 1
    global_atomic_add v3, v4, s[66:67]
L_sg_q:
    s_mov_b64 exec, s[12:13]
    s_branch L_task
L_sig_kv:
    s_cmp_eq_u32 s64, 1
    s_cbranch_scc1 L_ei_skv
    s_mov_b32 s65, 200
    s_cmp_eq_u32 s22, 0
    s_cbranch_scc0 L_wfd_eiskv
    v_mov_b32 v3, s65
    s_mov_b32 s14, 0
L_wf_eiskv:
    global_load_dword v4, v3, s[6:7] sc1
    s_waitcnt vmcnt(0)
    v_readfirstlane_b32 s15, v4
    s_add_u32 s14, s14, 1
    s_cmp_gt_u32 s14, 400000
    s_cbranch_scc1 L_wfd_eiskv
    s_cmp_ge_u32 s15, 1
    s_cbranch_scc1 L_wfd_eiskv
    s_sleep 4
    s_branch L_wf_eiskv
L_wfd_eiskv:
    s_barrier
    s_mov_b32 s64, 1
L_ei_skv:
    s_waitcnt vmcnt(0)
    s_barrier
    v_cmp_eq_u32 vcc, 0, v0
    s_and_saveexec_b64 s[12:13], vcc
    s_cbranch_execz L_sg_kv
    v_mov_b32 v3, s51
    v_mov_b32 v4, 2
    global_atomic_add v3, v4, s[66:67]
L_sg_kv:
    s_mov_b64 exec, s[12:13]
    s_branch L_task
L_t_v:
    s_lshl_b32 s25, s22, 12
    s_add_u32 s26, s25, 0
    s_add_u32 m0, s26, 0
    s_nop 0
    buffer_load_dwordx4 v2, s[8:11], s16 offen lds
    s_add_u32 m0, s26, 1024
    s_nop 0
    buffer_load_dwordx4 v3, s[8:11], s16 offen lds
    s_add_u32 m0, s26, 2048
    s_nop 0
    buffer_load_dwordx4 v4, s[8:11], s16 offen lds
    s_add_u32 m0, s26, 3072
    s_nop 0
    buffer_load_dwordx4 v5, s[8:11], s16 offen lds
    s_add_u32 m0, s26, 16384
    s_nop 0
    buffer_load_dwordx4 v6, s[12:15], s17 offen lds
    s_add_u32 m0, s26, 17408
    s_nop 0
    buffer_load_dwordx4 v7, s[12:15], s17 offen lds
    s_add_u32 m0, s26, 18432
    s_nop 0
    buffer_load_dwordx4 v8, s[12:15], s17 offen lds
    s_add_u32 m0, s26, 19456
    s_nop 0
    buffer_load_dwordx4 v9, s[12:15], s17 offen lds
    s_add_u32 s16, s16, s27
    s_add_u32 s17, s17, s28
    s_add_u32 s26, s25, 32768
    s_add_u32 m0, s26, 0
    s_nop 0
    buffer_load_dwordx4 v2, s[8:11], s16 offen lds
    s_add_u32 m0, s26, 1024
    s_nop 0
    buffer_load_dwordx4 v3, s[8:11], s16 offen lds
    s_add_u32 m0, s26, 2048
    s_nop 0
    buffer_load_dwordx4 v4, s[8:11], s16 offen lds
    s_add_u32 m0, s26, 3072
    s_nop 0
    buffer_load_dwordx4 v5, s[8:11], s16 offen lds
    s_add_u32 m0, s26, 16384
    s_nop 0
    buffer_load_dwordx4 v6, s[12:15], s17 offen lds
    s_add_u32 m0, s26, 17408
    s_nop 0
    buffer_load_dwordx4 v7, s[12:15], s17 offen lds
    s_add_u32 m0, s26, 18432
    s_nop 0
    buffer_load_dwordx4 v8, s[12:15], s17 offen lds
    s_add_u32 m0, s26, 19456
    s_nop 0
    buffer_load_dwordx4 v9, s[12:15], s17 offen lds
    s_add_u32 s16, s16, s27
    s_add_u32 s17, s17, s28
    s_add_u32 s26, s25, 65536
    s_add_u32 m0, s26, 0
    s_nop 0
    buffer_load_dwordx4 v2, s[8:11], s16 offen lds
    s_add_u32 m0, s26, 1024
    s_nop 0
    buffer_load_dwordx4 v3, s[8:11], s16 offen lds
    s_add_u32 m0, s26, 2048
    s_nop 0
    buffer_load_dwordx4 v4, s[8:11], s16 offen lds
    s_add_u32 m0, s26, 3072
    s_nop 0
    buffer_load_dwordx4 v5, s[8:11], s16 offen lds
    s_add_u32 m0, s26, 16384
    s_nop 0
    buffer_load_dwordx4 v6, s[12:15], s17 offen lds
    s_add_u32 m0, s26, 17408
    s_nop 0
    buffer_load_dwordx4 v7, s[12:15], s17 offen lds
    s_add_u32 m0, s26, 18432
    s_nop 0
    buffer_load_dwordx4 v8, s[12:15], s17 offen lds
    s_add_u32 m0, s26, 19456
    s_nop 0
    buffer_load_dwordx4 v9, s[12:15], s17 offen lds
    s_add_u32 s16, s16, s27
    s_add_u32 s17, s17, s28
    s_waitcnt vmcnt(16)
    s_barrier
    ds_read_b128 v[24:27], v10 offset:0
    ds_read_b128 v[28:31], v10 offset:2048
    ds_read_b128 v[32:35], v10 offset:4096
    ds_read_b128 v[36:39], v10 offset:6144
    ds_read_b64_tr_b16 v[40:41], v14 offset:0
    ds_read_b64_tr_b16 v[42:43], v14 offset:2048
    ds_read_b64_tr_b16 v[44:45], v15 offset:0
    ds_read_b64_tr_b16 v[46:47], v15 offset:2048
    ds_read_b64_tr_b16 v[48:49], v16 offset:0
    ds_read_b64_tr_b16 v[50:51], v16 offset:2048
    ds_read_b64_tr_b16 v[52:53], v17 offset:0
    ds_read_b64_tr_b16 v[54:55], v17 offset:2048
    s_mov_b32 s21, 0
    v_accvgpr_write_b32 a0, 0
    v_accvgpr_write_b32 a1, 0
    v_accvgpr_write_b32 a2, 0
    v_accvgpr_write_b32 a3, 0
    v_accvgpr_write_b32 a4, 0
    v_accvgpr_write_b32 a5, 0
    v_accvgpr_write_b32 a6, 0
    v_accvgpr_write_b32 a7, 0
    v_accvgpr_write_b32 a8, 0
    v_accvgpr_write_b32 a9, 0
    v_accvgpr_write_b32 a10, 0
    v_accvgpr_write_b32 a11, 0
    v_accvgpr_write_b32 a12, 0
    v_accvgpr_write_b32 a13, 0
    v_accvgpr_write_b32 a14, 0
    v_accvgpr_write_b32 a15, 0
    v_accvgpr_write_b32 a16, 0
    v_accvgpr_write_b32 a17, 0
    v_accvgpr_write_b32 a18, 0
    v_accvgpr_write_b32 a19, 0
    v_accvgpr_write_b32 a20, 0
    v_accvgpr_write_b32 a21, 0
    v_accvgpr_write_b32 a22, 0
    v_accvgpr_write_b32 a23, 0
    v_accvgpr_write_b32 a24, 0
    v_accvgpr_write_b32 a25, 0
    v_accvgpr_write_b32 a26, 0
    v_accvgpr_write_b32 a27, 0
    v_accvgpr_write_b32 a28, 0
    v_accvgpr_write_b32 a29, 0
    v_accvgpr_write_b32 a30, 0
    v_accvgpr_write_b32 a31, 0
    v_accvgpr_write_b32 a32, 0
    v_accvgpr_write_b32 a33, 0
    v_accvgpr_write_b32 a34, 0
    v_accvgpr_write_b32 a35, 0
    v_accvgpr_write_b32 a36, 0
    v_accvgpr_write_b32 a37, 0
    v_accvgpr_write_b32 a38, 0
    v_accvgpr_write_b32 a39, 0
    v_accvgpr_write_b32 a40, 0
    v_accvgpr_write_b32 a41, 0
    v_accvgpr_write_b32 a42, 0
    v_accvgpr_write_b32 a43, 0
    v_accvgpr_write_b32 a44, 0
    v_accvgpr_write_b32 a45, 0
    v_accvgpr_write_b32 a46, 0
    v_accvgpr_write_b32 a47, 0
    v_accvgpr_write_b32 a48, 0
    v_accvgpr_write_b32 a49, 0
    v_accvgpr_write_b32 a50, 0
    v_accvgpr_write_b32 a51, 0
    v_accvgpr_write_b32 a52, 0
    v_accvgpr_write_b32 a53, 0
    v_accvgpr_write_b32 a54, 0
    v_accvgpr_write_b32 a55, 0
    v_accvgpr_write_b32 a56, 0
    v_accvgpr_write_b32 a57, 0
    v_accvgpr_write_b32 a58, 0
    v_accvgpr_write_b32 a59, 0
    v_accvgpr_write_b32 a60, 0
    v_accvgpr_write_b32 a61, 0
    v_accvgpr_write_b32 a62, 0
    v_accvgpr_write_b32 a63, 0
    v_accvgpr_write_b32 a64, 0
    v_accvgpr_write_b32 a65, 0
    v_accvgpr_write_b32 a66, 0
    v_accvgpr_write_b32 a67, 0
    v_accvgpr_write_b32 a68, 0
    v_accvgpr_write_b32 a69, 0
    v_accvgpr_write_b32 a70, 0
    v_accvgpr_write_b32 a71, 0
    v_accvgpr_write_b32 a72, 0
    v_accvgpr_write_b32 a73, 0
    v_accvgpr_write_b32 a74, 0
    v_accvgpr_write_b32 a75, 0
    v_accvgpr_write_b32 a76, 0
    v_accvgpr_write_b32 a77, 0
    v_accvgpr_write_b32 a78, 0
    v_accvgpr_write_b32 a79, 0
    v_accvgpr_write_b32 a80, 0
    v_accvgpr_write_b32 a81, 0
    v_accvgpr_write_b32 a82, 0
    v_accvgpr_write_b32 a83, 0
    v_accvgpr_write_b32 a84, 0
    v_accvgpr_write_b32 a85, 0
    v_accvgpr_write_b32 a86, 0
    v_accvgpr_write_b32 a87, 0
    v_accvgpr_write_b32 a88, 0
    v_accvgpr_write_b32 a89, 0
    v_accvgpr_write_b32 a90, 0
    v_accvgpr_write_b32 a91, 0
    v_accvgpr_write_b32 a92, 0
    v_accvgpr_write_b32 a93, 0
    v_accvgpr_write_b32 a94, 0
    v_accvgpr_write_b32 a95, 0
    v_accvgpr_write_b32 a96, 0
    v_accvgpr_write_b32 a97, 0
    v_accvgpr_write_b32 a98, 0
    v_accvgpr_write_b32 a99, 0
    v_accvgpr_write_b32 a100, 0
    v_accvgpr_write_b32 a101, 0
    v_accvgpr_write_b32 a102, 0
    v_accvgpr_write_b32 a103, 0
    v_accvgpr_write_b32 a104, 0
    v_accvgpr_write_b32 a105, 0
    v_accvgpr_write_b32 a106, 0
    v_accvgpr_write_b32 a107, 0
    v_accvgpr_write_b32 a108, 0
    v_accvgpr_write_b32 a109, 0
    v_accvgpr_write_b32 a110, 0
    v_accvgpr_write_b32 a111, 0
    v_accvgpr_write_b32 a112, 0
    v_accvgpr_write_b32 a113, 0
    v_accvgpr_write_b32 a114, 0
    v_accvgpr_write_b32 a115, 0
    v_accvgpr_write_b32 a116, 0
    v_accvgpr_write_b32 a117, 0
    v_accvgpr_write_b32 a118, 0
    v_accvgpr_write_b32 a119, 0
    v_accvgpr_write_b32 a120, 0
    v_accvgpr_write_b32 a121, 0
    v_accvgpr_write_b32 a122, 0
    v_accvgpr_write_b32 a123, 0
    v_accvgpr_write_b32 a124, 0
    v_accvgpr_write_b32 a125, 0
    v_accvgpr_write_b32 a126, 0
    v_accvgpr_write_b32 a127, 0
    v_accvgpr_write_b32 a128, 0
    v_accvgpr_write_b32 a129, 0
    v_accvgpr_write_b32 a130, 0
    v_accvgpr_write_b32 a131, 0
    v_accvgpr_write_b32 a132, 0
    v_accvgpr_write_b32 a133, 0
    v_accvgpr_write_b32 a134, 0
    v_accvgpr_write_b32 a135, 0
    v_accvgpr_write_b32 a136, 0
    v_accvgpr_write_b32 a137, 0
    v_accvgpr_write_b32 a138, 0
    v_accvgpr_write_b32 a139, 0
    v_accvgpr_write_b32 a140, 0
    v_accvgpr_write_b32 a141, 0
    v_accvgpr_write_b32 a142, 0
    v_accvgpr_write_b32 a143, 0
    v_accvgpr_write_b32 a144, 0
    v_accvgpr_write_b32 a145, 0
    v_accvgpr_write_b32 a146, 0
    v_accvgpr_write_b32 a147, 0
    v_accvgpr_write_b32 a148, 0
    v_accvgpr_write_b32 a149, 0
    v_accvgpr_write_b32 a150, 0
    v_accvgpr_write_b32 a151, 0
    v_accvgpr_write_b32 a152, 0
    v_accvgpr_write_b32 a153, 0
    v_accvgpr_write_b32 a154, 0
    v_accvgpr_write_b32 a155, 0
    v_accvgpr_write_b32 a156, 0
    v_accvgpr_write_b32 a157, 0
    v_accvgpr_write_b32 a158, 0
    v_accvgpr_write_b32 a159, 0
    v_accvgpr_write_b32 a160, 0
    v_accvgpr_write_b32 a161, 0
    v_accvgpr_write_b32 a162, 0
    v_accvgpr_write_b32 a163, 0
    v_accvgpr_write_b32 a164, 0
    v_accvgpr_write_b32 a165, 0
    v_accvgpr_write_b32 a166, 0
    v_accvgpr_write_b32 a167, 0
    v_accvgpr_write_b32 a168, 0
    v_accvgpr_write_b32 a169, 0
    v_accvgpr_write_b32 a170, 0
    v_accvgpr_write_b32 a171, 0
    v_accvgpr_write_b32 a172, 0
    v_accvgpr_write_b32 a173, 0
    v_accvgpr_write_b32 a174, 0
    v_accvgpr_write_b32 a175, 0
    v_accvgpr_write_b32 a176, 0
    v_accvgpr_write_b32 a177, 0
    v_accvgpr_write_b32 a178, 0
    v_accvgpr_write_b32 a179, 0
    v_accvgpr_write_b32 a180, 0
    v_accvgpr_write_b32 a181, 0
    v_accvgpr_write_b32 a182, 0
    v_accvgpr_write_b32 a183, 0
    v_accvgpr_write_b32 a184, 0
    v_accvgpr_write_b32 a185, 0
    v_accvgpr_write_b32 a186, 0
    v_accvgpr_write_b32 a187, 0
    v_accvgpr_write_b32 a188, 0
    v_accvgpr_write_b32 a189, 0
    v_accvgpr_write_b32 a190, 0
    v_accvgpr_write_b32 a191, 0
    v_accvgpr_write_b32 a192, 0
    v_accvgpr_write_b32 a193, 0
    v_accvgpr_write_b32 a194, 0
    v_accvgpr_write_b32 a195, 0
    v_accvgpr_write_b32 a196, 0
    v_accvgpr_write_b32 a197, 0
    v_accvgpr_write_b32 a198, 0
    v_accvgpr_write_b32 a199, 0
    v_accvgpr_write_b32 a200, 0
    v_accvgpr_write_b32 a201, 0
    v_accvgpr_write_b32 a202, 0
    v_accvgpr_write_b32 a203, 0
    v_accvgpr_write_b32 a204, 0
    v_accvgpr_write_b32 a205, 0
    v_accvgpr_write_b32 a206, 0
    v_accvgpr_write_b32 a207, 0
    v_accvgpr_write_b32 a208, 0
    v_accvgpr_write_b32 a209, 0
    v_accvgpr_write_b32 a210, 0
    v_accvgpr_write_b32 a211, 0
    v_accvgpr_write_b32 a212, 0
    v_accvgpr_write_b32 a213, 0
    v_accvgpr_write_b32 a214, 0
    v_accvgpr_write_b32 a215, 0
    v_accvgpr_write_b32 a216, 0
    v_accvgpr_write_b32 a217, 0
    v_accvgpr_write_b32 a218, 0
    v_accvgpr_write_b32 a219, 0
    v_accvgpr_write_b32 a220, 0
    v_accvgpr_write_b32 a221, 0
    v_accvgpr_write_b32 a222, 0
    v_accvgpr_write_b32 a223, 0
    v_accvgpr_write_b32 a224, 0
    v_accvgpr_write_b32 a225, 0
    v_accvgpr_write_b32 a226, 0
    v_accvgpr_write_b32 a227, 0
    v_accvgpr_write_b32 a228, 0
    v_accvgpr_write_b32 a229, 0
    v_accvgpr_write_b32 a230, 0
    v_accvgpr_write_b32 a231, 0
    v_accvgpr_write_b32 a232, 0
    v_accvgpr_write_b32 a233, 0
    v_accvgpr_write_b32 a234, 0
    v_accvgpr_write_b32 a235, 0
    v_accvgpr_write_b32 a236, 0
    v_accvgpr_write_b32 a237, 0
    v_accvgpr_write_b32 a238, 0
    v_accvgpr_write_b32 a239, 0
    v_accvgpr_write_b32 a240, 0
    v_accvgpr_write_b32 a241, 0
    v_accvgpr_write_b32 a242, 0
    v_accvgpr_write_b32 a243, 0
    v_accvgpr_write_b32 a244, 0
    v_accvgpr_write_b32 a245, 0
    v_accvgpr_write_b32 a246, 0
    v_accvgpr_write_b32 a247, 0
    v_accvgpr_write_b32 a248, 0
    v_accvgpr_write_b32 a249, 0
    v_accvgpr_write_b32 a250, 0
    v_accvgpr_write_b32 a251, 0
    v_accvgpr_write_b32 a252, 0
    v_accvgpr_write_b32 a253, 0
    v_accvgpr_write_b32 a254, 0
    v_accvgpr_write_b32 a255, 0
.p2align 6
L_gemm_v:
    s_waitcnt lgkmcnt(0)
    v_mfma_f32_32x32x16_bf16 a[0:15], v[24:27], v[40:43], a[0:15]
    ds_read_b128 v[56:59], v11 offset:0
    v_mfma_f32_32x32x16_bf16 a[16:31], v[24:27], v[44:47], a[16:31]
    ds_read_b128 v[60:63], v11 offset:2048
    v_mfma_f32_32x32x16_bf16 a[32:47], v[24:27], v[48:51], a[32:47]
    ds_read_b128 v[64:67], v11 offset:4096
    v_mfma_f32_32x32x16_bf16 a[48:63], v[24:27], v[52:55], a[48:63]
    ds_read_b128 v[68:71], v11 offset:6144
    v_mfma_f32_32x32x16_bf16 a[64:79], v[28:31], v[40:43], a[64:79]
    ds_read_b64_tr_b16 v[72:73], v14 offset:8192
    v_mfma_f32_32x32x16_bf16 a[80:95], v[28:31], v[44:47], a[80:95]
    ds_read_b64_tr_b16 v[74:75], v14 offset:10240
    v_mfma_f32_32x32x16_bf16 a[96:111], v[28:31], v[48:51], a[96:111]
    ds_read_b64_tr_b16 v[76:77], v15 offset:8192
    v_mfma_f32_32x32x16_bf16 a[112:127], v[28:31], v[52:55], a[112:127]
    ds_read_b64_tr_b16 v[78:79], v15 offset:10240
    v_mfma_f32_32x32x16_bf16 a[128:143], v[32:35], v[40:43], a[128:143]
    ds_read_b64_tr_b16 v[80:81], v16 offset:8192
    v_mfma_f32_32x32x16_bf16 a[144:159], v[32:35], v[44:47], a[144:159]
    ds_read_b64_tr_b16 v[82:83], v16 offset:10240
    v_mfma_f32_32x32x16_bf16 a[160:175], v[32:35], v[48:51], a[160:175]
    ds_read_b64_tr_b16 v[84:85], v17 offset:8192
    v_mfma_f32_32x32x16_bf16 a[176:191], v[32:35], v[52:55], a[176:191]
    ds_read_b64_tr_b16 v[86:87], v17 offset:10240
    v_mfma_f32_32x32x16_bf16 a[192:207], v[36:39], v[40:43], a[192:207]
    v_mfma_f32_32x32x16_bf16 a[208:223], v[36:39], v[44:47], a[208:223]
    v_mfma_f32_32x32x16_bf16 a[224:239], v[36:39], v[48:51], a[224:239]
    v_mfma_f32_32x32x16_bf16 a[240:255], v[36:39], v[52:55], a[240:255]
    s_waitcnt vmcnt(8)
    s_waitcnt lgkmcnt(0)
    s_barrier
    s_add_u32 s26, s25, 98304
    v_mfma_f32_32x32x16_bf16 a[0:15], v[56:59], v[72:75], a[0:15]
    ds_read_b128 v[24:27], v10 offset:32768
    v_mfma_f32_32x32x16_bf16 a[16:31], v[56:59], v[76:79], a[16:31]
    ds_read_b128 v[28:31], v10 offset:34816
    v_mfma_f32_32x32x16_bf16 a[32:47], v[56:59], v[80:83], a[32:47]
    ds_read_b128 v[32:35], v10 offset:36864
    s_add_u32 m0, s26, 0
    s_nop 0
    v_mfma_f32_32x32x16_bf16 a[48:63], v[56:59], v[84:87], a[48:63]
    ds_read_b128 v[36:39], v10 offset:38912
    buffer_load_dwordx4 v2, s[8:11], s16 offen lds
    s_add_u32 m0, s26, 1024
    v_mfma_f32_32x32x16_bf16 a[64:79], v[60:63], v[72:75], a[64:79]
    ds_read_b64_tr_b16 v[40:41], v14 offset:32768
    s_nop 0
    buffer_load_dwordx4 v3, s[8:11], s16 offen lds
    v_mfma_f32_32x32x16_bf16 a[80:95], v[60:63], v[76:79], a[80:95]
    ds_read_b64_tr_b16 v[42:43], v14 offset:34816
    s_add_u32 m0, s26, 2048
    s_nop 0
    v_mfma_f32_32x32x16_bf16 a[96:111], v[60:63], v[80:83], a[96:111]
    ds_read_b64_tr_b16 v[44:45], v15 offset:32768
    buffer_load_dwordx4 v4, s[8:11], s16 offen lds
    s_add_u32 m0, s26, 3072
    v_mfma_f32_32x32x16_bf16 a[112:127], v[60:63], v[84:87], a[112:127]
    ds_read_b64_tr_b16 v[46:47], v15 offset:34816
    s_nop 0
    buffer_load_dwordx4 v5, s[8:11], s16 offen lds
    v_mfma_f32_32x32x16_bf16 a[128:143], v[64:67], v[72:75], a[128:143]
    ds_read_b64_tr_b16 v[48:49], v16 offset:32768
    s_add_u32 m0, s26, 16384
    s_nop 0
    v_mfma_f32_32x32x16_bf16 a[144:159], v[64:67], v[76:79], a[144:159]
    ds_read_b64_tr_b16 v[50:51], v16 offset:34816
    buffer_load_dwordx4 v6, s[12:15], s17 offen lds
    s_add_u32 m0, s26, 17408
    v_mfma_f32_32x32x16_bf16 a[160:175], v[64:67], v[80:83], a[160:175]
    ds_read_b64_tr_b16 v[52:53], v17 offset:32768
    s_nop 0
    buffer_load_dwordx4 v7, s[12:15], s17 offen lds
    v_mfma_f32_32x32x16_bf16 a[176:191], v[64:67], v[84:87], a[176:191]
    ds_read_b64_tr_b16 v[54:55], v17 offset:34816
    s_add_u32 m0, s26, 18432
    s_nop 0
    v_mfma_f32_32x32x16_bf16 a[192:207], v[68:71], v[72:75], a[192:207]
    buffer_load_dwordx4 v8, s[12:15], s17 offen lds
    s_add_u32 m0, s26, 19456
    v_mfma_f32_32x32x16_bf16 a[208:223], v[68:71], v[76:79], a[208:223]
    s_nop 0
    buffer_load_dwordx4 v9, s[12:15], s17 offen lds
    v_mfma_f32_32x32x16_bf16 a[224:239], v[68:71], v[80:83], a[224:239]
    s_add_u32 s16, s16, s27
    s_add_u32 s17, s17, s28
    v_mfma_f32_32x32x16_bf16 a[240:255], v[68:71], v[84:87], a[240:255]
    s_waitcnt lgkmcnt(0)
    v_mfma_f32_32x32x16_bf16 a[0:15], v[24:27], v[40:43], a[0:15]
    ds_read_b128 v[56:59], v11 offset:32768
    v_mfma_f32_32x32x16_bf16 a[16:31], v[24:27], v[44:47], a[16:31]
    ds_read_b128 v[60:63], v11 offset:34816
    v_mfma_f32_32x32x16_bf16 a[32:47], v[24:27], v[48:51], a[32:47]
    ds_read_b128 v[64:67], v11 offset:36864
    v_mfma_f32_32x32x16_bf16 a[48:63], v[24:27], v[52:55], a[48:63]
    ds_read_b128 v[68:71], v11 offset:38912
    v_mfma_f32_32x32x16_bf16 a[64:79], v[28:31], v[40:43], a[64:79]
    ds_read_b64_tr_b16 v[72:73], v14 offset:40960
    v_mfma_f32_32x32x16_bf16 a[80:95], v[28:31], v[44:47], a[80:95]
    ds_read_b64_tr_b16 v[74:75], v14 offset:43008
    v_mfma_f32_32x32x16_bf16 a[96:111], v[28:31], v[48:51], a[96:111]
    ds_read_b64_tr_b16 v[76:77], v15 offset:40960
    v_mfma_f32_32x32x16_bf16 a[112:127], v[28:31], v[52:55], a[112:127]
    ds_read_b64_tr_b16 v[78:79], v15 offset:43008
    v_mfma_f32_32x32x16_bf16 a[128:143], v[32:35], v[40:43], a[128:143]
    ds_read_b64_tr_b16 v[80:81], v16 offset:40960
    v_mfma_f32_32x32x16_bf16 a[144:159], v[32:35], v[44:47], a[144:159]
    ds_read_b64_tr_b16 v[82:83], v16 offset:43008
    v_mfma_f32_32x32x16_bf16 a[160:175], v[32:35], v[48:51], a[160:175]
    ds_read_b64_tr_b16 v[84:85], v17 offset:40960
    v_mfma_f32_32x32x16_bf16 a[176:191], v[32:35], v[52:55], a[176:191]
    ds_read_b64_tr_b16 v[86:87], v17 offset:43008
    v_mfma_f32_32x32x16_bf16 a[192:207], v[36:39], v[40:43], a[192:207]
    v_mfma_f32_32x32x16_bf16 a[208:223], v[36:39], v[44:47], a[208:223]
    v_mfma_f32_32x32x16_bf16 a[224:239], v[36:39], v[48:51], a[224:239]
    v_mfma_f32_32x32x16_bf16 a[240:255], v[36:39], v[52:55], a[240:255]
    s_waitcnt vmcnt(8)
    s_waitcnt lgkmcnt(0)
    s_barrier
    s_add_u32 s26, s25, 0
    v_mfma_f32_32x32x16_bf16 a[0:15], v[56:59], v[72:75], a[0:15]
    ds_read_b128 v[24:27], v12 offset:0
    v_mfma_f32_32x32x16_bf16 a[16:31], v[56:59], v[76:79], a[16:31]
    ds_read_b128 v[28:31], v12 offset:2048
    v_mfma_f32_32x32x16_bf16 a[32:47], v[56:59], v[80:83], a[32:47]
    ds_read_b128 v[32:35], v12 offset:4096
    s_add_u32 m0, s26, 0
    s_nop 0
    v_mfma_f32_32x32x16_bf16 a[48:63], v[56:59], v[84:87], a[48:63]
    ds_read_b128 v[36:39], v12 offset:6144
    buffer_load_dwordx4 v2, s[8:11], s16 offen lds
    s_add_u32 m0, s26, 1024
    v_mfma_f32_32x32x16_bf16 a[64:79], v[60:63], v[72:75], a[64:79]
    ds_read_b64_tr_b16 v[40:41], v18 offset:0
    s_nop 0
    buffer_load_dwordx4 v3, s[8:11], s16 offen lds
    v_mfma_f32_32x32x16_bf16 a[80:95], v[60:63], v[76:79], a[80:95]
    ds_read_b64_tr_b16 v[42:43], v18 offset:2048
    s_add_u32 m0, s26, 2048
    s_nop 0
    v_mfma_f32_32x32x16_bf16 a[96:111], v[60:63], v[80:83], a[96:111]
    ds_read_b64_tr_b16 v[44:45], v19 offset:0
    buffer_load_dwordx4 v4, s[8:11], s16 offen lds
    s_add_u32 m0, s26, 3072
    v_mfma_f32_32x32x16_bf16 a[112:127], v[60:63], v[84:87], a[112:127]
    ds_read_b64_tr_b16 v[46:47], v19 offset:2048
    s_nop 0
    buffer_load_dwordx4 v5, s[8:11], s16 offen lds
    v_mfma_f32_32x32x16_bf16 a[128:143], v[64:67], v[72:75], a[128:143]
    ds_read_b64_tr_b16 v[48:49], v20 offset:0
    s_add_u32 m0, s26, 16384
    s_nop 0
    v_mfma_f32_32x32x16_bf16 a[144:159], v[64:67], v[76:79], a[144:159]
    ds_read_b64_tr_b16 v[50:51], v20 offset:2048
    buffer_load_dwordx4 v6, s[12:15], s17 offen lds
    s_add_u32 m0, s26, 17408
    v_mfma_f32_32x32x16_bf16 a[160:175], v[64:67], v[80:83], a[160:175]
    ds_read_b64_tr_b16 v[52:53], v21 offset:0
    s_nop 0
    buffer_load_dwordx4 v7, s[12:15], s17 offen lds
    v_mfma_f32_32x32x16_bf16 a[176:191], v[64:67], v[84:87], a[176:191]
    ds_read_b64_tr_b16 v[54:55], v21 offset:2048
    s_add_u32 m0, s26, 18432
    s_nop 0
    v_mfma_f32_32x32x16_bf16 a[192:207], v[68:71], v[72:75], a[192:207]
    buffer_load_dwordx4 v8, s[12:15], s17 offen lds
    s_add_u32 m0, s26, 19456
    v_mfma_f32_32x32x16_bf16 a[208:223], v[68:71], v[76:79], a[208:223]
    s_nop 0
    buffer_load_dwordx4 v9, s[12:15], s17 offen lds
    v_mfma_f32_32x32x16_bf16 a[224:239], v[68:71], v[80:83], a[224:239]
    s_add_u32 s16, s16, s27
    s_add_u32 s17, s17, s28
    v_mfma_f32_32x32x16_bf16 a[240:255], v[68:71], v[84:87], a[240:255]
    s_waitcnt lgkmcnt(0)
    v_mfma_f32_32x32x16_bf16 a[0:15], v[24:27], v[40:43], a[0:15]
    ds_read_b128 v[56:59], v13 offset:0
    v_mfma_f32_32x32x16_bf16 a[16:31], v[24:27], v[44:47], a[16:31]
    ds_read_b128 v[60:63], v13 offset:2048
    v_mfma_f32_32x32x16_bf16 a[32:47], v[24:27], v[48:51], a[32:47]
    ds_read_b128 v[64:67], v13 offset:4096
    v_mfma_f32_32x32x16_bf16 a[48:63], v[24:27], v[52:55], a[48:63]
    ds_read_b128 v[68:71], v13 offset:6144
    v_mfma_f32_32x32x16_bf16 a[64:79], v[28:31], v[40:43], a[64:79]
    ds_read_b64_tr_b16 v[72:73], v18 offset:8192
    v_mfma_f32_32x32x16_bf16 a[80:95], v[28:31], v[44:47], a[80:95]
    ds_read_b64_tr_b16 v[74:75], v18 offset:10240
    v_mfma_f32_32x32x16_bf16 a[96:111], v[28:31], v[48:51], a[96:111]
    ds_read_b64_tr_b16 v[76:77], v19 offset:8192
    v_mfma_f32_32x32x16_bf16 a[112:127], v[28:31], v[52:55], a[112:127]
    ds_read_b64_tr_b16 v[78:79], v19 offset:10240
    v_mfma_f32_32x32x16_bf16 a[128:143], v[32:35], v[40:43], a[128:143]
    ds_read_b64_tr_b16 v[80:81], v20 offset:8192
    v_mfma_f32_32x32x16_bf16 a[144:159], v[32:35], v[44:47], a[144:159]
    ds_read_b64_tr_b16 v[82:83], v20 offset:10240
    v_mfma_f32_32x32x16_bf16 a[160:175], v[32:35], v[48:51], a[160:175]
    ds_read_b64_tr_b16 v[84:85], v21 offset:8192
    v_mfma_f32_32x32x16_bf16 a[176:191], v[32:35], v[52:55], a[176:191]
    ds_read_b64_tr_b16 v[86:87], v21 offset:10240
    v_mfma_f32_32x32x16_bf16 a[192:207], v[36:39], v[40:43], a[192:207]
    v_mfma_f32_32x32x16_bf16 a[208:223], v[36:39], v[44:47], a[208:223]
    v_mfma_f32_32x32x16_bf16 a[224:239], v[36:39], v[48:51], a[224:239]
    v_mfma_f32_32x32x16_bf16 a[240:255], v[36:39], v[52:55], a[240:255]
    s_waitcnt vmcnt(8)
    s_waitcnt lgkmcnt(0)
    s_barrier
    s_add_u32 s26, s25, 32768
    v_mfma_f32_32x32x16_bf16 a[0:15], v[56:59], v[72:75], a[0:15]
    ds_read_b128 v[24:27], v12 offset:32768
    v_mfma_f32_32x32x16_bf16 a[16:31], v[56:59], v[76:79], a[16:31]
    ds_read_b128 v[28:31], v12 offset:34816
    v_mfma_f32_32x32x16_bf16 a[32:47], v[56:59], v[80:83], a[32:47]
    ds_read_b128 v[32:35], v12 offset:36864
    s_add_u32 m0, s26, 0
    s_nop 0
    v_mfma_f32_32x32x16_bf16 a[48:63], v[56:59], v[84:87], a[48:63]
    ds_read_b128 v[36:39], v12 offset:38912
    buffer_load_dwordx4 v2, s[8:11], s16 offen lds
    s_add_u32 m0, s26, 1024
    v_mfma_f32_32x32x16_bf16 a[64:79], v[60:63], v[72:75], a[64:79]
    ds_read_b64_tr_b16 v[40:41], v18 offset:32768
    s_nop 0
    buffer_load_dwordx4 v3, s[8:11], s16 offen lds
    v_mfma_f32_32x32x16_bf16 a[80:95], v[60:63], v[76:79], a[80:95]
    ds_read_b64_tr_b16 v[42:43], v18 offset:34816
    s_add_u32 m0, s26, 2048
    s_nop 0
    v_mfma_f32_32x32x16_bf16 a[96:111], v[60:63], v[80:83], a[96:111]
    ds_read_b64_tr_b16 v[44:45], v19 offset:32768
    buffer_load_dwordx4 v4, s[8:11], s16 offen lds
    s_add_u32 m0, s26, 3072
    v_mfma_f32_32x32x16_bf16 a[112:127], v[60:63], v[84:87], a[112:127]
    ds_read_b64_tr_b16 v[46:47], v19 offset:34816
    s_nop 0
    buffer_load_dwordx4 v5, s[8:11], s16 offen lds
    v_mfma_f32_32x32x16_bf16 a[128:143], v[64:67], v[72:75], a[128:143]
    ds_read_b64_tr_b16 v[48:49], v20 offset:32768
    s_add_u32 m0, s26, 16384
    s_nop 0
    v_mfma_f32_32x32x16_bf16 a[144:159], v[64:67], v[76:79], a[144:159]
    ds_read_b64_tr_b16 v[50:51], v20 offset:34816
    buffer_load_dwordx4 v6, s[12:15], s17 offen lds
    s_add_u32 m0, s26, 17408
    v_mfma_f32_32x32x16_bf16 a[160:175], v[64:67], v[80:83], a[160:175]
    ds_read_b64_tr_b16 v[52:53], v21 offset:32768
    s_nop 0
    buffer_load_dwordx4 v7, s[12:15], s17 offen lds
    v_mfma_f32_32x32x16_bf16 a[176:191], v[64:67], v[84:87], a[176:191]
    ds_read_b64_tr_b16 v[54:55], v21 offset:34816
    s_add_u32 m0, s26, 18432
    s_nop 0
    v_mfma_f32_32x32x16_bf16 a[192:207], v[68:71], v[72:75], a[192:207]
    buffer_load_dwordx4 v8, s[12:15], s17 offen lds
    s_add_u32 m0, s26, 19456
    v_mfma_f32_32x32x16_bf16 a[208:223], v[68:71], v[76:79], a[208:223]
    s_nop 0
    buffer_load_dwordx4 v9, s[12:15], s17 offen lds
    v_mfma_f32_32x32x16_bf16 a[224:239], v[68:71], v[80:83], a[224:239]
    s_add_u32 s16, s16, s27
    s_add_u32 s17, s17, s28
    v_mfma_f32_32x32x16_bf16 a[240:255], v[68:71], v[84:87], a[240:255]
    s_waitcnt lgkmcnt(0)
    v_mfma_f32_32x32x16_bf16 a[0:15], v[24:27], v[40:43], a[0:15]
    ds_read_b128 v[56:59], v13 offset:32768
    v_mfma_f32_32x32x16_bf16 a[16:31], v[24:27], v[44:47], a[16:31]
    ds_read_b128 v[60:63], v13 offset:34816
    v_mfma_f32_32x32x16_bf16 a[32:47], v[24:27], v[48:51], a[32:47]
    ds_read_b128 v[64:67], v13 offset:36864
    v_mfma_f32_32x32x16_bf16 a[48:63], v[24:27], v[52:55], a[48:63]
    ds_read_b128 v[68:71], v13 offset:38912
    v_mfma_f32_32x32x16_bf16 a[64:79], v[28:31], v[40:43], a[64:79]
    ds_read_b64_tr_b16 v[72:73], v18 offset:40960
    v_mfma_f32_32x32x16_bf16 a[80:95], v[28:31], v[44:47], a[80:95]
    ds_read_b64_tr_b16 v[74:75], v18 offset:43008
    v_mfma_f32_32x32x16_bf16 a[96:111], v[28:31], v[48:51], a[96:111]
    ds_read_b64_tr_b16 v[76:77], v19 offset:40960
    v_mfma_f32_32x32x16_bf16 a[112:127], v[28:31], v[52:55], a[112:127]
    ds_read_b64_tr_b16 v[78:79], v19 offset:43008
    v_mfma_f32_32x32x16_bf16 a[128:143], v[32:35], v[40:43], a[128:143]
    ds_read_b64_tr_b16 v[80:81], v20 offset:40960
    v_mfma_f32_32x32x16_bf16 a[144:159], v[32:35], v[44:47], a[144:159]
    ds_read_b64_tr_b16 v[82:83], v20 offset:43008
    v_mfma_f32_32x32x16_bf16 a[160:175], v[32:35], v[48:51], a[160:175]
    ds_read_b64_tr_b16 v[84:85], v21 offset:40960
    v_mfma_f32_32x32x16_bf16 a[176:191], v[32:35], v[52:55], a[176:191]
    ds_read_b64_tr_b16 v[86:87], v21 offset:43008
    v_mfma_f32_32x32x16_bf16 a[192:207], v[36:39], v[40:43], a[192:207]
    v_mfma_f32_32x32x16_bf16 a[208:223], v[36:39], v[44:47], a[208:223]
    v_mfma_f32_32x32x16_bf16 a[224:239], v[36:39], v[48:51], a[224:239]
    v_mfma_f32_32x32x16_bf16 a[240:255], v[36:39], v[52:55], a[240:255]
    s_waitcnt vmcnt(8)
    s_waitcnt lgkmcnt(0)
    s_barrier
    s_add_u32 s26, s25, 65536
    v_mfma_f32_32x32x16_bf16 a[0:15], v[56:59], v[72:75], a[0:15]
    ds_read_b128 v[24:27], v10 offset:0
    v_mfma_f32_32x32x16_bf16 a[16:31], v[56:59], v[76:79], a[16:31]
    ds_read_b128 v[28:31], v10 offset:2048
    v_mfma_f32_32x32x16_bf16 a[32:47], v[56:59], v[80:83], a[32:47]
    ds_read_b128 v[32:35], v10 offset:4096
    s_add_u32 m0, s26, 0
    s_nop 0
    v_mfma_f32_32x32x16_bf16 a[48:63], v[56:59], v[84:87], a[48:63]
    ds_read_b128 v[36:39], v10 offset:6144
    buffer_load_dwordx4 v2, s[8:11], s16 offen lds
    s_add_u32 m0, s26, 1024
    v_mfma_f32_32x32x16_bf16 a[64:79], v[60:63], v[72:75], a[64:79]
    ds_read_b64_tr_b16 v[40:41], v14 offset:0
    s_nop 0
    buffer_load_dwordx4 v3, s[8:11], s16 offen lds
    v_mfma_f32_32x32x16_bf16 a[80:95], v[60:63], v[76:79], a[80:95]
    ds_read_b64_tr_b16 v[42:43], v14 offset:2048
    s_add_u32 m0, s26, 2048
    s_nop 0
    v_mfma_f32_32x32x16_bf16 a[96:111], v[60:63], v[80:83], a[96:111]
    ds_read_b64_tr_b16 v[44:45], v15 offset:0
    buffer_load_dwordx4 v4, s[8:11], s16 offen lds
    s_add_u32 m0, s26, 3072
    v_mfma_f32_32x32x16_bf16 a[112:127], v[60:63], v[84:87], a[112:127]
    ds_read_b64_tr_b16 v[46:47], v15 offset:2048
    s_nop 0
    buffer_load_dwordx4 v5, s[8:11], s16 offen lds
    v_mfma_f32_32x32x16_bf16 a[128:143], v[64:67], v[72:75], a[128:143]
    ds_read_b64_tr_b16 v[48:49], v16 offset:0
    s_add_u32 m0, s26, 16384
    s_nop 0
    v_mfma_f32_32x32x16_bf16 a[144:159], v[64:67], v[76:79], a[144:159]
    ds_read_b64_tr_b16 v[50:51], v16 offset:2048
    buffer_load_dwordx4 v6, s[12:15], s17 offen lds
    s_add_u32 m0, s26, 17408
    v_mfma_f32_32x32x16_bf16 a[160:175], v[64:67], v[80:83], a[160:175]
    ds_read_b64_tr_b16 v[52:53], v17 offset:0
    s_nop 0
    buffer_load_dwordx4 v7, s[12:15], s17 offen lds
    v_mfma_f32_32x32x16_bf16 a[176:191], v[64:67], v[84:87], a[176:191]
    ds_read_b64_tr_b16 v[54:55], v17 offset:2048
    s_add_u32 m0, s26, 18432
    s_nop 0
    v_mfma_f32_32x32x16_bf16 a[192:207], v[68:71], v[72:75], a[192:207]
    buffer_load_dwordx4 v8, s[12:15], s17 offen lds
    s_add_u32 m0, s26, 19456
    v_mfma_f32_32x32x16_bf16 a[208:223], v[68:71], v[76:79], a[208:223]
    s_nop 0
    buffer_load_dwordx4 v9, s[12:15], s17 offen lds
    v_mfma_f32_32x32x16_bf16 a[224:239], v[68:71], v[80:83], a[224:239]
    s_add_u32 s16, s16, s27
    s_add_u32 s17, s17, s28
    v_mfma_f32_32x32x16_bf16 a[240:255], v[68:71], v[84:87], a[240:255]
    s_add_u32 s21, s21, 4
    s_cmp_lt_u32 s21, s20
    s_cbranch_scc1 L_gemm_v
    s_waitcnt vmcnt(0) lgkmcnt(0)
    s_nop 15
    s_barrier
    s_lshl_b32 s38, s35, 21
    s_lshl_b32 s39, s37, 14
    s_add_u32 s38, s38, s39
    s_add_u32 s38, s38, 33554432
    s_add_u32 s42, s32, s38
    s_addc_u32 s43, s33, 0
    s_lshl_b32 s25, s22, 15
    v_and_b32 v88, 31, v1
    v_lshlrev_b32 v90, 6, v88
    v_lshrrev_b32 v89, 5, v1
    v_bfe_u32 v92, v1, 1, 2
    v_xor_b32 v89, v89, v92
    v_add_u32 v90, s25, v90
    v_lshl_add_u32 v93, v89, 4, v90
    v_xor_b32 v89, 2, v89
    v_lshl_add_u32 v94, v89, 4, v90
    v_accvgpr_read_b32 v24, a0
    v_accvgpr_read_b32 v25, a1
    v_accvgpr_read_b32 v26, a2
    v_accvgpr_read_b32 v27, a3
    v_accvgpr_read_b32 v28, a4
    v_accvgpr_read_b32 v29, a5
    v_accvgpr_read_b32 v30, a6
    v_accvgpr_read_b32 v31, a7
    v_accvgpr_read_b32 v32, a8
    v_accvgpr_read_b32 v33, a9
    v_accvgpr_read_b32 v34, a10
    v_accvgpr_read_b32 v35, a11
    v_accvgpr_read_b32 v36, a12
    v_accvgpr_read_b32 v37, a13
    v_accvgpr_read_b32 v38, a14
    v_accvgpr_read_b32 v39, a15
    v_cvt_pk_bf16_f32 v40, v24, v25
    v_cvt_pk_bf16_f32 v41, v26, v27
    v_cvt_pk_bf16_f32 v42, v32, v33
    v_cvt_pk_bf16_f32 v43, v34, v35
    v_cvt_pk_bf16_f32 v44, v28, v29
    v_cvt_pk_bf16_f32 v45, v30, v31
    v_cvt_pk_bf16_f32 v46, v36, v37
    v_cvt_pk_bf16_f32 v47, v38, v39
    ds_write_b128 v93, v[40:43] offset:0
    ds_write_b128 v94, v[44:47] offset:0
    v_accvgpr_read_b32 v48, a16
    v_accvgpr_read_b32 v49, a17
    v_accvgpr_read_b32 v50, a18
    v_accvgpr_read_b32 v51, a19
    v_accvgpr_read_b32 v52, a20
    v_accvgpr_read_b32 v53, a21
    v_accvgpr_read_b32 v54, a22
    v_accvgpr_read_b32 v55, a23
    v_accvgpr_read_b32 v56, a24
    v_accvgpr_read_b32 v57, a25
    v_accvgpr_read_b32 v58, a26
    v_accvgpr_read_b32 v59, a27
    v_accvgpr_read_b32 v60, a28
    v_accvgpr_read_b32 v61, a29
    v_accvgpr_read_b32 v62, a30
    v_accvgpr_read_b32 v63, a31
    v_cvt_pk_bf16_f32 v64, v48, v49
    v_cvt_pk_bf16_f32 v65, v50, v51
    v_cvt_pk_bf16_f32 v66, v56, v57
    v_cvt_pk_bf16_f32 v67, v58, v59
    v_cvt_pk_bf16_f32 v68, v52, v53
    v_cvt_pk_bf16_f32 v69, v54, v55
    v_cvt_pk_bf16_f32 v70, v60, v61
    v_cvt_pk_bf16_f32 v71, v62, v63
    ds_write_b128 v93, v[64:67] offset:2048
    ds_write_b128 v94, v[68:71] offset:2048
    v_accvgpr_read_b32 v24, a32
    v_accvgpr_read_b32 v25, a33
    v_accvgpr_read_b32 v26, a34
    v_accvgpr_read_b32 v27, a35
    v_accvgpr_read_b32 v28, a36
    v_accvgpr_read_b32 v29, a37
    v_accvgpr_read_b32 v30, a38
    v_accvgpr_read_b32 v31, a39
    v_accvgpr_read_b32 v32, a40
    v_accvgpr_read_b32 v33, a41
    v_accvgpr_read_b32 v34, a42
    v_accvgpr_read_b32 v35, a43
    v_accvgpr_read_b32 v36, a44
    v_accvgpr_read_b32 v37, a45
    v_accvgpr_read_b32 v38, a46
    v_accvgpr_read_b32 v39, a47
    v_cvt_pk_bf16_f32 v40, v24, v25
    v_cvt_pk_bf16_f32 v41, v26, v27
    v_cvt_pk_bf16_f32 v42, v32, v33
    v_cvt_pk_bf16_f32 v43, v34, v35
    v_cvt_pk_bf16_f32 v44, v28, v29
    v_cvt_pk_bf16_f32 v45, v30, v31
    v_cvt_pk_bf16_f32 v46, v36, v37
    v_cvt_pk_bf16_f32 v47, v38, v39
    ds_write_b128 v93, v[40:43] offset:4096
    ds_write_b128 v94, v[44:47] offset:4096
    v_accvgpr_read_b32 v48, a48
    v_accvgpr_read_b32 v49, a49
    v_accvgpr_read_b32 v50, a50
    v_accvgpr_read_b32 v51, a51
    v_accvgpr_read_b32 v52, a52
    v_accvgpr_read_b32 v53, a53
    v_accvgpr_read_b32 v54, a54
    v_accvgpr_read_b32 v55, a55
    v_accvgpr_read_b32 v56, a56
    v_accvgpr_read_b32 v57, a57
    v_accvgpr_read_b32 v58, a58
    v_accvgpr_read_b32 v59, a59
    v_accvgpr_read_b32 v60, a60
    v_accvgpr_read_b32 v61, a61
    v_accvgpr_read_b32 v62, a62
    v_accvgpr_read_b32 v63, a63
    v_cvt_pk_bf16_f32 v64, v48, v49
    v_cvt_pk_bf16_f32 v65, v50, v51
    v_cvt_pk_bf16_f32 v66, v56, v57
    v_cvt_pk_bf16_f32 v67, v58, v59
    v_cvt_pk_bf16_f32 v68, v52, v53
    v_cvt_pk_bf16_f32 v69, v54, v55
    v_cvt_pk_bf16_f32 v70, v60, v61
    v_cvt_pk_bf16_f32 v71, v62, v63
    ds_write_b128 v93, v[64:67] offset:6144
    ds_write_b128 v94, v[68:71] offset:6144
    v_accvgpr_read_b32 v24, a64
    v_accvgpr_read_b32 v25, a65
    v_accvgpr_read_b32 v26, a66
    v_accvgpr_read_b32 v27, a67
    v_accvgpr_read_b32 v28, a68
    v_accvgpr_read_b32 v29, a69
    v_accvgpr_read_b32 v30, a70
    v_accvgpr_read_b32 v31, a71
    v_accvgpr_read_b32 v32, a72
    v_accvgpr_read_b32 v33, a73
    v_accvgpr_read_b32 v34, a74
    v_accvgpr_read_b32 v35, a75
    v_accvgpr_read_b32 v36, a76
    v_accvgpr_read_b32 v37, a77
    v_accvgpr_read_b32 v38, a78
    v_accvgpr_read_b32 v39, a79
    v_cvt_pk_bf16_f32 v40, v24, v25
    v_cvt_pk_bf16_f32 v41, v26, v27
    v_cvt_pk_bf16_f32 v42, v32, v33
    v_cvt_pk_bf16_f32 v43, v34, v35
    v_cvt_pk_bf16_f32 v44, v28, v29
    v_cvt_pk_bf16_f32 v45, v30, v31
    v_cvt_pk_bf16_f32 v46, v36, v37
    v_cvt_pk_bf16_f32 v47, v38, v39
    ds_write_b128 v93, v[40:43] offset:8192
    ds_write_b128 v94, v[44:47] offset:8192
    v_accvgpr_read_b32 v48, a80
    v_accvgpr_read_b32 v49, a81
    v_accvgpr_read_b32 v50, a82
    v_accvgpr_read_b32 v51, a83
    v_accvgpr_read_b32 v52, a84
    v_accvgpr_read_b32 v53, a85
    v_accvgpr_read_b32 v54, a86
    v_accvgpr_read_b32 v55, a87
    v_accvgpr_read_b32 v56, a88
    v_accvgpr_read_b32 v57, a89
    v_accvgpr_read_b32 v58, a90
    v_accvgpr_read_b32 v59, a91
    v_accvgpr_read_b32 v60, a92
    v_accvgpr_read_b32 v61, a93
    v_accvgpr_read_b32 v62, a94
    v_accvgpr_read_b32 v63, a95
    v_cvt_pk_bf16_f32 v64, v48, v49
    v_cvt_pk_bf16_f32 v65, v50, v51
    v_cvt_pk_bf16_f32 v66, v56, v57
    v_cvt_pk_bf16_f32 v67, v58, v59
    v_cvt_pk_bf16_f32 v68, v52, v53
    v_cvt_pk_bf16_f32 v69, v54, v55
    v_cvt_pk_bf16_f32 v70, v60, v61
    v_cvt_pk_bf16_f32 v71, v62, v63
    ds_write_b128 v93, v[64:67] offset:10240
    ds_write_b128 v94, v[68:71] offset:10240
    v_accvgpr_read_b32 v24, a96
    v_accvgpr_read_b32 v25, a97
    v_accvgpr_read_b32 v26, a98
    v_accvgpr_read_b32 v27, a99
    v_accvgpr_read_b32 v28, a100
    v_accvgpr_read_b32 v29, a101
    v_accvgpr_read_b32 v30, a102
    v_accvgpr_read_b32 v31, a103
    v_accvgpr_read_b32 v32, a104
    v_accvgpr_read_b32 v33, a105
    v_accvgpr_read_b32 v34, a106
    v_accvgpr_read_b32 v35, a107
    v_accvgpr_read_b32 v36, a108
    v_accvgpr_read_b32 v37, a109
    v_accvgpr_read_b32 v38, a110
    v_accvgpr_read_b32 v39, a111
    v_cvt_pk_bf16_f32 v40, v24, v25
    v_cvt_pk_bf16_f32 v41, v26, v27
    v_cvt_pk_bf16_f32 v42, v32, v33
    v_cvt_pk_bf16_f32 v43, v34, v35
    v_cvt_pk_bf16_f32 v44, v28, v29
    v_cvt_pk_bf16_f32 v45, v30, v31
    v_cvt_pk_bf16_f32 v46, v36, v37
    v_cvt_pk_bf16_f32 v47, v38, v39
    ds_write_b128 v93, v[40:43] offset:12288
    ds_write_b128 v94, v[44:47] offset:12288
    v_accvgpr_read_b32 v48, a112
    v_accvgpr_read_b32 v49, a113
    v_accvgpr_read_b32 v50, a114
    v_accvgpr_read_b32 v51, a115
    v_accvgpr_read_b32 v52, a116
    v_accvgpr_read_b32 v53, a117
    v_accvgpr_read_b32 v54, a118
    v_accvgpr_read_b32 v55, a119
    v_accvgpr_read_b32 v56, a120
    v_accvgpr_read_b32 v57, a121
    v_accvgpr_read_b32 v58, a122
    v_accvgpr_read_b32 v59, a123
    v_accvgpr_read_b32 v60, a124
    v_accvgpr_read_b32 v61, a125
    v_accvgpr_read_b32 v62, a126
    v_accvgpr_read_b32 v63, a127
    v_cvt_pk_bf16_f32 v64, v48, v49
    v_cvt_pk_bf16_f32 v65, v50, v51
    v_cvt_pk_bf16_f32 v66, v56, v57
    v_cvt_pk_bf16_f32 v67, v58, v59
    v_cvt_pk_bf16_f32 v68, v52, v53
    v_cvt_pk_bf16_f32 v69, v54, v55
    v_cvt_pk_bf16_f32 v70, v60, v61
    v_cvt_pk_bf16_f32 v71, v62, v63
    ds_write_b128 v93, v[64:67] offset:14336
    ds_write_b128 v94, v[68:71] offset:14336
    v_accvgpr_read_b32 v24, a128
    v_accvgpr_read_b32 v25, a129
    v_accvgpr_read_b32 v26, a130
    v_accvgpr_read_b32 v27, a131
    v_accvgpr_read_b32 v28, a132
    v_accvgpr_read_b32 v29, a133
    v_accvgpr_read_b32 v30, a134
    v_accvgpr_read_b32 v31, a135
    v_accvgpr_read_b32 v32, a136
    v_accvgpr_read_b32 v33, a137
    v_accvgpr_read_b32 v34, a138
    v_accvgpr_read_b32 v35, a139
    v_accvgpr_read_b32 v36, a140
    v_accvgpr_read_b32 v37, a141
    v_accvgpr_read_b32 v38, a142
    v_accvgpr_read_b32 v39, a143
    v_cvt_pk_bf16_f32 v40, v24, v25
    v_cvt_pk_bf16_f32 v41, v26, v27
    v_cvt_pk_bf16_f32 v42, v32, v33
    v_cvt_pk_bf16_f32 v43, v34, v35
    v_cvt_pk_bf16_f32 v44, v28, v29
    v_cvt_pk_bf16_f32 v45, v30, v31
    v_cvt_pk_bf16_f32 v46, v36, v37
    v_cvt_pk_bf16_f32 v47, v38, v39
    ds_write_b128 v93, v[40:43] offset:16384
    ds_write_b128 v94, v[44:47] offset:16384
    v_accvgpr_read_b32 v48, a144
    v_accvgpr_read_b32 v49, a145
    v_accvgpr_read_b32 v50, a146
    v_accvgpr_read_b32 v51, a147
    v_accvgpr_read_b32 v52, a148
    v_accvgpr_read_b32 v53, a149
    v_accvgpr_read_b32 v54, a150
    v_accvgpr_read_b32 v55, a151
    v_accvgpr_read_b32 v56, a152
    v_accvgpr_read_b32 v57, a153
    v_accvgpr_read_b32 v58, a154
    v_accvgpr_read_b32 v59, a155
    v_accvgpr_read_b32 v60, a156
    v_accvgpr_read_b32 v61, a157
    v_accvgpr_read_b32 v62, a158
    v_accvgpr_read_b32 v63, a159
    v_cvt_pk_bf16_f32 v64, v48, v49
    v_cvt_pk_bf16_f32 v65, v50, v51
    v_cvt_pk_bf16_f32 v66, v56, v57
    v_cvt_pk_bf16_f32 v67, v58, v59
    v_cvt_pk_bf16_f32 v68, v52, v53
    v_cvt_pk_bf16_f32 v69, v54, v55
    v_cvt_pk_bf16_f32 v70, v60, v61
    v_cvt_pk_bf16_f32 v71, v62, v63
    ds_write_b128 v93, v[64:67] offset:18432
    ds_write_b128 v94, v[68:71] offset:18432
    v_accvgpr_read_b32 v24, a160
    v_accvgpr_read_b32 v25, a161
    v_accvgpr_read_b32 v26, a162
    v_accvgpr_read_b32 v27, a163
    v_accvgpr_read_b32 v28, a164
    v_accvgpr_read_b32 v29, a165
    v_accvgpr_read_b32 v30, a166
    v_accvgpr_read_b32 v31, a167
    v_accvgpr_read_b32 v32, a168
    v_accvgpr_read_b32 v33, a169
    v_accvgpr_read_b32 v34, a170
    v_accvgpr_read_b32 v35, a171
    v_accvgpr_read_b32 v36, a172
    v_accvgpr_read_b32 v37, a173
    v_accvgpr_read_b32 v38, a174
    v_accvgpr_read_b32 v39, a175
    v_cvt_pk_bf16_f32 v40, v24, v25
    v_cvt_pk_bf16_f32 v41, v26, v27
    v_cvt_pk_bf16_f32 v42, v32, v33
    v_cvt_pk_bf16_f32 v43, v34, v35
    v_cvt_pk_bf16_f32 v44, v28, v29
    v_cvt_pk_bf16_f32 v45, v30, v31
    v_cvt_pk_bf16_f32 v46, v36, v37
    v_cvt_pk_bf16_f32 v47, v38, v39
    ds_write_b128 v93, v[40:43] offset:20480
    ds_write_b128 v94, v[44:47] offset:20480
    v_accvgpr_read_b32 v48, a176
    v_accvgpr_read_b32 v49, a177
    v_accvgpr_read_b32 v50, a178
    v_accvgpr_read_b32 v51, a179
    v_accvgpr_read_b32 v52, a180
    v_accvgpr_read_b32 v53, a181
    v_accvgpr_read_b32 v54, a182
    v_accvgpr_read_b32 v55, a183
    v_accvgpr_read_b32 v56, a184
    v_accvgpr_read_b32 v57, a185
    v_accvgpr_read_b32 v58, a186
    v_accvgpr_read_b32 v59, a187
    v_accvgpr_read_b32 v60, a188
    v_accvgpr_read_b32 v61, a189
    v_accvgpr_read_b32 v62, a190
    v_accvgpr_read_b32 v63, a191
    v_cvt_pk_bf16_f32 v64, v48, v49
    v_cvt_pk_bf16_f32 v65, v50, v51
    v_cvt_pk_bf16_f32 v66, v56, v57
    v_cvt_pk_bf16_f32 v67, v58, v59
    v_cvt_pk_bf16_f32 v68, v52, v53
    v_cvt_pk_bf16_f32 v69, v54, v55
    v_cvt_pk_bf16_f32 v70, v60, v61
    v_cvt_pk_bf16_f32 v71, v62, v63
    ds_write_b128 v93, v[64:67] offset:22528
    ds_write_b128 v94, v[68:71] offset:22528
    v_accvgpr_read_b32 v24, a192
    v_accvgpr_read_b32 v25, a193
    v_accvgpr_read_b32 v26, a194
    v_accvgpr_read_b32 v27, a195
    v_accvgpr_read_b32 v28, a196
    v_accvgpr_read_b32 v29, a197
    v_accvgpr_read_b32 v30, a198
    v_accvgpr_read_b32 v31, a199
    v_accvgpr_read_b32 v32, a200
    v_accvgpr_read_b32 v33, a201
    v_accvgpr_read_b32 v34, a202
    v_accvgpr_read_b32 v35, a203
    v_accvgpr_read_b32 v36, a204
    v_accvgpr_read_b32 v37, a205
    v_accvgpr_read_b32 v38, a206
    v_accvgpr_read_b32 v39, a207
    v_cvt_pk_bf16_f32 v40, v24, v25
    v_cvt_pk_bf16_f32 v41, v26, v27
    v_cvt_pk_bf16_f32 v42, v32, v33
    v_cvt_pk_bf16_f32 v43, v34, v35
    v_cvt_pk_bf16_f32 v44, v28, v29
    v_cvt_pk_bf16_f32 v45, v30, v31
    v_cvt_pk_bf16_f32 v46, v36, v37
    v_cvt_pk_bf16_f32 v47, v38, v39
    ds_write_b128 v93, v[40:43] offset:24576
    ds_write_b128 v94, v[44:47] offset:24576
    v_accvgpr_read_b32 v48, a208
    v_accvgpr_read_b32 v49, a209
    v_accvgpr_read_b32 v50, a210
    v_accvgpr_read_b32 v51, a211
    v_accvgpr_read_b32 v52, a212
    v_accvgpr_read_b32 v53, a213
    v_accvgpr_read_b32 v54, a214
    v_accvgpr_read_b32 v55, a215
    v_accvgpr_read_b32 v56, a216
    v_accvgpr_read_b32 v57, a217
    v_accvgpr_read_b32 v58, a218
    v_accvgpr_read_b32 v59, a219
    v_accvgpr_read_b32 v60, a220
    v_accvgpr_read_b32 v61, a221
    v_accvgpr_read_b32 v62, a222
    v_accvgpr_read_b32 v63, a223
    v_cvt_pk_bf16_f32 v64, v48, v49
    v_cvt_pk_bf16_f32 v65, v50, v51
    v_cvt_pk_bf16_f32 v66, v56, v57
    v_cvt_pk_bf16_f32 v67, v58, v59
    v_cvt_pk_bf16_f32 v68, v52, v53
    v_cvt_pk_bf16_f32 v69, v54, v55
    v_cvt_pk_bf16_f32 v70, v60, v61
    v_cvt_pk_bf16_f32 v71, v62, v63
    ds_write_b128 v93, v[64:67] offset:26624
    ds_write_b128 v94, v[68:71] offset:26624
    v_accvgpr_read_b32 v24, a224
    v_accvgpr_read_b32 v25, a225
    v_accvgpr_read_b32 v26, a226
    v_accvgpr_read_b32 v27, a227
    v_accvgpr_read_b32 v28, a228
    v_accvgpr_read_b32 v29, a229
    v_accvgpr_read_b32 v30, a230
    v_accvgpr_read_b32 v31, a231
    v_accvgpr_read_b32 v32, a232
    v_accvgpr_read_b32 v33, a233
    v_accvgpr_read_b32 v34, a234
    v_accvgpr_read_b32 v35, a235
    v_accvgpr_read_b32 v36, a236
    v_accvgpr_read_b32 v37, a237
    v_accvgpr_read_b32 v38, a238
    v_accvgpr_read_b32 v39, a239
    v_cvt_pk_bf16_f32 v40, v24, v25
    v_cvt_pk_bf16_f32 v41, v26, v27
    v_cvt_pk_bf16_f32 v42, v32, v33
    v_cvt_pk_bf16_f32 v43, v34, v35
    v_cvt_pk_bf16_f32 v44, v28, v29
    v_cvt_pk_bf16_f32 v45, v30, v31
    v_cvt_pk_bf16_f32 v46, v36, v37
    v_cvt_pk_bf16_f32 v47, v38, v39
    ds_write_b128 v93, v[40:43] offset:28672
    ds_write_b128 v94, v[44:47] offset:28672
    v_accvgpr_read_b32 v48, a240
    v_accvgpr_read_b32 v49, a241
    v_accvgpr_read_b32 v50, a242
    v_accvgpr_read_b32 v51, a243
    v_accvgpr_read_b32 v52, a244
    v_accvgpr_read_b32 v53, a245
    v_accvgpr_read_b32 v54, a246
    v_accvgpr_read_b32 v55, a247
    v_accvgpr_read_b32 v56, a248
    v_accvgpr_read_b32 v57, a249
    v_accvgpr_read_b32 v58, a250
    v_accvgpr_read_b32 v59, a251
    v_accvgpr_read_b32 v60, a252
    v_accvgpr_read_b32 v61, a253
    v_accvgpr_read_b32 v62, a254
    v_accvgpr_read_b32 v63, a255
    v_cvt_pk_bf16_f32 v64, v48, v49
    v_cvt_pk_bf16_f32 v65, v50, v51
    v_cvt_pk_bf16_f32 v66, v56, v57
    v_cvt_pk_bf16_f32 v67, v58, v59
    v_cvt_pk_bf16_f32 v68, v52, v53
    v_cvt_pk_bf16_f32 v69, v54, v55
    v_cvt_pk_bf16_f32 v70, v60, v61
    v_cvt_pk_bf16_f32 v71, v62, v63
    ds_write_b128 v93, v[64:67] offset:30720
    ds_write_b128 v94, v[68:71] offset:30720
    v_lshlrev_b32 v91, 4, v1
    v_add_u32 v91, s25, v91
    v_and_b32 v88, 3, v1
    v_bfe_u32 v89, v1, 3, 2
    v_xor_b32 v88, v88, v89
    v_lshrrev_b32 v89, 2, v1
    v_lshlrev_b32 v89, 6, v89
    v_lshl_add_u32 v92, v88, 4, v89
    s_lshr_b32 s23, s22, 1
    s_lshl_b32 s23, s23, 20
    s_and_b32 s24, s22, 1
    s_lshl_b32 s24, s24, 13
    s_add_u32 s23, s23, s24
    v_add_u32 v92, s23, v92
    v_add_u32 v95, 4096, v92
    s_waitcnt lgkmcnt(0)
    ds_read_b128 v[24:27], v91 offset:0
    ds_read_b128 v[28:31], v91 offset:1024
    ds_read_b128 v[32:35], v91 offset:2048
    ds_read_b128 v[36:39], v91 offset:3072
    s_waitcnt lgkmcnt(0)
    global_store_dwordx4 v92, v[24:27], s[42:43] offset:0 sc1
    global_store_dwordx4 v92, v[28:31], s[42:43] offset:1024 sc1
    global_store_dwordx4 v92, v[32:35], s[42:43] offset:2048 sc1
    global_store_dwordx4 v92, v[36:39], s[42:43] offset:3072 sc1
    ds_read_b128 v[40:43], v91 offset:4096
    ds_read_b128 v[44:47], v91 offset:5120
    ds_read_b128 v[48:51], v91 offset:6144
    ds_read_b128 v[52:55], v91 offset:7168
    s_waitcnt lgkmcnt(0)
    global_store_dwordx4 v95, v[40:43], s[42:43] offset:0 sc1
    global_store_dwordx4 v95, v[44:47], s[42:43] offset:1024 sc1
    global_store_dwordx4 v95, v[48:51], s[42:43] offset:2048 sc1
    global_store_dwordx4 v95, v[52:55], s[42:43] offset:3072 sc1
    v_add_u32 v92, 262144, v92
    v_add_u32 v95, 262144, v95
    ds_read_b128 v[24:27], v91 offset:8192
    ds_read_b128 v[28:31], v91 offset:9216
    ds_read_b128 v[32:35], v91 offset:10240
    ds_read_b128 v[36:39], v91 offset:11264
    s_waitcnt lgkmcnt(0)
    global_store_dwordx4 v92, v[24:27], s[42:43] offset:0 sc1
    global_store_dwordx4 v92, v[28:31], s[42:43] offset:1024 sc1
    global_store_dwordx4 v92, v[32:35], s[42:43] offset:2048 sc1
    global_store_dwordx4 v92, v[36:39], s[42:43] offset:3072 sc1
    ds_read_b128 v[40:43], v91 offset:12288
    ds_read_b128 v[44:47], v91 offset:13312
    ds_read_b128 v[48:51], v91 offset:14336
    ds_read_b128 v[52:55], v91 offset:15360
    s_waitcnt lgkmcnt(0)
    global_store_dwordx4 v95, v[40:43], s[42:43] offset:0 sc1
    global_store_dwordx4 v95, v[44:47], s[42:43] offset:1024 sc1
    global_store_dwordx4 v95, v[48:51], s[42:43] offset:2048 sc1
    global_store_dwordx4 v95, v[52:55], s[42:43] offset:3072 sc1
    v_add_u32 v92, 262144, v92
    v_add_u32 v95, 262144, v95
    ds_read_b128 v[24:27], v91 offset:16384
    ds_read_b128 v[28:31], v91 offset:17408
    ds_read_b128 v[32:35], v91 offset:18432
    ds_read_b128 v[36:39], v91 offset:19456
    s_waitcnt lgkmcnt(0)
    global_store_dwordx4 v92, v[24:27], s[42:43] offset:0 sc1
    global_store_dwordx4 v92, v[28:31], s[42:43] offset:1024 sc1
    global_store_dwordx4 v92, v[32:35], s[42:43] offset:2048 sc1
    global_store_dwordx4 v92, v[36:39], s[42:43] offset:3072 sc1
    ds_read_b128 v[40:43], v91 offset:20480
    ds_read_b128 v[44:47], v91 offset:21504
    ds_read_b128 v[48:51], v91 offset:22528
    ds_read_b128 v[52:55], v91 offset:23552
    s_waitcnt lgkmcnt(0)
    global_store_dwordx4 v95, v[40:43], s[42:43] offset:0 sc1
    global_store_dwordx4 v95, v[44:47], s[42:43] offset:1024 sc1
    global_store_dwordx4 v95, v[48:51], s[42:43] offset:2048 sc1
    global_store_dwordx4 v95, v[52:55], s[42:43] offset:3072 sc1
    v_add_u32 v92, 262144, v92
    v_add_u32 v95, 262144, v95
    ds_read_b128 v[24:27], v91 offset:24576
    ds_read_b128 v[28:31], v91 offset:25600
    ds_read_b128 v[32:35], v91 offset:26624
    ds_read_b128 v[36:39], v91 offset:27648
    s_waitcnt lgkmcnt(0)
    global_store_dwordx4 v92, v[24:27], s[42:43] offset:0 sc1
    global_store_dwordx4 v92, v[28:31], s[42:43] offset:1024 sc1
    global_store_dwordx4 v92, v[32:35], s[42:43] offset:2048 sc1
    global_store_dwordx4 v92, v[36:39], s[42:43] offset:3072 sc1
    ds_read_b128 v[40:43], v91 offset:28672
    ds_read_b128 v[44:47], v91 offset:29696
    ds_read_b128 v[48:51], v91 offset:30720
    ds_read_b128 v[52:55], v91 offset:31744
    s_waitcnt lgkmcnt(0)
    global_store_dwordx4 v95, v[40:43], s[42:43] offset:0 sc1
    global_store_dwordx4 v95, v[44:47], s[42:43] offset:1024 sc1
    global_store_dwordx4 v95, v[48:51], s[42:43] offset:2048 sc1
    global_store_dwordx4 v95, v[52:55], s[42:43] offset:3072 sc1
    s_branch L_sig_kv
L_t_f1:
    s_load_dwordx2 s[40:41], s[0:1], 64
    s_mov_b32 s18, 1024
    s_mov_b32 s19, 3584
    s_mov_b32 s20, 16
    s_mov_b32 s27, 64
    s_mov_b32 s28, 114688
    s_waitcnt lgkmcnt(0)
    s_mov_b32 s8, s30
    s_mov_b32 s9, s31
    s_mov_b32 s10, 2097152
    s_mov_b32 s11, 0x00020000
    s_mov_b32 s12, s40
    s_mov_b32 s13, s41
    s_mov_b32 s14, 1835008
    s_mov_b32 s15, 0x00020000
    s_lshl_b32 s16, s35, 18
    s_lshl_b32 s17, s37, 9
    v_lshrrev_b32 v88, 2, v1
    s_lshl_b32 s23, s22, 6
    v_add_u32 v88, s23, v88
    v_mul_lo_u32 v88, v88, s18
    v_and_b32 v89, 3, v1
    v_bfe_u32 v90, v1, 4, 2
    v_xor_b32 v89, v89, v90
    v_lshl_add_u32 v2, v89, 4, v88
    s_lshl_b32 s23, s18, 4
    v_add_u32 v3, s23, v2
    v_add_u32 v4, s23, v3
    v_add_u32 v5, s23, v4
    v_lshrrev_b32 v88, 5, v1
    v_add_u32 v88, 0, v88
    v_and_b32 v89, 3, v88
    v_lshlrev_b32 v89, 2, v89
    v_and_b32 v90, 31, v1
    v_xor_b32 v89, v89, v90
    s_lshl_b32 s23, s22, 3
    v_add_u32 v88, s23, v88
    v_mul_lo_u32 v88, v88, s19
    v_lshl_add_u32 v6, v89, 4, v88
    v_lshrrev_b32 v88, 5, v1
    v_add_u32 v88, 2, v88
    v_and_b32 v89, 3, v88
    v_lshlrev_b32 v89, 2, v89
    v_and_b32 v90, 31, v1
    v_xor_b32 v89, v89, v90
    s_lshl_b32 s23, s22, 3
    v_add_u32 v88, s23, v88
    v_mul_lo_u32 v88, v88, s19
    v_lshl_add_u32 v7, v89, 4, v88
    v_lshrrev_b32 v88, 5, v1
    v_add_u32 v88, 4, v88
    v_and_b32 v89, 3, v88
    v_lshlrev_b32 v89, 2, v89
    v_and_b32 v90, 31, v1
    v_xor_b32 v89, v89, v90
    s_lshl_b32 s23, s22, 3
    v_add_u32 v88, s23, v88
    v_mul_lo_u32 v88, v88, s19
    v_lshl_add_u32 v8, v89, 4, v88
    v_lshrrev_b32 v88, 5, v1
    v_add_u32 v88, 6, v88
    v_and_b32 v89, 3, v88
    v_lshlrev_b32 v89, 2, v89
    v_and_b32 v90, 31, v1
    v_xor_b32 v89, v89, v90
    s_lshl_b32 s23, s22, 3
    v_add_u32 v88, s23, v88
    v_mul_lo_u32 v88, v88, s19
    v_lshl_add_u32 v9, v89, 4, v88
    v_and_b32 v88, 31, v1
    s_lshr_b32 s23, s22, 1
    s_lshl_b32 s23, s23, 7
    v_add_u32 v89, s23, v88
    v_lshlrev_b32 v89, 6, v89
    v_bfe_u32 v88, v1, 2, 2
    v_lshrrev_b32 v90, 5, v1
    v_add_u32 v90, 0, v90
    v_xor_b32 v90, v90, v88
    v_lshl_add_u32 v10, v90, 4, v89
    v_add_u32 v12, 65536, v10
    v_and_b32 v88, 31, v1
    s_lshr_b32 s23, s22, 1
    s_lshl_b32 s23, s23, 7
    v_add_u32 v89, s23, v88
    v_lshlrev_b32 v89, 6, v89
    v_bfe_u32 v88, v1, 2, 2
    v_lshrrev_b32 v90, 5, v1
    v_add_u32 v90, 2, v90
    v_xor_b32 v90, v90, v88
    v_lshl_add_u32 v11, v90, 4, v89
    v_add_u32 v13, 65536, v11
    v_bfe_u32 v88, v1, 2, 2
    v_lshrrev_b32 v89, 5, v1
    v_lshl_add_u32 v89, v89, 3, v88
    v_lshlrev_b32 v89, 9, v89
    v_xor_b32 v88, 0, v88
    v_lshlrev_b32 v88, 2, v88
    v_bfe_u32 v90, v1, 4, 1
    v_lshl_add_u32 v88, v90, 1, v88
    v_bfe_u32 v90, v1, 1, 1
    v_add_u32 v88, v88, v90
    s_and_b32 s23, s22, 1
    s_lshl_b32 s23, s23, 4
    v_add_u32 v88, s23, v88
    v_lshl_add_u32 v89, v88, 4, v89
    v_and_b32 v90, 1, v1
    v_lshl_add_u32 v89, v90, 3, v89
    v_add_u32 v14, 16384, v89
    v_add_u32 v18, 65536, v14
    v_bfe_u32 v88, v1, 2, 2
    v_lshrrev_b32 v89, 5, v1
    v_lshl_add_u32 v89, v89, 3, v88
    v_lshlrev_b32 v89, 9, v89
    v_xor_b32 v88, 1, v88
    v_lshlrev_b32 v88, 2, v88
    v_bfe_u32 v90, v1, 4, 1
    v_lshl_add_u32 v88, v90, 1, v88
    v_bfe_u32 v90, v1, 1, 1
    v_add_u32 v88, v88, v90
    s_and_b32 s23, s22, 1
    s_lshl_b32 s23, s23, 4
    v_add_u32 v88, s23, v88
    v_lshl_add_u32 v89, v88, 4, v89
    v_and_b32 v90, 1, v1
    v_lshl_add_u32 v89, v90, 3, v89
    v_add_u32 v15, 16384, v89
    v_add_u32 v19, 65536, v15
    v_bfe_u32 v88, v1, 2, 2
    v_lshrrev_b32 v89, 5, v1
    v_lshl_add_u32 v89, v89, 3, v88
    v_lshlrev_b32 v89, 9, v89
    v_xor_b32 v88, 2, v88
    v_lshlrev_b32 v88, 2, v88
    v_bfe_u32 v90, v1, 4, 1
    v_lshl_add_u32 v88, v90, 1, v88
    v_bfe_u32 v90, v1, 1, 1
    v_add_u32 v88, v88, v90
    s_and_b32 s23, s22, 1
    s_lshl_b32 s23, s23, 4
    v_add_u32 v88, s23, v88
    v_lshl_add_u32 v89, v88, 4, v89
    v_and_b32 v90, 1, v1
    v_lshl_add_u32 v89, v90, 3, v89
    v_add_u32 v16, 16384, v89
    v_add_u32 v20, 65536, v16
    v_bfe_u32 v88, v1, 2, 2
    v_lshrrev_b32 v89, 5, v1
    v_lshl_add_u32 v89, v89, 3, v88
    v_lshlrev_b32 v89, 9, v89
    v_xor_b32 v88, 3, v88
    v_lshlrev_b32 v88, 2, v88
    v_bfe_u32 v90, v1, 4, 1
    v_lshl_add_u32 v88, v90, 1, v88
    v_bfe_u32 v90, v1, 1, 1
    v_add_u32 v88, v88, v90
    s_and_b32 s23, s22, 1
    s_lshl_b32 s23, s23, 4
    v_add_u32 v88, s23, v88
    v_lshl_add_u32 v89, v88, 4, v89
    v_and_b32 v90, 1, v1
    v_lshl_add_u32 v89, v90, 3, v89
    v_add_u32 v17, 16384, v89
    v_add_u32 v21, 65536, v17
    s_lshl_b32 s25, s22, 12
    s_add_u32 s26, s25, 0
    s_add_u32 m0, s26, 0
    s_nop 0
    buffer_load_dwordx4 v2, s[8:11], s16 offen lds
    s_add_u32 m0, s26, 1024
    s_nop 0
    buffer_load_dwordx4 v3, s[8:11], s16 offen lds
    s_add_u32 m0, s26, 2048
    s_nop 0
    buffer_load_dwordx4 v4, s[8:11], s16 offen lds
    s_add_u32 m0, s26, 3072
    s_nop 0
    buffer_load_dwordx4 v5, s[8:11], s16 offen lds
    s_add_u32 m0, s26, 16384
    s_nop 0
    buffer_load_dwordx4 v6, s[12:15], s17 offen lds
    s_add_u32 m0, s26, 17408
    s_nop 0
    buffer_load_dwordx4 v7, s[12:15], s17 offen lds
    s_add_u32 m0, s26, 18432
    s_nop 0
    buffer_load_dwordx4 v8, s[12:15], s17 offen lds
    s_add_u32 m0, s26, 19456
    s_nop 0
    buffer_load_dwordx4 v9, s[12:15], s17 offen lds
    s_add_u32 s16, s16, s27
    s_add_u32 s17, s17, s28
    s_add_u32 s26, s25, 32768
    s_add_u32 m0, s26, 0
    s_nop 0
    buffer_load_dwordx4 v2, s[8:11], s16 offen lds
    s_add_u32 m0, s26, 1024
    s_nop 0
    buffer_load_dwordx4 v3, s[8:11], s16 offen lds
    s_add_u32 m0, s26, 2048
    s_nop 0
    buffer_load_dwordx4 v4, s[8:11], s16 offen lds
    s_add_u32 m0, s26, 3072
    s_nop 0
    buffer_load_dwordx4 v5, s[8:11], s16 offen lds
    s_add_u32 m0, s26, 16384
    s_nop 0
    buffer_load_dwordx4 v6, s[12:15], s17 offen lds
    s_add_u32 m0, s26, 17408
    s_nop 0
    buffer_load_dwordx4 v7, s[12:15], s17 offen lds
    s_add_u32 m0, s26, 18432
    s_nop 0
    buffer_load_dwordx4 v8, s[12:15], s17 offen lds
    s_add_u32 m0, s26, 19456
    s_nop 0
    buffer_load_dwordx4 v9, s[12:15], s17 offen lds
    s_add_u32 s16, s16, s27
    s_add_u32 s17, s17, s28
    s_add_u32 s26, s25, 65536
    s_add_u32 m0, s26, 0
    s_nop 0
    buffer_load_dwordx4 v2, s[8:11], s16 offen lds
    s_add_u32 m0, s26, 1024
    s_nop 0
    buffer_load_dwordx4 v3, s[8:11], s16 offen lds
    s_add_u32 m0, s26, 2048
    s_nop 0
    buffer_load_dwordx4 v4, s[8:11], s16 offen lds
    s_add_u32 m0, s26, 3072
    s_nop 0
    buffer_load_dwordx4 v5, s[8:11], s16 offen lds
    s_add_u32 m0, s26, 16384
    s_nop 0
    buffer_load_dwordx4 v6, s[12:15], s17 offen lds
    s_add_u32 m0, s26, 17408
    s_nop 0
    buffer_load_dwordx4 v7, s[12:15], s17 offen lds
    s_add_u32 m0, s26, 18432
    s_nop 0
    buffer_load_dwordx4 v8, s[12:15], s17 offen lds
    s_add_u32 m0, s26, 19456
    s_nop 0
    buffer_load_dwordx4 v9, s[12:15], s17 offen lds
    s_add_u32 s16, s16, s27
    s_add_u32 s17, s17, s28
    s_waitcnt vmcnt(16)
    s_barrier
    ds_read_b128 v[24:27], v10 offset:0
    ds_read_b128 v[28:31], v10 offset:2048
    ds_read_b128 v[32:35], v10 offset:4096
    ds_read_b128 v[36:39], v10 offset:6144
    ds_read_b64_tr_b16 v[40:41], v14 offset:0
    ds_read_b64_tr_b16 v[42:43], v14 offset:2048
    ds_read_b64_tr_b16 v[44:45], v15 offset:0
    ds_read_b64_tr_b16 v[46:47], v15 offset:2048
    ds_read_b64_tr_b16 v[48:49], v16 offset:0
    ds_read_b64_tr_b16 v[50:51], v16 offset:2048
    ds_read_b64_tr_b16 v[52:53], v17 offset:0
    ds_read_b64_tr_b16 v[54:55], v17 offset:2048
    s_mov_b32 s21, 0
    v_accvgpr_write_b32 a0, 0
    v_accvgpr_write_b32 a1, 0
    v_accvgpr_write_b32 a2, 0
    v_accvgpr_write_b32 a3, 0
    v_accvgpr_write_b32 a4, 0
    v_accvgpr_write_b32 a5, 0
    v_accvgpr_write_b32 a6, 0
    v_accvgpr_write_b32 a7, 0
    v_accvgpr_write_b32 a8, 0
    v_accvgpr_write_b32 a9, 0
    v_accvgpr_write_b32 a10, 0
    v_accvgpr_write_b32 a11, 0
    v_accvgpr_write_b32 a12, 0
    v_accvgpr_write_b32 a13, 0
    v_accvgpr_write_b32 a14, 0
    v_accvgpr_write_b32 a15, 0
    v_accvgpr_write_b32 a16, 0
    v_accvgpr_write_b32 a17, 0
    v_accvgpr_write_b32 a18, 0
    v_accvgpr_write_b32 a19, 0
    v_accvgpr_write_b32 a20, 0
    v_accvgpr_write_b32 a21, 0
    v_accvgpr_write_b32 a22, 0
    v_accvgpr_write_b32 a23, 0
    v_accvgpr_write_b32 a24, 0
    v_accvgpr_write_b32 a25, 0
    v_accvgpr_write_b32 a26, 0
    v_accvgpr_write_b32 a27, 0
    v_accvgpr_write_b32 a28, 0
    v_accvgpr_write_b32 a29, 0
    v_accvgpr_write_b32 a30, 0
    v_accvgpr_write_b32 a31, 0
    v_accvgpr_write_b32 a32, 0
    v_accvgpr_write_b32 a33, 0
    v_accvgpr_write_b32 a34, 0
    v_accvgpr_write_b32 a35, 0
    v_accvgpr_write_b32 a36, 0
    v_accvgpr_write_b32 a37, 0
    v_accvgpr_write_b32 a38, 0
    v_accvgpr_write_b32 a39, 0
    v_accvgpr_write_b32 a40, 0
    v_accvgpr_write_b32 a41, 0
    v_accvgpr_write_b32 a42, 0
    v_accvgpr_write_b32 a43, 0
    v_accvgpr_write_b32 a44, 0
    v_accvgpr_write_b32 a45, 0
    v_accvgpr_write_b32 a46, 0
    v_accvgpr_write_b32 a47, 0
    v_accvgpr_write_b32 a48, 0
    v_accvgpr_write_b32 a49, 0
    v_accvgpr_write_b32 a50, 0
    v_accvgpr_write_b32 a51, 0
    v_accvgpr_write_b32 a52, 0
    v_accvgpr_write_b32 a53, 0
    v_accvgpr_write_b32 a54, 0
    v_accvgpr_write_b32 a55, 0
    v_accvgpr_write_b32 a56, 0
    v_accvgpr_write_b32 a57, 0
    v_accvgpr_write_b32 a58, 0
    v_accvgpr_write_b32 a59, 0
    v_accvgpr_write_b32 a60, 0
    v_accvgpr_write_b32 a61, 0
    v_accvgpr_write_b32 a62, 0
    v_accvgpr_write_b32 a63, 0
    v_accvgpr_write_b32 a64, 0
    v_accvgpr_write_b32 a65, 0
    v_accvgpr_write_b32 a66, 0
    v_accvgpr_write_b32 a67, 0
    v_accvgpr_write_b32 a68, 0
    v_accvgpr_write_b32 a69, 0
    v_accvgpr_write_b32 a70, 0
    v_accvgpr_write_b32 a71, 0
    v_accvgpr_write_b32 a72, 0
    v_accvgpr_write_b32 a73, 0
    v_accvgpr_write_b32 a74, 0
    v_accvgpr_write_b32 a75, 0
    v_accvgpr_write_b32 a76, 0
    v_accvgpr_write_b32 a77, 0
    v_accvgpr_write_b32 a78, 0
    v_accvgpr_write_b32 a79, 0
    v_accvgpr_write_b32 a80, 0
    v_accvgpr_write_b32 a81, 0
    v_accvgpr_write_b32 a82, 0
    v_accvgpr_write_b32 a83, 0
    v_accvgpr_write_b32 a84, 0
    v_accvgpr_write_b32 a85, 0
    v_accvgpr_write_b32 a86, 0
    v_accvgpr_write_b32 a87, 0
    v_accvgpr_write_b32 a88, 0
    v_accvgpr_write_b32 a89, 0
    v_accvgpr_write_b32 a90, 0
    v_accvgpr_write_b32 a91, 0
    v_accvgpr_write_b32 a92, 0
    v_accvgpr_write_b32 a93, 0
    v_accvgpr_write_b32 a94, 0
    v_accvgpr_write_b32 a95, 0
    v_accvgpr_write_b32 a96, 0
    v_accvgpr_write_b32 a97, 0
    v_accvgpr_write_b32 a98, 0
    v_accvgpr_write_b32 a99, 0
    v_accvgpr_write_b32 a100, 0
    v_accvgpr_write_b32 a101, 0
    v_accvgpr_write_b32 a102, 0
    v_accvgpr_write_b32 a103, 0
    v_accvgpr_write_b32 a104, 0
    v_accvgpr_write_b32 a105, 0
    v_accvgpr_write_b32 a106, 0
    v_accvgpr_write_b32 a107, 0
    v_accvgpr_write_b32 a108, 0
    v_accvgpr_write_b32 a109, 0
    v_accvgpr_write_b32 a110, 0
    v_accvgpr_write_b32 a111, 0
    v_accvgpr_write_b32 a112, 0
    v_accvgpr_write_b32 a113, 0
    v_accvgpr_write_b32 a114, 0
    v_accvgpr_write_b32 a115, 0
    v_accvgpr_write_b32 a116, 0
    v_accvgpr_write_b32 a117, 0
    v_accvgpr_write_b32 a118, 0
    v_accvgpr_write_b32 a119, 0
    v_accvgpr_write_b32 a120, 0
    v_accvgpr_write_b32 a121, 0
    v_accvgpr_write_b32 a122, 0
    v_accvgpr_write_b32 a123, 0
    v_accvgpr_write_b32 a124, 0
    v_accvgpr_write_b32 a125, 0
    v_accvgpr_write_b32 a126, 0
    v_accvgpr_write_b32 a127, 0
    v_accvgpr_write_b32 a128, 0
    v_accvgpr_write_b32 a129, 0
    v_accvgpr_write_b32 a130, 0
    v_accvgpr_write_b32 a131, 0
    v_accvgpr_write_b32 a132, 0
    v_accvgpr_write_b32 a133, 0
    v_accvgpr_write_b32 a134, 0
    v_accvgpr_write_b32 a135, 0
    v_accvgpr_write_b32 a136, 0
    v_accvgpr_write_b32 a137, 0
    v_accvgpr_write_b32 a138, 0
    v_accvgpr_write_b32 a139, 0
    v_accvgpr_write_b32 a140, 0
    v_accvgpr_write_b32 a141, 0
    v_accvgpr_write_b32 a142, 0
    v_accvgpr_write_b32 a143, 0
    v_accvgpr_write_b32 a144, 0
    v_accvgpr_write_b32 a145, 0
    v_accvgpr_write_b32 a146, 0
    v_accvgpr_write_b32 a147, 0
    v_accvgpr_write_b32 a148, 0
    v_accvgpr_write_b32 a149, 0
    v_accvgpr_write_b32 a150, 0
    v_accvgpr_write_b32 a151, 0
    v_accvgpr_write_b32 a152, 0
    v_accvgpr_write_b32 a153, 0
    v_accvgpr_write_b32 a154, 0
    v_accvgpr_write_b32 a155, 0
    v_accvgpr_write_b32 a156, 0
    v_accvgpr_write_b32 a157, 0
    v_accvgpr_write_b32 a158, 0
    v_accvgpr_write_b32 a159, 0
    v_accvgpr_write_b32 a160, 0
    v_accvgpr_write_b32 a161, 0
    v_accvgpr_write_b32 a162, 0
    v_accvgpr_write_b32 a163, 0
    v_accvgpr_write_b32 a164, 0
    v_accvgpr_write_b32 a165, 0
    v_accvgpr_write_b32 a166, 0
    v_accvgpr_write_b32 a167, 0
    v_accvgpr_write_b32 a168, 0
    v_accvgpr_write_b32 a169, 0
    v_accvgpr_write_b32 a170, 0
    v_accvgpr_write_b32 a171, 0
    v_accvgpr_write_b32 a172, 0
    v_accvgpr_write_b32 a173, 0
    v_accvgpr_write_b32 a174, 0
    v_accvgpr_write_b32 a175, 0
    v_accvgpr_write_b32 a176, 0
    v_accvgpr_write_b32 a177, 0
    v_accvgpr_write_b32 a178, 0
    v_accvgpr_write_b32 a179, 0
    v_accvgpr_write_b32 a180, 0
    v_accvgpr_write_b32 a181, 0
    v_accvgpr_write_b32 a182, 0
    v_accvgpr_write_b32 a183, 0
    v_accvgpr_write_b32 a184, 0
    v_accvgpr_write_b32 a185, 0
    v_accvgpr_write_b32 a186, 0
    v_accvgpr_write_b32 a187, 0
    v_accvgpr_write_b32 a188, 0
    v_accvgpr_write_b32 a189, 0
    v_accvgpr_write_b32 a190, 0
    v_accvgpr_write_b32 a191, 0
    v_accvgpr_write_b32 a192, 0
    v_accvgpr_write_b32 a193, 0
    v_accvgpr_write_b32 a194, 0
    v_accvgpr_write_b32 a195, 0
    v_accvgpr_write_b32 a196, 0
    v_accvgpr_write_b32 a197, 0
    v_accvgpr_write_b32 a198, 0
    v_accvgpr_write_b32 a199, 0
    v_accvgpr_write_b32 a200, 0
    v_accvgpr_write_b32 a201, 0
    v_accvgpr_write_b32 a202, 0
    v_accvgpr_write_b32 a203, 0
    v_accvgpr_write_b32 a204, 0
    v_accvgpr_write_b32 a205, 0
    v_accvgpr_write_b32 a206, 0
    v_accvgpr_write_b32 a207, 0
    v_accvgpr_write_b32 a208, 0
    v_accvgpr_write_b32 a209, 0
    v_accvgpr_write_b32 a210, 0
    v_accvgpr_write_b32 a211, 0
    v_accvgpr_write_b32 a212, 0
    v_accvgpr_write_b32 a213, 0
    v_accvgpr_write_b32 a214, 0
    v_accvgpr_write_b32 a215, 0
    v_accvgpr_write_b32 a216, 0
    v_accvgpr_write_b32 a217, 0
    v_accvgpr_write_b32 a218, 0
    v_accvgpr_write_b32 a219, 0
    v_accvgpr_write_b32 a220, 0
    v_accvgpr_write_b32 a221, 0
    v_accvgpr_write_b32 a222, 0
    v_accvgpr_write_b32 a223, 0
    v_accvgpr_write_b32 a224, 0
    v_accvgpr_write_b32 a225, 0
    v_accvgpr_write_b32 a226, 0
    v_accvgpr_write_b32 a227, 0
    v_accvgpr_write_b32 a228, 0
    v_accvgpr_write_b32 a229, 0
    v_accvgpr_write_b32 a230, 0
    v_accvgpr_write_b32 a231, 0
    v_accvgpr_write_b32 a232, 0
    v_accvgpr_write_b32 a233, 0
    v_accvgpr_write_b32 a234, 0
    v_accvgpr_write_b32 a235, 0
    v_accvgpr_write_b32 a236, 0
    v_accvgpr_write_b32 a237, 0
    v_accvgpr_write_b32 a238, 0
    v_accvgpr_write_b32 a239, 0
    v_accvgpr_write_b32 a240, 0
    v_accvgpr_write_b32 a241, 0
    v_accvgpr_write_b32 a242, 0
    v_accvgpr_write_b32 a243, 0
    v_accvgpr_write_b32 a244, 0
    v_accvgpr_write_b32 a245, 0
    v_accvgpr_write_b32 a246, 0
    v_accvgpr_write_b32 a247, 0
    v_accvgpr_write_b32 a248, 0
    v_accvgpr_write_b32 a249, 0
    v_accvgpr_write_b32 a250, 0
    v_accvgpr_write_b32 a251, 0
    v_accvgpr_write_b32 a252, 0
    v_accvgpr_write_b32 a253, 0
    v_accvgpr_write_b32 a254, 0
    v_accvgpr_write_b32 a255, 0
.p2align 6
L_gemm_f1:
    s_waitcnt lgkmcnt(0)
    v_mfma_f32_32x32x16_bf16 a[0:15], v[40:43], v[24:27], a[0:15]
    ds_read_b128 v[56:59], v11 offset:0
    v_mfma_f32_32x32x16_bf16 a[16:31], v[44:47], v[24:27], a[16:31]
    ds_read_b128 v[60:63], v11 offset:2048
    v_mfma_f32_32x32x16_bf16 a[32:47], v[48:51], v[24:27], a[32:47]
    ds_read_b128 v[64:67], v11 offset:4096
    v_mfma_f32_32x32x16_bf16 a[48:63], v[52:55], v[24:27], a[48:63]
    ds_read_b128 v[68:71], v11 offset:6144
    v_mfma_f32_32x32x16_bf16 a[64:79], v[40:43], v[28:31], a[64:79]
    ds_read_b64_tr_b16 v[72:73], v14 offset:8192
    v_mfma_f32_32x32x16_bf16 a[80:95], v[44:47], v[28:31], a[80:95]
    ds_read_b64_tr_b16 v[74:75], v14 offset:10240
    v_mfma_f32_32x32x16_bf16 a[96:111], v[48:51], v[28:31], a[96:111]
    ds_read_b64_tr_b16 v[76:77], v15 offset:8192
    v_mfma_f32_32x32x16_bf16 a[112:127], v[52:55], v[28:31], a[112:127]
    ds_read_b64_tr_b16 v[78:79], v15 offset:10240
    v_mfma_f32_32x32x16_bf16 a[128:143], v[40:43], v[32:35], a[128:143]
    ds_read_b64_tr_b16 v[80:81], v16 offset:8192
    v_mfma_f32_32x32x16_bf16 a[144:159], v[44:47], v[32:35], a[144:159]
    ds_read_b64_tr_b16 v[82:83], v16 offset:10240
    v_mfma_f32_32x32x16_bf16 a[160:175], v[48:51], v[32:35], a[160:175]
    ds_read_b64_tr_b16 v[84:85], v17 offset:8192
    v_mfma_f32_32x32x16_bf16 a[176:191], v[52:55], v[32:35], a[176:191]
    ds_read_b64_tr_b16 v[86:87], v17 offset:10240
    v_mfma_f32_32x32x16_bf16 a[192:207], v[40:43], v[36:39], a[192:207]
    v_mfma_f32_32x32x16_bf16 a[208:223], v[44:47], v[36:39], a[208:223]
    v_mfma_f32_32x32x16_bf16 a[224:239], v[48:51], v[36:39], a[224:239]
    v_mfma_f32_32x32x16_bf16 a[240:255], v[52:55], v[36:39], a[240:255]
    s_waitcnt vmcnt(8)
    s_waitcnt lgkmcnt(0)
    s_barrier
    s_add_u32 s26, s25, 98304
    v_mfma_f32_32x32x16_bf16 a[0:15], v[72:75], v[56:59], a[0:15]
    ds_read_b128 v[24:27], v10 offset:32768
    v_mfma_f32_32x32x16_bf16 a[16:31], v[76:79], v[56:59], a[16:31]
    ds_read_b128 v[28:31], v10 offset:34816
    v_mfma_f32_32x32x16_bf16 a[32:47], v[80:83], v[56:59], a[32:47]
    ds_read_b128 v[32:35], v10 offset:36864
    s_add_u32 m0, s26, 0
    s_nop 0
    v_mfma_f32_32x32x16_bf16 a[48:63], v[84:87], v[56:59], a[48:63]
    ds_read_b128 v[36:39], v10 offset:38912
    buffer_load_dwordx4 v2, s[8:11], s16 offen lds
    s_add_u32 m0, s26, 1024
    v_mfma_f32_32x32x16_bf16 a[64:79], v[72:75], v[60:63], a[64:79]
    ds_read_b64_tr_b16 v[40:41], v14 offset:32768
    s_nop 0
    buffer_load_dwordx4 v3, s[8:11], s16 offen lds
    v_mfma_f32_32x32x16_bf16 a[80:95], v[76:79], v[60:63], a[80:95]
    ds_read_b64_tr_b16 v[42:43], v14 offset:34816
    s_add_u32 m0, s26, 2048
    s_nop 0
    v_mfma_f32_32x32x16_bf16 a[96:111], v[80:83], v[60:63], a[96:111]
    ds_read_b64_tr_b16 v[44:45], v15 offset:32768
    buffer_load_dwordx4 v4, s[8:11], s16 offen lds
    s_add_u32 m0, s26, 3072
    v_mfma_f32_32x32x16_bf16 a[112:127], v[84:87], v[60:63], a[112:127]
    ds_read_b64_tr_b16 v[46:47], v15 offset:34816
    s_nop 0
    buffer_load_dwordx4 v5, s[8:11], s16 offen lds
    v_mfma_f32_32x32x16_bf16 a[128:143], v[72:75], v[64:67], a[128:143]
    ds_read_b64_tr_b16 v[48:49], v16 offset:32768
    s_add_u32 m0, s26, 16384
    s_nop 0
    v_mfma_f32_32x32x16_bf16 a[144:159], v[76:79], v[64:67], a[144:159]
    ds_read_b64_tr_b16 v[50:51], v16 offset:34816
    buffer_load_dwordx4 v6, s[12:15], s17 offen lds
    s_add_u32 m0, s26, 17408
    v_mfma_f32_32x32x16_bf16 a[160:175], v[80:83], v[64:67], a[160:175]
    ds_read_b64_tr_b16 v[52:53], v17 offset:32768
    s_nop 0
    buffer_load_dwordx4 v7, s[12:15], s17 offen lds
    v_mfma_f32_32x32x16_bf16 a[176:191], v[84:87], v[64:67], a[176:191]
    ds_read_b64_tr_b16 v[54:55], v17 offset:34816
    s_add_u32 m0, s26, 18432
    s_nop 0
    v_mfma_f32_32x32x16_bf16 a[192:207], v[72:75], v[68:71], a[192:207]
    buffer_load_dwordx4 v8, s[12:15], s17 offen lds
    s_add_u32 m0, s26, 19456
    v_mfma_f32_32x32x16_bf16 a[208:223], v[76:79], v[68:71], a[208:223]
    s_nop 0
    buffer_load_dwordx4 v9, s[12:15], s17 offen lds
    v_mfma_f32_32x32x16_bf16 a[224:239], v[80:83], v[68:71], a[224:239]
    s_add_u32 s16, s16, s27
    s_add_u32 s17, s17, s28
    v_mfma_f32_32x32x16_bf16 a[240:255], v[84:87], v[68:71], a[240:255]
    s_waitcnt lgkmcnt(0)
    v_mfma_f32_32x32x16_bf16 a[0:15], v[40:43], v[24:27], a[0:15]
    ds_read_b128 v[56:59], v11 offset:32768
    v_mfma_f32_32x32x16_bf16 a[16:31], v[44:47], v[24:27], a[16:31]
    ds_read_b128 v[60:63], v11 offset:34816
    v_mfma_f32_32x32x16_bf16 a[32:47], v[48:51], v[24:27], a[32:47]
    ds_read_b128 v[64:67], v11 offset:36864
    v_mfma_f32_32x32x16_bf16 a[48:63], v[52:55], v[24:27], a[48:63]
    ds_read_b128 v[68:71], v11 offset:38912
    v_mfma_f32_32x32x16_bf16 a[64:79], v[40:43], v[28:31], a[64:79]
    ds_read_b64_tr_b16 v[72:73], v14 offset:40960
    v_mfma_f32_32x32x16_bf16 a[80:95], v[44:47], v[28:31], a[80:95]
    ds_read_b64_tr_b16 v[74:75], v14 offset:43008
    v_mfma_f32_32x32x16_bf16 a[96:111], v[48:51], v[28:31], a[96:111]
    ds_read_b64_tr_b16 v[76:77], v15 offset:40960
    v_mfma_f32_32x32x16_bf16 a[112:127], v[52:55], v[28:31], a[112:127]
    ds_read_b64_tr_b16 v[78:79], v15 offset:43008
    v_mfma_f32_32x32x16_bf16 a[128:143], v[40:43], v[32:35], a[128:143]
    ds_read_b64_tr_b16 v[80:81], v16 offset:40960
    v_mfma_f32_32x32x16_bf16 a[144:159], v[44:47], v[32:35], a[144:159]
    ds_read_b64_tr_b16 v[82:83], v16 offset:43008
    v_mfma_f32_32x32x16_bf16 a[160:175], v[48:51], v[32:35], a[160:175]
    ds_read_b64_tr_b16 v[84:85], v17 offset:40960
    v_mfma_f32_32x32x16_bf16 a[176:191], v[52:55], v[32:35], a[176:191]
    ds_read_b64_tr_b16 v[86:87], v17 offset:43008
    v_mfma_f32_32x32x16_bf16 a[192:207], v[40:43], v[36:39], a[192:207]
    v_mfma_f32_32x32x16_bf16 a[208:223], v[44:47], v[36:39], a[208:223]
    v_mfma_f32_32x32x16_bf16 a[224:239], v[48:51], v[36:39], a[224:239]
    v_mfma_f32_32x32x16_bf16 a[240:255], v[52:55], v[36:39], a[240:255]
    s_waitcnt vmcnt(8)
    s_waitcnt lgkmcnt(0)
    s_barrier
    s_add_u32 s26, s25, 0
    v_mfma_f32_32x32x16_bf16 a[0:15], v[72:75], v[56:59], a[0:15]
    ds_read_b128 v[24:27], v12 offset:0
    v_mfma_f32_32x32x16_bf16 a[16:31], v[76:79], v[56:59], a[16:31]
    ds_read_b128 v[28:31], v12 offset:2048
    v_mfma_f32_32x32x16_bf16 a[32:47], v[80:83], v[56:59], a[32:47]
    ds_read_b128 v[32:35], v12 offset:4096
    s_add_u32 m0, s26, 0
    s_nop 0
    v_mfma_f32_32x32x16_bf16 a[48:63], v[84:87], v[56:59], a[48:63]
    ds_read_b128 v[36:39], v12 offset:6144
    buffer_load_dwordx4 v2, s[8:11], s16 offen lds
    s_add_u32 m0, s26, 1024
    v_mfma_f32_32x32x16_bf16 a[64:79], v[72:75], v[60:63], a[64:79]
    ds_read_b64_tr_b16 v[40:41], v18 offset:0
    s_nop 0
    buffer_load_dwordx4 v3, s[8:11], s16 offen lds
    v_mfma_f32_32x32x16_bf16 a[80:95], v[76:79], v[60:63], a[80:95]
    ds_read_b64_tr_b16 v[42:43], v18 offset:2048
    s_add_u32 m0, s26, 2048
    s_nop 0
    v_mfma_f32_32x32x16_bf16 a[96:111], v[80:83], v[60:63], a[96:111]
    ds_read_b64_tr_b16 v[44:45], v19 offset:0
    buffer_load_dwordx4 v4, s[8:11], s16 offen lds
    s_add_u32 m0, s26, 3072
    v_mfma_f32_32x32x16_bf16 a[112:127], v[84:87], v[60:63], a[112:127]
    ds_read_b64_tr_b16 v[46:47], v19 offset:2048
    s_nop 0
    buffer_load_dwordx4 v5, s[8:11], s16 offen lds
    v_mfma_f32_32x32x16_bf16 a[128:143], v[72:75], v[64:67], a[128:143]
    ds_read_b64_tr_b16 v[48:49], v20 offset:0
    s_add_u32 m0, s26, 16384
    s_nop 0
    v_mfma_f32_32x32x16_bf16 a[144:159], v[76:79], v[64:67], a[144:159]
    ds_read_b64_tr_b16 v[50:51], v20 offset:2048
    buffer_load_dwordx4 v6, s[12:15], s17 offen lds
    s_add_u32 m0, s26, 17408
    v_mfma_f32_32x32x16_bf16 a[160:175], v[80:83], v[64:67], a[160:175]
    ds_read_b64_tr_b16 v[52:53], v21 offset:0
    s_nop 0
    buffer_load_dwordx4 v7, s[12:15], s17 offen lds
    v_mfma_f32_32x32x16_bf16 a[176:191], v[84:87], v[64:67], a[176:191]
    ds_read_b64_tr_b16 v[54:55], v21 offset:2048
    s_add_u32 m0, s26, 18432
    s_nop 0
    v_mfma_f32_32x32x16_bf16 a[192:207], v[72:75], v[68:71], a[192:207]
    buffer_load_dwordx4 v8, s[12:15], s17 offen lds
    s_add_u32 m0, s26, 19456
    v_mfma_f32_32x32x16_bf16 a[208:223], v[76:79], v[68:71], a[208:223]
    s_nop 0
    buffer_load_dwordx4 v9, s[12:15], s17 offen lds
    v_mfma_f32_32x32x16_bf16 a[224:239], v[80:83], v[68:71], a[224:239]
    s_add_u32 s16, s16, s27
    s_add_u32 s17, s17, s28
    v_mfma_f32_32x32x16_bf16 a[240:255], v[84:87], v[68:71], a[240:255]
    s_waitcnt lgkmcnt(0)
    v_mfma_f32_32x32x16_bf16 a[0:15], v[40:43], v[24:27], a[0:15]
    ds_read_b128 v[56:59], v13 offset:0
    v_mfma_f32_32x32x16_bf16 a[16:31], v[44:47], v[24:27], a[16:31]
    ds_read_b128 v[60:63], v13 offset:2048
    v_mfma_f32_32x32x16_bf16 a[32:47], v[48:51], v[24:27], a[32:47]
    ds_read_b128 v[64:67], v13 offset:4096
    v_mfma_f32_32x32x16_bf16 a[48:63], v[52:55], v[24:27], a[48:63]
    ds_read_b128 v[68:71], v13 offset:6144
    v_mfma_f32_32x32x16_bf16 a[64:79], v[40:43], v[28:31], a[64:79]
    ds_read_b64_tr_b16 v[72:73], v18 offset:8192
    v_mfma_f32_32x32x16_bf16 a[80:95], v[44:47], v[28:31], a[80:95]
    ds_read_b64_tr_b16 v[74:75], v18 offset:10240
    v_mfma_f32_32x32x16_bf16 a[96:111], v[48:51], v[28:31], a[96:111]
    ds_read_b64_tr_b16 v[76:77], v19 offset:8192
    v_mfma_f32_32x32x16_bf16 a[112:127], v[52:55], v[28:31], a[112:127]
    ds_read_b64_tr_b16 v[78:79], v19 offset:10240
    v_mfma_f32_32x32x16_bf16 a[128:143], v[40:43], v[32:35], a[128:143]
    ds_read_b64_tr_b16 v[80:81], v20 offset:8192
    v_mfma_f32_32x32x16_bf16 a[144:159], v[44:47], v[32:35], a[144:159]
    ds_read_b64_tr_b16 v[82:83], v20 offset:10240
    v_mfma_f32_32x32x16_bf16 a[160:175], v[48:51], v[32:35], a[160:175]
    ds_read_b64_tr_b16 v[84:85], v21 offset:8192
    v_mfma_f32_32x32x16_bf16 a[176:191], v[52:55], v[32:35], a[176:191]
    ds_read_b64_tr_b16 v[86:87], v21 offset:10240
    v_mfma_f32_32x32x16_bf16 a[192:207], v[40:43], v[36:39], a[192:207]
    v_mfma_f32_32x32x16_bf16 a[208:223], v[44:47], v[36:39], a[208:223]
    v_mfma_f32_32x32x16_bf16 a[224:239], v[48:51], v[36:39], a[224:239]
    v_mfma_f32_32x32x16_bf16 a[240:255], v[52:55], v[36:39], a[240:255]
    s_waitcnt vmcnt(8)
    s_waitcnt lgkmcnt(0)
    s_barrier
    s_add_u32 s26, s25, 32768
    v_mfma_f32_32x32x16_bf16 a[0:15], v[72:75], v[56:59], a[0:15]
    ds_read_b128 v[24:27], v12 offset:32768
    v_mfma_f32_32x32x16_bf16 a[16:31], v[76:79], v[56:59], a[16:31]
    ds_read_b128 v[28:31], v12 offset:34816
    v_mfma_f32_32x32x16_bf16 a[32:47], v[80:83], v[56:59], a[32:47]
    ds_read_b128 v[32:35], v12 offset:36864
    s_add_u32 m0, s26, 0
    s_nop 0
    v_mfma_f32_32x32x16_bf16 a[48:63], v[84:87], v[56:59], a[48:63]
    ds_read_b128 v[36:39], v12 offset:38912
    buffer_load_dwordx4 v2, s[8:11], s16 offen lds
    s_add_u32 m0, s26, 1024
    v_mfma_f32_32x32x16_bf16 a[64:79], v[72:75], v[60:63], a[64:79]
    ds_read_b64_tr_b16 v[40:41], v18 offset:32768
    s_nop 0
    buffer_load_dwordx4 v3, s[8:11], s16 offen lds
    v_mfma_f32_32x32x16_bf16 a[80:95], v[76:79], v[60:63], a[80:95]
    ds_read_b64_tr_b16 v[42:43], v18 offset:34816
    s_add_u32 m0, s26, 2048
    s_nop 0
    v_mfma_f32_32x32x16_bf16 a[96:111], v[80:83], v[60:63], a[96:111]
    ds_read_b64_tr_b16 v[44:45], v19 offset:32768
    buffer_load_dwordx4 v4, s[8:11], s16 offen lds
    s_add_u32 m0, s26, 3072
    v_mfma_f32_32x32x16_bf16 a[112:127], v[84:87], v[60:63], a[112:127]
    ds_read_b64_tr_b16 v[46:47], v19 offset:34816
    s_nop 0
    buffer_load_dwordx4 v5, s[8:11], s16 offen lds
    v_mfma_f32_32x32x16_bf16 a[128:143], v[72:75], v[64:67], a[128:143]
    ds_read_b64_tr_b16 v[48:49], v20 offset:32768
    s_add_u32 m0, s26, 16384
    s_nop 0
    v_mfma_f32_32x32x16_bf16 a[144:159], v[76:79], v[64:67], a[144:159]
    ds_read_b64_tr_b16 v[50:51], v20 offset:34816
    buffer_load_dwordx4 v6, s[12:15], s17 offen lds
    s_add_u32 m0, s26, 17408
    v_mfma_f32_32x32x16_bf16 a[160:175], v[80:83], v[64:67], a[160:175]
    ds_read_b64_tr_b16 v[52:53], v21 offset:32768
    s_nop 0
    buffer_load_dwordx4 v7, s[12:15], s17 offen lds
    v_mfma_f32_32x32x16_bf16 a[176:191], v[84:87], v[64:67], a[176:191]
    ds_read_b64_tr_b16 v[54:55], v21 offset:34816
    s_add_u32 m0, s26, 18432
    s_nop 0
    v_mfma_f32_32x32x16_bf16 a[192:207], v[72:75], v[68:71], a[192:207]
    buffer_load_dwordx4 v8, s[12:15], s17 offen lds
    s_add_u32 m0, s26, 19456
    v_mfma_f32_32x32x16_bf16 a[208:223], v[76:79], v[68:71], a[208:223]
    s_nop 0
    buffer_load_dwordx4 v9, s[12:15], s17 offen lds
    v_mfma_f32_32x32x16_bf16 a[224:239], v[80:83], v[68:71], a[224:239]
    s_add_u32 s16, s16, s27
    s_add_u32 s17, s17, s28
    v_mfma_f32_32x32x16_bf16 a[240:255], v[84:87], v[68:71], a[240:255]
    s_waitcnt lgkmcnt(0)
    v_mfma_f32_32x32x16_bf16 a[0:15], v[40:43], v[24:27], a[0:15]
    ds_read_b128 v[56:59], v13 offset:32768
    v_mfma_f32_32x32x16_bf16 a[16:31], v[44:47], v[24:27], a[16:31]
    ds_read_b128 v[60:63], v13 offset:34816
    v_mfma_f32_32x32x16_bf16 a[32:47], v[48:51], v[24:27], a[32:47]
    ds_read_b128 v[64:67], v13 offset:36864
    v_mfma_f32_32x32x16_bf16 a[48:63], v[52:55], v[24:27], a[48:63]
    ds_read_b128 v[68:71], v13 offset:38912
    v_mfma_f32_32x32x16_bf16 a[64:79], v[40:43], v[28:31], a[64:79]
    ds_read_b64_tr_b16 v[72:73], v18 offset:40960
    v_mfma_f32_32x32x16_bf16 a[80:95], v[44:47], v[28:31], a[80:95]
    ds_read_b64_tr_b16 v[74:75], v18 offset:43008
    v_mfma_f32_32x32x16_bf16 a[96:111], v[48:51], v[28:31], a[96:111]
    ds_read_b64_tr_b16 v[76:77], v19 offset:40960
    v_mfma_f32_32x32x16_bf16 a[112:127], v[52:55], v[28:31], a[112:127]
    ds_read_b64_tr_b16 v[78:79], v19 offset:43008
    v_mfma_f32_32x32x16_bf16 a[128:143], v[40:43], v[32:35], a[128:143]
    ds_read_b64_tr_b16 v[80:81], v20 offset:40960
    v_mfma_f32_32x32x16_bf16 a[144:159], v[44:47], v[32:35], a[144:159]
    ds_read_b64_tr_b16 v[82:83], v20 offset:43008
    v_mfma_f32_32x32x16_bf16 a[160:175], v[48:51], v[32:35], a[160:175]
    ds_read_b64_tr_b16 v[84:85], v21 offset:40960
    v_mfma_f32_32x32x16_bf16 a[176:191], v[52:55], v[32:35], a[176:191]
    ds_read_b64_tr_b16 v[86:87], v21 offset:43008
    v_mfma_f32_32x32x16_bf16 a[192:207], v[40:43], v[36:39], a[192:207]
    v_mfma_f32_32x32x16_bf16 a[208:223], v[44:47], v[36:39], a[208:223]
    v_mfma_f32_32x32x16_bf16 a[224:239], v[48:51], v[36:39], a[224:239]
    v_mfma_f32_32x32x16_bf16 a[240:255], v[52:55], v[36:39], a[240:255]
    s_waitcnt vmcnt(8)
    s_waitcnt lgkmcnt(0)
    s_barrier
    s_add_u32 s26, s25, 65536
    v_mfma_f32_32x32x16_bf16 a[0:15], v[72:75], v[56:59], a[0:15]
    ds_read_b128 v[24:27], v10 offset:0
    v_mfma_f32_32x32x16_bf16 a[16:31], v[76:79], v[56:59], a[16:31]
    ds_read_b128 v[28:31], v10 offset:2048
    v_mfma_f32_32x32x16_bf16 a[32:47], v[80:83], v[56:59], a[32:47]
    ds_read_b128 v[32:35], v10 offset:4096
    s_add_u32 m0, s26, 0
    s_nop 0
    v_mfma_f32_32x32x16_bf16 a[48:63], v[84:87], v[56:59], a[48:63]
    ds_read_b128 v[36:39], v10 offset:6144
    buffer_load_dwordx4 v2, s[8:11], s16 offen lds
    s_add_u32 m0, s26, 1024
    v_mfma_f32_32x32x16_bf16 a[64:79], v[72:75], v[60:63], a[64:79]
    ds_read_b64_tr_b16 v[40:41], v14 offset:0
    s_nop 0
    buffer_load_dwordx4 v3, s[8:11], s16 offen lds
    v_mfma_f32_32x32x16_bf16 a[80:95], v[76:79], v[60:63], a[80:95]
    ds_read_b64_tr_b16 v[42:43], v14 offset:2048
    s_add_u32 m0, s26, 2048
    s_nop 0
    v_mfma_f32_32x32x16_bf16 a[96:111], v[80:83], v[60:63], a[96:111]
    ds_read_b64_tr_b16 v[44:45], v15 offset:0
    buffer_load_dwordx4 v4, s[8:11], s16 offen lds
    s_add_u32 m0, s26, 3072
    v_mfma_f32_32x32x16_bf16 a[112:127], v[84:87], v[60:63], a[112:127]
    ds_read_b64_tr_b16 v[46:47], v15 offset:2048
    s_nop 0
    buffer_load_dwordx4 v5, s[8:11], s16 offen lds
    v_mfma_f32_32x32x16_bf16 a[128:143], v[72:75], v[64:67], a[128:143]
    ds_read_b64_tr_b16 v[48:49], v16 offset:0
    s_add_u32 m0, s26, 16384
    s_nop 0
    v_mfma_f32_32x32x16_bf16 a[144:159], v[76:79], v[64:67], a[144:159]
    ds_read_b64_tr_b16 v[50:51], v16 offset:2048
    buffer_load_dwordx4 v6, s[12:15], s17 offen lds
    s_add_u32 m0, s26, 17408
    v_mfma_f32_32x32x16_bf16 a[160:175], v[80:83], v[64:67], a[160:175]
    ds_read_b64_tr_b16 v[52:53], v17 offset:0
    s_nop 0
    buffer_load_dwordx4 v7, s[12:15], s17 offen lds
    v_mfma_f32_32x32x16_bf16 a[176:191], v[84:87], v[64:67], a[176:191]
    ds_read_b64_tr_b16 v[54:55], v17 offset:2048
    s_add_u32 m0, s26, 18432
    s_nop 0
    v_mfma_f32_32x32x16_bf16 a[192:207], v[72:75], v[68:71], a[192:207]
    buffer_load_dwordx4 v8, s[12:15], s17 offen lds
    s_add_u32 m0, s26, 19456
    v_mfma_f32_32x32x16_bf16 a[208:223], v[76:79], v[68:71], a[208:223]
    s_nop 0
    buffer_load_dwordx4 v9, s[12:15], s17 offen lds
    v_mfma_f32_32x32x16_bf16 a[224:239], v[80:83], v[68:71], a[224:239]
    s_add_u32 s16, s16, s27
    s_add_u32 s17, s17, s28
    v_mfma_f32_32x32x16_bf16 a[240:255], v[84:87], v[68:71], a[240:255]
    s_add_u32 s21, s21, 4
    s_cmp_lt_u32 s21, s20
    s_cbranch_scc1 L_gemm_f1
    s_waitcnt vmcnt(0) lgkmcnt(0)
    s_nop 15
    s_barrier
    s_mul_i32 s38, s35, 917504
    s_lshl_b32 s39, s37, 9
    s_add_u32 s38, s38, s39
    s_add_u32 s38, s38, 75497472
    s_add_u32 s42, s32, s38
    s_addc_u32 s43, s33, 0
    s_mov_b32 s44, 3584
    s_lshl_b32 s25, s22, 15
    v_and_b32 v88, 31, v1
    v_lshlrev_b32 v90, 8, v88
    v_add_u32 v90, s25, v90
    v_and_b32 v89, 15, v88
    v_lshrrev_b32 v88, 5, v1
    v_xor_b32 v89, v89, v88
    v_xor_b32 v93, 0, v89
    v_lshl_add_u32 v93, v93, 4, v90
    v_xor_b32 v94, 2, v89
    v_lshl_add_u32 v94, v94, 4, v90
    v_xor_b32 v95, 4, v89
    v_lshl_add_u32 v95, v95, 4, v90
    v_xor_b32 v96, 6, v89
    v_lshl_add_u32 v96, v96, 4, v90
    v_xor_b32 v97, 8, v89
    v_lshl_add_u32 v97, v97, 4, v90
    v_xor_b32 v98, 10, v89
    v_lshl_add_u32 v98, v98, 4, v90
    v_xor_b32 v99, 12, v89
    v_lshl_add_u32 v99, v99, 4, v90
    v_xor_b32 v100, 14, v89
    v_lshl_add_u32 v100, v100, 4, v90
    v_accvgpr_read_b32 v24, a0
    v_accvgpr_read_b32 v25, a1
    v_accvgpr_read_b32 v26, a2
    v_accvgpr_read_b32 v27, a3
    v_accvgpr_read_b32 v28, a4
    v_accvgpr_read_b32 v29, a5
    v_accvgpr_read_b32 v30, a6
    v_accvgpr_read_b32 v31, a7
    v_accvgpr_read_b32 v32, a8
    v_accvgpr_read_b32 v33, a9
    v_accvgpr_read_b32 v34, a10
    v_accvgpr_read_b32 v35, a11
    v_accvgpr_read_b32 v36, a12
    v_accvgpr_read_b32 v37, a13
    v_accvgpr_read_b32 v38, a14
    v_accvgpr_read_b32 v39, a15
    v_max_f32 v24, 0, v24
    v_max_f32 v25, 0, v25
    v_max_f32 v26, 0, v26
    v_max_f32 v27, 0, v27
    v_max_f32 v28, 0, v28
    v_max_f32 v29, 0, v29
    v_max_f32 v30, 0, v30
    v_max_f32 v31, 0, v31
    v_max_f32 v32, 0, v32
    v_max_f32 v33, 0, v33
    v_max_f32 v34, 0, v34
    v_max_f32 v35, 0, v35
    v_max_f32 v36, 0, v36
    v_max_f32 v37, 0, v37
    v_max_f32 v38, 0, v38
    v_max_f32 v39, 0, v39
    v_cvt_pk_bf16_f32 v40, v24, v25
    v_cvt_pk_bf16_f32 v41, v26, v27
    v_cvt_pk_bf16_f32 v42, v28, v29
    v_cvt_pk_bf16_f32 v43, v30, v31
    v_cvt_pk_bf16_f32 v44, v32, v33
    v_cvt_pk_bf16_f32 v45, v34, v35
    v_cvt_pk_bf16_f32 v46, v36, v37
    v_cvt_pk_bf16_f32 v47, v38, v39
    s_nop 1
    v_permlane32_swap_b32 v40, v42
    v_permlane32_swap_b32 v41, v43
    v_permlane32_swap_b32 v44, v46
    v_permlane32_swap_b32 v45, v47
    ds_write_b128 v93, v[40:43] offset:0
    ds_write_b128 v94, v[44:47] offset:0
    v_accvgpr_read_b32 v48, a16
    v_accvgpr_read_b32 v49, a17
    v_accvgpr_read_b32 v50, a18
    v_accvgpr_read_b32 v51, a19
    v_accvgpr_read_b32 v52, a20
    v_accvgpr_read_b32 v53, a21
    v_accvgpr_read_b32 v54, a22
    v_accvgpr_read_b32 v55, a23
    v_accvgpr_read_b32 v56, a24
    v_accvgpr_read_b32 v57, a25
    v_accvgpr_read_b32 v58, a26
    v_accvgpr_read_b32 v59, a27
    v_accvgpr_read_b32 v60, a28
    v_accvgpr_read_b32 v61, a29
    v_accvgpr_read_b32 v62, a30
    v_accvgpr_read_b32 v63, a31
    v_max_f32 v48, 0, v48
    v_max_f32 v49, 0, v49
    v_max_f32 v50, 0, v50
    v_max_f32 v51, 0, v51
    v_max_f32 v52, 0, v52
    v_max_f32 v53, 0, v53
    v_max_f32 v54, 0, v54
    v_max_f32 v55, 0, v55
    v_max_f32 v56, 0, v56
    v_max_f32 v57, 0, v57
    v_max_f32 v58, 0, v58
    v_max_f32 v59, 0, v59
    v_max_f32 v60, 0, v60
    v_max_f32 v61, 0, v61
    v_max_f32 v62, 0, v62
    v_max_f32 v63, 0, v63
    v_cvt_pk_bf16_f32 v64, v48, v49
    v_cvt_pk_bf16_f32 v65, v50, v51
    v_cvt_pk_bf16_f32 v66, v52, v53
    v_cvt_pk_bf16_f32 v67, v54, v55
    v_cvt_pk_bf16_f32 v68, v56, v57
    v_cvt_pk_bf16_f32 v69, v58, v59
    v_cvt_pk_bf16_f32 v70, v60, v61
    v_cvt_pk_bf16_f32 v71, v62, v63
    s_nop 1
    v_permlane32_swap_b32 v64, v66
    v_permlane32_swap_b32 v65, v67
    v_permlane32_swap_b32 v68, v70
    v_permlane32_swap_b32 v69, v71
    ds_write_b128 v95, v[64:67] offset:0
    ds_write_b128 v96, v[68:71] offset:0
    v_accvgpr_read_b32 v24, a32
    v_accvgpr_read_b32 v25, a33
    v_accvgpr_read_b32 v26, a34
    v_accvgpr_read_b32 v27, a35
    v_accvgpr_read_b32 v28, a36
    v_accvgpr_read_b32 v29, a37
    v_accvgpr_read_b32 v30, a38
    v_accvgpr_read_b32 v31, a39
    v_accvgpr_read_b32 v32, a40
    v_accvgpr_read_b32 v33, a41
    v_accvgpr_read_b32 v34, a42
    v_accvgpr_read_b32 v35, a43
    v_accvgpr_read_b32 v36, a44
    v_accvgpr_read_b32 v37, a45
    v_accvgpr_read_b32 v38, a46
    v_accvgpr_read_b32 v39, a47
    v_max_f32 v24, 0, v24
    v_max_f32 v25, 0, v25
    v_max_f32 v26, 0, v26
    v_max_f32 v27, 0, v27
    v_max_f32 v28, 0, v28
    v_max_f32 v29, 0, v29
    v_max_f32 v30, 0, v30
    v_max_f32 v31, 0, v31
    v_max_f32 v32, 0, v32
    v_max_f32 v33, 0, v33
    v_max_f32 v34, 0, v34
    v_max_f32 v35, 0, v35
    v_max_f32 v36, 0, v36
    v_max_f32 v37, 0, v37
    v_max_f32 v38, 0, v38
    v_max_f32 v39, 0, v39
    v_cvt_pk_bf16_f32 v40, v24, v25
    v_cvt_pk_bf16_f32 v41, v26, v27
    v_cvt_pk_bf16_f32 v42, v28, v29
    v_cvt_pk_bf16_f32 v43, v30, v31
    v_cvt_pk_bf16_f32 v44, v32, v33
    v_cvt_pk_bf16_f32 v45, v34, v35
    v_cvt_pk_bf16_f32 v46, v36, v37
    v_cvt_pk_bf16_f32 v47, v38, v39
    s_nop 1
    v_permlane32_swap_b32 v40, v42
    v_permlane32_swap_b32 v41, v43
    v_permlane32_swap_b32 v44, v46
    v_permlane32_swap_b32 v45, v47
    ds_write_b128 v97, v[40:43] offset:0
    ds_write_b128 v98, v[44:47] offset:0
    v_accvgpr_read_b32 v48, a48
    v_accvgpr_read_b32 v49, a49
    v_accvgpr_read_b32 v50, a50
    v_accvgpr_read_b32 v51, a51
    v_accvgpr_read_b32 v52, a52
    v_accvgpr_read_b32 v53, a53
    v_accvgpr_read_b32 v54, a54
    v_accvgpr_read_b32 v55, a55
    v_accvgpr_read_b32 v56, a56
    v_accvgpr_read_b32 v57, a57
    v_accvgpr_read_b32 v58, a58
    v_accvgpr_read_b32 v59, a59
    v_accvgpr_read_b32 v60, a60
    v_accvgpr_read_b32 v61, a61
    v_accvgpr_read_b32 v62, a62
    v_accvgpr_read_b32 v63, a63
    v_max_f32 v48, 0, v48
    v_max_f32 v49, 0, v49
    v_max_f32 v50, 0, v50
    v_max_f32 v51, 0, v51
    v_max_f32 v52, 0, v52
    v_max_f32 v53, 0, v53
    v_max_f32 v54, 0, v54
    v_max_f32 v55, 0, v55
    v_max_f32 v56, 0, v56
    v_max_f32 v57, 0, v57
    v_max_f32 v58, 0, v58
    v_max_f32 v59, 0, v59
    v_max_f32 v60, 0, v60
    v_max_f32 v61, 0, v61
    v_max_f32 v62, 0, v62
    v_max_f32 v63, 0, v63
    v_cvt_pk_bf16_f32 v64, v48, v49
    v_cvt_pk_bf16_f32 v65, v50, v51
    v_cvt_pk_bf16_f32 v66, v52, v53
    v_cvt_pk_bf16_f32 v67, v54, v55
    v_cvt_pk_bf16_f32 v68, v56, v57
    v_cvt_pk_bf16_f32 v69, v58, v59
    v_cvt_pk_bf16_f32 v70, v60, v61
    v_cvt_pk_bf16_f32 v71, v62, v63
    s_nop 1
    v_permlane32_swap_b32 v64, v66
    v_permlane32_swap_b32 v65, v67
    v_permlane32_swap_b32 v68, v70
    v_permlane32_swap_b32 v69, v71
    ds_write_b128 v99, v[64:67] offset:0
    ds_write_b128 v100, v[68:71] offset:0
    v_accvgpr_read_b32 v24, a64
    v_accvgpr_read_b32 v25, a65
    v_accvgpr_read_b32 v26, a66
    v_accvgpr_read_b32 v27, a67
    v_accvgpr_read_b32 v28, a68
    v_accvgpr_read_b32 v29, a69
    v_accvgpr_read_b32 v30, a70
    v_accvgpr_read_b32 v31, a71
    v_accvgpr_read_b32 v32, a72
    v_accvgpr_read_b32 v33, a73
    v_accvgpr_read_b32 v34, a74
    v_accvgpr_read_b32 v35, a75
    v_accvgpr_read_b32 v36, a76
    v_accvgpr_read_b32 v37, a77
    v_accvgpr_read_b32 v38, a78
    v_accvgpr_read_b32 v39, a79
    v_max_f32 v24, 0, v24
    v_max_f32 v25, 0, v25
    v_max_f32 v26, 0, v26
    v_max_f32 v27, 0, v27
    v_max_f32 v28, 0, v28
    v_max_f32 v29, 0, v29
    v_max_f32 v30, 0, v30
    v_max_f32 v31, 0, v31
    v_max_f32 v32, 0, v32
    v_max_f32 v33, 0, v33
    v_max_f32 v34, 0, v34
    v_max_f32 v35, 0, v35
    v_max_f32 v36, 0, v36
    v_max_f32 v37, 0, v37
    v_max_f32 v38, 0, v38
    v_max_f32 v39, 0, v39
    v_cvt_pk_bf16_f32 v40, v24, v25
    v_cvt_pk_bf16_f32 v41, v26, v27
    v_cvt_pk_bf16_f32 v42, v28, v29
    v_cvt_pk_bf16_f32 v43, v30, v31
    v_cvt_pk_bf16_f32 v44, v32, v33
    v_cvt_pk_bf16_f32 v45, v34, v35
    v_cvt_pk_bf16_f32 v46, v36, v37
    v_cvt_pk_bf16_f32 v47, v38, v39
    s_nop 1
    v_permlane32_swap_b32 v40, v42
    v_permlane32_swap_b32 v41, v43
    v_permlane32_swap_b32 v44, v46
    v_permlane32_swap_b32 v45, v47
    ds_write_b128 v93, v[40:43] offset:8192
    ds_write_b128 v94, v[44:47] offset:8192
    v_accvgpr_read_b32 v48, a80
    v_accvgpr_read_b32 v49, a81
    v_accvgpr_read_b32 v50, a82
    v_accvgpr_read_b32 v51, a83
    v_accvgpr_read_b32 v52, a84
    v_accvgpr_read_b32 v53, a85
    v_accvgpr_read_b32 v54, a86
    v_accvgpr_read_b32 v55, a87
    v_accvgpr_read_b32 v56, a88
    v_accvgpr_read_b32 v57, a89
    v_accvgpr_read_b32 v58, a90
    v_accvgpr_read_b32 v59, a91
    v_accvgpr_read_b32 v60, a92
    v_accvgpr_read_b32 v61, a93
    v_accvgpr_read_b32 v62, a94
    v_accvgpr_read_b32 v63, a95
    v_max_f32 v48, 0, v48
    v_max_f32 v49, 0, v49
    v_max_f32 v50, 0, v50
    v_max_f32 v51, 0, v51
    v_max_f32 v52, 0, v52
    v_max_f32 v53, 0, v53
    v_max_f32 v54, 0, v54
    v_max_f32 v55, 0, v55
    v_max_f32 v56, 0, v56
    v_max_f32 v57, 0, v57
    v_max_f32 v58, 0, v58
    v_max_f32 v59, 0, v59
    v_max_f32 v60, 0, v60
    v_max_f32 v61, 0, v61
    v_max_f32 v62, 0, v62
    v_max_f32 v63, 0, v63
    v_cvt_pk_bf16_f32 v64, v48, v49
    v_cvt_pk_bf16_f32 v65, v50, v51
    v_cvt_pk_bf16_f32 v66, v52, v53
    v_cvt_pk_bf16_f32 v67, v54, v55
    v_cvt_pk_bf16_f32 v68, v56, v57
    v_cvt_pk_bf16_f32 v69, v58, v59
    v_cvt_pk_bf16_f32 v70, v60, v61
    v_cvt_pk_bf16_f32 v71, v62, v63
    s_nop 1
    v_permlane32_swap_b32 v64, v66
    v_permlane32_swap_b32 v65, v67
    v_permlane32_swap_b32 v68, v70
    v_permlane32_swap_b32 v69, v71
    ds_write_b128 v95, v[64:67] offset:8192
    ds_write_b128 v96, v[68:71] offset:8192
    v_accvgpr_read_b32 v24, a96
    v_accvgpr_read_b32 v25, a97
    v_accvgpr_read_b32 v26, a98
    v_accvgpr_read_b32 v27, a99
    v_accvgpr_read_b32 v28, a100
    v_accvgpr_read_b32 v29, a101
    v_accvgpr_read_b32 v30, a102
    v_accvgpr_read_b32 v31, a103
    v_accvgpr_read_b32 v32, a104
    v_accvgpr_read_b32 v33, a105
    v_accvgpr_read_b32 v34, a106
    v_accvgpr_read_b32 v35, a107
    v_accvgpr_read_b32 v36, a108
    v_accvgpr_read_b32 v37, a109
    v_accvgpr_read_b32 v38, a110
    v_accvgpr_read_b32 v39, a111
    v_max_f32 v24, 0, v24
    v_max_f32 v25, 0, v25
    v_max_f32 v26, 0, v26
    v_max_f32 v27, 0, v27
    v_max_f32 v28, 0, v28
    v_max_f32 v29, 0, v29
    v_max_f32 v30, 0, v30
    v_max_f32 v31, 0, v31
    v_max_f32 v32, 0, v32
    v_max_f32 v33, 0, v33
    v_max_f32 v34, 0, v34
    v_max_f32 v35, 0, v35
    v_max_f32 v36, 0, v36
    v_max_f32 v37, 0, v37
    v_max_f32 v38, 0, v38
    v_max_f32 v39, 0, v39
    v_cvt_pk_bf16_f32 v40, v24, v25
    v_cvt_pk_bf16_f32 v41, v26, v27
    v_cvt_pk_bf16_f32 v42, v28, v29
    v_cvt_pk_bf16_f32 v43, v30, v31
    v_cvt_pk_bf16_f32 v44, v32, v33
    v_cvt_pk_bf16_f32 v45, v34, v35
    v_cvt_pk_bf16_f32 v46, v36, v37
    v_cvt_pk_bf16_f32 v47, v38, v39
    s_nop 1
    v_permlane32_swap_b32 v40, v42
    v_permlane32_swap_b32 v41, v43
    v_permlane32_swap_b32 v44, v46
    v_permlane32_swap_b32 v45, v47
    ds_write_b128 v97, v[40:43] offset:8192
    ds_write_b128 v98, v[44:47] offset:8192
    v_accvgpr_read_b32 v48, a112
    v_accvgpr_read_b32 v49, a113
    v_accvgpr_read_b32 v50, a114
    v_accvgpr_read_b32 v51, a115
    v_accvgpr_read_b32 v52, a116
    v_accvgpr_read_b32 v53, a117
    v_accvgpr_read_b32 v54, a118
    v_accvgpr_read_b32 v55, a119
    v_accvgpr_read_b32 v56, a120
    v_accvgpr_read_b32 v57, a121
    v_accvgpr_read_b32 v58, a122
    v_accvgpr_read_b32 v59, a123
    v_accvgpr_read_b32 v60, a124
    v_accvgpr_read_b32 v61, a125
    v_accvgpr_read_b32 v62, a126
    v_accvgpr_read_b32 v63, a127
    v_max_f32 v48, 0, v48
    v_max_f32 v49, 0, v49
    v_max_f32 v50, 0, v50
    v_max_f32 v51, 0, v51
    v_max_f32 v52, 0, v52
    v_max_f32 v53, 0, v53
    v_max_f32 v54, 0, v54
    v_max_f32 v55, 0, v55
    v_max_f32 v56, 0, v56
    v_max_f32 v57, 0, v57
    v_max_f32 v58, 0, v58
    v_max_f32 v59, 0, v59
    v_max_f32 v60, 0, v60
    v_max_f32 v61, 0, v61
    v_max_f32 v62, 0, v62
    v_max_f32 v63, 0, v63
    v_cvt_pk_bf16_f32 v64, v48, v49
    v_cvt_pk_bf16_f32 v65, v50, v51
    v_cvt_pk_bf16_f32 v66, v52, v53
    v_cvt_pk_bf16_f32 v67, v54, v55
    v_cvt_pk_bf16_f32 v68, v56, v57
    v_cvt_pk_bf16_f32 v69, v58, v59
    v_cvt_pk_bf16_f32 v70, v60, v61
    v_cvt_pk_bf16_f32 v71, v62, v63
    s_nop 1
    v_permlane32_swap_b32 v64, v66
    v_permlane32_swap_b32 v65, v67
    v_permlane32_swap_b32 v68, v70
    v_permlane32_swap_b32 v69, v71
    ds_write_b128 v99, v[64:67] offset:8192
    ds_write_b128 v100, v[68:71] offset:8192
    v_accvgpr_read_b32 v24, a128
    v_accvgpr_read_b32 v25, a129
    v_accvgpr_read_b32 v26, a130
    v_accvgpr_read_b32 v27, a131
    v_accvgpr_read_b32 v28, a132
    v_accvgpr_read_b32 v29, a133
    v_accvgpr_read_b32 v30, a134
    v_accvgpr_read_b32 v31, a135
    v_accvgpr_read_b32 v32, a136
    v_accvgpr_read_b32 v33, a137
    v_accvgpr_read_b32 v34, a138
    v_accvgpr_read_b32 v35, a139
    v_accvgpr_read_b32 v36, a140
    v_accvgpr_read_b32 v37, a141
    v_accvgpr_read_b32 v38, a142
    v_accvgpr_read_b32 v39, a143
    v_max_f32 v24, 0, v24
    v_max_f32 v25, 0, v25
    v_max_f32 v26, 0, v26
    v_max_f32 v27, 0, v27
    v_max_f32 v28, 0, v28
    v_max_f32 v29, 0, v29
    v_max_f32 v30, 0, v30
    v_max_f32 v31, 0, v31
    v_max_f32 v32, 0, v32
    v_max_f32 v33, 0, v33
    v_max_f32 v34, 0, v34
    v_max_f32 v35, 0, v35
    v_max_f32 v36, 0, v36
    v_max_f32 v37, 0, v37
    v_max_f32 v38, 0, v38
    v_max_f32 v39, 0, v39
    v_cvt_pk_bf16_f32 v40, v24, v25
    v_cvt_pk_bf16_f32 v41, v26, v27
    v_cvt_pk_bf16_f32 v42, v28, v29
    v_cvt_pk_bf16_f32 v43, v30, v31
    v_cvt_pk_bf16_f32 v44, v32, v33
    v_cvt_pk_bf16_f32 v45, v34, v35
    v_cvt_pk_bf16_f32 v46, v36, v37
    v_cvt_pk_bf16_f32 v47, v38, v39
    s_nop 1
    v_permlane32_swap_b32 v40, v42
    v_permlane32_swap_b32 v41, v43
    v_permlane32_swap_b32 v44, v46
    v_permlane32_swap_b32 v45, v47
    ds_write_b128 v93, v[40:43] offset:16384
    ds_write_b128 v94, v[44:47] offset:16384
    v_accvgpr_read_b32 v48, a144
    v_accvgpr_read_b32 v49, a145
    v_accvgpr_read_b32 v50, a146
    v_accvgpr_read_b32 v51, a147
    v_accvgpr_read_b32 v52, a148
    v_accvgpr_read_b32 v53, a149
    v_accvgpr_read_b32 v54, a150
    v_accvgpr_read_b32 v55, a151
    v_accvgpr_read_b32 v56, a152
    v_accvgpr_read_b32 v57, a153
    v_accvgpr_read_b32 v58, a154
    v_accvgpr_read_b32 v59, a155
    v_accvgpr_read_b32 v60, a156
    v_accvgpr_read_b32 v61, a157
    v_accvgpr_read_b32 v62, a158
    v_accvgpr_read_b32 v63, a159
    v_max_f32 v48, 0, v48
    v_max_f32 v49, 0, v49
    v_max_f32 v50, 0, v50
    v_max_f32 v51, 0, v51
    v_max_f32 v52, 0, v52
    v_max_f32 v53, 0, v53
    v_max_f32 v54, 0, v54
    v_max_f32 v55, 0, v55
    v_max_f32 v56, 0, v56
    v_max_f32 v57, 0, v57
    v_max_f32 v58, 0, v58
    v_max_f32 v59, 0, v59
    v_max_f32 v60, 0, v60
    v_max_f32 v61, 0, v61
    v_max_f32 v62, 0, v62
    v_max_f32 v63, 0, v63
    v_cvt_pk_bf16_f32 v64, v48, v49
    v_cvt_pk_bf16_f32 v65, v50, v51
    v_cvt_pk_bf16_f32 v66, v52, v53
    v_cvt_pk_bf16_f32 v67, v54, v55
    v_cvt_pk_bf16_f32 v68, v56, v57
    v_cvt_pk_bf16_f32 v69, v58, v59
    v_cvt_pk_bf16_f32 v70, v60, v61
    v_cvt_pk_bf16_f32 v71, v62, v63
    s_nop 1
    v_permlane32_swap_b32 v64, v66
    v_permlane32_swap_b32 v65, v67
    v_permlane32_swap_b32 v68, v70
    v_permlane32_swap_b32 v69, v71
    ds_write_b128 v95, v[64:67] offset:16384
    ds_write_b128 v96, v[68:71] offset:16384
    v_accvgpr_read_b32 v24, a160
    v_accvgpr_read_b32 v25, a161
    v_accvgpr_read_b32 v26, a162
    v_accvgpr_read_b32 v27, a163
    v_accvgpr_read_b32 v28, a164
    v_accvgpr_read_b32 v29, a165
    v_accvgpr_read_b32 v30, a166
    v_accvgpr_read_b32 v31, a167
    v_accvgpr_read_b32 v32, a168
    v_accvgpr_read_b32 v33, a169
    v_accvgpr_read_b32 v34, a170
    v_accvgpr_read_b32 v35, a171
    v_accvgpr_read_b32 v36, a172
    v_accvgpr_read_b32 v37, a173
    v_accvgpr_read_b32 v38, a174
    v_accvgpr_read_b32 v39, a175
    v_max_f32 v24, 0, v24
    v_max_f32 v25, 0, v25
    v_max_f32 v26, 0, v26
    v_max_f32 v27, 0, v27
    v_max_f32 v28, 0, v28
    v_max_f32 v29, 0, v29
    v_max_f32 v30, 0, v30
    v_max_f32 v31, 0, v31
    v_max_f32 v32, 0, v32
    v_max_f32 v33, 0, v33
    v_max_f32 v34, 0, v34
    v_max_f32 v35, 0, v35
    v_max_f32 v36, 0, v36
    v_max_f32 v37, 0, v37
    v_max_f32 v38, 0, v38
    v_max_f32 v39, 0, v39
    v_cvt_pk_bf16_f32 v40, v24, v25
    v_cvt_pk_bf16_f32 v41, v26, v27
    v_cvt_pk_bf16_f32 v42, v28, v29
    v_cvt_pk_bf16_f32 v43, v30, v31
    v_cvt_pk_bf16_f32 v44, v32, v33
    v_cvt_pk_bf16_f32 v45, v34, v35
    v_cvt_pk_bf16_f32 v46, v36, v37
    v_cvt_pk_bf16_f32 v47, v38, v39
    s_nop 1
    v_permlane32_swap_b32 v40, v42
    v_permlane32_swap_b32 v41, v43
    v_permlane32_swap_b32 v44, v46
    v_permlane32_swap_b32 v45, v47
    ds_write_b128 v97, v[40:43] offset:16384
    ds_write_b128 v98, v[44:47] offset:16384
    v_accvgpr_read_b32 v48, a176
    v_accvgpr_read_b32 v49, a177
    v_accvgpr_read_b32 v50, a178
    v_accvgpr_read_b32 v51, a179
    v_accvgpr_read_b32 v52, a180
    v_accvgpr_read_b32 v53, a181
    v_accvgpr_read_b32 v54, a182
    v_accvgpr_read_b32 v55, a183
    v_accvgpr_read_b32 v56, a184
    v_accvgpr_read_b32 v57, a185
    v_accvgpr_read_b32 v58, a186
    v_accvgpr_read_b32 v59, a187
    v_accvgpr_read_b32 v60, a188
    v_accvgpr_read_b32 v61, a189
    v_accvgpr_read_b32 v62, a190
    v_accvgpr_read_b32 v63, a191
    v_max_f32 v48, 0, v48
    v_max_f32 v49, 0, v49
    v_max_f32 v50, 0, v50
    v_max_f32 v51, 0, v51
    v_max_f32 v52, 0, v52
    v_max_f32 v53, 0, v53
    v_max_f32 v54, 0, v54
    v_max_f32 v55, 0, v55
    v_max_f32 v56, 0, v56
    v_max_f32 v57, 0, v57
    v_max_f32 v58, 0, v58
    v_max_f32 v59, 0, v59
    v_max_f32 v60, 0, v60
    v_max_f32 v61, 0, v61
    v_max_f32 v62, 0, v62
    v_max_f32 v63, 0, v63
    v_cvt_pk_bf16_f32 v64, v48, v49
    v_cvt_pk_bf16_f32 v65, v50, v51
    v_cvt_pk_bf16_f32 v66, v52, v53
    v_cvt_pk_bf16_f32 v67, v54, v55
    v_cvt_pk_bf16_f32 v68, v56, v57
    v_cvt_pk_bf16_f32 v69, v58, v59
    v_cvt_pk_bf16_f32 v70, v60, v61
    v_cvt_pk_bf16_f32 v71, v62, v63
    s_nop 1
    v_permlane32_swap_b32 v64, v66
    v_permlane32_swap_b32 v65, v67
    v_permlane32_swap_b32 v68, v70
    v_permlane32_swap_b32 v69, v71
    ds_write_b128 v99, v[64:67] offset:16384
    ds_write_b128 v100, v[68:71] offset:16384
    v_accvgpr_read_b32 v24, a192
    v_accvgpr_read_b32 v25, a193
    v_accvgpr_read_b32 v26, a194
    v_accvgpr_read_b32 v27, a195
    v_accvgpr_read_b32 v28, a196
    v_accvgpr_read_b32 v29, a197
    v_accvgpr_read_b32 v30, a198
    v_accvgpr_read_b32 v31, a199
    v_accvgpr_read_b32 v32, a200
    v_accvgpr_read_b32 v33, a201
    v_accvgpr_read_b32 v34, a202
    v_accvgpr_read_b32 v35, a203
    v_accvgpr_read_b32 v36, a204
    v_accvgpr_read_b32 v37, a205
    v_accvgpr_read_b32 v38, a206
    v_accvgpr_read_b32 v39, a207
    v_max_f32 v24, 0, v24
    v_max_f32 v25, 0, v25
    v_max_f32 v26, 0, v26
    v_max_f32 v27, 0, v27
    v_max_f32 v28, 0, v28
    v_max_f32 v29, 0, v29
    v_max_f32 v30, 0, v30
    v_max_f32 v31, 0, v31
    v_max_f32 v32, 0, v32
    v_max_f32 v33, 0, v33
    v_max_f32 v34, 0, v34
    v_max_f32 v35, 0, v35
    v_max_f32 v36, 0, v36
    v_max_f32 v37, 0, v37
    v_max_f32 v38, 0, v38
    v_max_f32 v39, 0, v39
    v_cvt_pk_bf16_f32 v40, v24, v25
    v_cvt_pk_bf16_f32 v41, v26, v27
    v_cvt_pk_bf16_f32 v42, v28, v29
    v_cvt_pk_bf16_f32 v43, v30, v31
    v_cvt_pk_bf16_f32 v44, v32, v33
    v_cvt_pk_bf16_f32 v45, v34, v35
    v_cvt_pk_bf16_f32 v46, v36, v37
    v_cvt_pk_bf16_f32 v47, v38, v39
    s_nop 1
    v_permlane32_swap_b32 v40, v42
    v_permlane32_swap_b32 v41, v43
    v_permlane32_swap_b32 v44, v46
    v_permlane32_swap_b32 v45, v47
    ds_write_b128 v93, v[40:43] offset:24576
    ds_write_b128 v94, v[44:47] offset:24576
    v_accvgpr_read_b32 v48, a208
    v_accvgpr_read_b32 v49, a209
    v_accvgpr_read_b32 v50, a210
    v_accvgpr_read_b32 v51, a211
    v_accvgpr_read_b32 v52, a212
    v_accvgpr_read_b32 v53, a213
    v_accvgpr_read_b32 v54, a214
    v_accvgpr_read_b32 v55, a215
    v_accvgpr_read_b32 v56, a216
    v_accvgpr_read_b32 v57, a217
    v_accvgpr_read_b32 v58, a218
    v_accvgpr_read_b32 v59, a219
    v_accvgpr_read_b32 v60, a220
    v_accvgpr_read_b32 v61, a221
    v_accvgpr_read_b32 v62, a222
    v_accvgpr_read_b32 v63, a223
    v_max_f32 v48, 0, v48
    v_max_f32 v49, 0, v49
    v_max_f32 v50, 0, v50
    v_max_f32 v51, 0, v51
    v_max_f32 v52, 0, v52
    v_max_f32 v53, 0, v53
    v_max_f32 v54, 0, v54
    v_max_f32 v55, 0, v55
    v_max_f32 v56, 0, v56
    v_max_f32 v57, 0, v57
    v_max_f32 v58, 0, v58
    v_max_f32 v59, 0, v59
    v_max_f32 v60, 0, v60
    v_max_f32 v61, 0, v61
    v_max_f32 v62, 0, v62
    v_max_f32 v63, 0, v63
    v_cvt_pk_bf16_f32 v64, v48, v49
    v_cvt_pk_bf16_f32 v65, v50, v51
    v_cvt_pk_bf16_f32 v66, v52, v53
    v_cvt_pk_bf16_f32 v67, v54, v55
    v_cvt_pk_bf16_f32 v68, v56, v57
    v_cvt_pk_bf16_f32 v69, v58, v59
    v_cvt_pk_bf16_f32 v70, v60, v61
    v_cvt_pk_bf16_f32 v71, v62, v63
    s_nop 1
    v_permlane32_swap_b32 v64, v66
    v_permlane32_swap_b32 v65, v67
    v_permlane32_swap_b32 v68, v70
    v_permlane32_swap_b32 v69, v71
    ds_write_b128 v95, v[64:67] offset:24576
    ds_write_b128 v96, v[68:71] offset:24576
    v_accvgpr_read_b32 v24, a224
    v_accvgpr_read_b32 v25, a225
    v_accvgpr_read_b32 v26, a226
    v_accvgpr_read_b32 v27, a227
    v_accvgpr_read_b32 v28, a228
    v_accvgpr_read_b32 v29, a229
    v_accvgpr_read_b32 v30, a230
    v_accvgpr_read_b32 v31, a231
    v_accvgpr_read_b32 v32, a232
    v_accvgpr_read_b32 v33, a233
    v_accvgpr_read_b32 v34, a234
    v_accvgpr_read_b32 v35, a235
    v_accvgpr_read_b32 v36, a236
    v_accvgpr_read_b32 v37, a237
    v_accvgpr_read_b32 v38, a238
    v_accvgpr_read_b32 v39, a239
    v_max_f32 v24, 0, v24
    v_max_f32 v25, 0, v25
    v_max_f32 v26, 0, v26
    v_max_f32 v27, 0, v27
    v_max_f32 v28, 0, v28
    v_max_f32 v29, 0, v29
    v_max_f32 v30, 0, v30
    v_max_f32 v31, 0, v31
    v_max_f32 v32, 0, v32
    v_max_f32 v33, 0, v33
    v_max_f32 v34, 0, v34
    v_max_f32 v35, 0, v35
    v_max_f32 v36, 0, v36
    v_max_f32 v37, 0, v37
    v_max_f32 v38, 0, v38
    v_max_f32 v39, 0, v39
    v_cvt_pk_bf16_f32 v40, v24, v25
    v_cvt_pk_bf16_f32 v41, v26, v27
    v_cvt_pk_bf16_f32 v42, v28, v29
    v_cvt_pk_bf16_f32 v43, v30, v31
    v_cvt_pk_bf16_f32 v44, v32, v33
    v_cvt_pk_bf16_f32 v45, v34, v35
    v_cvt_pk_bf16_f32 v46, v36, v37
    v_cvt_pk_bf16_f32 v47, v38, v39
    s_nop 1
    v_permlane32_swap_b32 v40, v42
    v_permlane32_swap_b32 v41, v43
    v_permlane32_swap_b32 v44, v46
    v_permlane32_swap_b32 v45, v47
    ds_write_b128 v97, v[40:43] offset:24576
    ds_write_b128 v98, v[44:47] offset:24576
    v_accvgpr_read_b32 v48, a240
    v_accvgpr_read_b32 v49, a241
    v_accvgpr_read_b32 v50, a242
    v_accvgpr_read_b32 v51, a243
    v_accvgpr_read_b32 v52, a244
    v_accvgpr_read_b32 v53, a245
    v_accvgpr_read_b32 v54, a246
    v_accvgpr_read_b32 v55, a247
    v_accvgpr_read_b32 v56, a248
    v_accvgpr_read_b32 v57, a249
    v_accvgpr_read_b32 v58, a250
    v_accvgpr_read_b32 v59, a251
    v_accvgpr_read_b32 v60, a252
    v_accvgpr_read_b32 v61, a253
    v_accvgpr_read_b32 v62, a254
    v_accvgpr_read_b32 v63, a255
    v_max_f32 v48, 0, v48
    v_max_f32 v49, 0, v49
    v_max_f32 v50, 0, v50
    v_max_f32 v51, 0, v51
    v_max_f32 v52, 0, v52
    v_max_f32 v53, 0, v53
    v_max_f32 v54, 0, v54
    v_max_f32 v55, 0, v55
    v_max_f32 v56, 0, v56
    v_max_f32 v57, 0, v57
    v_max_f32 v58, 0, v58
    v_max_f32 v59, 0, v59
    v_max_f32 v60, 0, v60
    v_max_f32 v61, 0, v61
    v_max_f32 v62, 0, v62
    v_max_f32 v63, 0, v63
    v_cvt_pk_bf16_f32 v64, v48, v49
    v_cvt_pk_bf16_f32 v65, v50, v51
    v_cvt_pk_bf16_f32 v66, v52, v53
    v_cvt_pk_bf16_f32 v67, v54, v55
    v_cvt_pk_bf16_f32 v68, v56, v57
    v_cvt_pk_bf16_f32 v69, v58, v59
    v_cvt_pk_bf16_f32 v70, v60, v61
    v_cvt_pk_bf16_f32 v71, v62, v63
    s_nop 1
    v_permlane32_swap_b32 v64, v66
    v_permlane32_swap_b32 v65, v67
    v_permlane32_swap_b32 v68, v70
    v_permlane32_swap_b32 v69, v71
    ds_write_b128 v99, v[64:67] offset:24576
    ds_write_b128 v100, v[68:71] offset:24576
    v_lshrrev_b32 v88, 4, v1
    v_lshlrev_b32 v91, 4, v1
    v_add_u32 v91, s25, v91
    s_lshr_b32 s23, s22, 1
    s_lshl_b32 s23, s23, 7
    v_add_u32 v92, s23, v88
    v_mul_lo_u32 v92, v92, s44
    s_and_b32 s23, s22, 1
    s_lshl_b32 s23, s23, 8
    v_add_u32 v92, s23, v92
    v_and_b32 v89, 15, v1
    s_lshl_b32 s24, s44, 2
    s_waitcnt lgkmcnt(0)
    v_add_u32 v101, 0, v88
    v_xor_b32 v101, v101, v89
    v_lshl_add_u32 v101, v101, 4, v92
    s_mul_i32 s23, s24, 0
    v_add_u32 v101, s23, v101
    v_add_u32 v102, 4, v88
    v_xor_b32 v102, v102, v89
    v_lshl_add_u32 v102, v102, 4, v92
    s_mul_i32 s23, s24, 1
    v_add_u32 v102, s23, v102
    v_add_u32 v103, 8, v88
    v_xor_b32 v103, v103, v89
    v_lshl_add_u32 v103, v103, 4, v92
    s_mul_i32 s23, s24, 2
    v_add_u32 v103, s23, v103
    v_add_u32 v104, 12, v88
    v_xor_b32 v104, v104, v89
    v_lshl_add_u32 v104, v104, 4, v92
    s_mul_i32 s23, s24, 3
    v_add_u32 v104, s23, v104
    s_lshl_b32 s23, s24, 2
    ds_read_b128 v[24:27], v91 offset:0
    ds_read_b128 v[28:31], v91 offset:1024
    ds_read_b128 v[32:35], v91 offset:2048
    ds_read_b128 v[36:39], v91 offset:3072
    s_waitcnt lgkmcnt(0)
    global_store_dwordx4 v101, v[24:27], s[42:43] sc1
    global_store_dwordx4 v102, v[28:31], s[42:43] sc1
    global_store_dwordx4 v103, v[32:35], s[42:43] sc1
    global_store_dwordx4 v104, v[36:39], s[42:43] sc1
    v_add_u32 v101, s23, v101
    v_add_u32 v102, s23, v102
    v_add_u32 v103, s23, v103
    v_add_u32 v104, s23, v104
    ds_read_b128 v[40:43], v91 offset:4096
    ds_read_b128 v[44:47], v91 offset:5120
    ds_read_b128 v[48:51], v91 offset:6144
    ds_read_b128 v[52:55], v91 offset:7168
    s_waitcnt lgkmcnt(0)
    global_store_dwordx4 v101, v[40:43], s[42:43] sc1
    global_store_dwordx4 v102, v[44:47], s[42:43] sc1
    global_store_dwordx4 v103, v[48:51], s[42:43] sc1
    global_store_dwordx4 v104, v[52:55], s[42:43] sc1
    v_add_u32 v101, s23, v101
    v_add_u32 v102, s23, v102
    v_add_u32 v103, s23, v103
    v_add_u32 v104, s23, v104
    ds_read_b128 v[24:27], v91 offset:8192
    ds_read_b128 v[28:31], v91 offset:9216
    ds_read_b128 v[32:35], v91 offset:10240
    ds_read_b128 v[36:39], v91 offset:11264
    s_waitcnt lgkmcnt(0)
    global_store_dwordx4 v101, v[24:27], s[42:43] sc1
    global_store_dwordx4 v102, v[28:31], s[42:43] sc1
    global_store_dwordx4 v103, v[32:35], s[42:43] sc1
    global_store_dwordx4 v104, v[36:39], s[42:43] sc1
    v_add_u32 v101, s23, v101
    v_add_u32 v102, s23, v102
    v_add_u32 v103, s23, v103
    v_add_u32 v104, s23, v104
    ds_read_b128 v[40:43], v91 offset:12288
    ds_read_b128 v[44:47], v91 offset:13312
    ds_read_b128 v[48:51], v91 offset:14336
    ds_read_b128 v[52:55], v91 offset:15360
    s_waitcnt lgkmcnt(0)
    global_store_dwordx4 v101, v[40:43], s[42:43] sc1
    global_store_dwordx4 v102, v[44:47], s[42:43] sc1
    global_store_dwordx4 v103, v[48:51], s[42:43] sc1
    global_store_dwordx4 v104, v[52:55], s[42:43] sc1
    v_add_u32 v101, s23, v101
    v_add_u32 v102, s23, v102
    v_add_u32 v103, s23, v103
    v_add_u32 v104, s23, v104
    ds_read_b128 v[24:27], v91 offset:16384
    ds_read_b128 v[28:31], v91 offset:17408
    ds_read_b128 v[32:35], v91 offset:18432
    ds_read_b128 v[36:39], v91 offset:19456
    s_waitcnt lgkmcnt(0)
    global_store_dwordx4 v101, v[24:27], s[42:43] sc1
    global_store_dwordx4 v102, v[28:31], s[42:43] sc1
    global_store_dwordx4 v103, v[32:35], s[42:43] sc1
    global_store_dwordx4 v104, v[36:39], s[42:43] sc1
    v_add_u32 v101, s23, v101
    v_add_u32 v102, s23, v102
    v_add_u32 v103, s23, v103
    v_add_u32 v104, s23, v104
    ds_read_b128 v[40:43], v91 offset:20480
    ds_read_b128 v[44:47], v91 offset:21504
    ds_read_b128 v[48:51], v91 offset:22528
    ds_read_b128 v[52:55], v91 offset:23552
    s_waitcnt lgkmcnt(0)
    global_store_dwordx4 v101, v[40:43], s[42:43] sc1
    global_store_dwordx4 v102, v[44:47], s[42:43] sc1
    global_store_dwordx4 v103, v[48:51], s[42:43] sc1
    global_store_dwordx4 v104, v[52:55], s[42:43] sc1
    v_add_u32 v101, s23, v101
    v_add_u32 v102, s23, v102
    v_add_u32 v103, s23, v103
    v_add_u32 v104, s23, v104
    ds_read_b128 v[24:27], v91 offset:24576
    ds_read_b128 v[28:31], v91 offset:25600
    ds_read_b128 v[32:35], v91 offset:26624
    ds_read_b128 v[36:39], v91 offset:27648
    s_waitcnt lgkmcnt(0)
    global_store_dwordx4 v101, v[24:27], s[42:43] sc1
    global_store_dwordx4 v102, v[28:31], s[42:43] sc1
    global_store_dwordx4 v103, v[32:35], s[42:43] sc1
    global_store_dwordx4 v104, v[36:39], s[42:43] sc1
    v_add_u32 v101, s23, v101
    v_add_u32 v102, s23, v102
    v_add_u32 v103, s23, v103
    v_add_u32 v104, s23, v104
    ds_read_b128 v[40:43], v91 offset:28672
    ds_read_b128 v[44:47], v91 offset:29696
    ds_read_b128 v[48:51], v91 offset:30720
    ds_read_b128 v[52:55], v91 offset:31744
    s_waitcnt lgkmcnt(0)
    global_store_dwordx4 v101, v[40:43], s[42:43] sc1
    global_store_dwordx4 v102, v[44:47], s[42:43] sc1
    global_store_dwordx4 v103, v[48:51], s[42:43] sc1
    global_store_dwordx4 v104, v[52:55], s[42:43] sc1
    s_add_u32 s51, s51, 256
    s_cmp_eq_u32 s64, 1
    s_cbranch_scc1 L_ei_sf1
    s_mov_b32 s65, 200
    s_cmp_eq_u32 s22, 0
    s_cbranch_scc0 L_wfd_eisf1
    v_mov_b32 v3, s65
    s_mov_b32 s14, 0
L_wf_eisf1:
    global_load_dword v4, v3, s[6:7] sc1
    s_waitcnt vmcnt(0)
    v_readfirstlane_b32 s15, v4
    s_add_u32 s14, s14, 1
    s_cmp_gt_u32 s14, 400000
    s_cbranch_scc1 L_wfd_eisf1
    s_cmp_ge_u32 s15, 1
    s_cbranch_scc1 L_wfd_eisf1
    s_sleep 4
    s_branch L_wf_eisf1
L_wfd_eisf1:
    s_barrier
    s_mov_b32 s64, 1
L_ei_sf1:
    s_waitcnt vmcnt(0)
    s_barrier
    v_cmp_eq_u32 vcc, 0, v0
    s_and_saveexec_b64 s[12:13], vcc
    s_cbranch_execz L_sg_f1
    v_mov_b32 v3, s51
    v_mov_b32 v4, 1
    global_atomic_add v3, v4, s[66:67]
L_sg_f1:
    s_mov_b64 exec, s[12:13]
    s_branch L_task
L_t_n:
    s_mov_b32 s38, 32
    s_cmp_eq_u32 s36, 6
    s_cselect_b32 s38, 24, s38
    s_cmp_eq_u32 s36, 8
    s_cselect_b32 s38, 16, s38
    s_load_dwordx2 s[40:41], s[0:1], s38
    s_mov_b32 s18, 1024
    s_mov_b32 s19, 8192
    s_mov_b32 s20, 16
    s_mov_b32 s27, 64
    s_mov_b32 s28, 262144
    s_waitcnt lgkmcnt(0)
    s_mov_b32 s8, s30
    s_mov_b32 s9, s31
    s_mov_b32 s10, 2097152
    s_mov_b32 s11, 0x00020000
    s_mov_b32 s12, s40
    s_mov_b32 s13, s41
    s_mov_b32 s14, 4194304
    s_mov_b32 s15, 0x00020000
    s_lshl_b32 s16, s35, 18
    s_lshl_b32 s17, s37, 8
    v_lshrrev_b32 v88, 2, v1
    s_lshl_b32 s23, s22, 6
    v_add_u32 v88, s23, v88
    v_mul_lo_u32 v88, v88, s18
    v_and_b32 v89, 3, v1
    v_bfe_u32 v90, v1, 4, 2
    v_xor_b32 v89, v89, v90
    v_lshl_add_u32 v2, v89, 4, v88
    s_lshl_b32 s23, s18, 4
    v_add_u32 v3, s23, v2
    v_add_u32 v4, s23, v3
    v_add_u32 v5, s23, v4
    v_lshrrev_b32 v88, 4, v1
    v_lshlrev_b32 v89, 2, v88
    v_and_b32 v90, 15, v1
    v_xor_b32 v89, v89, v90
    s_lshl_b32 s23, s22, 3
    s_add_u32 s23, s23, 0
    v_add_u32 v88, s23, v88
    v_mul_lo_u32 v88, v88, s19
    v_lshl_add_u32 v6, v89, 4, v88
    v_lshrrev_b32 v88, 4, v1
    v_lshlrev_b32 v89, 2, v88
    v_and_b32 v90, 15, v1
    v_xor_b32 v89, v89, v90
    s_lshl_b32 s23, s22, 3
    s_add_u32 s23, s23, 4
    v_add_u32 v88, s23, v88
    v_mul_lo_u32 v88, v88, s19
    v_lshl_add_u32 v7, v89, 4, v88
    v_and_b32 v88, 31, v1
    s_lshr_b32 s23, s22, 1
    s_lshl_b32 s23, s23, 7
    v_add_u32 v89, s23, v88
    v_lshlrev_b32 v89, 6, v89
    v_bfe_u32 v88, v1, 2, 2
    v_lshrrev_b32 v90, 5, v1
    v_add_u32 v90, 0, v90
    v_xor_b32 v90, v90, v88
    v_lshl_add_u32 v10, v90, 4, v89
    v_add_u32 v12, 65536, v10
    v_and_b32 v88, 31, v1
    s_lshr_b32 s23, s22, 1
    s_lshl_b32 s23, s23, 7
    v_add_u32 v89, s23, v88
    v_lshlrev_b32 v89, 6, v89
    v_bfe_u32 v88, v1, 2, 2
    v_lshrrev_b32 v90, 5, v1
    v_add_u32 v90, 2, v90
    v_xor_b32 v90, v90, v88
    v_lshl_add_u32 v11, v90, 4, v89
    v_add_u32 v13, 65536, v11
    v_bfe_u32 v88, v1, 2, 2
    v_lshrrev_b32 v89, 5, v1
    v_lshl_add_u32 v89, v89, 3, v88
    v_lshlrev_b32 v89, 8, v89
    s_and_b32 s23, s22, 1
    s_lshl_b32 s23, s23, 1
    s_add_u32 s23, s23, 0
    v_xor_b32 v88, s23, v88
    v_lshlrev_b32 v88, 2, v88
    v_bfe_u32 v90, v1, 4, 1
    v_lshl_add_u32 v88, v90, 1, v88
    v_bfe_u32 v90, v1, 1, 1
    v_add_u32 v88, v88, v90
    v_lshl_add_u32 v89, v88, 4, v89
    v_and_b32 v90, 1, v1
    v_lshl_add_u32 v89, v90, 3, v89
    v_add_u32 v14, 16384, v89
    v_add_u32 v18, 65536, v14
    v_bfe_u32 v88, v1, 2, 2
    v_lshrrev_b32 v89, 5, v1
    v_lshl_add_u32 v89, v89, 3, v88
    v_lshlrev_b32 v89, 8, v89
    s_and_b32 s23, s22, 1
    s_lshl_b32 s23, s23, 1
    s_add_u32 s23, s23, 1
    v_xor_b32 v88, s23, v88
    v_lshlrev_b32 v88, 2, v88
    v_bfe_u32 v90, v1, 4, 1
    v_lshl_add_u32 v88, v90, 1, v88
    v_bfe_u32 v90, v1, 1, 1
    v_add_u32 v88, v88, v90
    v_lshl_add_u32 v89, v88, 4, v89
    v_and_b32 v90, 1, v1
    v_lshl_add_u32 v89, v90, 3, v89
    v_add_u32 v15, 16384, v89
    v_add_u32 v19, 65536, v15
    s_lshl_b32 s39, s37, 13
    s_lshl_b32 s38, s35, 21
    s_add_u32 s39, s39, s38
    s_mov_b32 s38, 33554432
    s_cmp_eq_u32 s36, 6
    s_cselect_b32 s38, 16777216, s38
    s_cmp_eq_u32 s36, 8
    s_cselect_b32 s38, 0, s38
    s_add_u32 s38, s38, s39
    s_add_u32 s42, s32, s38
    s_addc_u32 s43, s33, 0
    s_cmp_eq_u32 s36, 7
    s_cbranch_scc1 L_t_nv
    s_lshl_b32 s25, s22, 12
    s_lshl_b32 s24, s22, 11
    s_add_u32 s26, s25, 0
    s_add_u32 s29, s24, 0
    s_add_u32 m0, s26, 0
    s_nop 0
    buffer_load_dwordx4 v2, s[8:11], s16 offen lds
    s_add_u32 m0, s26, 1024
    s_nop 0
    buffer_load_dwordx4 v3, s[8:11], s16 offen lds
    s_add_u32 m0, s26, 2048
    s_nop 0
    buffer_load_dwordx4 v4, s[8:11], s16 offen lds
    s_add_u32 m0, s26, 3072
    s_nop 0
    buffer_load_dwordx4 v5, s[8:11], s16 offen lds
    s_add_u32 m0, s29, 16384
    s_nop 0
    buffer_load_dwordx4 v6, s[12:15], s17 offen lds
    s_add_u32 m0, s29, 17408
    s_nop 0
    buffer_load_dwordx4 v7, s[12:15], s17 offen lds
    s_add_u32 s16, s16, s27
    s_add_u32 s17, s17, s28
    s_add_u32 s26, s25, 32768
    s_add_u32 s29, s24, 32768
    s_add_u32 m0, s26, 0
    s_nop 0
    buffer_load_dwordx4 v2, s[8:11], s16 offen lds
    s_add_u32 m0, s26, 1024
    s_nop 0
    buffer_load_dwordx4 v3, s[8:11], s16 offen lds
    s_add_u32 m0, s26, 2048
    s_nop 0
    buffer_load_dwordx4 v4, s[8:11], s16 offen lds
    s_add_u32 m0, s26, 3072
    s_nop 0
    buffer_load_dwordx4 v5, s[8:11], s16 offen lds
    s_add_u32 m0, s29, 16384
    s_nop 0
    buffer_load_dwordx4 v6, s[12:15], s17 offen lds
    s_add_u32 m0, s29, 17408
    s_nop 0
    buffer_load_dwordx4 v7, s[12:15], s17 offen lds
    s_add_u32 s16, s16, s27
    s_add_u32 s17, s17, s28
    s_add_u32 s26, s25, 65536
    s_add_u32 s29, s24, 65536
    s_add_u32 m0, s26, 0
    s_nop 0
    buffer_load_dwordx4 v2, s[8:11], s16 offen lds
    s_add_u32 m0, s26, 1024
    s_nop 0
    buffer_load_dwordx4 v3, s[8:11], s16 offen lds
    s_add_u32 m0, s26, 2048
    s_nop 0
    buffer_load_dwordx4 v4, s[8:11], s16 offen lds
    s_add_u32 m0, s26, 3072
    s_nop 0
    buffer_load_dwordx4 v5, s[8:11], s16 offen lds
    s_add_u32 m0, s29, 16384
    s_nop 0
    buffer_load_dwordx4 v6, s[12:15], s17 offen lds
    s_add_u32 m0, s29, 17408
    s_nop 0
    buffer_load_dwordx4 v7, s[12:15], s17 offen lds
    s_add_u32 s16, s16, s27
    s_add_u32 s17, s17, s28
    v_accvgpr_write_b32 a0, 0
    v_accvgpr_write_b32 a1, 0
    v_accvgpr_write_b32 a2, 0
    v_accvgpr_write_b32 a3, 0
    v_accvgpr_write_b32 a4, 0
    v_accvgpr_write_b32 a5, 0
    v_accvgpr_write_b32 a6, 0
    v_accvgpr_write_b32 a7, 0
    v_accvgpr_write_b32 a8, 0
    v_accvgpr_write_b32 a9, 0
    v_accvgpr_write_b32 a10, 0
    v_accvgpr_write_b32 a11, 0
    v_accvgpr_write_b32 a12, 0
    v_accvgpr_write_b32 a13, 0
    v_accvgpr_write_b32 a14, 0
    v_accvgpr_write_b32 a15, 0
    v_accvgpr_write_b32 a16, 0
    v_accvgpr_write_b32 a17, 0
    v_accvgpr_write_b32 a18, 0
    v_accvgpr_write_b32 a19, 0
    v_accvgpr_write_b32 a20, 0
    v_accvgpr_write_b32 a21, 0
    v_accvgpr_write_b32 a22, 0
    v_accvgpr_write_b32 a23, 0
    v_accvgpr_write_b32 a24, 0
    v_accvgpr_write_b32 a25, 0
    v_accvgpr_write_b32 a26, 0
    v_accvgpr_write_b32 a27, 0
    v_accvgpr_write_b32 a28, 0
    v_accvgpr_write_b32 a29, 0
    v_accvgpr_write_b32 a30, 0
    v_accvgpr_write_b32 a31, 0
    v_accvgpr_write_b32 a32, 0
    v_accvgpr_write_b32 a33, 0
    v_accvgpr_write_b32 a34, 0
    v_accvgpr_write_b32 a35, 0
    v_accvgpr_write_b32 a36, 0
    v_accvgpr_write_b32 a37, 0
    v_accvgpr_write_b32 a38, 0
    v_accvgpr_write_b32 a39, 0
    v_accvgpr_write_b32 a40, 0
    v_accvgpr_write_b32 a41, 0
    v_accvgpr_write_b32 a42, 0
    v_accvgpr_write_b32 a43, 0
    v_accvgpr_write_b32 a44, 0
    v_accvgpr_write_b32 a45, 0
    v_accvgpr_write_b32 a46, 0
    v_accvgpr_write_b32 a47, 0
    v_accvgpr_write_b32 a48, 0
    v_accvgpr_write_b32 a49, 0
    v_accvgpr_write_b32 a50, 0
    v_accvgpr_write_b32 a51, 0
    v_accvgpr_write_b32 a52, 0
    v_accvgpr_write_b32 a53, 0
    v_accvgpr_write_b32 a54, 0
    v_accvgpr_write_b32 a55, 0
    v_accvgpr_write_b32 a56, 0
    v_accvgpr_write_b32 a57, 0
    v_accvgpr_write_b32 a58, 0
    v_accvgpr_write_b32 a59, 0
    v_accvgpr_write_b32 a60, 0
    v_accvgpr_write_b32 a61, 0
    v_accvgpr_write_b32 a62, 0
    v_accvgpr_write_b32 a63, 0
    v_accvgpr_write_b32 a64, 0
    v_accvgpr_write_b32 a65, 0
    v_accvgpr_write_b32 a66, 0
    v_accvgpr_write_b32 a67, 0
    v_accvgpr_write_b32 a68, 0
    v_accvgpr_write_b32 a69, 0
    v_accvgpr_write_b32 a70, 0
    v_accvgpr_write_b32 a71, 0
    v_accvgpr_write_b32 a72, 0
    v_accvgpr_write_b32 a73, 0
    v_accvgpr_write_b32 a74, 0
    v_accvgpr_write_b32 a75, 0
    v_accvgpr_write_b32 a76, 0
    v_accvgpr_write_b32 a77, 0
    v_accvgpr_write_b32 a78, 0
    v_accvgpr_write_b32 a79, 0
    v_accvgpr_write_b32 a80, 0
    v_accvgpr_write_b32 a81, 0
    v_accvgpr_write_b32 a82, 0
    v_accvgpr_write_b32 a83, 0
    v_accvgpr_write_b32 a84, 0
    v_accvgpr_write_b32 a85, 0
    v_accvgpr_write_b32 a86, 0
    v_accvgpr_write_b32 a87, 0
    v_accvgpr_write_b32 a88, 0
    v_accvgpr_write_b32 a89, 0
    v_accvgpr_write_b32 a90, 0
    v_accvgpr_write_b32 a91, 0
    v_accvgpr_write_b32 a92, 0
    v_accvgpr_write_b32 a93, 0
    v_accvgpr_write_b32 a94, 0
    v_accvgpr_write_b32 a95, 0
    v_accvgpr_write_b32 a96, 0
    v_accvgpr_write_b32 a97, 0
    v_accvgpr_write_b32 a98, 0
    v_accvgpr_write_b32 a99, 0
    v_accvgpr_write_b32 a100, 0
    v_accvgpr_write_b32 a101, 0
    v_accvgpr_write_b32 a102, 0
    v_accvgpr_write_b32 a103, 0
    v_accvgpr_write_b32 a104, 0
    v_accvgpr_write_b32 a105, 0
    v_accvgpr_write_b32 a106, 0
    v_accvgpr_write_b32 a107, 0
    v_accvgpr_write_b32 a108, 0
    v_accvgpr_write_b32 a109, 0
    v_accvgpr_write_b32 a110, 0
    v_accvgpr_write_b32 a111, 0
    v_accvgpr_write_b32 a112, 0
    v_accvgpr_write_b32 a113, 0
    v_accvgpr_write_b32 a114, 0
    v_accvgpr_write_b32 a115, 0
    v_accvgpr_write_b32 a116, 0
    v_accvgpr_write_b32 a117, 0
    v_accvgpr_write_b32 a118, 0
    v_accvgpr_write_b32 a119, 0
    v_accvgpr_write_b32 a120, 0
    v_accvgpr_write_b32 a121, 0
    v_accvgpr_write_b32 a122, 0
    v_accvgpr_write_b32 a123, 0
    v_accvgpr_write_b32 a124, 0
    v_accvgpr_write_b32 a125, 0
    v_accvgpr_write_b32 a126, 0
    v_accvgpr_write_b32 a127, 0
    s_waitcnt vmcnt(12)
    s_barrier
    ds_read_b128 v[24:27], v10 offset:0
    ds_read_b128 v[28:31], v10 offset:2048
    ds_read_b128 v[32:35], v10 offset:4096
    ds_read_b128 v[36:39], v10 offset:6144
    ds_read_b64_tr_b16 v[40:41], v14 offset:0
    ds_read_b64_tr_b16 v[42:43], v14 offset:1024
    ds_read_b64_tr_b16 v[44:45], v15 offset:0
    ds_read_b64_tr_b16 v[46:47], v15 offset:1024
    s_mov_b32 s21, 0
.p2align 6
L_gemmn_k:
    s_waitcnt lgkmcnt(0)
    v_mfma_f32_32x32x16_bf16 a[0:15], v[40:43], v[24:27], a[0:15]
    ds_read_b128 v[56:59], v11 offset:0
    v_mfma_f32_32x32x16_bf16 a[16:31], v[44:47], v[24:27], a[16:31]
    ds_read_b128 v[60:63], v11 offset:2048
    v_mfma_f32_32x32x16_bf16 a[32:47], v[40:43], v[28:31], a[32:47]
    ds_read_b128 v[64:67], v11 offset:4096
    v_mfma_f32_32x32x16_bf16 a[48:63], v[44:47], v[28:31], a[48:63]
    ds_read_b128 v[68:71], v11 offset:6144
    v_mfma_f32_32x32x16_bf16 a[64:79], v[40:43], v[32:35], a[64:79]
    ds_read_b64_tr_b16 v[72:73], v14 offset:4096
    v_mfma_f32_32x32x16_bf16 a[80:95], v[44:47], v[32:35], a[80:95]
    ds_read_b64_tr_b16 v[74:75], v14 offset:5120
    v_mfma_f32_32x32x16_bf16 a[96:111], v[40:43], v[36:39], a[96:111]
    ds_read_b64_tr_b16 v[76:77], v15 offset:4096
    v_mfma_f32_32x32x16_bf16 a[112:127], v[44:47], v[36:39], a[112:127]
    ds_read_b64_tr_b16 v[78:79], v15 offset:5120
    s_waitcnt vmcnt(6)
    s_waitcnt lgkmcnt(0)
    s_barrier
    s_add_u32 s26, s25, 98304
    s_add_u32 s29, s24, 98304
    v_mfma_f32_32x32x16_bf16 a[0:15], v[72:75], v[56:59], a[0:15]
    ds_read_b128 v[24:27], v10 offset:32768
    s_add_u32 m0, s26, 0
    s_nop 0
    buffer_load_dwordx4 v2, s[8:11], s16 offen lds
    v_mfma_f32_32x32x16_bf16 a[16:31], v[76:79], v[56:59], a[16:31]
    ds_read_b128 v[28:31], v10 offset:34816
    s_add_u32 m0, s26, 1024
    s_nop 0
    buffer_load_dwordx4 v3, s[8:11], s16 offen lds
    v_mfma_f32_32x32x16_bf16 a[32:47], v[72:75], v[60:63], a[32:47]
    ds_read_b128 v[32:35], v10 offset:36864
    s_add_u32 m0, s26, 2048
    s_nop 0
    buffer_load_dwordx4 v4, s[8:11], s16 offen lds
    v_mfma_f32_32x32x16_bf16 a[48:63], v[76:79], v[60:63], a[48:63]
    ds_read_b128 v[36:39], v10 offset:38912
    s_add_u32 m0, s26, 3072
    s_nop 0
    buffer_load_dwordx4 v5, s[8:11], s16 offen lds
    v_mfma_f32_32x32x16_bf16 a[64:79], v[72:75], v[64:67], a[64:79]
    ds_read_b64_tr_b16 v[40:41], v14 offset:32768
    s_add_u32 m0, s29, 16384
    s_nop 0
    buffer_load_dwordx4 v6, s[12:15], s17 offen lds
    v_mfma_f32_32x32x16_bf16 a[80:95], v[76:79], v[64:67], a[80:95]
    ds_read_b64_tr_b16 v[42:43], v14 offset:33792
    s_add_u32 m0, s29, 17408
    s_nop 0
    buffer_load_dwordx4 v7, s[12:15], s17 offen lds
    v_mfma_f32_32x32x16_bf16 a[96:111], v[72:75], v[68:71], a[96:111]
    ds_read_b64_tr_b16 v[44:45], v15 offset:32768
    s_add_u32 s16, s16, s27
    s_add_u32 s17, s17, s28
    v_mfma_f32_32x32x16_bf16 a[112:127], v[76:79], v[68:71], a[112:127]
    ds_read_b64_tr_b16 v[46:47], v15 offset:33792
    s_waitcnt lgkmcnt(0)
    v_mfma_f32_32x32x16_bf16 a[0:15], v[40:43], v[24:27], a[0:15]
    ds_read_b128 v[56:59], v11 offset:32768
    v_mfma_f32_32x32x16_bf16 a[16:31], v[44:47], v[24:27], a[16:31]
    ds_read_b128 v[60:63], v11 offset:34816
    v_mfma_f32_32x32x16_bf16 a[32:47], v[40:43], v[28:31], a[32:47]
    ds_read_b128 v[64:67], v11 offset:36864
    v_mfma_f32_32x32x16_bf16 a[48:63], v[44:47], v[28:31], a[48:63]
    ds_read_b128 v[68:71], v11 offset:38912
    v_mfma_f32_32x32x16_bf16 a[64:79], v[40:43], v[32:35], a[64:79]
    ds_read_b64_tr_b16 v[72:73], v14 offset:36864
    v_mfma_f32_32x32x16_bf16 a[80:95], v[44:47], v[32:35], a[80:95]
    ds_read_b64_tr_b16 v[74:75], v14 offset:37888
    v_mfma_f32_32x32x16_bf16 a[96:111], v[40:43], v[36:39], a[96:111]
    ds_read_b64_tr_b16 v[76:77], v15 offset:36864
    v_mfma_f32_32x32x16_bf16 a[112:127], v[44:47], v[36:39], a[112:127]
    ds_read_b64_tr_b16 v[78:79], v15 offset:37888
    s_waitcnt vmcnt(6)
    s_waitcnt lgkmcnt(0)
    s_barrier
    s_add_u32 s26, s25, 0
    s_add_u32 s29, s24, 0
    v_mfma_f32_32x32x16_bf16 a[0:15], v[72:75], v[56:59], a[0:15]
    ds_read_b128 v[24:27], v12 offset:0
    s_add_u32 m0, s26, 0
    s_nop 0
    buffer_load_dwordx4 v2, s[8:11], s16 offen lds
    v_mfma_f32_32x32x16_bf16 a[16:31], v[76:79], v[56:59], a[16:31]
    ds_read_b128 v[28:31], v12 offset:2048
    s_add_u32 m0, s26, 1024
    s_nop 0
    buffer_load_dwordx4 v3, s[8:11], s16 offen lds
    v_mfma_f32_32x32x16_bf16 a[32:47], v[72:75], v[60:63], a[32:47]
    ds_read_b128 v[32:35], v12 offset:4096
    s_add_u32 m0, s26, 2048
    s_nop 0
    buffer_load_dwordx4 v4, s[8:11], s16 offen lds
    v_mfma_f32_32x32x16_bf16 a[48:63], v[76:79], v[60:63], a[48:63]
    ds_read_b128 v[36:39], v12 offset:6144
    s_add_u32 m0, s26, 3072
    s_nop 0
    buffer_load_dwordx4 v5, s[8:11], s16 offen lds
    v_mfma_f32_32x32x16_bf16 a[64:79], v[72:75], v[64:67], a[64:79]
    ds_read_b64_tr_b16 v[40:41], v18 offset:0
    s_add_u32 m0, s29, 16384
    s_nop 0
    buffer_load_dwordx4 v6, s[12:15], s17 offen lds
    v_mfma_f32_32x32x16_bf16 a[80:95], v[76:79], v[64:67], a[80:95]
    ds_read_b64_tr_b16 v[42:43], v18 offset:1024
    s_add_u32 m0, s29, 17408
    s_nop 0
    buffer_load_dwordx4 v7, s[12:15], s17 offen lds
    v_mfma_f32_32x32x16_bf16 a[96:111], v[72:75], v[68:71], a[96:111]
    ds_read_b64_tr_b16 v[44:45], v19 offset:0
    s_add_u32 s16, s16, s27
    s_add_u32 s17, s17, s28
    v_mfma_f32_32x32x16_bf16 a[112:127], v[76:79], v[68:71], a[112:127]
    ds_read_b64_tr_b16 v[46:47], v19 offset:1024
    s_waitcnt lgkmcnt(0)
    v_mfma_f32_32x32x16_bf16 a[0:15], v[40:43], v[24:27], a[0:15]
    ds_read_b128 v[56:59], v13 offset:0
    v_mfma_f32_32x32x16_bf16 a[16:31], v[44:47], v[24:27], a[16:31]
    ds_read_b128 v[60:63], v13 offset:2048
    v_mfma_f32_32x32x16_bf16 a[32:47], v[40:43], v[28:31], a[32:47]
    ds_read_b128 v[64:67], v13 offset:4096
    v_mfma_f32_32x32x16_bf16 a[48:63], v[44:47], v[28:31], a[48:63]
    ds_read_b128 v[68:71], v13 offset:6144
    v_mfma_f32_32x32x16_bf16 a[64:79], v[40:43], v[32:35], a[64:79]
    ds_read_b64_tr_b16 v[72:73], v18 offset:4096
    v_mfma_f32_32x32x16_bf16 a[80:95], v[44:47], v[32:35], a[80:95]
    ds_read_b64_tr_b16 v[74:75], v18 offset:5120
    v_mfma_f32_32x32x16_bf16 a[96:111], v[40:43], v[36:39], a[96:111]
    ds_read_b64_tr_b16 v[76:77], v19 offset:4096
    v_mfma_f32_32x32x16_bf16 a[112:127], v[44:47], v[36:39], a[112:127]
    ds_read_b64_tr_b16 v[78:79], v19 offset:5120
    s_waitcnt vmcnt(6)
    s_waitcnt lgkmcnt(0)
    s_barrier
    s_add_u32 s26, s25, 32768
    s_add_u32 s29, s24, 32768
    v_mfma_f32_32x32x16_bf16 a[0:15], v[72:75], v[56:59], a[0:15]
    ds_read_b128 v[24:27], v12 offset:32768
    s_add_u32 m0, s26, 0
    s_nop 0
    buffer_load_dwordx4 v2, s[8:11], s16 offen lds
    v_mfma_f32_32x32x16_bf16 a[16:31], v[76:79], v[56:59], a[16:31]
    ds_read_b128 v[28:31], v12 offset:34816
    s_add_u32 m0, s26, 1024
    s_nop 0
    buffer_load_dwordx4 v3, s[8:11], s16 offen lds
    v_mfma_f32_32x32x16_bf16 a[32:47], v[72:75], v[60:63], a[32:47]
    ds_read_b128 v[32:35], v12 offset:36864
    s_add_u32 m0, s26, 2048
    s_nop 0
    buffer_load_dwordx4 v4, s[8:11], s16 offen lds
    v_mfma_f32_32x32x16_bf16 a[48:63], v[76:79], v[60:63], a[48:63]
    ds_read_b128 v[36:39], v12 offset:38912
    s_add_u32 m0, s26, 3072
    s_nop 0
    buffer_load_dwordx4 v5, s[8:11], s16 offen lds
    v_mfma_f32_32x32x16_bf16 a[64:79], v[72:75], v[64:67], a[64:79]
    ds_read_b64_tr_b16 v[40:41], v18 offset:32768
    s_add_u32 m0, s29, 16384
    s_nop 0
    buffer_load_dwordx4 v6, s[12:15], s17 offen lds
    v_mfma_f32_32x32x16_bf16 a[80:95], v[76:79], v[64:67], a[80:95]
    ds_read_b64_tr_b16 v[42:43], v18 offset:33792
    s_add_u32 m0, s29, 17408
    s_nop 0
    buffer_load_dwordx4 v7, s[12:15], s17 offen lds
    v_mfma_f32_32x32x16_bf16 a[96:111], v[72:75], v[68:71], a[96:111]
    ds_read_b64_tr_b16 v[44:45], v19 offset:32768
    s_add_u32 s16, s16, s27
    s_add_u32 s17, s17, s28
    v_mfma_f32_32x32x16_bf16 a[112:127], v[76:79], v[68:71], a[112:127]
    ds_read_b64_tr_b16 v[46:47], v19 offset:33792
    s_waitcnt lgkmcnt(0)
    v_mfma_f32_32x32x16_bf16 a[0:15], v[40:43], v[24:27], a[0:15]
    ds_read_b128 v[56:59], v13 offset:32768
    v_mfma_f32_32x32x16_bf16 a[16:31], v[44:47], v[24:27], a[16:31]
    ds_read_b128 v[60:63], v13 offset:34816
    v_mfma_f32_32x32x16_bf16 a[32:47], v[40:43], v[28:31], a[32:47]
    ds_read_b128 v[64:67], v13 offset:36864
    v_mfma_f32_32x32x16_bf16 a[48:63], v[44:47], v[28:31], a[48:63]
    ds_read_b128 v[68:71], v13 offset:38912
    v_mfma_f32_32x32x16_bf16 a[64:79], v[40:43], v[32:35], a[64:79]
    ds_read_b64_tr_b16 v[72:73], v18 offset:36864
    v_mfma_f32_32x32x16_bf16 a[80:95], v[44:47], v[32:35], a[80:95]
    ds_read_b64_tr_b16 v[74:75], v18 offset:37888
    v_mfma_f32_32x32x16_bf16 a[96:111], v[40:43], v[36:39], a[96:111]
    ds_read_b64_tr_b16 v[76:77], v19 offset:36864
    v_mfma_f32_32x32x16_bf16 a[112:127], v[44:47], v[36:39], a[112:127]
    ds_read_b64_tr_b16 v[78:79], v19 offset:37888
    s_waitcnt vmcnt(6)
    s_waitcnt lgkmcnt(0)
    s_barrier
    s_add_u32 s26, s25, 65536
    s_add_u32 s29, s24, 65536
    v_mfma_f32_32x32x16_bf16 a[0:15], v[72:75], v[56:59], a[0:15]
    ds_read_b128 v[24:27], v10 offset:0
    s_add_u32 m0, s26, 0
    s_nop 0
    buffer_load_dwordx4 v2, s[8:11], s16 offen lds
    v_mfma_f32_32x32x16_bf16 a[16:31], v[76:79], v[56:59], a[16:31]
    ds_read_b128 v[28:31], v10 offset:2048
    s_add_u32 m0, s26, 1024
    s_nop 0
    buffer_load_dwordx4 v3, s[8:11], s16 offen lds
    v_mfma_f32_32x32x16_bf16 a[32:47], v[72:75], v[60:63], a[32:47]
    ds_read_b128 v[32:35], v10 offset:4096
    s_add_u32 m0, s26, 2048
    s_nop 0
    buffer_load_dwordx4 v4, s[8:11], s16 offen lds
    v_mfma_f32_32x32x16_bf16 a[48:63], v[76:79], v[60:63], a[48:63]
    ds_read_b128 v[36:39], v10 offset:6144
    s_add_u32 m0, s26, 3072
    s_nop 0
    buffer_load_dwordx4 v5, s[8:11], s16 offen lds
    v_mfma_f32_32x32x16_bf16 a[64:79], v[72:75], v[64:67], a[64:79]
    ds_read_b64_tr_b16 v[40:41], v14 offset:0
    s_add_u32 m0, s29, 16384
    s_nop 0
    buffer_load_dwordx4 v6, s[12:15], s17 offen lds
    v_mfma_f32_32x32x16_bf16 a[80:95], v[76:79], v[64:67], a[80:95]
    ds_read_b64_tr_b16 v[42:43], v14 offset:1024
    s_add_u32 m0, s29, 17408
    s_nop 0
    buffer_load_dwordx4 v7, s[12:15], s17 offen lds
    v_mfma_f32_32x32x16_bf16 a[96:111], v[72:75], v[68:71], a[96:111]
    ds_read_b64_tr_b16 v[44:45], v15 offset:0
    s_add_u32 s16, s16, s27
    s_add_u32 s17, s17, s28
    v_mfma_f32_32x32x16_bf16 a[112:127], v[76:79], v[68:71], a[112:127]
    ds_read_b64_tr_b16 v[46:47], v15 offset:1024
    s_add_u32 s21, s21, 4
    s_cmp_lt_u32 s21, s20
    s_cbranch_scc1 L_gemmn_k
    s_waitcnt vmcnt(0) lgkmcnt(0)
    s_nop 15
    s_barrier
    s_lshl_b32 s25, s22, 14
    v_and_b32 v88, 31, v1
    v_lshlrev_b32 v90, 7, v88
    v_add_u32 v90, s25, v90
    v_and_b32 v89, 7, v88
    v_lshrrev_b32 v88, 5, v1
    v_xor_b32 v89, v89, v88
    v_xor_b32 v93, 0, v89
    v_lshl_add_u32 v93, v93, 4, v90
    v_xor_b32 v94, 2, v89
    v_lshl_add_u32 v94, v94, 4, v90
    v_xor_b32 v95, 4, v89
    v_lshl_add_u32 v95, v95, 4, v90
    v_xor_b32 v96, 6, v89
    v_lshl_add_u32 v96, v96, 4, v90
    v_accvgpr_read_b32 v24, a0
    v_accvgpr_read_b32 v25, a1
    v_accvgpr_read_b32 v26, a2
    v_accvgpr_read_b32 v27, a3
    v_accvgpr_read_b32 v28, a4
    v_accvgpr_read_b32 v29, a5
    v_accvgpr_read_b32 v30, a6
    v_accvgpr_read_b32 v31, a7
    v_accvgpr_read_b32 v32, a8
    v_accvgpr_read_b32 v33, a9
    v_accvgpr_read_b32 v34, a10
    v_accvgpr_read_b32 v35, a11
    v_accvgpr_read_b32 v36, a12
    v_accvgpr_read_b32 v37, a13
    v_accvgpr_read_b32 v38, a14
    v_accvgpr_read_b32 v39, a15
    v_cvt_pk_bf16_f32 v40, v24, v25
    v_cvt_pk_bf16_f32 v41, v26, v27
    v_cvt_pk_bf16_f32 v42, v28, v29
    v_cvt_pk_bf16_f32 v43, v30, v31
    v_cvt_pk_bf16_f32 v44, v32, v33
    v_cvt_pk_bf16_f32 v45, v34, v35
    v_cvt_pk_bf16_f32 v46, v36, v37
    v_cvt_pk_bf16_f32 v47, v38, v39
    s_nop 1
    v_permlane32_swap_b32 v40, v42
    v_permlane32_swap_b32 v41, v43
    v_permlane32_swap_b32 v44, v46
    v_permlane32_swap_b32 v45, v47
    ds_write_b128 v93, v[40:43] offset:0
    ds_write_b128 v94, v[44:47] offset:0
    v_accvgpr_read_b32 v48, a16
    v_accvgpr_read_b32 v49, a17
    v_accvgpr_read_b32 v50, a18
    v_accvgpr_read_b32 v51, a19
    v_accvgpr_read_b32 v52, a20
    v_accvgpr_read_b32 v53, a21
    v_accvgpr_read_b32 v54, a22
    v_accvgpr_read_b32 v55, a23
    v_accvgpr_read_b32 v56, a24
    v_accvgpr_read_b32 v57, a25
    v_accvgpr_read_b32 v58, a26
    v_accvgpr_read_b32 v59, a27
    v_accvgpr_read_b32 v60, a28
    v_accvgpr_read_b32 v61, a29
    v_accvgpr_read_b32 v62, a30
    v_accvgpr_read_b32 v63, a31
    v_cvt_pk_bf16_f32 v64, v48, v49
    v_cvt_pk_bf16_f32 v65, v50, v51
    v_cvt_pk_bf16_f32 v66, v52, v53
    v_cvt_pk_bf16_f32 v67, v54, v55
    v_cvt_pk_bf16_f32 v68, v56, v57
    v_cvt_pk_bf16_f32 v69, v58, v59
    v_cvt_pk_bf16_f32 v70, v60, v61
    v_cvt_pk_bf16_f32 v71, v62, v63
    s_nop 1
    v_permlane32_swap_b32 v64, v66
    v_permlane32_swap_b32 v65, v67
    v_permlane32_swap_b32 v68, v70
    v_permlane32_swap_b32 v69, v71
    ds_write_b128 v95, v[64:67] offset:0
    ds_write_b128 v96, v[68:71] offset:0
    v_accvgpr_read_b32 v24, a32
    v_accvgpr_read_b32 v25, a33
    v_accvgpr_read_b32 v26, a34
    v_accvgpr_read_b32 v27, a35
    v_accvgpr_read_b32 v28, a36
    v_accvgpr_read_b32 v29, a37
    v_accvgpr_read_b32 v30, a38
    v_accvgpr_read_b32 v31, a39
    v_accvgpr_read_b32 v32, a40
    v_accvgpr_read_b32 v33, a41
    v_accvgpr_read_b32 v34, a42
    v_accvgpr_read_b32 v35, a43
    v_accvgpr_read_b32 v36, a44
    v_accvgpr_read_b32 v37, a45
    v_accvgpr_read_b32 v38, a46
    v_accvgpr_read_b32 v39, a47
    v_cvt_pk_bf16_f32 v40, v24, v25
    v_cvt_pk_bf16_f32 v41, v26, v27
    v_cvt_pk_bf16_f32 v42, v28, v29
    v_cvt_pk_bf16_f32 v43, v30, v31
    v_cvt_pk_bf16_f32 v44, v32, v33
    v_cvt_pk_bf16_f32 v45, v34, v35
    v_cvt_pk_bf16_f32 v46, v36, v37
    v_cvt_pk_bf16_f32 v47, v38, v39
    s_nop 1
    v_permlane32_swap_b32 v40, v42
    v_permlane32_swap_b32 v41, v43
    v_permlane32_swap_b32 v44, v46
    v_permlane32_swap_b32 v45, v47
    ds_write_b128 v93, v[40:43] offset:4096
    ds_write_b128 v94, v[44:47] offset:4096
    v_accvgpr_read_b32 v48, a48
    v_accvgpr_read_b32 v49, a49
    v_accvgpr_read_b32 v50, a50
    v_accvgpr_read_b32 v51, a51
    v_accvgpr_read_b32 v52, a52
    v_accvgpr_read_b32 v53, a53
    v_accvgpr_read_b32 v54, a54
    v_accvgpr_read_b32 v55, a55
    v_accvgpr_read_b32 v56, a56
    v_accvgpr_read_b32 v57, a57
    v_accvgpr_read_b32 v58, a58
    v_accvgpr_read_b32 v59, a59
    v_accvgpr_read_b32 v60, a60
    v_accvgpr_read_b32 v61, a61
    v_accvgpr_read_b32 v62, a62
    v_accvgpr_read_b32 v63, a63
    v_cvt_pk_bf16_f32 v64, v48, v49
    v_cvt_pk_bf16_f32 v65, v50, v51
    v_cvt_pk_bf16_f32 v66, v52, v53
    v_cvt_pk_bf16_f32 v67, v54, v55
    v_cvt_pk_bf16_f32 v68, v56, v57
    v_cvt_pk_bf16_f32 v69, v58, v59
    v_cvt_pk_bf16_f32 v70, v60, v61
    v_cvt_pk_bf16_f32 v71, v62, v63
    s_nop 1
    v_permlane32_swap_b32 v64, v66
    v_permlane32_swap_b32 v65, v67
    v_permlane32_swap_b32 v68, v70
    v_permlane32_swap_b32 v69, v71
    ds_write_b128 v95, v[64:67] offset:4096
    ds_write_b128 v96, v[68:71] offset:4096
    v_accvgpr_read_b32 v24, a64
    v_accvgpr_read_b32 v25, a65
    v_accvgpr_read_b32 v26, a66
    v_accvgpr_read_b32 v27, a67
    v_accvgpr_read_b32 v28, a68
    v_accvgpr_read_b32 v29, a69
    v_accvgpr_read_b32 v30, a70
    v_accvgpr_read_b32 v31, a71
    v_accvgpr_read_b32 v32, a72
    v_accvgpr_read_b32 v33, a73
    v_accvgpr_read_b32 v34, a74
    v_accvgpr_read_b32 v35, a75
    v_accvgpr_read_b32 v36, a76
    v_accvgpr_read_b32 v37, a77
    v_accvgpr_read_b32 v38, a78
    v_accvgpr_read_b32 v39, a79
    v_cvt_pk_bf16_f32 v40, v24, v25
    v_cvt_pk_bf16_f32 v41, v26, v27
    v_cvt_pk_bf16_f32 v42, v28, v29
    v_cvt_pk_bf16_f32 v43, v30, v31
    v_cvt_pk_bf16_f32 v44, v32, v33
    v_cvt_pk_bf16_f32 v45, v34, v35
    v_cvt_pk_bf16_f32 v46, v36, v37
    v_cvt_pk_bf16_f32 v47, v38, v39
    s_nop 1
    v_permlane32_swap_b32 v40, v42
    v_permlane32_swap_b32 v41, v43
    v_permlane32_swap_b32 v44, v46
    v_permlane32_swap_b32 v45, v47
    ds_write_b128 v93, v[40:43] offset:8192
    ds_write_b128 v94, v[44:47] offset:8192
    v_accvgpr_read_b32 v48, a80
    v_accvgpr_read_b32 v49, a81
    v_accvgpr_read_b32 v50, a82
    v_accvgpr_read_b32 v51, a83
    v_accvgpr_read_b32 v52, a84
    v_accvgpr_read_b32 v53, a85
    v_accvgpr_read_b32 v54, a86
    v_accvgpr_read_b32 v55, a87
    v_accvgpr_read_b32 v56, a88
    v_accvgpr_read_b32 v57, a89
    v_accvgpr_read_b32 v58, a90
    v_accvgpr_read_b32 v59, a91
    v_accvgpr_read_b32 v60, a92
    v_accvgpr_read_b32 v61, a93
    v_accvgpr_read_b32 v62, a94
    v_accvgpr_read_b32 v63, a95
    v_cvt_pk_bf16_f32 v64, v48, v49
    v_cvt_pk_bf16_f32 v65, v50, v51
    v_cvt_pk_bf16_f32 v66, v52, v53
    v_cvt_pk_bf16_f32 v67, v54, v55
    v_cvt_pk_bf16_f32 v68, v56, v57
    v_cvt_pk_bf16_f32 v69, v58, v59
    v_cvt_pk_bf16_f32 v70, v60, v61
    v_cvt_pk_bf16_f32 v71, v62, v63
    s_nop 1
    v_permlane32_swap_b32 v64, v66
    v_permlane32_swap_b32 v65, v67
    v_permlane32_swap_b32 v68, v70
    v_permlane32_swap_b32 v69, v71
    ds_write_b128 v95, v[64:67] offset:8192
    ds_write_b128 v96, v[68:71] offset:8192
    v_accvgpr_read_b32 v24, a96
    v_accvgpr_read_b32 v25, a97
    v_accvgpr_read_b32 v26, a98
    v_accvgpr_read_b32 v27, a99
    v_accvgpr_read_b32 v28, a100
    v_accvgpr_read_b32 v29, a101
    v_accvgpr_read_b32 v30, a102
    v_accvgpr_read_b32 v31, a103
    v_accvgpr_read_b32 v32, a104
    v_accvgpr_read_b32 v33, a105
    v_accvgpr_read_b32 v34, a106
    v_accvgpr_read_b32 v35, a107
    v_accvgpr_read_b32 v36, a108
    v_accvgpr_read_b32 v37, a109
    v_accvgpr_read_b32 v38, a110
    v_accvgpr_read_b32 v39, a111
    v_cvt_pk_bf16_f32 v40, v24, v25
    v_cvt_pk_bf16_f32 v41, v26, v27
    v_cvt_pk_bf16_f32 v42, v28, v29
    v_cvt_pk_bf16_f32 v43, v30, v31
    v_cvt_pk_bf16_f32 v44, v32, v33
    v_cvt_pk_bf16_f32 v45, v34, v35
    v_cvt_pk_bf16_f32 v46, v36, v37
    v_cvt_pk_bf16_f32 v47, v38, v39
    s_nop 1
    v_permlane32_swap_b32 v40, v42
    v_permlane32_swap_b32 v41, v43
    v_permlane32_swap_b32 v44, v46
    v_permlane32_swap_b32 v45, v47
    ds_write_b128 v93, v[40:43] offset:12288
    ds_write_b128 v94, v[44:47] offset:12288
    v_accvgpr_read_b32 v48, a112
    v_accvgpr_read_b32 v49, a113
    v_accvgpr_read_b32 v50, a114
    v_accvgpr_read_b32 v51, a115
    v_accvgpr_read_b32 v52, a116
    v_accvgpr_read_b32 v53, a117
    v_accvgpr_read_b32 v54, a118
    v_accvgpr_read_b32 v55, a119
    v_accvgpr_read_b32 v56, a120
    v_accvgpr_read_b32 v57, a121
    v_accvgpr_read_b32 v58, a122
    v_accvgpr_read_b32 v59, a123
    v_accvgpr_read_b32 v60, a124
    v_accvgpr_read_b32 v61, a125
    v_accvgpr_read_b32 v62, a126
    v_accvgpr_read_b32 v63, a127
    v_cvt_pk_bf16_f32 v64, v48, v49
    v_cvt_pk_bf16_f32 v65, v50, v51
    v_cvt_pk_bf16_f32 v66, v52, v53
    v_cvt_pk_bf16_f32 v67, v54, v55
    v_cvt_pk_bf16_f32 v68, v56, v57
    v_cvt_pk_bf16_f32 v69, v58, v59
    v_cvt_pk_bf16_f32 v70, v60, v61
    v_cvt_pk_bf16_f32 v71, v62, v63
    s_nop 1
    v_permlane32_swap_b32 v64, v66
    v_permlane32_swap_b32 v65, v67
    v_permlane32_swap_b32 v68, v70
    v_permlane32_swap_b32 v69, v71
    ds_write_b128 v95, v[64:67] offset:12288
    ds_write_b128 v96, v[68:71] offset:12288
    v_and_b32 v88, 15, v1
    v_lshrrev_b32 v89, 4, v1
    v_and_b32 v92, 7, v88
    v_xor_b32 v89, v89, v92
    v_lshlrev_b32 v91, 7, v88
    v_add_u32 v91, s25, v91
    v_lshlrev_b32 v92, 4, v1
    s_lshr_b32 s23, s22, 1
    s_lshl_b32 s23, s23, 20
    s_and_b32 s24, s22, 1
    s_lshl_b32 s24, s24, 11
    s_add_u32 s23, s23, s24
    v_add_u32 v92, s23, v92
    v_add_u32 v101, 4096, v92
    v_xor_b32 v93, 0, v89
    v_lshl_add_u32 v93, v93, 4, v91
    v_xor_b32 v94, 4, v89
    v_lshl_add_u32 v94, v94, 4, v91
    s_waitcnt lgkmcnt(0)
    ds_read_b128 v[24:27], v93 offset:0
    ds_read_b128 v[28:31], v94 offset:0
    ds_read_b128 v[32:35], v93 offset:2048
    ds_read_b128 v[36:39], v94 offset:2048
    s_waitcnt lgkmcnt(0)
    global_store_dwordx4 v92, v[24:27], s[42:43] offset:0 sc1
    global_store_dwordx4 v92, v[28:31], s[42:43] offset:1024 sc1
    global_store_dwordx4 v101, v[32:35], s[42:43] offset:0 sc1
    global_store_dwordx4 v101, v[36:39], s[42:43] offset:1024 sc1
    v_add_u32 v92, 262144, v92
    v_add_u32 v101, 262144, v101
    s_nop 1
    ds_read_b128 v[24:27], v93 offset:4096
    ds_read_b128 v[28:31], v94 offset:4096
    ds_read_b128 v[32:35], v93 offset:6144
    ds_read_b128 v[36:39], v94 offset:6144
    s_waitcnt lgkmcnt(0)
    global_store_dwordx4 v92, v[24:27], s[42:43] offset:0 sc1
    global_store_dwordx4 v92, v[28:31], s[42:43] offset:1024 sc1
    global_store_dwordx4 v101, v[32:35], s[42:43] offset:0 sc1
    global_store_dwordx4 v101, v[36:39], s[42:43] offset:1024 sc1
    v_add_u32 v92, 262144, v92
    v_add_u32 v101, 262144, v101
    s_nop 1
    ds_read_b128 v[24:27], v93 offset:8192
    ds_read_b128 v[28:31], v94 offset:8192
    ds_read_b128 v[32:35], v93 offset:10240
    ds_read_b128 v[36:39], v94 offset:10240
    s_waitcnt lgkmcnt(0)
    global_store_dwordx4 v92, v[24:27], s[42:43] offset:0 sc1
    global_store_dwordx4 v92, v[28:31], s[42:43] offset:1024 sc1
    global_store_dwordx4 v101, v[32:35], s[42:43] offset:0 sc1
    global_store_dwordx4 v101, v[36:39], s[42:43] offset:1024 sc1
    v_add_u32 v92, 262144, v92
    v_add_u32 v101, 262144, v101
    s_nop 1
    ds_read_b128 v[24:27], v93 offset:12288
    ds_read_b128 v[28:31], v94 offset:12288
    ds_read_b128 v[32:35], v93 offset:14336
    ds_read_b128 v[36:39], v94 offset:14336
    s_waitcnt lgkmcnt(0)
    global_store_dwordx4 v92, v[24:27], s[42:43] offset:0 sc1
    global_store_dwordx4 v92, v[28:31], s[42:43] offset:1024 sc1
    global_store_dwordx4 v101, v[32:35], s[42:43] offset:0 sc1
    global_store_dwordx4 v101, v[36:39], s[42:43] offset:1024 sc1
    s_nop 1
    s_branch L_sig_n
L_t_nv:
    s_lshl_b32 s25, s22, 12
    s_lshl_b32 s24, s22, 11
    s_add_u32 s26, s25, 0
    s_add_u32 s29, s24, 0
    s_add_u32 m0, s26, 0
    s_nop 0
    buffer_load_dwordx4 v2, s[8:11], s16 offen lds
    s_add_u32 m0, s26, 1024
    s_nop 0
    buffer_load_dwordx4 v3, s[8:11], s16 offen lds
    s_add_u32 m0, s26, 2048
    s_nop 0
    buffer_load_dwordx4 v4, s[8:11], s16 offen lds
    s_add_u32 m0, s26, 3072
    s_nop 0
    buffer_load_dwordx4 v5, s[8:11], s16 offen lds
    s_add_u32 m0, s29, 16384
    s_nop 0
    buffer_load_dwordx4 v6, s[12:15], s17 offen lds
    s_add_u32 m0, s29, 17408
    s_nop 0
    buffer_load_dwordx4 v7, s[12:15], s17 offen lds
    s_add_u32 s16, s16, s27
    s_add_u32 s17, s17, s28
    s_add_u32 s26, s25, 32768
    s_add_u32 s29, s24, 32768
    s_add_u32 m0, s26, 0
    s_nop 0
    buffer_load_dwordx4 v2, s[8:11], s16 offen lds
    s_add_u32 m0, s26, 1024
    s_nop 0
    buffer_load_dwordx4 v3, s[8:11], s16 offen lds
    s_add_u32 m0, s26, 2048
    s_nop 0
    buffer_load_dwordx4 v4, s[8:11], s16 offen lds
    s_add_u32 m0, s26, 3072
    s_nop 0
    buffer_load_dwordx4 v5, s[8:11], s16 offen lds
    s_add_u32 m0, s29, 16384
    s_nop 0
    buffer_load_dwordx4 v6, s[12:15], s17 offen lds
    s_add_u32 m0, s29, 17408
    s_nop 0
    buffer_load_dwordx4 v7, s[12:15], s17 offen lds
    s_add_u32 s16, s16, s27
    s_add_u32 s17, s17, s28
    s_add_u32 s26, s25, 65536
    s_add_u32 s29, s24, 65536
    s_add_u32 m0, s26, 0
    s_nop 0
    buffer_load_dwordx4 v2, s[8:11], s16 offen lds
    s_add_u32 m0, s26, 1024
    s_nop 0
    buffer_load_dwordx4 v3, s[8:11], s16 offen lds
    s_add_u32 m0, s26, 2048
    s_nop 0
    buffer_load_dwordx4 v4, s[8:11], s16 offen lds
    s_add_u32 m0, s26, 3072
    s_nop 0
    buffer_load_dwordx4 v5, s[8:11], s16 offen lds
    s_add_u32 m0, s29, 16384
    s_nop 0
    buffer_load_dwordx4 v6, s[12:15], s17 offen lds
    s_add_u32 m0, s29, 17408
    s_nop 0
    buffer_load_dwordx4 v7, s[12:15], s17 offen lds
    s_add_u32 s16, s16, s27
    s_add_u32 s17, s17, s28
    v_accvgpr_write_b32 a0, 0
    v_accvgpr_write_b32 a1, 0
    v_accvgpr_write_b32 a2, 0
    v_accvgpr_write_b32 a3, 0
    v_accvgpr_write_b32 a4, 0
    v_accvgpr_write_b32 a5, 0
    v_accvgpr_write_b32 a6, 0
    v_accvgpr_write_b32 a7, 0
    v_accvgpr_write_b32 a8, 0
    v_accvgpr_write_b32 a9, 0
    v_accvgpr_write_b32 a10, 0
    v_accvgpr_write_b32 a11, 0
    v_accvgpr_write_b32 a12, 0
    v_accvgpr_write_b32 a13, 0
    v_accvgpr_write_b32 a14, 0
    v_accvgpr_write_b32 a15, 0
    v_accvgpr_write_b32 a16, 0
    v_accvgpr_write_b32 a17, 0
    v_accvgpr_write_b32 a18, 0
    v_accvgpr_write_b32 a19, 0
    v_accvgpr_write_b32 a20, 0
    v_accvgpr_write_b32 a21, 0
    v_accvgpr_write_b32 a22, 0
    v_accvgpr_write_b32 a23, 0
    v_accvgpr_write_b32 a24, 0
    v_accvgpr_write_b32 a25, 0
    v_accvgpr_write_b32 a26, 0
    v_accvgpr_write_b32 a27, 0
    v_accvgpr_write_b32 a28, 0
    v_accvgpr_write_b32 a29, 0
    v_accvgpr_write_b32 a30, 0
    v_accvgpr_write_b32 a31, 0
    v_accvgpr_write_b32 a32, 0
    v_accvgpr_write_b32 a33, 0
    v_accvgpr_write_b32 a34, 0
    v_accvgpr_write_b32 a35, 0
    v_accvgpr_write_b32 a36, 0
    v_accvgpr_write_b32 a37, 0
    v_accvgpr_write_b32 a38, 0
    v_accvgpr_write_b32 a39, 0
    v_accvgpr_write_b32 a40, 0
    v_accvgpr_write_b32 a41, 0
    v_accvgpr_write_b32 a42, 0
    v_accvgpr_write_b32 a43, 0
    v_accvgpr_write_b32 a44, 0
    v_accvgpr_write_b32 a45, 0
    v_accvgpr_write_b32 a46, 0
    v_accvgpr_write_b32 a47, 0
    v_accvgpr_write_b32 a48, 0
    v_accvgpr_write_b32 a49, 0
    v_accvgpr_write_b32 a50, 0
    v_accvgpr_write_b32 a51, 0
    v_accvgpr_write_b32 a52, 0
    v_accvgpr_write_b32 a53, 0
    v_accvgpr_write_b32 a54, 0
    v_accvgpr_write_b32 a55, 0
    v_accvgpr_write_b32 a56, 0
    v_accvgpr_write_b32 a57, 0
    v_accvgpr_write_b32 a58, 0
    v_accvgpr_write_b32 a59, 0
    v_accvgpr_write_b32 a60, 0
    v_accvgpr_write_b32 a61, 0
    v_accvgpr_write_b32 a62, 0
    v_accvgpr_write_b32 a63, 0
    v_accvgpr_write_b32 a64, 0
    v_accvgpr_write_b32 a65, 0
    v_accvgpr_write_b32 a66, 0
    v_accvgpr_write_b32 a67, 0
    v_accvgpr_write_b32 a68, 0
    v_accvgpr_write_b32 a69, 0
    v_accvgpr_write_b32 a70, 0
    v_accvgpr_write_b32 a71, 0
    v_accvgpr_write_b32 a72, 0
    v_accvgpr_write_b32 a73, 0
    v_accvgpr_write_b32 a74, 0
    v_accvgpr_write_b32 a75, 0
    v_accvgpr_write_b32 a76, 0
    v_accvgpr_write_b32 a77, 0
    v_accvgpr_write_b32 a78, 0
    v_accvgpr_write_b32 a79, 0
    v_accvgpr_write_b32 a80, 0
    v_accvgpr_write_b32 a81, 0
    v_accvgpr_write_b32 a82, 0
    v_accvgpr_write_b32 a83, 0
    v_accvgpr_write_b32 a84, 0
    v_accvgpr_write_b32 a85, 0
    v_accvgpr_write_b32 a86, 0
    v_accvgpr_write_b32 a87, 0
    v_accvgpr_write_b32 a88, 0
    v_accvgpr_write_b32 a89, 0
    v_accvgpr_write_b32 a90, 0
    v_accvgpr_write_b32 a91, 0
    v_accvgpr_write_b32 a92, 0
    v_accvgpr_write_b32 a93, 0
    v_accvgpr_write_b32 a94, 0
    v_accvgpr_write_b32 a95, 0
    v_accvgpr_write_b32 a96, 0
    v_accvgpr_write_b32 a97, 0
    v_accvgpr_write_b32 a98, 0
    v_accvgpr_write_b32 a99, 0
    v_accvgpr_write_b32 a100, 0
    v_accvgpr_write_b32 a101, 0
    v_accvgpr_write_b32 a102, 0
    v_accvgpr_write_b32 a103, 0
    v_accvgpr_write_b32 a104, 0
    v_accvgpr_write_b32 a105, 0
    v_accvgpr_write_b32 a106, 0
    v_accvgpr_write_b32 a107, 0
    v_accvgpr_write_b32 a108, 0
    v_accvgpr_write_b32 a109, 0
    v_accvgpr_write_b32 a110, 0
    v_accvgpr_write_b32 a111, 0
    v_accvgpr_write_b32 a112, 0
    v_accvgpr_write_b32 a113, 0
    v_accvgpr_write_b32 a114, 0
    v_accvgpr_write_b32 a115, 0
    v_accvgpr_write_b32 a116, 0
    v_accvgpr_write_b32 a117, 0
    v_accvgpr_write_b32 a118, 0
    v_accvgpr_write_b32 a119, 0
    v_accvgpr_write_b32 a120, 0
    v_accvgpr_write_b32 a121, 0
    v_accvgpr_write_b32 a122, 0
    v_accvgpr_write_b32 a123, 0
    v_accvgpr_write_b32 a124, 0
    v_accvgpr_write_b32 a125, 0
    v_accvgpr_write_b32 a126, 0
    v_accvgpr_write_b32 a127, 0
    s_waitcnt vmcnt(12)
    s_barrier
    ds_read_b128 v[24:27], v10 offset:0
    ds_read_b128 v[28:31], v10 offset:2048
    ds_read_b128 v[32:35], v10 offset:4096
    ds_read_b128 v[36:39], v10 offset:6144
    ds_read_b64_tr_b16 v[40:41], v14 offset:0
    ds_read_b64_tr_b16 v[42:43], v14 offset:1024
    ds_read_b64_tr_b16 v[44:45], v15 offset:0
    ds_read_b64_tr_b16 v[46:47], v15 offset:1024
    s_mov_b32 s21, 0
.p2align 6
L_gemmn_v:
    s_waitcnt lgkmcnt(0)
    v_mfma_f32_32x32x16_bf16 a[0:15], v[24:27], v[40:43], a[0:15]
    ds_read_b128 v[56:59], v11 offset:0
    v_mfma_f32_32x32x16_bf16 a[16:31], v[24:27], v[44:47], a[16:31]
    ds_read_b128 v[60:63], v11 offset:2048
    v_mfma_f32_32x32x16_bf16 a[32:47], v[28:31], v[40:43], a[32:47]
    ds_read_b128 v[64:67], v11 offset:4096
    v_mfma_f32_32x32x16_bf16 a[48:63], v[28:31], v[44:47], a[48:63]
    ds_read_b128 v[68:71], v11 offset:6144
    v_mfma_f32_32x32x16_bf16 a[64:79], v[32:35], v[40:43], a[64:79]
    ds_read_b64_tr_b16 v[72:73], v14 offset:4096
    v_mfma_f32_32x32x16_bf16 a[80:95], v[32:35], v[44:47], a[80:95]
    ds_read_b64_tr_b16 v[74:75], v14 offset:5120
    v_mfma_f32_32x32x16_bf16 a[96:111], v[36:39], v[40:43], a[96:111]
    ds_read_b64_tr_b16 v[76:77], v15 offset:4096
    v_mfma_f32_32x32x16_bf16 a[112:127], v[36:39], v[44:47], a[112:127]
    ds_read_b64_tr_b16 v[78:79], v15 offset:5120
    s_waitcnt vmcnt(6)
    s_waitcnt lgkmcnt(0)
    s_barrier
    s_add_u32 s26, s25, 98304
    s_add_u32 s29, s24, 98304
    v_mfma_f32_32x32x16_bf16 a[0:15], v[56:59], v[72:75], a[0:15]
    ds_read_b128 v[24:27], v10 offset:32768
    s_add_u32 m0, s26, 0
    s_nop 0
    buffer_load_dwordx4 v2, s[8:11], s16 offen lds
    v_mfma_f32_32x32x16_bf16 a[16:31], v[56:59], v[76:79], a[16:31]
    ds_read_b128 v[28:31], v10 offset:34816
    s_add_u32 m0, s26, 1024
    s_nop 0
    buffer_load_dwordx4 v3, s[8:11], s16 offen lds
    v_mfma_f32_32x32x16_bf16 a[32:47], v[60:63], v[72:75], a[32:47]
    ds_read_b128 v[32:35], v10 offset:36864
    s_add_u32 m0, s26, 2048
    s_nop 0
    buffer_load_dwordx4 v4, s[8:11], s16 offen lds
    v_mfma_f32_32x32x16_bf16 a[48:63], v[60:63], v[76:79], a[48:63]
    ds_read_b128 v[36:39], v10 offset:38912
    s_add_u32 m0, s26, 3072
    s_nop 0
    buffer_load_dwordx4 v5, s[8:11], s16 offen lds
    v_mfma_f32_32x32x16_bf16 a[64:79], v[64:67], v[72:75], a[64:79]
    ds_read_b64_tr_b16 v[40:41], v14 offset:32768
    s_add_u32 m0, s29, 16384
    s_nop 0
    buffer_load_dwordx4 v6, s[12:15], s17 offen lds
    v_mfma_f32_32x32x16_bf16 a[80:95], v[64:67], v[76:79], a[80:95]
    ds_read_b64_tr_b16 v[42:43], v14 offset:33792
    s_add_u32 m0, s29, 17408
    s_nop 0
    buffer_load_dwordx4 v7, s[12:15], s17 offen lds
    v_mfma_f32_32x32x16_bf16 a[96:111], v[68:71], v[72:75], a[96:111]
    ds_read_b64_tr_b16 v[44:45], v15 offset:32768
    s_add_u32 s16, s16, s27
    s_add_u32 s17, s17, s28
    v_mfma_f32_32x32x16_bf16 a[112:127], v[68:71], v[76:79], a[112:127]
    ds_read_b64_tr_b16 v[46:47], v15 offset:33792
    s_waitcnt lgkmcnt(0)
    v_mfma_f32_32x32x16_bf16 a[0:15], v[24:27], v[40:43], a[0:15]
    ds_read_b128 v[56:59], v11 offset:32768
    v_mfma_f32_32x32x16_bf16 a[16:31], v[24:27], v[44:47], a[16:31]
    ds_read_b128 v[60:63], v11 offset:34816
    v_mfma_f32_32x32x16_bf16 a[32:47], v[28:31], v[40:43], a[32:47]
    ds_read_b128 v[64:67], v11 offset:36864
    v_mfma_f32_32x32x16_bf16 a[48:63], v[28:31], v[44:47], a[48:63]
    ds_read_b128 v[68:71], v11 offset:38912
    v_mfma_f32_32x32x16_bf16 a[64:79], v[32:35], v[40:43], a[64:79]
    ds_read_b64_tr_b16 v[72:73], v14 offset:36864
    v_mfma_f32_32x32x16_bf16 a[80:95], v[32:35], v[44:47], a[80:95]
    ds_read_b64_tr_b16 v[74:75], v14 offset:37888
    v_mfma_f32_32x32x16_bf16 a[96:111], v[36:39], v[40:43], a[96:111]
    ds_read_b64_tr_b16 v[76:77], v15 offset:36864
    v_mfma_f32_32x32x16_bf16 a[112:127], v[36:39], v[44:47], a[112:127]
    ds_read_b64_tr_b16 v[78:79], v15 offset:37888
    s_waitcnt vmcnt(6)
    s_waitcnt lgkmcnt(0)
    s_barrier
    s_add_u32 s26, s25, 0
    s_add_u32 s29, s24, 0
    v_mfma_f32_32x32x16_bf16 a[0:15], v[56:59], v[72:75], a[0:15]
    ds_read_b128 v[24:27], v12 offset:0
    s_add_u32 m0, s26, 0
    s_nop 0
    buffer_load_dwordx4 v2, s[8:11], s16 offen lds
    v_mfma_f32_32x32x16_bf16 a[16:31], v[56:59], v[76:79], a[16:31]
    ds_read_b128 v[28:31], v12 offset:2048
    s_add_u32 m0, s26, 1024
    s_nop 0
    buffer_load_dwordx4 v3, s[8:11], s16 offen lds
    v_mfma_f32_32x32x16_bf16 a[32:47], v[60:63], v[72:75], a[32:47]
    ds_read_b128 v[32:35], v12 offset:4096
    s_add_u32 m0, s26, 2048
    s_nop 0
    buffer_load_dwordx4 v4, s[8:11], s16 offen lds
    v_mfma_f32_32x32x16_bf16 a[48:63], v[60:63], v[76:79], a[48:63]
    ds_read_b128 v[36:39], v12 offset:6144
    s_add_u32 m0, s26, 3072
    s_nop 0
    buffer_load_dwordx4 v5, s[8:11], s16 offen lds
    v_mfma_f32_32x32x16_bf16 a[64:79], v[64:67], v[72:75], a[64:79]
    ds_read_b64_tr_b16 v[40:41], v18 offset:0
    s_add_u32 m0, s29, 16384
    s_nop 0
    buffer_load_dwordx4 v6, s[12:15], s17 offen lds
    v_mfma_f32_32x32x16_bf16 a[80:95], v[64:67], v[76:79], a[80:95]
    ds_read_b64_tr_b16 v[42:43], v18 offset:1024
    s_add_u32 m0, s29, 17408
    s_nop 0
    buffer_load_dwordx4 v7, s[12:15], s17 offen lds
    v_mfma_f32_32x32x16_bf16 a[96:111], v[68:71], v[72:75], a[96:111]
    ds_read_b64_tr_b16 v[44:45], v19 offset:0
    s_add_u32 s16, s16, s27
    s_add_u32 s17, s17, s28
    v_mfma_f32_32x32x16_bf16 a[112:127], v[68:71], v[76:79], a[112:127]
    ds_read_b64_tr_b16 v[46:47], v19 offset:1024
    s_waitcnt lgkmcnt(0)
    v_mfma_f32_32x32x16_bf16 a[0:15], v[24:27], v[40:43], a[0:15]
    ds_read_b128 v[56:59], v13 offset:0
    v_mfma_f32_32x32x16_bf16 a[16:31], v[24:27], v[44:47], a[16:31]
    ds_read_b128 v[60:63], v13 offset:2048
    v_mfma_f32_32x32x16_bf16 a[32:47], v[28:31], v[40:43], a[32:47]
    ds_read_b128 v[64:67], v13 offset:4096
    v_mfma_f32_32x32x16_bf16 a[48:63], v[28:31], v[44:47], a[48:63]
    ds_read_b128 v[68:71], v13 offset:6144
    v_mfma_f32_32x32x16_bf16 a[64:79], v[32:35], v[40:43], a[64:79]
    ds_read_b64_tr_b16 v[72:73], v18 offset:4096
    v_mfma_f32_32x32x16_bf16 a[80:95], v[32:35], v[44:47], a[80:95]
    ds_read_b64_tr_b16 v[74:75], v18 offset:5120
    v_mfma_f32_32x32x16_bf16 a[96:111], v[36:39], v[40:43], a[96:111]
    ds_read_b64_tr_b16 v[76:77], v19 offset:4096
    v_mfma_f32_32x32x16_bf16 a[112:127], v[36:39], v[44:47], a[112:127]
    ds_read_b64_tr_b16 v[78:79], v19 offset:5120
    s_waitcnt vmcnt(6)
    s_waitcnt lgkmcnt(0)
    s_barrier
    s_add_u32 s26, s25, 32768
    s_add_u32 s29, s24, 32768
    v_mfma_f32_32x32x16_bf16 a[0:15], v[56:59], v[72:75], a[0:15]
    ds_read_b128 v[24:27], v12 offset:32768
    s_add_u32 m0, s26, 0
    s_nop 0
    buffer_load_dwordx4 v2, s[8:11], s16 offen lds
    v_mfma_f32_32x32x16_bf16 a[16:31], v[56:59], v[76:79], a[16:31]
    ds_read_b128 v[28:31], v12 offset:34816
    s_add_u32 m0, s26, 1024
    s_nop 0
    buffer_load_dwordx4 v3, s[8:11], s16 offen lds
    v_mfma_f32_32x32x16_bf16 a[32:47], v[60:63], v[72:75], a[32:47]
    ds_read_b128 v[32:35], v12 offset:36864
    s_add_u32 m0, s26, 2048
    s_nop 0
    buffer_load_dwordx4 v4, s[8:11], s16 offen lds
    v_mfma_f32_32x32x16_bf16 a[48:63], v[60:63], v[76:79], a[48:63]
    ds_read_b128 v[36:39], v12 offset:38912
    s_add_u32 m0, s26, 3072
    s_nop 0
    buffer_load_dwordx4 v5, s[8:11], s16 offen lds
    v_mfma_f32_32x32x16_bf16 a[64:79], v[64:67], v[72:75], a[64:79]
    ds_read_b64_tr_b16 v[40:41], v18 offset:32768
    s_add_u32 m0, s29, 16384
    s_nop 0
    buffer_load_dwordx4 v6, s[12:15], s17 offen lds
    v_mfma_f32_32x32x16_bf16 a[80:95], v[64:67], v[76:79], a[80:95]
    ds_read_b64_tr_b16 v[42:43], v18 offset:33792
    s_add_u32 m0, s29, 17408
    s_nop 0
    buffer_load_dwordx4 v7, s[12:15], s17 offen lds
    v_mfma_f32_32x32x16_bf16 a[96:111], v[68:71], v[72:75], a[96:111]
    ds_read_b64_tr_b16 v[44:45], v19 offset:32768
    s_add_u32 s16, s16, s27
    s_add_u32 s17, s17, s28
    v_mfma_f32_32x32x16_bf16 a[112:127], v[68:71], v[76:79], a[112:127]
    ds_read_b64_tr_b16 v[46:47], v19 offset:33792
    s_waitcnt lgkmcnt(0)
    v_mfma_f32_32x32x16_bf16 a[0:15], v[24:27], v[40:43], a[0:15]
    ds_read_b128 v[56:59], v13 offset:32768
    v_mfma_f32_32x32x16_bf16 a[16:31], v[24:27], v[44:47], a[16:31]
    ds_read_b128 v[60:63], v13 offset:34816
    v_mfma_f32_32x32x16_bf16 a[32:47], v[28:31], v[40:43], a[32:47]
    ds_read_b128 v[64:67], v13 offset:36864
    v_mfma_f32_32x32x16_bf16 a[48:63], v[28:31], v[44:47], a[48:63]
    ds_read_b128 v[68:71], v13 offset:38912
    v_mfma_f32_32x32x16_bf16 a[64:79], v[32:35], v[40:43], a[64:79]
    ds_read_b64_tr_b16 v[72:73], v18 offset:36864
    v_mfma_f32_32x32x16_bf16 a[80:95], v[32:35], v[44:47], a[80:95]
    ds_read_b64_tr_b16 v[74:75], v18 offset:37888
    v_mfma_f32_32x32x16_bf16 a[96:111], v[36:39], v[40:43], a[96:111]
    ds_read_b64_tr_b16 v[76:77], v19 offset:36864
    v_mfma_f32_32x32x16_bf16 a[112:127], v[36:39], v[44:47], a[112:127]
    ds_read_b64_tr_b16 v[78:79], v19 offset:37888
    s_waitcnt vmcnt(6)
    s_waitcnt lgkmcnt(0)
    s_barrier
    s_add_u32 s26, s25, 65536
    s_add_u32 s29, s24, 65536
    v_mfma_f32_32x32x16_bf16 a[0:15], v[56:59], v[72:75], a[0:15]
    ds_read_b128 v[24:27], v10 offset:0
    s_add_u32 m0, s26, 0
    s_nop 0
    buffer_load_dwordx4 v2, s[8:11], s16 offen lds
    v_mfma_f32_32x32x16_bf16 a[16:31], v[56:59], v[76:79], a[16:31]
    ds_read_b128 v[28:31], v10 offset:2048
    s_add_u32 m0, s26, 1024
    s_nop 0
    buffer_load_dwordx4 v3, s[8:11], s16 offen lds
    v_mfma_f32_32x32x16_bf16 a[32:47], v[60:63], v[72:75], a[32:47]
    ds_read_b128 v[32:35], v10 offset:4096
    s_add_u32 m0, s26, 2048
    s_nop 0
    buffer_load_dwordx4 v4, s[8:11], s16 offen lds
    v_mfma_f32_32x32x16_bf16 a[48:63], v[60:63], v[76:79], a[48:63]
    ds_read_b128 v[36:39], v10 offset:6144
    s_add_u32 m0, s26, 3072
    s_nop 0
    buffer_load_dwordx4 v5, s[8:11], s16 offen lds
    v_mfma_f32_32x32x16_bf16 a[64:79], v[64:67], v[72:75], a[64:79]
    ds_read_b64_tr_b16 v[40:41], v14 offset:0
    s_add_u32 m0, s29, 16384
    s_nop 0
    buffer_load_dwordx4 v6, s[12:15], s17 offen lds
    v_mfma_f32_32x32x16_bf16 a[80:95], v[64:67], v[76:79], a[80:95]
    ds_read_b64_tr_b16 v[42:43], v14 offset:1024
    s_add_u32 m0, s29, 17408
    s_nop 0
    buffer_load_dwordx4 v7, s[12:15], s17 offen lds
    v_mfma_f32_32x32x16_bf16 a[96:111], v[68:71], v[72:75], a[96:111]
    ds_read_b64_tr_b16 v[44:45], v15 offset:0
    s_add_u32 s16, s16, s27
    s_add_u32 s17, s17, s28
    v_mfma_f32_32x32x16_bf16 a[112:127], v[68:71], v[76:79], a[112:127]
    ds_read_b64_tr_b16 v[46:47], v15 offset:1024
    s_add_u32 s21, s21, 4
    s_cmp_lt_u32 s21, s20
    s_cbranch_scc1 L_gemmn_v
    s_waitcnt vmcnt(0) lgkmcnt(0)
    s_nop 15
    s_barrier
    s_lshl_b32 s25, s22, 14
    v_and_b32 v88, 31, v1
    v_lshlrev_b32 v90, 6, v88
    v_lshrrev_b32 v89, 5, v1
    v_bfe_u32 v92, v1, 1, 2
    v_xor_b32 v89, v89, v92
    v_add_u32 v90, s25, v90
    v_lshl_add_u32 v93, v89, 4, v90
    v_xor_b32 v89, 2, v89
    v_lshl_add_u32 v94, v89, 4, v90
    v_accvgpr_read_b32 v24, a0
    v_accvgpr_read_b32 v25, a1
    v_accvgpr_read_b32 v26, a2
    v_accvgpr_read_b32 v27, a3
    v_accvgpr_read_b32 v28, a4
    v_accvgpr_read_b32 v29, a5
    v_accvgpr_read_b32 v30, a6
    v_accvgpr_read_b32 v31, a7
    v_accvgpr_read_b32 v32, a8
    v_accvgpr_read_b32 v33, a9
    v_accvgpr_read_b32 v34, a10
    v_accvgpr_read_b32 v35, a11
    v_accvgpr_read_b32 v36, a12
    v_accvgpr_read_b32 v37, a13
    v_accvgpr_read_b32 v38, a14
    v_accvgpr_read_b32 v39, a15
    v_cvt_pk_bf16_f32 v40, v24, v25
    v_cvt_pk_bf16_f32 v41, v26, v27
    v_cvt_pk_bf16_f32 v42, v32, v33
    v_cvt_pk_bf16_f32 v43, v34, v35
    v_cvt_pk_bf16_f32 v44, v28, v29
    v_cvt_pk_bf16_f32 v45, v30, v31
    v_cvt_pk_bf16_f32 v46, v36, v37
    v_cvt_pk_bf16_f32 v47, v38, v39
    ds_write_b128 v93, v[40:43] offset:0
    ds_write_b128 v94, v[44:47] offset:0
    v_accvgpr_read_b32 v48, a16
    v_accvgpr_read_b32 v49, a17
    v_accvgpr_read_b32 v50, a18
    v_accvgpr_read_b32 v51, a19
    v_accvgpr_read_b32 v52, a20
    v_accvgpr_read_b32 v53, a21
    v_accvgpr_read_b32 v54, a22
    v_accvgpr_read_b32 v55, a23
    v_accvgpr_read_b32 v56, a24
    v_accvgpr_read_b32 v57, a25
    v_accvgpr_read_b32 v58, a26
    v_accvgpr_read_b32 v59, a27
    v_accvgpr_read_b32 v60, a28
    v_accvgpr_read_b32 v61, a29
    v_accvgpr_read_b32 v62, a30
    v_accvgpr_read_b32 v63, a31
    v_cvt_pk_bf16_f32 v64, v48, v49
    v_cvt_pk_bf16_f32 v65, v50, v51
    v_cvt_pk_bf16_f32 v66, v56, v57
    v_cvt_pk_bf16_f32 v67, v58, v59
    v_cvt_pk_bf16_f32 v68, v52, v53
    v_cvt_pk_bf16_f32 v69, v54, v55
    v_cvt_pk_bf16_f32 v70, v60, v61
    v_cvt_pk_bf16_f32 v71, v62, v63
    ds_write_b128 v93, v[64:67] offset:2048
    ds_write_b128 v94, v[68:71] offset:2048
    v_accvgpr_read_b32 v24, a32
    v_accvgpr_read_b32 v25, a33
    v_accvgpr_read_b32 v26, a34
    v_accvgpr_read_b32 v27, a35
    v_accvgpr_read_b32 v28, a36
    v_accvgpr_read_b32 v29, a37
    v_accvgpr_read_b32 v30, a38
    v_accvgpr_read_b32 v31, a39
    v_accvgpr_read_b32 v32, a40
    v_accvgpr_read_b32 v33, a41
    v_accvgpr_read_b32 v34, a42
    v_accvgpr_read_b32 v35, a43
    v_accvgpr_read_b32 v36, a44
    v_accvgpr_read_b32 v37, a45
    v_accvgpr_read_b32 v38, a46
    v_accvgpr_read_b32 v39, a47
    v_cvt_pk_bf16_f32 v40, v24, v25
    v_cvt_pk_bf16_f32 v41, v26, v27
    v_cvt_pk_bf16_f32 v42, v32, v33
    v_cvt_pk_bf16_f32 v43, v34, v35
    v_cvt_pk_bf16_f32 v44, v28, v29
    v_cvt_pk_bf16_f32 v45, v30, v31
    v_cvt_pk_bf16_f32 v46, v36, v37
    v_cvt_pk_bf16_f32 v47, v38, v39
    ds_write_b128 v93, v[40:43] offset:4096
    ds_write_b128 v94, v[44:47] offset:4096
    v_accvgpr_read_b32 v48, a48
    v_accvgpr_read_b32 v49, a49
    v_accvgpr_read_b32 v50, a50
    v_accvgpr_read_b32 v51, a51
    v_accvgpr_read_b32 v52, a52
    v_accvgpr_read_b32 v53, a53
    v_accvgpr_read_b32 v54, a54
    v_accvgpr_read_b32 v55, a55
    v_accvgpr_read_b32 v56, a56
    v_accvgpr_read_b32 v57, a57
    v_accvgpr_read_b32 v58, a58
    v_accvgpr_read_b32 v59, a59
    v_accvgpr_read_b32 v60, a60
    v_accvgpr_read_b32 v61, a61
    v_accvgpr_read_b32 v62, a62
    v_accvgpr_read_b32 v63, a63
    v_cvt_pk_bf16_f32 v64, v48, v49
    v_cvt_pk_bf16_f32 v65, v50, v51
    v_cvt_pk_bf16_f32 v66, v56, v57
    v_cvt_pk_bf16_f32 v67, v58, v59
    v_cvt_pk_bf16_f32 v68, v52, v53
    v_cvt_pk_bf16_f32 v69, v54, v55
    v_cvt_pk_bf16_f32 v70, v60, v61
    v_cvt_pk_bf16_f32 v71, v62, v63
    ds_write_b128 v93, v[64:67] offset:6144
    ds_write_b128 v94, v[68:71] offset:6144
    v_accvgpr_read_b32 v24, a64
    v_accvgpr_read_b32 v25, a65
    v_accvgpr_read_b32 v26, a66
    v_accvgpr_read_b32 v27, a67
    v_accvgpr_read_b32 v28, a68
    v_accvgpr_read_b32 v29, a69
    v_accvgpr_read_b32 v30, a70
    v_accvgpr_read_b32 v31, a71
    v_accvgpr_read_b32 v32, a72
    v_accvgpr_read_b32 v33, a73
    v_accvgpr_read_b32 v34, a74
    v_accvgpr_read_b32 v35, a75
    v_accvgpr_read_b32 v36, a76
    v_accvgpr_read_b32 v37, a77
    v_accvgpr_read_b32 v38, a78
    v_accvgpr_read_b32 v39, a79
    v_cvt_pk_bf16_f32 v40, v24, v25
    v_cvt_pk_bf16_f32 v41, v26, v27
    v_cvt_pk_bf16_f32 v42, v32, v33
    v_cvt_pk_bf16_f32 v43, v34, v35
    v_cvt_pk_bf16_f32 v44, v28, v29
    v_cvt_pk_bf16_f32 v45, v30, v31
    v_cvt_pk_bf16_f32 v46, v36, v37
    v_cvt_pk_bf16_f32 v47, v38, v39
    ds_write_b128 v93, v[40:43] offset:8192
    ds_write_b128 v94, v[44:47] offset:8192
    v_accvgpr_read_b32 v48, a80
    v_accvgpr_read_b32 v49, a81
    v_accvgpr_read_b32 v50, a82
    v_accvgpr_read_b32 v51, a83
    v_accvgpr_read_b32 v52, a84
    v_accvgpr_read_b32 v53, a85
    v_accvgpr_read_b32 v54, a86
    v_accvgpr_read_b32 v55, a87
    v_accvgpr_read_b32 v56, a88
    v_accvgpr_read_b32 v57, a89
    v_accvgpr_read_b32 v58, a90
    v_accvgpr_read_b32 v59, a91
    v_accvgpr_read_b32 v60, a92
    v_accvgpr_read_b32 v61, a93
    v_accvgpr_read_b32 v62, a94
    v_accvgpr_read_b32 v63, a95
    v_cvt_pk_bf16_f32 v64, v48, v49
    v_cvt_pk_bf16_f32 v65, v50, v51
    v_cvt_pk_bf16_f32 v66, v56, v57
    v_cvt_pk_bf16_f32 v67, v58, v59
    v_cvt_pk_bf16_f32 v68, v52, v53
    v_cvt_pk_bf16_f32 v69, v54, v55
    v_cvt_pk_bf16_f32 v70, v60, v61
    v_cvt_pk_bf16_f32 v71, v62, v63
    ds_write_b128 v93, v[64:67] offset:10240
    ds_write_b128 v94, v[68:71] offset:10240
    v_accvgpr_read_b32 v24, a96
    v_accvgpr_read_b32 v25, a97
    v_accvgpr_read_b32 v26, a98
    v_accvgpr_read_b32 v27, a99
    v_accvgpr_read_b32 v28, a100
    v_accvgpr_read_b32 v29, a101
    v_accvgpr_read_b32 v30, a102
    v_accvgpr_read_b32 v31, a103
    v_accvgpr_read_b32 v32, a104
    v_accvgpr_read_b32 v33, a105
    v_accvgpr_read_b32 v34, a106
    v_accvgpr_read_b32 v35, a107
    v_accvgpr_read_b32 v36, a108
    v_accvgpr_read_b32 v37, a109
    v_accvgpr_read_b32 v38, a110
    v_accvgpr_read_b32 v39, a111
    v_cvt_pk_bf16_f32 v40, v24, v25
    v_cvt_pk_bf16_f32 v41, v26, v27
    v_cvt_pk_bf16_f32 v42, v32, v33
    v_cvt_pk_bf16_f32 v43, v34, v35
    v_cvt_pk_bf16_f32 v44, v28, v29
    v_cvt_pk_bf16_f32 v45, v30, v31
    v_cvt_pk_bf16_f32 v46, v36, v37
    v_cvt_pk_bf16_f32 v47, v38, v39
    ds_write_b128 v93, v[40:43] offset:12288
    ds_write_b128 v94, v[44:47] offset:12288
    v_accvgpr_read_b32 v48, a112
    v_accvgpr_read_b32 v49, a113
    v_accvgpr_read_b32 v50, a114
    v_accvgpr_read_b32 v51, a115
    v_accvgpr_read_b32 v52, a116
    v_accvgpr_read_b32 v53, a117
    v_accvgpr_read_b32 v54, a118
    v_accvgpr_read_b32 v55, a119
    v_accvgpr_read_b32 v56, a120
    v_accvgpr_read_b32 v57, a121
    v_accvgpr_read_b32 v58, a122
    v_accvgpr_read_b32 v59, a123
    v_accvgpr_read_b32 v60, a124
    v_accvgpr_read_b32 v61, a125
    v_accvgpr_read_b32 v62, a126
    v_accvgpr_read_b32 v63, a127
    v_cvt_pk_bf16_f32 v64, v48, v49
    v_cvt_pk_bf16_f32 v65, v50, v51
    v_cvt_pk_bf16_f32 v66, v56, v57
    v_cvt_pk_bf16_f32 v67, v58, v59
    v_cvt_pk_bf16_f32 v68, v52, v53
    v_cvt_pk_bf16_f32 v69, v54, v55
    v_cvt_pk_bf16_f32 v70, v60, v61
    v_cvt_pk_bf16_f32 v71, v62, v63
    ds_write_b128 v93, v[64:67] offset:14336
    ds_write_b128 v94, v[68:71] offset:14336
    v_lshlrev_b32 v91, 4, v1
    v_add_u32 v91, s25, v91
    v_and_b32 v88, 3, v1
    v_bfe_u32 v89, v1, 3, 2
    v_xor_b32 v88, v88, v89
    v_lshrrev_b32 v89, 2, v1
    v_lshlrev_b32 v89, 6, v89
    v_lshl_add_u32 v92, v88, 4, v89
    s_lshr_b32 s23, s22, 1
    s_lshl_b32 s23, s23, 20
    s_and_b32 s24, s22, 1
    s_lshl_b32 s24, s24, 12
    s_add_u32 s23, s23, s24
    v_add_u32 v92, s23, v92
    s_waitcnt lgkmcnt(0)
    ds_read_b128 v[24:27], v91 offset:0
    ds_read_b128 v[28:31], v91 offset:1024
    ds_read_b128 v[32:35], v91 offset:2048
    ds_read_b128 v[36:39], v91 offset:3072
    s_waitcnt lgkmcnt(0)
    global_store_dwordx4 v92, v[24:27], s[42:43] offset:0 sc1
    global_store_dwordx4 v92, v[28:31], s[42:43] offset:1024 sc1
    global_store_dwordx4 v92, v[32:35], s[42:43] offset:2048 sc1
    global_store_dwordx4 v92, v[36:39], s[42:43] offset:3072 sc1
    v_add_u32 v92, 262144, v92
    s_nop 1
    ds_read_b128 v[24:27], v91 offset:4096
    ds_read_b128 v[28:31], v91 offset:5120
    ds_read_b128 v[32:35], v91 offset:6144
    ds_read_b128 v[36:39], v91 offset:7168
    s_waitcnt lgkmcnt(0)
    global_store_dwordx4 v92, v[24:27], s[42:43] offset:0 sc1
    global_store_dwordx4 v92, v[28:31], s[42:43] offset:1024 sc1
    global_store_dwordx4 v92, v[32:35], s[42:43] offset:2048 sc1
    global_store_dwordx4 v92, v[36:39], s[42:43] offset:3072 sc1
    v_add_u32 v92, 262144, v92
    s_nop 1
    ds_read_b128 v[24:27], v91 offset:8192
    ds_read_b128 v[28:31], v91 offset:9216
    ds_read_b128 v[32:35], v91 offset:10240
    ds_read_b128 v[36:39], v91 offset:11264
    s_waitcnt lgkmcnt(0)
    global_store_dwordx4 v92, v[24:27], s[42:43] offset:0 sc1
    global_store_dwordx4 v92, v[28:31], s[42:43] offset:1024 sc1
    global_store_dwordx4 v92, v[32:35], s[42:43] offset:2048 sc1
    global_store_dwordx4 v92, v[36:39], s[42:43] offset:3072 sc1
    v_add_u32 v92, 262144, v92
    s_nop 1
    ds_read_b128 v[24:27], v91 offset:12288
    ds_read_b128 v[28:31], v91 offset:13312
    ds_read_b128 v[32:35], v91 offset:14336
    ds_read_b128 v[36:39], v91 offset:15360
    s_waitcnt lgkmcnt(0)
    global_store_dwordx4 v92, v[24:27], s[42:43] offset:0 sc1
    global_store_dwordx4 v92, v[28:31], s[42:43] offset:1024 sc1
    global_store_dwordx4 v92, v[32:35], s[42:43] offset:2048 sc1
    global_store_dwordx4 v92, v[36:39], s[42:43] offset:3072 sc1
    s_nop 1
L_sig_n:
    s_cmp_eq_u32 s36, 8
    s_cbranch_scc1 L_sig_nq
    s_cmp_eq_u32 s64, 1
    s_cbranch_scc1 L_ei_sn
    s_mov_b32 s65, 200
    s_cmp_eq_u32 s22, 0
    s_cbranch_scc0 L_wfd_eisn
    v_mov_b32 v3, s65
    s_mov_b32 s14, 0
L_wf_eisn:
    global_load_dword v4, v3, s[6:7] sc1
    s_waitcnt vmcnt(0)
    v_readfirstlane_b32 s15, v4
    s_add_u32 s14, s14, 1
    s_cmp_gt_u32 s14, 400000
    s_cbranch_scc1 L_wfd_eisn
    s_cmp_ge_u32 s15, 1
    s_cbranch_scc1 L_wfd_eisn
    s_sleep 4
    s_branch L_wf_eisn
L_wfd_eisn:
    s_barrier
    s_mov_b32 s64, 1
L_ei_sn:
    s_waitcnt vmcnt(0)
    s_barrier
    v_cmp_eq_u32 vcc, 0, v0
    s_and_saveexec_b64 s[12:13], vcc
    s_cbranch_execz L_sg_n
    v_mov_b32 v3, s51
    v_mov_b32 v4, 1
    global_atomic_add v3, v4, s[66:67]
L_sg_n:
    s_mov_b64 exec, s[12:13]
    s_branch L_task
L_sig_nq:
    s_add_u32 s51, s51, 128
    s_cmp_eq_u32 s64, 1
    s_cbranch_scc1 L_ei_snq
    s_mov_b32 s65, 200
    s_cmp_eq_u32 s22, 0
    s_cbranch_scc0 L_wfd_eisnq
    v_mov_b32 v3, s65
    s_mov_b32 s14, 0
L_wf_eisnq:
    global_load_dword v4, v3, s[6:7] sc1
    s_waitcnt vmcnt(0)
    v_readfirstlane_b32 s15, v4
    s_add_u32 s14, s14, 1
    s_cmp_gt_u32 s14, 400000
    s_cbranch_scc1 L_wfd_eisnq
    s_cmp_ge_u32 s15, 1
    s_cbranch_scc1 L_wfd_eisnq
    s_sleep 4
    s_branch L_wf_eisnq
L_wfd_eisnq:
    s_barrier
    s_mov_b32 s64, 1
L_ei_snq:
    s_waitcnt vmcnt(0)
    s_barrier
    v_cmp_eq_u32 vcc, 0, v0
    s_and_saveexec_b64 s[12:13], vcc
    s_cbranch_execz L_sg_nq
    v_mov_b32 v3, s51
    v_mov_b32 v4, 1
    global_atomic_add v3, v4, s[66:67]
L_sg_nq:
    s_mov_b64 exec, s[12:13]
    s_branch L_task
L_t_g:
    s_load_dwordx2 s[46:47], s[0:1], 80
    s_lshl_b32 s52, s35, 8
    s_lshl_b32 s38, s52, 2
    s_add_u32 s38, s38, 88080384
    s_add_u32 s48, s32, s38
    s_addc_u32 s49, s33, 0
    s_waitcnt lgkmcnt(0)
    v_and_b32 v116, 31, v1
    s_lshr_b32 s23, s22, 1
    s_lshl_b32 s23, s23, 7
    s_add_u32 s23, s23, s52
    v_add_u32 v116, s23, v116
    v_lshlrev_b32 v116, 10, v116
    v_lshrrev_b32 v117, 5, v1
    v_lshlrev_b32 v117, 4, v117
    v_add_u32 v110, v116, v117
    v_mov_b32 v111, v117
    v_add_u32 v112, 32768, v110
    v_add_u32 v113, 65536, v110
    v_add_u32 v114, 98304, v110
    v_accvgpr_write_b32 a0, 0
    v_accvgpr_write_b32 a1, 0
    v_accvgpr_write_b32 a2, 0
    v_accvgpr_write_b32 a3, 0
    v_accvgpr_write_b32 a4, 0
    v_accvgpr_write_b32 a5, 0
    v_accvgpr_write_b32 a6, 0
    v_accvgpr_write_b32 a7, 0
    v_accvgpr_write_b32 a8, 0
    v_accvgpr_write_b32 a9, 0
    v_accvgpr_write_b32 a10, 0
    v_accvgpr_write_b32 a11, 0
    v_accvgpr_write_b32 a12, 0
    v_accvgpr_write_b32 a13, 0
    v_accvgpr_write_b32 a14, 0
    v_accvgpr_write_b32 a15, 0
    v_accvgpr_write_b32 a16, 0
    v_accvgpr_write_b32 a17, 0
    v_accvgpr_write_b32 a18, 0
    v_accvgpr_write_b32 a19, 0
    v_accvgpr_write_b32 a20, 0
    v_accvgpr_write_b32 a21, 0
    v_accvgpr_write_b32 a22, 0
    v_accvgpr_write_b32 a23, 0
    v_accvgpr_write_b32 a24, 0
    v_accvgpr_write_b32 a25, 0
    v_accvgpr_write_b32 a26, 0
    v_accvgpr_write_b32 a27, 0
    v_accvgpr_write_b32 a28, 0
    v_accvgpr_write_b32 a29, 0
    v_accvgpr_write_b32 a30, 0
    v_accvgpr_write_b32 a31, 0
    v_accvgpr_write_b32 a32, 0
    v_accvgpr_write_b32 a33, 0
    v_accvgpr_write_b32 a34, 0
    v_accvgpr_write_b32 a35, 0
    v_accvgpr_write_b32 a36, 0
    v_accvgpr_write_b32 a37, 0
    v_accvgpr_write_b32 a38, 0
    v_accvgpr_write_b32 a39, 0
    v_accvgpr_write_b32 a40, 0
    v_accvgpr_write_b32 a41, 0
    v_accvgpr_write_b32 a42, 0
    v_accvgpr_write_b32 a43, 0
    v_accvgpr_write_b32 a44, 0
    v_accvgpr_write_b32 a45, 0
    v_accvgpr_write_b32 a46, 0
    v_accvgpr_write_b32 a47, 0
    v_accvgpr_write_b32 a48, 0
    v_accvgpr_write_b32 a49, 0
    v_accvgpr_write_b32 a50, 0
    v_accvgpr_write_b32 a51, 0
    v_accvgpr_write_b32 a52, 0
    v_accvgpr_write_b32 a53, 0
    v_accvgpr_write_b32 a54, 0
    v_accvgpr_write_b32 a55, 0
    v_accvgpr_write_b32 a56, 0
    v_accvgpr_write_b32 a57, 0
    v_accvgpr_write_b32 a58, 0
    v_accvgpr_write_b32 a59, 0
    v_accvgpr_write_b32 a60, 0
    v_accvgpr_write_b32 a61, 0
    v_accvgpr_write_b32 a62, 0
    v_accvgpr_write_b32 a63, 0
    global_load_dwordx4 v[24:27], v111, s[46:47] offset:0
    global_load_dwordx4 a[64:67], v110, s[30:31] offset:0
    global_load_dwordx4 a[68:71], v112, s[30:31] offset:0
    global_load_dwordx4 a[72:75], v113, s[30:31] offset:0
    global_load_dwordx4 a[76:79], v114, s[30:31] offset:0
    global_load_dwordx4 v[28:31], v111, s[46:47] offset:32
    global_load_dwordx4 a[80:83], v110, s[30:31] offset:32
    global_load_dwordx4 a[84:87], v112, s[30:31] offset:32
    global_load_dwordx4 a[88:91], v113, s[30:31] offset:32
    global_load_dwordx4 a[92:95], v114, s[30:31] offset:32
    global_load_dwordx4 v[32:35], v111, s[46:47] offset:64
    global_load_dwordx4 a[96:99], v110, s[30:31] offset:64
    global_load_dwordx4 a[100:103], v112, s[30:31] offset:64
    global_load_dwordx4 a[104:107], v113, s[30:31] offset:64
    global_load_dwordx4 a[108:111], v114, s[30:31] offset:64
    global_load_dwordx4 v[36:39], v111, s[46:47] offset:96
    global_load_dwordx4 a[112:115], v110, s[30:31] offset:96
    global_load_dwordx4 a[116:119], v112, s[30:31] offset:96
    global_load_dwordx4 a[120:123], v113, s[30:31] offset:96
    global_load_dwordx4 a[124:127], v114, s[30:31] offset:96
    global_load_dwordx4 v[40:43], v111, s[46:47] offset:128
    global_load_dwordx4 a[128:131], v110, s[30:31] offset:128
    global_load_dwordx4 a[132:135], v112, s[30:31] offset:128
    global_load_dwordx4 a[136:139], v113, s[30:31] offset:128
    global_load_dwordx4 a[140:143], v114, s[30:31] offset:128
    global_load_dwordx4 v[44:47], v111, s[46:47] offset:160
    global_load_dwordx4 a[144:147], v110, s[30:31] offset:160
    global_load_dwordx4 a[148:151], v112, s[30:31] offset:160
    global_load_dwordx4 a[152:155], v113, s[30:31] offset:160
    global_load_dwordx4 a[156:159], v114, s[30:31] offset:160
    global_load_dwordx4 v[48:51], v111, s[46:47] offset:192
    global_load_dwordx4 a[160:163], v110, s[30:31] offset:192
    global_load_dwordx4 a[164:167], v112, s[30:31] offset:192
    global_load_dwordx4 a[168:171], v113, s[30:31] offset:192
    global_load_dwordx4 a[172:175], v114, s[30:31] offset:192
    global_load_dwordx4 v[52:55], v111, s[46:47] offset:224
    global_load_dwordx4 a[176:179], v110, s[30:31] offset:224
    global_load_dwordx4 a[180:183], v112, s[30:31] offset:224
    global_load_dwordx4 a[184:187], v113, s[30:31] offset:224
    global_load_dwordx4 a[188:191], v114, s[30:31] offset:224
    global_load_dwordx4 v[56:59], v111, s[46:47] offset:256
    global_load_dwordx4 a[192:195], v110, s[30:31] offset:256
    global_load_dwordx4 a[196:199], v112, s[30:31] offset:256
    global_load_dwordx4 a[200:203], v113, s[30:31] offset:256
    global_load_dwordx4 a[204:207], v114, s[30:31] offset:256
    global_load_dwordx4 v[60:63], v111, s[46:47] offset:288
    global_load_dwordx4 a[208:211], v110, s[30:31] offset:288
    global_load_dwordx4 a[212:215], v112, s[30:31] offset:288
    global_load_dwordx4 a[216:219], v113, s[30:31] offset:288
    global_load_dwordx4 a[220:223], v114, s[30:31] offset:288
    global_load_dwordx4 v[64:67], v111, s[46:47] offset:320
    global_load_dwordx4 a[224:227], v110, s[30:31] offset:320
    global_load_dwordx4 a[228:231], v112, s[30:31] offset:320
    global_load_dwordx4 a[232:235], v113, s[30:31] offset:320
    global_load_dwordx4 a[236:239], v114, s[30:31] offset:320
    s_waitcnt vmcnt(0)
    v_mfma_f32_32x32x16_bf16 a[0:15], v[24:27], a[64:67], a[0:15]
    v_mfma_f32_32x32x16_bf16 a[16:31], v[24:27], a[68:71], a[16:31]
    v_mfma_f32_32x32x16_bf16 a[32:47], v[24:27], a[72:75], a[32:47]
    v_mfma_f32_32x32x16_bf16 a[48:63], v[24:27], a[76:79], a[48:63]
    v_mfma_f32_32x32x16_bf16 a[0:15], v[28:31], a[80:83], a[0:15]
    v_mfma_f32_32x32x16_bf16 a[16:31], v[28:31], a[84:87], a[16:31]
    v_mfma_f32_32x32x16_bf16 a[32:47], v[28:31], a[88:91], a[32:47]
    v_mfma_f32_32x32x16_bf16 a[48:63], v[28:31], a[92:95], a[48:63]
    v_mfma_f32_32x32x16_bf16 a[0:15], v[32:35], a[96:99], a[0:15]
    v_mfma_f32_32x32x16_bf16 a[16:31], v[32:35], a[100:103], a[16:31]
    v_mfma_f32_32x32x16_bf16 a[32:47], v[32:35], a[104:107], a[32:47]
    v_mfma_f32_32x32x16_bf16 a[48:63], v[32:35], a[108:111], a[48:63]
    v_mfma_f32_32x32x16_bf16 a[0:15], v[36:39], a[112:115], a[0:15]
    v_mfma_f32_32x32x16_bf16 a[16:31], v[36:39], a[116:119], a[16:31]
    v_mfma_f32_32x32x16_bf16 a[32:47], v[36:39], a[120:123], a[32:47]
    v_mfma_f32_32x32x16_bf16 a[48:63], v[36:39], a[124:127], a[48:63]
    v_mfma_f32_32x32x16_bf16 a[0:15], v[40:43], a[128:131], a[0:15]
    v_mfma_f32_32x32x16_bf16 a[16:31], v[40:43], a[132:135], a[16:31]
    v_mfma_f32_32x32x16_bf16 a[32:47], v[40:43], a[136:139], a[32:47]
    v_mfma_f32_32x32x16_bf16 a[48:63], v[40:43], a[140:143], a[48:63]
    v_mfma_f32_32x32x16_bf16 a[0:15], v[44:47], a[144:147], a[0:15]
    v_mfma_f32_32x32x16_bf16 a[16:31], v[44:47], a[148:151], a[16:31]
    v_mfma_f32_32x32x16_bf16 a[32:47], v[44:47], a[152:155], a[32:47]
    v_mfma_f32_32x32x16_bf16 a[48:63], v[44:47], a[156:159], a[48:63]
    v_mfma_f32_32x32x16_bf16 a[0:15], v[48:51], a[160:163], a[0:15]
    v_mfma_f32_32x32x16_bf16 a[16:31], v[48:51], a[164:167], a[16:31]
    v_mfma_f32_32x32x16_bf16 a[32:47], v[48:51], a[168:171], a[32:47]
    v_mfma_f32_32x32x16_bf16 a[48:63], v[48:51], a[172:175], a[48:63]
    v_mfma_f32_32x32x16_bf16 a[0:15], v[52:55], a[176:179], a[0:15]
    v_mfma_f32_32x32x16_bf16 a[16:31], v[52:55], a[180:183], a[16:31]
    v_mfma_f32_32x32x16_bf16 a[32:47], v[52:55], a[184:187], a[32:47]
    v_mfma_f32_32x32x16_bf16 a[48:63], v[52:55], a[188:191], a[48:63]
    v_mfma_f32_32x32x16_bf16 a[0:15], v[56:59], a[192:195], a[0:15]
    v_mfma_f32_32x32x16_bf16 a[16:31], v[56:59], a[196:199], a[16:31]
    v_mfma_f32_32x32x16_bf16 a[32:47], v[56:59], a[200:203], a[32:47]
    v_mfma_f32_32x32x16_bf16 a[48:63], v[56:59], a[204:207], a[48:63]
    v_mfma_f32_32x32x16_bf16 a[0:15], v[60:63], a[208:211], a[0:15]
    v_mfma_f32_32x32x16_bf16 a[16:31], v[60:63], a[212:215], a[16:31]
    v_mfma_f32_32x32x16_bf16 a[32:47], v[60:63], a[216:219], a[32:47]
    v_mfma_f32_32x32x16_bf16 a[48:63], v[60:63], a[220:223], a[48:63]
    v_mfma_f32_32x32x16_bf16 a[0:15], v[64:67], a[224:227], a[0:15]
    v_mfma_f32_32x32x16_bf16 a[16:31], v[64:67], a[228:231], a[16:31]
    v_mfma_f32_32x32x16_bf16 a[32:47], v[64:67], a[232:235], a[32:47]
    v_mfma_f32_32x32x16_bf16 a[48:63], v[64:67], a[236:239], a[48:63]
    s_nop 7
    global_load_dwordx4 v[24:27], v111, s[46:47] offset:352
    global_load_dwordx4 a[64:67], v110, s[30:31] offset:352
    global_load_dwordx4 a[68:71], v112, s[30:31] offset:352
    global_load_dwordx4 a[72:75], v113, s[30:31] offset:352
    global_load_dwordx4 a[76:79], v114, s[30:31] offset:352
    global_load_dwordx4 v[28:31], v111, s[46:47] offset:384
    global_load_dwordx4 a[80:83], v110, s[30:31] offset:384
    global_load_dwordx4 a[84:87], v112, s[30:31] offset:384
    global_load_dwordx4 a[88:91], v113, s[30:31] offset:384
    global_load_dwordx4 a[92:95], v114, s[30:31] offset:384
    global_load_dwordx4 v[32:35], v111, s[46:47] offset:416
    global_load_dwordx4 a[96:99], v110, s[30:31] offset:416
    global_load_dwordx4 a[100:103], v112, s[30:31] offset:416
    global_load_dwordx4 a[104:107], v113, s[30:31] offset:416
    global_load_dwordx4 a[108:111], v114, s[30:31] offset:416
    global_load_dwordx4 v[36:39], v111, s[46:47] offset:448
    global_load_dwordx4 a[112:115], v110, s[30:31] offset:448
    global_load_dwordx4 a[116:119], v112, s[30:31] offset:448
    global_load_dwordx4 a[120:123], v113, s[30:31] offset:448
    global_load_dwordx4 a[124:127], v114, s[30:31] offset:448
    global_load_dwordx4 v[40:43], v111, s[46:47] offset:480
    global_load_dwordx4 a[128:131], v110, s[30:31] offset:480
    global_load_dwordx4 a[132:135], v112, s[30:31] offset:480
    global_load_dwordx4 a[136:139], v113, s[30:31] offset:480
    global_load_dwordx4 a[140:143], v114, s[30:31] offset:480
    global_load_dwordx4 v[44:47], v111, s[46:47] offset:512
    global_load_dwordx4 a[144:147], v110, s[30:31] offset:512
    global_load_dwordx4 a[148:151], v112, s[30:31] offset:512
    global_load_dwordx4 a[152:155], v113, s[30:31] offset:512
    global_load_dwordx4 a[156:159], v114, s[30:31] offset:512
    global_load_dwordx4 v[48:51], v111, s[46:47] offset:544
    global_load_dwordx4 a[160:163], v110, s[30:31] offset:544
    global_load_dwordx4 a[164:167], v112, s[30:31] offset:544
    global_load_dwordx4 a[168:171], v113, s[30:31] offset:544
    global_load_dwordx4 a[172:175], v114, s[30:31] offset:544
    global_load_dwordx4 v[52:55], v111, s[46:47] offset:576
    global_load_dwordx4 a[176:179], v110, s[30:31] offset:576
    global_load_dwordx4 a[180:183], v112, s[30:31] offset:576
    global_load_dwordx4 a[184:187], v113, s[30:31] offset:576
    global_load_dwordx4 a[188:191], v114, s[30:31] offset:576
    global_load_dwordx4 v[56:59], v111, s[46:47] offset:608
    global_load_dwordx4 a[192:195], v110, s[30:31] offset:608
    global_load_dwordx4 a[196:199], v112, s[30:31] offset:608
    global_load_dwordx4 a[200:203], v113, s[30:31] offset:608
    global_load_dwordx4 a[204:207], v114, s[30:31] offset:608
    global_load_dwordx4 v[60:63], v111, s[46:47] offset:640
    global_load_dwordx4 a[208:211], v110, s[30:31] offset:640
    global_load_dwordx4 a[212:215], v112, s[30:31] offset:640
    global_load_dwordx4 a[216:219], v113, s[30:31] offset:640
    global_load_dwordx4 a[220:223], v114, s[30:31] offset:640
    global_load_dwordx4 v[64:67], v111, s[46:47] offset:672
    global_load_dwordx4 a[224:227], v110, s[30:31] offset:672
    global_load_dwordx4 a[228:231], v112, s[30:31] offset:672
    global_load_dwordx4 a[232:235], v113, s[30:31] offset:672
    global_load_dwordx4 a[236:239], v114, s[30:31] offset:672
    s_waitcnt vmcnt(0)
    v_mfma_f32_32x32x16_bf16 a[0:15], v[24:27], a[64:67], a[0:15]
    v_mfma_f32_32x32x16_bf16 a[16:31], v[24:27], a[68:71], a[16:31]
    v_mfma_f32_32x32x16_bf16 a[32:47], v[24:27], a[72:75], a[32:47]
    v_mfma_f32_32x32x16_bf16 a[48:63], v[24:27], a[76:79], a[48:63]
    v_mfma_f32_32x32x16_bf16 a[0:15], v[28:31], a[80:83], a[0:15]
    v_mfma_f32_32x32x16_bf16 a[16:31], v[28:31], a[84:87], a[16:31]
    v_mfma_f32_32x32x16_bf16 a[32:47], v[28:31], a[88:91], a[32:47]
    v_mfma_f32_32x32x16_bf16 a[48:63], v[28:31], a[92:95], a[48:63]
    v_mfma_f32_32x32x16_bf16 a[0:15], v[32:35], a[96:99], a[0:15]
    v_mfma_f32_32x32x16_bf16 a[16:31], v[32:35], a[100:103], a[16:31]
    v_mfma_f32_32x32x16_bf16 a[32:47], v[32:35], a[104:107], a[32:47]
    v_mfma_f32_32x32x16_bf16 a[48:63], v[32:35], a[108:111], a[48:63]
    v_mfma_f32_32x32x16_bf16 a[0:15], v[36:39], a[112:115], a[0:15]
    v_mfma_f32_32x32x16_bf16 a[16:31], v[36:39], a[116:119], a[16:31]
    v_mfma_f32_32x32x16_bf16 a[32:47], v[36:39], a[120:123], a[32:47]
    v_mfma_f32_32x32x16_bf16 a[48:63], v[36:39], a[124:127], a[48:63]
    v_mfma_f32_32x32x16_bf16 a[0:15], v[40:43], a[128:131], a[0:15]
    v_mfma_f32_32x32x16_bf16 a[16:31], v[40:43], a[132:135], a[16:31]
    v_mfma_f32_32x32x16_bf16 a[32:47], v[40:43], a[136:139], a[32:47]
    v_mfma_f32_32x32x16_bf16 a[48:63], v[40:43], a[140:143], a[48:63]
    v_mfma_f32_32x32x16_bf16 a[0:15], v[44:47], a[144:147], a[0:15]
    v_mfma_f32_32x32x16_bf16 a[16:31], v[44:47], a[148:151], a[16:31]
    v_mfma_f32_32x32x16_bf16 a[32:47], v[44:47], a[152:155], a[32:47]
    v_mfma_f32_32x32x16_bf16 a[48:63], v[44:47], a[156:159], a[48:63]
    v_mfma_f32_32x32x16_bf16 a[0:15], v[48:51], a[160:163], a[0:15]
    v_mfma_f32_32x32x16_bf16 a[16:31], v[48:51], a[164:167], a[16:31]
    v_mfma_f32_32x32x16_bf16 a[32:47], v[48:51], a[168:171], a[32:47]
    v_mfma_f32_32x32x16_bf16 a[48:63], v[48:51], a[172:175], a[48:63]
    v_mfma_f32_32x32x16_bf16 a[0:15], v[52:55], a[176:179], a[0:15]
    v_mfma_f32_32x32x16_bf16 a[16:31], v[52:55], a[180:183], a[16:31]
    v_mfma_f32_32x32x16_bf16 a[32:47], v[52:55], a[184:187], a[32:47]
    v_mfma_f32_32x32x16_bf16 a[48:63], v[52:55], a[188:191], a[48:63]
    v_mfma_f32_32x32x16_bf16 a[0:15], v[56:59], a[192:195], a[0:15]
    v_mfma_f32_32x32x16_bf16 a[16:31], v[56:59], a[196:199], a[16:31]
    v_mfma_f32_32x32x16_bf16 a[32:47], v[56:59], a[200:203], a[32:47]
    v_mfma_f32_32x32x16_bf16 a[48:63], v[56:59], a[204:207], a[48:63]
    v_mfma_f32_32x32x16_bf16 a[0:15], v[60:63], a[208:211], a[0:15]
    v_mfma_f32_32x32x16_bf16 a[16:31], v[60:63], a[212:215], a[16:31]
    v_mfma_f32_32x32x16_bf16 a[32:47], v[60:63], a[216:219], a[32:47]
    v_mfma_f32_32x32x16_bf16 a[48:63], v[60:63], a[220:223], a[48:63]
    v_mfma_f32_32x32x16_bf16 a[0:15], v[64:67], a[224:227], a[0:15]
    v_mfma_f32_32x32x16_bf16 a[16:31], v[64:67], a[228:231], a[16:31]
    v_mfma_f32_32x32x16_bf16 a[32:47], v[64:67], a[232:235], a[32:47]
    v_mfma_f32_32x32x16_bf16 a[48:63], v[64:67], a[236:239], a[48:63]
    s_nop 7
    global_load_dwordx4 v[24:27], v111, s[46:47] offset:704
    global_load_dwordx4 a[64:67], v110, s[30:31] offset:704
    global_load_dwordx4 a[68:71], v112, s[30:31] offset:704
    global_load_dwordx4 a[72:75], v113, s[30:31] offset:704
    global_load_dwordx4 a[76:79], v114, s[30:31] offset:704
    global_load_dwordx4 v[28:31], v111, s[46:47] offset:736
    global_load_dwordx4 a[80:83], v110, s[30:31] offset:736
    global_load_dwordx4 a[84:87], v112, s[30:31] offset:736
    global_load_dwordx4 a[88:91], v113, s[30:31] offset:736
    global_load_dwordx4 a[92:95], v114, s[30:31] offset:736
    global_load_dwordx4 v[32:35], v111, s[46:47] offset:768
    global_load_dwordx4 a[96:99], v110, s[30:31] offset:768
    global_load_dwordx4 a[100:103], v112, s[30:31] offset:768
    global_load_dwordx4 a[104:107], v113, s[30:31] offset:768
    global_load_dwordx4 a[108:111], v114, s[30:31] offset:768
    global_load_dwordx4 v[36:39], v111, s[46:47] offset:800
    global_load_dwordx4 a[112:115], v110, s[30:31] offset:800
    global_load_dwordx4 a[116:119], v112, s[30:31] offset:800
    global_load_dwordx4 a[120:123], v113, s[30:31] offset:800
    global_load_dwordx4 a[124:127], v114, s[30:31] offset:800
    global_load_dwordx4 v[40:43], v111, s[46:47] offset:832
    global_load_dwordx4 a[128:131], v110, s[30:31] offset:832
    global_load_dwordx4 a[132:135], v112, s[30:31] offset:832
    global_load_dwordx4 a[136:139], v113, s[30:31] offset:832
    global_load_dwordx4 a[140:143], v114, s[30:31] offset:832
    global_load_dwordx4 v[44:47], v111, s[46:47] offset:864
    global_load_dwordx4 a[144:147], v110, s[30:31] offset:864
    global_load_dwordx4 a[148:151], v112, s[30:31] offset:864
    global_load_dwordx4 a[152:155], v113, s[30:31] offset:864
    global_load_dwordx4 a[156:159], v114, s[30:31] offset:864
    global_load_dwordx4 v[48:51], v111, s[46:47] offset:896
    global_load_dwordx4 a[160:163], v110, s[30:31] offset:896
    global_load_dwordx4 a[164:167], v112, s[30:31] offset:896
    global_load_dwordx4 a[168:171], v113, s[30:31] offset:896
    global_load_dwordx4 a[172:175], v114, s[30:31] offset:896
    global_load_dwordx4 v[52:55], v111, s[46:47] offset:928
    global_load_dwordx4 a[176:179], v110, s[30:31] offset:928
    global_load_dwordx4 a[180:183], v112, s[30:31] offset:928
    global_load_dwordx4 a[184:187], v113, s[30:31] offset:928
    global_load_dwordx4 a[188:191], v114, s[30:31] offset:928
    global_load_dwordx4 v[56:59], v111, s[46:47] offset:960
    global_load_dwordx4 a[192:195], v110, s[30:31] offset:960
    global_load_dwordx4 a[196:199], v112, s[30:31] offset:960
    global_load_dwordx4 a[200:203], v113, s[30:31] offset:960
    global_load_dwordx4 a[204:207], v114, s[30:31] offset:960
    global_load_dwordx4 v[60:63], v111, s[46:47] offset:992
    global_load_dwordx4 a[208:211], v110, s[30:31] offset:992
    global_load_dwordx4 a[212:215], v112, s[30:31] offset:992
    global_load_dwordx4 a[216:219], v113, s[30:31] offset:992
    global_load_dwordx4 a[220:223], v114, s[30:31] offset:992
    s_waitcnt vmcnt(0)
    v_mfma_f32_32x32x16_bf16 a[0:15], v[24:27], a[64:67], a[0:15]
    v_mfma_f32_32x32x16_bf16 a[16:31], v[24:27], a[68:71], a[16:31]
    v_mfma_f32_32x32x16_bf16 a[32:47], v[24:27], a[72:75], a[32:47]
    v_mfma_f32_32x32x16_bf16 a[48:63], v[24:27], a[76:79], a[48:63]
    v_mfma_f32_32x32x16_bf16 a[0:15], v[28:31], a[80:83], a[0:15]
    v_mfma_f32_32x32x16_bf16 a[16:31], v[28:31], a[84:87], a[16:31]
    v_mfma_f32_32x32x16_bf16 a[32:47], v[28:31], a[88:91], a[32:47]
    v_mfma_f32_32x32x16_bf16 a[48:63], v[28:31], a[92:95], a[48:63]
    v_mfma_f32_32x32x16_bf16 a[0:15], v[32:35], a[96:99], a[0:15]
    v_mfma_f32_32x32x16_bf16 a[16:31], v[32:35], a[100:103], a[16:31]
    v_mfma_f32_32x32x16_bf16 a[32:47], v[32:35], a[104:107], a[32:47]
    v_mfma_f32_32x32x16_bf16 a[48:63], v[32:35], a[108:111], a[48:63]
    v_mfma_f32_32x32x16_bf16 a[0:15], v[36:39], a[112:115], a[0:15]
    v_mfma_f32_32x32x16_bf16 a[16:31], v[36:39], a[116:119], a[16:31]
    v_mfma_f32_32x32x16_bf16 a[32:47], v[36:39], a[120:123], a[32:47]
    v_mfma_f32_32x32x16_bf16 a[48:63], v[36:39], a[124:127], a[48:63]
    v_mfma_f32_32x32x16_bf16 a[0:15], v[40:43], a[128:131], a[0:15]
    v_mfma_f32_32x32x16_bf16 a[16:31], v[40:43], a[132:135], a[16:31]
    v_mfma_f32_32x32x16_bf16 a[32:47], v[40:43], a[136:139], a[32:47]
    v_mfma_f32_32x32x16_bf16 a[48:63], v[40:43], a[140:143], a[48:63]
    v_mfma_f32_32x32x16_bf16 a[0:15], v[44:47], a[144:147], a[0:15]
    v_mfma_f32_32x32x16_bf16 a[16:31], v[44:47], a[148:151], a[16:31]
    v_mfma_f32_32x32x16_bf16 a[32:47], v[44:47], a[152:155], a[32:47]
    v_mfma_f32_32x32x16_bf16 a[48:63], v[44:47], a[156:159], a[48:63]
    v_mfma_f32_32x32x16_bf16 a[0:15], v[48:51], a[160:163], a[0:15]
    v_mfma_f32_32x32x16_bf16 a[16:31], v[48:51], a[164:167], a[16:31]
    v_mfma_f32_32x32x16_bf16 a[32:47], v[48:51], a[168:171], a[32:47]
    v_mfma_f32_32x32x16_bf16 a[48:63], v[48:51], a[172:175], a[48:63]
    v_mfma_f32_32x32x16_bf16 a[0:15], v[52:55], a[176:179], a[0:15]
    v_mfma_f32_32x32x16_bf16 a[16:31], v[52:55], a[180:183], a[16:31]
    v_mfma_f32_32x32x16_bf16 a[32:47], v[52:55], a[184:187], a[32:47]
    v_mfma_f32_32x32x16_bf16 a[48:63], v[52:55], a[188:191], a[48:63]
    v_mfma_f32_32x32x16_bf16 a[0:15], v[56:59], a[192:195], a[0:15]
    v_mfma_f32_32x32x16_bf16 a[16:31], v[56:59], a[196:199], a[16:31]
    v_mfma_f32_32x32x16_bf16 a[32:47], v[56:59], a[200:203], a[32:47]
    v_mfma_f32_32x32x16_bf16 a[48:63], v[56:59], a[204:207], a[48:63]
    v_mfma_f32_32x32x16_bf16 a[0:15], v[60:63], a[208:211], a[0:15]
    v_mfma_f32_32x32x16_bf16 a[16:31], v[60:63], a[212:215], a[16:31]
    v_mfma_f32_32x32x16_bf16 a[32:47], v[60:63], a[216:219], a[32:47]
    v_mfma_f32_32x32x16_bf16 a[48:63], v[60:63], a[220:223], a[48:63]
    s_nop 7
    s_nop 15
    v_accvgpr_read_b32 v104, a0
    v_accvgpr_read_b32 v105, a16
    v_accvgpr_read_b32 v106, a32
    v_accvgpr_read_b32 v107, a48
    v_mul_f32 v104, 0xbfb8aa3b, v104
    v_mul_f32 v105, 0xbfb8aa3b, v105
    v_mul_f32 v106, 0xbfb8aa3b, v106
    v_mul_f32 v107, 0xbfb8aa3b, v107
    v_exp_f32 v104, v104
    v_exp_f32 v105, v105
    v_exp_f32 v106, v106
    v_exp_f32 v107, v107
    s_nop 0
    v_add_f32 v104, 1.0, v104
    v_add_f32 v105, 1.0, v105
    v_add_f32 v106, 1.0, v106
    v_add_f32 v107, 1.0, v107
    v_rcp_f32 v104, v104
    v_rcp_f32 v105, v105
    v_rcp_f32 v106, v106
    v_rcp_f32 v107, v107
    s_nop 0
    s_and_b32 s23, s22, 1
    s_cmp_eq_u32 s23, 0
    s_cbranch_scc0 L_gate_nost
    v_and_b32 v116, 31, v1
    s_lshr_b32 s23, s22, 1
    s_lshl_b32 s23, s23, 7
    v_add_u32 v116, s23, v116
    v_lshlrev_b32 v116, 2, v116
    s_mov_b64 exec, 0xffffffff
    global_store_dword v116, v104, s[48:49] offset:0 sc1
    global_store_dword v116, v105, s[48:49] offset:128 sc1
    global_store_dword v116, v106, s[48:49] offset:256 sc1
    global_store_dword v116, v107, s[48:49] offset:384 sc1
    s_mov_b64 exec, -1
L_gate_nost:
    s_add_u32 s51, s51, 384
    s_cmp_eq_u32 s64, 1
    s_cbranch_scc1 L_ei_sg
    s_mov_b32 s65, 200
    s_cmp_eq_u32 s22, 0
    s_cbranch_scc0 L_wfd_eisg
    v_mov_b32 v3, s65
    s_mov_b32 s14, 0
L_wf_eisg:
    global_load_dword v4, v3, s[6:7] sc1
    s_waitcnt vmcnt(0)
    v_readfirstlane_b32 s15, v4
    s_add_u32 s14, s14, 1
    s_cmp_gt_u32 s14, 400000
    s_cbranch_scc1 L_wfd_eisg
    s_cmp_ge_u32 s15, 1
    s_cbranch_scc1 L_wfd_eisg
    s_sleep 4
    s_branch L_wf_eisg
L_wfd_eisg:
    s_barrier
    s_mov_b32 s64, 1
L_ei_sg:
    s_waitcnt vmcnt(0)
    s_barrier
    v_cmp_eq_u32 vcc, 0, v0
    s_and_saveexec_b64 s[12:13], vcc
    s_cbranch_execz L_sg_g
    v_mov_b32 v3, s51
    v_mov_b32 v4, 1
    global_atomic_add v3, v4, s[66:67]
L_sg_g:
    s_mov_b64 exec, s[12:13]
    s_branch L_task
L_t_f2:
    s_load_dwordx2 s[40:41], s[0:1], 72
    s_waitcnt lgkmcnt(0)
    s_add_u32 s52, s51, 256
    s_cmp_eq_u32 s64, 1
    s_cbranch_scc1 L_ei_wf1
    s_mov_b32 s65, 200
    s_cmp_eq_u32 s22, 0
    s_cbranch_scc0 L_wfd_eiwf1
    v_mov_b32 v3, s65
    s_mov_b32 s14, 0
L_wf_eiwf1:
    global_load_dword v4, v3, s[6:7] sc1
    s_waitcnt vmcnt(0)
    v_readfirstlane_b32 s15, v4
    s_add_u32 s14, s14, 1
    s_cmp_gt_u32 s14, 400000
    s_cbranch_scc1 L_wfd_eiwf1
    s_cmp_ge_u32 s15, 1
    s_cbranch_scc1 L_wfd_eiwf1
    s_sleep 4
    s_branch L_wf_eiwf1
L_wfd_eiwf1:
    s_barrier
    s_mov_b32 s64, 1
L_ei_wf1:
    s_cmp_eq_u32 s22, 0
    s_cbranch_scc0 L_wfd_f1
    v_mov_b32 v3, s52
    s_mov_b32 s14, 0
L_wf_f1:
    global_load_dword v4, v3, s[66:67] sc1
    s_waitcnt vmcnt(0)
    v_readfirstlane_b32 s15, v4
    s_add_u32 s14, s14, 1
    s_cmp_gt_u32 s14, 400000
    s_cbranch_scc1 L_wfd_f1
    s_cmp_eq_u32 s15, 7
    s_cbranch_scc1 L_wfd_f1
    s_sleep 16
    s_branch L_wf_f1
L_wfd_f1:
    s_barrier
    s_add_u32 s44, s32, 75497472
    s_addc_u32 s45, s33, 0
    s_mov_b32 s18, 3584
    s_mov_b32 s19, 1024
    s_mov_b32 s27, 64
    s_mov_b32 s28, 32768
    s_lshl_b32 s54, s53, 9
    s_cmp_eq_u32 s53, 3
    s_cselect_b32 s54, 1408, s54
    s_cmp_lt_u32 s53, 2
    s_cselect_b32 s20, 16, 12
    s_mov_b32 s8, s44
    s_mov_b32 s9, s45
    s_mov_b32 s10, 7340032
    s_mov_b32 s11, 0x00020000
    s_mov_b32 s12, s40
    s_mov_b32 s13, s41
    s_mov_b32 s14, 1835008
    s_mov_b32 s15, 0x00020000
    s_mul_i32 s16, s35, 917504
    s_lshl_b32 s38, s54, 1
    s_add_u32 s16, s16, s38
    s_lshl_b32 s17, s37, 9
    s_lshl_b32 s38, s54, 10
    s_add_u32 s17, s17, s38
    v_lshrrev_b32 v88, 2, v1
    s_lshl_b32 s23, s22, 6
    v_add_u32 v88, s23, v88
    v_mul_lo_u32 v88, v88, s18
    v_and_b32 v89, 3, v1
    v_bfe_u32 v90, v1, 4, 2
    v_xor_b32 v89, v89, v90
    v_lshl_add_u32 v2, v89, 4, v88
    s_lshl_b32 s23, s18, 4
    v_add_u32 v3, s23, v2
    v_add_u32 v4, s23, v3
    v_add_u32 v5, s23, v4
    v_lshrrev_b32 v88, 5, v1
    v_add_u32 v88, 0, v88
    v_and_b32 v89, 3, v88
    v_lshlrev_b32 v89, 2, v89
    v_and_b32 v90, 31, v1
    v_xor_b32 v89, v89, v90
    s_lshl_b32 s23, s22, 3
    v_add_u32 v88, s23, v88
    v_mul_lo_u32 v88, v88, s19
    v_lshl_add_u32 v6, v89, 4, v88
    v_lshrrev_b32 v88, 5, v1
    v_add_u32 v88, 2, v88
    v_and_b32 v89, 3, v88
    v_lshlrev_b32 v89, 2, v89
    v_and_b32 v90, 31, v1
    v_xor_b32 v89, v89, v90
    s_lshl_b32 s23, s22, 3
    v_add_u32 v88, s23, v88
    v_mul_lo_u32 v88, v88, s19
    v_lshl_add_u32 v7, v89, 4, v88
    v_lshrrev_b32 v88, 5, v1
    v_add_u32 v88, 4, v88
    v_and_b32 v89, 3, v88
    v_lshlrev_b32 v89, 2, v89
    v_and_b32 v90, 31, v1
    v_xor_b32 v89, v89, v90
    s_lshl_b32 s23, s22, 3
    v_add_u32 v88, s23, v88
    v_mul_lo_u32 v88, v88, s19
    v_lshl_add_u32 v8, v89, 4, v88
    v_lshrrev_b32 v88, 5, v1
    v_add_u32 v88, 6, v88
    v_and_b32 v89, 3, v88
    v_lshlrev_b32 v89, 2, v89
    v_and_b32 v90, 31, v1
    v_xor_b32 v89, v89, v90
    s_lshl_b32 s23, s22, 3
    v_add_u32 v88, s23, v88
    v_mul_lo_u32 v88, v88, s19
    v_lshl_add_u32 v9, v89, 4, v88
    v_and_b32 v88, 31, v1
    s_lshr_b32 s23, s22, 1
    s_lshl_b32 s23, s23, 7
    v_add_u32 v89, s23, v88
    v_lshlrev_b32 v89, 6, v89
    v_bfe_u32 v88, v1, 2, 2
    v_lshrrev_b32 v90, 5, v1
    v_add_u32 v90, 0, v90
    v_xor_b32 v90, v90, v88
    v_lshl_add_u32 v10, v90, 4, v89
    v_add_u32 v12, 65536, v10
    v_and_b32 v88, 31, v1
    s_lshr_b32 s23, s22, 1
    s_lshl_b32 s23, s23, 7
    v_add_u32 v89, s23, v88
    v_lshlrev_b32 v89, 6, v89
    v_bfe_u32 v88, v1, 2, 2
    v_lshrrev_b32 v90, 5, v1
    v_add_u32 v90, 2, v90
    v_xor_b32 v90, v90, v88
    v_lshl_add_u32 v11, v90, 4, v89
    v_add_u32 v13, 65536, v11
    v_bfe_u32 v88, v1, 2, 2
    v_lshrrev_b32 v89, 5, v1
    v_lshl_add_u32 v89, v89, 3, v88
    v_lshlrev_b32 v89, 9, v89
    v_xor_b32 v88, 0, v88
    v_lshlrev_b32 v88, 2, v88
    v_bfe_u32 v90, v1, 4, 1
    v_lshl_add_u32 v88, v90, 1, v88
    v_bfe_u32 v90, v1, 1, 1
    v_add_u32 v88, v88, v90
    s_and_b32 s23, s22, 1
    s_lshl_b32 s23, s23, 4
    v_add_u32 v88, s23, v88
    v_lshl_add_u32 v89, v88, 4, v89
    v_and_b32 v90, 1, v1
    v_lshl_add_u32 v89, v90, 3, v89
    v_add_u32 v14, 16384, v89
    v_add_u32 v18, 65536, v14
    v_bfe_u32 v88, v1, 2, 2
    v_lshrrev_b32 v89, 5, v1
    v_lshl_add_u32 v89, v89, 3, v88
    v_lshlrev_b32 v89, 9, v89
    v_xor_b32 v88, 1, v88
    v_lshlrev_b32 v88, 2, v88
    v_bfe_u32 v90, v1, 4, 1
    v_lshl_add_u32 v88, v90, 1, v88
    v_bfe_u32 v90, v1, 1, 1
    v_add_u32 v88, v88, v90
    s_and_b32 s23, s22, 1
    s_lshl_b32 s23, s23, 4
    v_add_u32 v88, s23, v88
    v_lshl_add_u32 v89, v88, 4, v89
    v_and_b32 v90, 1, v1
    v_lshl_add_u32 v89, v90, 3, v89
    v_add_u32 v15, 16384, v89
    v_add_u32 v19, 65536, v15
    v_bfe_u32 v88, v1, 2, 2
    v_lshrrev_b32 v89, 5, v1
    v_lshl_add_u32 v89, v89, 3, v88
    v_lshlrev_b32 v89, 9, v89
    v_xor_b32 v88, 2, v88
    v_lshlrev_b32 v88, 2, v88
    v_bfe_u32 v90, v1, 4, 1
    v_lshl_add_u32 v88, v90, 1, v88
    v_bfe_u32 v90, v1, 1, 1
    v_add_u32 v88, v88, v90
    s_and_b32 s23, s22, 1
    s_lshl_b32 s23, s23, 4
    v_add_u32 v88, s23, v88
    v_lshl_add_u32 v89, v88, 4, v89
    v_and_b32 v90, 1, v1
    v_lshl_add_u32 v89, v90, 3, v89
    v_add_u32 v16, 16384, v89
    v_add_u32 v20, 65536, v16
    v_bfe_u32 v88, v1, 2, 2
    v_lshrrev_b32 v89, 5, v1
    v_lshl_add_u32 v89, v89, 3, v88
    v_lshlrev_b32 v89, 9, v89
    v_xor_b32 v88, 3, v88
    v_lshlrev_b32 v88, 2, v88
    v_bfe_u32 v90, v1, 4, 1
    v_lshl_add_u32 v88, v90, 1, v88
    v_bfe_u32 v90, v1, 1, 1
    v_add_u32 v88, v88, v90
    s_and_b32 s23, s22, 1
    s_lshl_b32 s23, s23, 4
    v_add_u32 v88, s23, v88
    v_lshl_add_u32 v89, v88, 4, v89
    v_and_b32 v90, 1, v1
    v_lshl_add_u32 v89, v90, 3, v89
    v_add_u32 v17, 16384, v89
    v_add_u32 v21, 65536, v17
    s_lshl_b32 s25, s22, 12
    s_add_u32 s26, s25, 0
    s_add_u32 m0, s26, 0
    s_nop 0
    buffer_load_dwordx4 v2, s[8:11], s16 offen lds
    s_add_u32 m0, s26, 1024
    s_nop 0
    buffer_load_dwordx4 v3, s[8:11], s16 offen lds
    s_add_u32 m0, s26, 2048
    s_nop 0
    buffer_load_dwordx4 v4, s[8:11], s16 offen lds
    s_add_u32 m0, s26, 3072
    s_nop 0
    buffer_load_dwordx4 v5, s[8:11], s16 offen lds
    s_add_u32 m0, s26, 16384
    s_nop 0
    buffer_load_dwordx4 v6, s[12:15], s17 offen lds
    s_add_u32 m0, s26, 17408
    s_nop 0
    buffer_load_dwordx4 v7, s[12:15], s17 offen lds
    s_add_u32 m0, s26, 18432
    s_nop 0
    buffer_load_dwordx4 v8, s[12:15], s17 offen lds
    s_add_u32 m0, s26, 19456
    s_nop 0
    buffer_load_dwordx4 v9, s[12:15], s17 offen lds
    s_add_u32 s16, s16, s27
    s_add_u32 s17, s17, s28
    s_add_u32 s26, s25, 32768
    s_add_u32 m0, s26, 0
    s_nop 0
    buffer_load_dwordx4 v2, s[8:11], s16 offen lds
    s_add_u32 m0, s26, 1024
    s_nop 0
    buffer_load_dwordx4 v3, s[8:11], s16 offen lds
    s_add_u32 m0, s26, 2048
    s_nop 0
    buffer_load_dwordx4 v4, s[8:11], s16 offen lds
    s_add_u32 m0, s26, 3072
    s_nop 0
    buffer_load_dwordx4 v5, s[8:11], s16 offen lds
    s_add_u32 m0, s26, 16384
    s_nop 0
    buffer_load_dwordx4 v6, s[12:15], s17 offen lds
    s_add_u32 m0, s26, 17408
    s_nop 0
    buffer_load_dwordx4 v7, s[12:15], s17 offen lds
    s_add_u32 m0, s26, 18432
    s_nop 0
    buffer_load_dwordx4 v8, s[12:15], s17 offen lds
    s_add_u32 m0, s26, 19456
    s_nop 0
    buffer_load_dwordx4 v9, s[12:15], s17 offen lds
    s_add_u32 s16, s16, s27
    s_add_u32 s17, s17, s28
    s_add_u32 s26, s25, 65536
    s_add_u32 m0, s26, 0
    s_nop 0
    buffer_load_dwordx4 v2, s[8:11], s16 offen lds
    s_add_u32 m0, s26, 1024
    s_nop 0
    buffer_load_dwordx4 v3, s[8:11], s16 offen lds
    s_add_u32 m0, s26, 2048
    s_nop 0
    buffer_load_dwordx4 v4, s[8:11], s16 offen lds
    s_add_u32 m0, s26, 3072
    s_nop 0
    buffer_load_dwordx4 v5, s[8:11], s16 offen lds
    s_add_u32 m0, s26, 16384
    s_nop 0
    buffer_load_dwordx4 v6, s[12:15], s17 offen lds
    s_add_u32 m0, s26, 17408
    s_nop 0
    buffer_load_dwordx4 v7, s[12:15], s17 offen lds
    s_add_u32 m0, s26, 18432
    s_nop 0
    buffer_load_dwordx4 v8, s[12:15], s17 offen lds
    s_add_u32 m0, s26, 19456
    s_nop 0
    buffer_load_dwordx4 v9, s[12:15], s17 offen lds
    s_add_u32 s16, s16, s27
    s_add_u32 s17, s17, s28
    s_waitcnt vmcnt(16)
    s_barrier
    ds_read_b128 v[24:27], v10 offset:0
    ds_read_b128 v[28:31], v10 offset:2048
    ds_read_b128 v[32:35], v10 offset:4096
    ds_read_b128 v[36:39], v10 offset:6144
    ds_read_b64_tr_b16 v[40:41], v14 offset:0
    ds_read_b64_tr_b16 v[42:43], v14 offset:2048
    ds_read_b64_tr_b16 v[44:45], v15 offset:0
    ds_read_b64_tr_b16 v[46:47], v15 offset:2048
    ds_read_b64_tr_b16 v[48:49], v16 offset:0
    ds_read_b64_tr_b16 v[50:51], v16 offset:2048
    ds_read_b64_tr_b16 v[52:53], v17 offset:0
    ds_read_b64_tr_b16 v[54:55], v17 offset:2048
    s_mov_b32 s21, 0
    v_accvgpr_write_b32 a0, 0
    v_accvgpr_write_b32 a1, 0
    v_accvgpr_write_b32 a2, 0
    v_accvgpr_write_b32 a3, 0
    v_accvgpr_write_b32 a4, 0
    v_accvgpr_write_b32 a5, 0
    v_accvgpr_write_b32 a6, 0
    v_accvgpr_write_b32 a7, 0
    v_accvgpr_write_b32 a8, 0
    v_accvgpr_write_b32 a9, 0
    v_accvgpr_write_b32 a10, 0
    v_accvgpr_write_b32 a11, 0
    v_accvgpr_write_b32 a12, 0
    v_accvgpr_write_b32 a13, 0
    v_accvgpr_write_b32 a14, 0
    v_accvgpr_write_b32 a15, 0
    v_accvgpr_write_b32 a16, 0
    v_accvgpr_write_b32 a17, 0
    v_accvgpr_write_b32 a18, 0
    v_accvgpr_write_b32 a19, 0
    v_accvgpr_write_b32 a20, 0
    v_accvgpr_write_b32 a21, 0
    v_accvgpr_write_b32 a22, 0
    v_accvgpr_write_b32 a23, 0
    v_accvgpr_write_b32 a24, 0
    v_accvgpr_write_b32 a25, 0
    v_accvgpr_write_b32 a26, 0
    v_accvgpr_write_b32 a27, 0
    v_accvgpr_write_b32 a28, 0
    v_accvgpr_write_b32 a29, 0
    v_accvgpr_write_b32 a30, 0
    v_accvgpr_write_b32 a31, 0
    v_accvgpr_write_b32 a32, 0
    v_accvgpr_write_b32 a33, 0
    v_accvgpr_write_b32 a34, 0
    v_accvgpr_write_b32 a35, 0
    v_accvgpr_write_b32 a36, 0
    v_accvgpr_write_b32 a37, 0
    v_accvgpr_write_b32 a38, 0
    v_accvgpr_write_b32 a39, 0
    v_accvgpr_write_b32 a40, 0
    v_accvgpr_write_b32 a41, 0
    v_accvgpr_write_b32 a42, 0
    v_accvgpr_write_b32 a43, 0
    v_accvgpr_write_b32 a44, 0
    v_accvgpr_write_b32 a45, 0
    v_accvgpr_write_b32 a46, 0
    v_accvgpr_write_b32 a47, 0
    v_accvgpr_write_b32 a48, 0
    v_accvgpr_write_b32 a49, 0
    v_accvgpr_write_b32 a50, 0
    v_accvgpr_write_b32 a51, 0
    v_accvgpr_write_b32 a52, 0
    v_accvgpr_write_b32 a53, 0
    v_accvgpr_write_b32 a54, 0
    v_accvgpr_write_b32 a55, 0
    v_accvgpr_write_b32 a56, 0
    v_accvgpr_write_b32 a57, 0
    v_accvgpr_write_b32 a58, 0
    v_accvgpr_write_b32 a59, 0
    v_accvgpr_write_b32 a60, 0
    v_accvgpr_write_b32 a61, 0
    v_accvgpr_write_b32 a62, 0
    v_accvgpr_write_b32 a63, 0
    v_accvgpr_write_b32 a64, 0
    v_accvgpr_write_b32 a65, 0
    v_accvgpr_write_b32 a66, 0
    v_accvgpr_write_b32 a67, 0
    v_accvgpr_write_b32 a68, 0
    v_accvgpr_write_b32 a69, 0
    v_accvgpr_write_b32 a70, 0
    v_accvgpr_write_b32 a71, 0
    v_accvgpr_write_b32 a72, 0
    v_accvgpr_write_b32 a73, 0
    v_accvgpr_write_b32 a74, 0
    v_accvgpr_write_b32 a75, 0
    v_accvgpr_write_b32 a76, 0
    v_accvgpr_write_b32 a77, 0
    v_accvgpr_write_b32 a78, 0
    v_accvgpr_write_b32 a79, 0
    v_accvgpr_write_b32 a80, 0
    v_accvgpr_write_b32 a81, 0
    v_accvgpr_write_b32 a82, 0
    v_accvgpr_write_b32 a83, 0
    v_accvgpr_write_b32 a84, 0
    v_accvgpr_write_b32 a85, 0
    v_accvgpr_write_b32 a86, 0
    v_accvgpr_write_b32 a87, 0
    v_accvgpr_write_b32 a88, 0
    v_accvgpr_write_b32 a89, 0
    v_accvgpr_write_b32 a90, 0
    v_accvgpr_write_b32 a91, 0
    v_accvgpr_write_b32 a92, 0
    v_accvgpr_write_b32 a93, 0
    v_accvgpr_write_b32 a94, 0
    v_accvgpr_write_b32 a95, 0
    v_accvgpr_write_b32 a96, 0
    v_accvgpr_write_b32 a97, 0
    v_accvgpr_write_b32 a98, 0
    v_accvgpr_write_b32 a99, 0
    v_accvgpr_write_b32 a100, 0
    v_accvgpr_write_b32 a101, 0
    v_accvgpr_write_b32 a102, 0
    v_accvgpr_write_b32 a103, 0
    v_accvgpr_write_b32 a104, 0
    v_accvgpr_write_b32 a105, 0
    v_accvgpr_write_b32 a106, 0
    v_accvgpr_write_b32 a107, 0
    v_accvgpr_write_b32 a108, 0
    v_accvgpr_write_b32 a109, 0
    v_accvgpr_write_b32 a110, 0
    v_accvgpr_write_b32 a111, 0
    v_accvgpr_write_b32 a112, 0
    v_accvgpr_write_b32 a113, 0
    v_accvgpr_write_b32 a114, 0
    v_accvgpr_write_b32 a115, 0
    v_accvgpr_write_b32 a116, 0
    v_accvgpr_write_b32 a117, 0
    v_accvgpr_write_b32 a118, 0
    v_accvgpr_write_b32 a119, 0
    v_accvgpr_write_b32 a120, 0
    v_accvgpr_write_b32 a121, 0
    v_accvgpr_write_b32 a122, 0
    v_accvgpr_write_b32 a123, 0
    v_accvgpr_write_b32 a124, 0
    v_accvgpr_write_b32 a125, 0
    v_accvgpr_write_b32 a126, 0
    v_accvgpr_write_b32 a127, 0
    v_accvgpr_write_b32 a128, 0
    v_accvgpr_write_b32 a129, 0
    v_accvgpr_write_b32 a130, 0
    v_accvgpr_write_b32 a131, 0
    v_accvgpr_write_b32 a132, 0
    v_accvgpr_write_b32 a133, 0
    v_accvgpr_write_b32 a134, 0
    v_accvgpr_write_b32 a135, 0
    v_accvgpr_write_b32 a136, 0
    v_accvgpr_write_b32 a137, 0
    v_accvgpr_write_b32 a138, 0
    v_accvgpr_write_b32 a139, 0
    v_accvgpr_write_b32 a140, 0
    v_accvgpr_write_b32 a141, 0
    v_accvgpr_write_b32 a142, 0
    v_accvgpr_write_b32 a143, 0
    v_accvgpr_write_b32 a144, 0
    v_accvgpr_write_b32 a145, 0
    v_accvgpr_write_b32 a146, 0
    v_accvgpr_write_b32 a147, 0
    v_accvgpr_write_b32 a148, 0
    v_accvgpr_write_b32 a149, 0
    v_accvgpr_write_b32 a150, 0
    v_accvgpr_write_b32 a151, 0
    v_accvgpr_write_b32 a152, 0
    v_accvgpr_write_b32 a153, 0
    v_accvgpr_write_b32 a154, 0
    v_accvgpr_write_b32 a155, 0
    v_accvgpr_write_b32 a156, 0
    v_accvgpr_write_b32 a157, 0
    v_accvgpr_write_b32 a158, 0
    v_accvgpr_write_b32 a159, 0
    v_accvgpr_write_b32 a160, 0
    v_accvgpr_write_b32 a161, 0
    v_accvgpr_write_b32 a162, 0
    v_accvgpr_write_b32 a163, 0
    v_accvgpr_write_b32 a164, 0
    v_accvgpr_write_b32 a165, 0
    v_accvgpr_write_b32 a166, 0
    v_accvgpr_write_b32 a167, 0
    v_accvgpr_write_b32 a168, 0
    v_accvgpr_write_b32 a169, 0
    v_accvgpr_write_b32 a170, 0
    v_accvgpr_write_b32 a171, 0
    v_accvgpr_write_b32 a172, 0
    v_accvgpr_write_b32 a173, 0
    v_accvgpr_write_b32 a174, 0
    v_accvgpr_write_b32 a175, 0
    v_accvgpr_write_b32 a176, 0
    v_accvgpr_write_b32 a177, 0
    v_accvgpr_write_b32 a178, 0
    v_accvgpr_write_b32 a179, 0
    v_accvgpr_write_b32 a180, 0
    v_accvgpr_write_b32 a181, 0
    v_accvgpr_write_b32 a182, 0
    v_accvgpr_write_b32 a183, 0
    v_accvgpr_write_b32 a184, 0
    v_accvgpr_write_b32 a185, 0
    v_accvgpr_write_b32 a186, 0
    v_accvgpr_write_b32 a187, 0
    v_accvgpr_write_b32 a188, 0
    v_accvgpr_write_b32 a189, 0
    v_accvgpr_write_b32 a190, 0
    v_accvgpr_write_b32 a191, 0
    v_accvgpr_write_b32 a192, 0
    v_accvgpr_write_b32 a193, 0
    v_accvgpr_write_b32 a194, 0
    v_accvgpr_write_b32 a195, 0
    v_accvgpr_write_b32 a196, 0
    v_accvgpr_write_b32 a197, 0
    v_accvgpr_write_b32 a198, 0
    v_accvgpr_write_b32 a199, 0
    v_accvgpr_write_b32 a200, 0
    v_accvgpr_write_b32 a201, 0
    v_accvgpr_write_b32 a202, 0
    v_accvgpr_write_b32 a203, 0
    v_accvgpr_write_b32 a204, 0
    v_accvgpr_write_b32 a205, 0
    v_accvgpr_write_b32 a206, 0
    v_accvgpr_write_b32 a207, 0
    v_accvgpr_write_b32 a208, 0
    v_accvgpr_write_b32 a209, 0
    v_accvgpr_write_b32 a210, 0
    v_accvgpr_write_b32 a211, 0
    v_accvgpr_write_b32 a212, 0
    v_accvgpr_write_b32 a213, 0
    v_accvgpr_write_b32 a214, 0
    v_accvgpr_write_b32 a215, 0
    v_accvgpr_write_b32 a216, 0
    v_accvgpr_write_b32 a217, 0
    v_accvgpr_write_b32 a218, 0
    v_accvgpr_write_b32 a219, 0
    v_accvgpr_write_b32 a220, 0
    v_accvgpr_write_b32 a221, 0
    v_accvgpr_write_b32 a222, 0
    v_accvgpr_write_b32 a223, 0
    v_accvgpr_write_b32 a224, 0
    v_accvgpr_write_b32 a225, 0
    v_accvgpr_write_b32 a226, 0
    v_accvgpr_write_b32 a227, 0
    v_accvgpr_write_b32 a228, 0
    v_accvgpr_write_b32 a229, 0
    v_accvgpr_write_b32 a230, 0
    v_accvgpr_write_b32 a231, 0
    v_accvgpr_write_b32 a232, 0
    v_accvgpr_write_b32 a233, 0
    v_accvgpr_write_b32 a234, 0
    v_accvgpr_write_b32 a235, 0
    v_accvgpr_write_b32 a236, 0
    v_accvgpr_write_b32 a237, 0
    v_accvgpr_write_b32 a238, 0
    v_accvgpr_write_b32 a239, 0
    v_accvgpr_write_b32 a240, 0
    v_accvgpr_write_b32 a241, 0
    v_accvgpr_write_b32 a242, 0
    v_accvgpr_write_b32 a243, 0
    v_accvgpr_write_b32 a244, 0
    v_accvgpr_write_b32 a245, 0
    v_accvgpr_write_b32 a246, 0
    v_accvgpr_write_b32 a247, 0
    v_accvgpr_write_b32 a248, 0
    v_accvgpr_write_b32 a249, 0
    v_accvgpr_write_b32 a250, 0
    v_accvgpr_write_b32 a251, 0
    v_accvgpr_write_b32 a252, 0
    v_accvgpr_write_b32 a253, 0
    v_accvgpr_write_b32 a254, 0
    v_accvgpr_write_b32 a255, 0
.p2align 6
L_gemm_f2:
    s_waitcnt lgkmcnt(0)
    v_mfma_f32_32x32x16_bf16 a[0:15], v[40:43], v[24:27], a[0:15]
    ds_read_b128 v[56:59], v11 offset:0
    v_mfma_f32_32x32x16_bf16 a[16:31], v[44:47], v[24:27], a[16:31]
    ds_read_b128 v[60:63], v11 offset:2048
    v_mfma_f32_32x32x16_bf16 a[32:47], v[48:51], v[24:27], a[32:47]
    ds_read_b128 v[64:67], v11 offset:4096
    v_mfma_f32_32x32x16_bf16 a[48:63], v[52:55], v[24:27], a[48:63]
    ds_read_b128 v[68:71], v11 offset:6144
    v_mfma_f32_32x32x16_bf16 a[64:79], v[40:43], v[28:31], a[64:79]
    ds_read_b64_tr_b16 v[72:73], v14 offset:8192
    v_mfma_f32_32x32x16_bf16 a[80:95], v[44:47], v[28:31], a[80:95]
    ds_read_b64_tr_b16 v[74:75], v14 offset:10240
    v_mfma_f32_32x32x16_bf16 a[96:111], v[48:51], v[28:31], a[96:111]
    ds_read_b64_tr_b16 v[76:77], v15 offset:8192
    v_mfma_f32_32x32x16_bf16 a[112:127], v[52:55], v[28:31], a[112:127]
    ds_read_b64_tr_b16 v[78:79], v15 offset:10240
    v_mfma_f32_32x32x16_bf16 a[128:143], v[40:43], v[32:35], a[128:143]
    ds_read_b64_tr_b16 v[80:81], v16 offset:8192
    v_mfma_f32_32x32x16_bf16 a[144:159], v[44:47], v[32:35], a[144:159]
    ds_read_b64_tr_b16 v[82:83], v16 offset:10240
    v_mfma_f32_32x32x16_bf16 a[160:175], v[48:51], v[32:35], a[160:175]
    ds_read_b64_tr_b16 v[84:85], v17 offset:8192
    v_mfma_f32_32x32x16_bf16 a[176:191], v[52:55], v[32:35], a[176:191]
    ds_read_b64_tr_b16 v[86:87], v17 offset:10240
    v_mfma_f32_32x32x16_bf16 a[192:207], v[40:43], v[36:39], a[192:207]
    v_mfma_f32_32x32x16_bf16 a[208:223], v[44:47], v[36:39], a[208:223]
    v_mfma_f32_32x32x16_bf16 a[224:239], v[48:51], v[36:39], a[224:239]
    v_mfma_f32_32x32x16_bf16 a[240:255], v[52:55], v[36:39], a[240:255]
    s_waitcnt vmcnt(8)
    s_waitcnt lgkmcnt(0)
    s_barrier
    s_add_u32 s26, s25, 98304
    v_mfma_f32_32x32x16_bf16 a[0:15], v[72:75], v[56:59], a[0:15]
    ds_read_b128 v[24:27], v10 offset:32768
    v_mfma_f32_32x32x16_bf16 a[16:31], v[76:79], v[56:59], a[16:31]
    ds_read_b128 v[28:31], v10 offset:34816
    v_mfma_f32_32x32x16_bf16 a[32:47], v[80:83], v[56:59], a[32:47]
    ds_read_b128 v[32:35], v10 offset:36864
    s_add_u32 m0, s26, 0
    s_nop 0
    v_mfma_f32_32x32x16_bf16 a[48:63], v[84:87], v[56:59], a[48:63]
    ds_read_b128 v[36:39], v10 offset:38912
    buffer_load_dwordx4 v2, s[8:11], s16 offen lds
    s_add_u32 m0, s26, 1024
    v_mfma_f32_32x32x16_bf16 a[64:79], v[72:75], v[60:63], a[64:79]
    ds_read_b64_tr_b16 v[40:41], v14 offset:32768
    s_nop 0
    buffer_load_dwordx4 v3, s[8:11], s16 offen lds
    v_mfma_f32_32x32x16_bf16 a[80:95], v[76:79], v[60:63], a[80:95]
    ds_read_b64_tr_b16 v[42:43], v14 offset:34816
    s_add_u32 m0, s26, 2048
    s_nop 0
    v_mfma_f32_32x32x16_bf16 a[96:111], v[80:83], v[60:63], a[96:111]
    ds_read_b64_tr_b16 v[44:45], v15 offset:32768
    buffer_load_dwordx4 v4, s[8:11], s16 offen lds
    s_add_u32 m0, s26, 3072
    v_mfma_f32_32x32x16_bf16 a[112:127], v[84:87], v[60:63], a[112:127]
    ds_read_b64_tr_b16 v[46:47], v15 offset:34816
    s_nop 0
    buffer_load_dwordx4 v5, s[8:11], s16 offen lds
    v_mfma_f32_32x32x16_bf16 a[128:143], v[72:75], v[64:67], a[128:143]
    ds_read_b64_tr_b16 v[48:49], v16 offset:32768
    s_add_u32 m0, s26, 16384
    s_nop 0
    v_mfma_f32_32x32x16_bf16 a[144:159], v[76:79], v[64:67], a[144:159]
    ds_read_b64_tr_b16 v[50:51], v16 offset:34816
    buffer_load_dwordx4 v6, s[12:15], s17 offen lds
    s_add_u32 m0, s26, 17408
    v_mfma_f32_32x32x16_bf16 a[160:175], v[80:83], v[64:67], a[160:175]
    ds_read_b64_tr_b16 v[52:53], v17 offset:32768
    s_nop 0
    buffer_load_dwordx4 v7, s[12:15], s17 offen lds
    v_mfma_f32_32x32x16_bf16 a[176:191], v[84:87], v[64:67], a[176:191]
    ds_read_b64_tr_b16 v[54:55], v17 offset:34816
    s_add_u32 m0, s26, 18432
    s_nop 0
    v_mfma_f32_32x32x16_bf16 a[192:207], v[72:75], v[68:71], a[192:207]
    buffer_load_dwordx4 v8, s[12:15], s17 offen lds
    s_add_u32 m0, s26, 19456
    v_mfma_f32_32x32x16_bf16 a[208:223], v[76:79], v[68:71], a[208:223]
    s_nop 0
    buffer_load_dwordx4 v9, s[12:15], s17 offen lds
    v_mfma_f32_32x32x16_bf16 a[224:239], v[80:83], v[68:71], a[224:239]
    s_add_u32 s16, s16, s27
    s_add_u32 s17, s17, s28
    v_mfma_f32_32x32x16_bf16 a[240:255], v[84:87], v[68:71], a[240:255]
    s_waitcnt lgkmcnt(0)
    v_mfma_f32_32x32x16_bf16 a[0:15], v[40:43], v[24:27], a[0:15]
    ds_read_b128 v[56:59], v11 offset:32768
    v_mfma_f32_32x32x16_bf16 a[16:31], v[44:47], v[24:27], a[16:31]
    ds_read_b128 v[60:63], v11 offset:34816
    v_mfma_f32_32x32x16_bf16 a[32:47], v[48:51], v[24:27], a[32:47]
    ds_read_b128 v[64:67], v11 offset:36864
    v_mfma_f32_32x32x16_bf16 a[48:63], v[52:55], v[24:27], a[48:63]
    ds_read_b128 v[68:71], v11 offset:38912
    v_mfma_f32_32x32x16_bf16 a[64:79], v[40:43], v[28:31], a[64:79]
    ds_read_b64_tr_b16 v[72:73], v14 offset:40960
    v_mfma_f32_32x32x16_bf16 a[80:95], v[44:47], v[28:31], a[80:95]
    ds_read_b64_tr_b16 v[74:75], v14 offset:43008
    v_mfma_f32_32x32x16_bf16 a[96:111], v[48:51], v[28:31], a[96:111]
    ds_read_b64_tr_b16 v[76:77], v15 offset:40960
    v_mfma_f32_32x32x16_bf16 a[112:127], v[52:55], v[28:31], a[112:127]
    ds_read_b64_tr_b16 v[78:79], v15 offset:43008
    v_mfma_f32_32x32x16_bf16 a[128:143], v[40:43], v[32:35], a[128:143]
    ds_read_b64_tr_b16 v[80:81], v16 offset:40960
    v_mfma_f32_32x32x16_bf16 a[144:159], v[44:47], v[32:35], a[144:159]
    ds_read_b64_tr_b16 v[82:83], v16 offset:43008
    v_mfma_f32_32x32x16_bf16 a[160:175], v[48:51], v[32:35], a[160:175]
    ds_read_b64_tr_b16 v[84:85], v17 offset:40960
    v_mfma_f32_32x32x16_bf16 a[176:191], v[52:55], v[32:35], a[176:191]
    ds_read_b64_tr_b16 v[86:87], v17 offset:43008
    v_mfma_f32_32x32x16_bf16 a[192:207], v[40:43], v[36:39], a[192:207]
    v_mfma_f32_32x32x16_bf16 a[208:223], v[44:47], v[36:39], a[208:223]
    v_mfma_f32_32x32x16_bf16 a[224:239], v[48:51], v[36:39], a[224:239]
    v_mfma_f32_32x32x16_bf16 a[240:255], v[52:55], v[36:39], a[240:255]
    s_waitcnt vmcnt(8)
    s_waitcnt lgkmcnt(0)
    s_barrier
    s_add_u32 s26, s25, 0
    v_mfma_f32_32x32x16_bf16 a[0:15], v[72:75], v[56:59], a[0:15]
    ds_read_b128 v[24:27], v12 offset:0
    v_mfma_f32_32x32x16_bf16 a[16:31], v[76:79], v[56:59], a[16:31]
    ds_read_b128 v[28:31], v12 offset:2048
    v_mfma_f32_32x32x16_bf16 a[32:47], v[80:83], v[56:59], a[32:47]
    ds_read_b128 v[32:35], v12 offset:4096
    s_add_u32 m0, s26, 0
    s_nop 0
    v_mfma_f32_32x32x16_bf16 a[48:63], v[84:87], v[56:59], a[48:63]
    ds_read_b128 v[36:39], v12 offset:6144
    buffer_load_dwordx4 v2, s[8:11], s16 offen lds
    s_add_u32 m0, s26, 1024
    v_mfma_f32_32x32x16_bf16 a[64:79], v[72:75], v[60:63], a[64:79]
    ds_read_b64_tr_b16 v[40:41], v18 offset:0
    s_nop 0
    buffer_load_dwordx4 v3, s[8:11], s16 offen lds
    v_mfma_f32_32x32x16_bf16 a[80:95], v[76:79], v[60:63], a[80:95]
    ds_read_b64_tr_b16 v[42:43], v18 offset:2048
    s_add_u32 m0, s26, 2048
    s_nop 0
    v_mfma_f32_32x32x16_bf16 a[96:111], v[80:83], v[60:63], a[96:111]
    ds_read_b64_tr_b16 v[44:45], v19 offset:0
    buffer_load_dwordx4 v4, s[8:11], s16 offen lds
    s_add_u32 m0, s26, 3072
    v_mfma_f32_32x32x16_bf16 a[112:127], v[84:87], v[60:63], a[112:127]
    ds_read_b64_tr_b16 v[46:47], v19 offset:2048
    s_nop 0
    buffer_load_dwordx4 v5, s[8:11], s16 offen lds
    v_mfma_f32_32x32x16_bf16 a[128:143], v[72:75], v[64:67], a[128:143]
    ds_read_b64_tr_b16 v[48:49], v20 offset:0
    s_add_u32 m0, s26, 16384
    s_nop 0
    v_mfma_f32_32x32x16_bf16 a[144:159], v[76:79], v[64:67], a[144:159]
    ds_read_b64_tr_b16 v[50:51], v20 offset:2048
    buffer_load_dwordx4 v6, s[12:15], s17 offen lds
    s_add_u32 m0, s26, 17408
    v_mfma_f32_32x32x16_bf16 a[160:175], v[80:83], v[64:67], a[160:175]
    ds_read_b64_tr_b16 v[52:53], v21 offset:0
    s_nop 0
    buffer_load_dwordx4 v7, s[12:15], s17 offen lds
    v_mfma_f32_32x32x16_bf16 a[176:191], v[84:87], v[64:67], a[176:191]
    ds_read_b64_tr_b16 v[54:55], v21 offset:2048
    s_add_u32 m0, s26, 18432
    s_nop 0
    v_mfma_f32_32x32x16_bf16 a[192:207], v[72:75], v[68:71], a[192:207]
    buffer_load_dwordx4 v8, s[12:15], s17 offen lds
    s_add_u32 m0, s26, 19456
    v_mfma_f32_32x32x16_bf16 a[208:223], v[76:79], v[68:71], a[208:223]
    s_nop 0
    buffer_load_dwordx4 v9, s[12:15], s17 offen lds
    v_mfma_f32_32x32x16_bf16 a[224:239], v[80:83], v[68:71], a[224:239]
    s_add_u32 s16, s16, s27
    s_add_u32 s17, s17, s28
    v_mfma_f32_32x32x16_bf16 a[240:255], v[84:87], v[68:71], a[240:255]
    s_waitcnt lgkmcnt(0)
    v_mfma_f32_32x32x16_bf16 a[0:15], v[40:43], v[24:27], a[0:15]
    ds_read_b128 v[56:59], v13 offset:0
    v_mfma_f32_32x32x16_bf16 a[16:31], v[44:47], v[24:27], a[16:31]
    ds_read_b128 v[60:63], v13 offset:2048
    v_mfma_f32_32x32x16_bf16 a[32:47], v[48:51], v[24:27], a[32:47]
    ds_read_b128 v[64:67], v13 offset:4096
    v_mfma_f32_32x32x16_bf16 a[48:63], v[52:55], v[24:27], a[48:63]
    ds_read_b128 v[68:71], v13 offset:6144
    v_mfma_f32_32x32x16_bf16 a[64:79], v[40:43], v[28:31], a[64:79]
    ds_read_b64_tr_b16 v[72:73], v18 offset:8192
    v_mfma_f32_32x32x16_bf16 a[80:95], v[44:47], v[28:31], a[80:95]
    ds_read_b64_tr_b16 v[74:75], v18 offset:10240
    v_mfma_f32_32x32x16_bf16 a[96:111], v[48:51], v[28:31], a[96:111]
    ds_read_b64_tr_b16 v[76:77], v19 offset:8192
    v_mfma_f32_32x32x16_bf16 a[112:127], v[52:55], v[28:31], a[112:127]
    ds_read_b64_tr_b16 v[78:79], v19 offset:10240
    v_mfma_f32_32x32x16_bf16 a[128:143], v[40:43], v[32:35], a[128:143]
    ds_read_b64_tr_b16 v[80:81], v20 offset:8192
    v_mfma_f32_32x32x16_bf16 a[144:159], v[44:47], v[32:35], a[144:159]
    ds_read_b64_tr_b16 v[82:83], v20 offset:10240
    v_mfma_f32_32x32x16_bf16 a[160:175], v[48:51], v[32:35], a[160:175]
    ds_read_b64_tr_b16 v[84:85], v21 offset:8192
    v_mfma_f32_32x32x16_bf16 a[176:191], v[52:55], v[32:35], a[176:191]
    ds_read_b64_tr_b16 v[86:87], v21 offset:10240
    v_mfma_f32_32x32x16_bf16 a[192:207], v[40:43], v[36:39], a[192:207]
    v_mfma_f32_32x32x16_bf16 a[208:223], v[44:47], v[36:39], a[208:223]
    v_mfma_f32_32x32x16_bf16 a[224:239], v[48:51], v[36:39], a[224:239]
    v_mfma_f32_32x32x16_bf16 a[240:255], v[52:55], v[36:39], a[240:255]
    s_waitcnt vmcnt(8)
    s_waitcnt lgkmcnt(0)
    s_barrier
    s_add_u32 s26, s25, 32768
    v_mfma_f32_32x32x16_bf16 a[0:15], v[72:75], v[56:59], a[0:15]
    ds_read_b128 v[24:27], v12 offset:32768
    v_mfma_f32_32x32x16_bf16 a[16:31], v[76:79], v[56:59], a[16:31]
    ds_read_b128 v[28:31], v12 offset:34816
    v_mfma_f32_32x32x16_bf16 a[32:47], v[80:83], v[56:59], a[32:47]
    ds_read_b128 v[32:35], v12 offset:36864
    s_add_u32 m0, s26, 0
    s_nop 0
    v_mfma_f32_32x32x16_bf16 a[48:63], v[84:87], v[56:59], a[48:63]
    ds_read_b128 v[36:39], v12 offset:38912
    buffer_load_dwordx4 v2, s[8:11], s16 offen lds
    s_add_u32 m0, s26, 1024
    v_mfma_f32_32x32x16_bf16 a[64:79], v[72:75], v[60:63], a[64:79]
    ds_read_b64_tr_b16 v[40:41], v18 offset:32768
    s_nop 0
    buffer_load_dwordx4 v3, s[8:11], s16 offen lds
    v_mfma_f32_32x32x16_bf16 a[80:95], v[76:79], v[60:63], a[80:95]
    ds_read_b64_tr_b16 v[42:43], v18 offset:34816
    s_add_u32 m0, s26, 2048
    s_nop 0
    v_mfma_f32_32x32x16_bf16 a[96:111], v[80:83], v[60:63], a[96:111]
    ds_read_b64_tr_b16 v[44:45], v19 offset:32768
    buffer_load_dwordx4 v4, s[8:11], s16 offen lds
    s_add_u32 m0, s26, 3072
    v_mfma_f32_32x32x16_bf16 a[112:127], v[84:87], v[60:63], a[112:127]
    ds_read_b64_tr_b16 v[46:47], v19 offset:34816
    s_nop 0
    buffer_load_dwordx4 v5, s[8:11], s16 offen lds
    v_mfma_f32_32x32x16_bf16 a[128:143], v[72:75], v[64:67], a[128:143]
    ds_read_b64_tr_b16 v[48:49], v20 offset:32768
    s_add_u32 m0, s26, 16384
    s_nop 0
    v_mfma_f32_32x32x16_bf16 a[144:159], v[76:79], v[64:67], a[144:159]
    ds_read_b64_tr_b16 v[50:51], v20 offset:34816
    buffer_load_dwordx4 v6, s[12:15], s17 offen lds
    s_add_u32 m0, s26, 17408
    v_mfma_f32_32x32x16_bf16 a[160:175], v[80:83], v[64:67], a[160:175]
    ds_read_b64_tr_b16 v[52:53], v21 offset:32768
    s_nop 0
    buffer_load_dwordx4 v7, s[12:15], s17 offen lds
    v_mfma_f32_32x32x16_bf16 a[176:191], v[84:87], v[64:67], a[176:191]
    ds_read_b64_tr_b16 v[54:55], v21 offset:34816
    s_add_u32 m0, s26, 18432
    s_nop 0
    v_mfma_f32_32x32x16_bf16 a[192:207], v[72:75], v[68:71], a[192:207]
    buffer_load_dwordx4 v8, s[12:15], s17 offen lds
    s_add_u32 m0, s26, 19456
    v_mfma_f32_32x32x16_bf16 a[208:223], v[76:79], v[68:71], a[208:223]
    s_nop 0
    buffer_load_dwordx4 v9, s[12:15], s17 offen lds
    v_mfma_f32_32x32x16_bf16 a[224:239], v[80:83], v[68:71], a[224:239]
    s_add_u32 s16, s16, s27
    s_add_u32 s17, s17, s28
    v_mfma_f32_32x32x16_bf16 a[240:255], v[84:87], v[68:71], a[240:255]
    s_waitcnt lgkmcnt(0)
    v_mfma_f32_32x32x16_bf16 a[0:15], v[40:43], v[24:27], a[0:15]
    ds_read_b128 v[56:59], v13 offset:32768
    v_mfma_f32_32x32x16_bf16 a[16:31], v[44:47], v[24:27], a[16:31]
    ds_read_b128 v[60:63], v13 offset:34816
    v_mfma_f32_32x32x16_bf16 a[32:47], v[48:51], v[24:27], a[32:47]
    ds_read_b128 v[64:67], v13 offset:36864
    v_mfma_f32_32x32x16_bf16 a[48:63], v[52:55], v[24:27], a[48:63]
    ds_read_b128 v[68:71], v13 offset:38912
    v_mfma_f32_32x32x16_bf16 a[64:79], v[40:43], v[28:31], a[64:79]
    ds_read_b64_tr_b16 v[72:73], v18 offset:40960
    v_mfma_f32_32x32x16_bf16 a[80:95], v[44:47], v[28:31], a[80:95]
    ds_read_b64_tr_b16 v[74:75], v18 offset:43008
    v_mfma_f32_32x32x16_bf16 a[96:111], v[48:51], v[28:31], a[96:111]
    ds_read_b64_tr_b16 v[76:77], v19 offset:40960
    v_mfma_f32_32x32x16_bf16 a[112:127], v[52:55], v[28:31], a[112:127]
    ds_read_b64_tr_b16 v[78:79], v19 offset:43008
    v_mfma_f32_32x32x16_bf16 a[128:143], v[40:43], v[32:35], a[128:143]
    ds_read_b64_tr_b16 v[80:81], v20 offset:40960
    v_mfma_f32_32x32x16_bf16 a[144:159], v[44:47], v[32:35], a[144:159]
    ds_read_b64_tr_b16 v[82:83], v20 offset:43008
    v_mfma_f32_32x32x16_bf16 a[160:175], v[48:51], v[32:35], a[160:175]
    ds_read_b64_tr_b16 v[84:85], v21 offset:40960
    v_mfma_f32_32x32x16_bf16 a[176:191], v[52:55], v[32:35], a[176:191]
    ds_read_b64_tr_b16 v[86:87], v21 offset:43008
    v_mfma_f32_32x32x16_bf16 a[192:207], v[40:43], v[36:39], a[192:207]
    v_mfma_f32_32x32x16_bf16 a[208:223], v[44:47], v[36:39], a[208:223]
    v_mfma_f32_32x32x16_bf16 a[224:239], v[48:51], v[36:39], a[224:239]
    v_mfma_f32_32x32x16_bf16 a[240:255], v[52:55], v[36:39], a[240:255]
    s_waitcnt vmcnt(8)
    s_waitcnt lgkmcnt(0)
    s_barrier
    s_add_u32 s26, s25, 65536
    v_mfma_f32_32x32x16_bf16 a[0:15], v[72:75], v[56:59], a[0:15]
    ds_read_b128 v[24:27], v10 offset:0
    v_mfma_f32_32x32x16_bf16 a[16:31], v[76:79], v[56:59], a[16:31]
    ds_read_b128 v[28:31], v10 offset:2048
    v_mfma_f32_32x32x16_bf16 a[32:47], v[80:83], v[56:59], a[32:47]
    ds_read_b128 v[32:35], v10 offset:4096
    s_add_u32 m0, s26, 0
    s_nop 0
    v_mfma_f32_32x32x16_bf16 a[48:63], v[84:87], v[56:59], a[48:63]
    ds_read_b128 v[36:39], v10 offset:6144
    buffer_load_dwordx4 v2, s[8:11], s16 offen lds
    s_add_u32 m0, s26, 1024
    v_mfma_f32_32x32x16_bf16 a[64:79], v[72:75], v[60:63], a[64:79]
    ds_read_b64_tr_b16 v[40:41], v14 offset:0
    s_nop 0
    buffer_load_dwordx4 v3, s[8:11], s16 offen lds
    v_mfma_f32_32x32x16_bf16 a[80:95], v[76:79], v[60:63], a[80:95]
    ds_read_b64_tr_b16 v[42:43], v14 offset:2048
    s_add_u32 m0, s26, 2048
    s_nop 0
    v_mfma_f32_32x32x16_bf16 a[96:111], v[80:83], v[60:63], a[96:111]
    ds_read_b64_tr_b16 v[44:45], v15 offset:0
    buffer_load_dwordx4 v4, s[8:11], s16 offen lds
    s_add_u32 m0, s26, 3072
    v_mfma_f32_32x32x16_bf16 a[112:127], v[84:87], v[60:63], a[112:127]
    ds_read_b64_tr_b16 v[46:47], v15 offset:2048
    s_nop 0
    buffer_load_dwordx4 v5, s[8:11], s16 offen lds
    v_mfma_f32_32x32x16_bf16 a[128:143], v[72:75], v[64:67], a[128:143]
    ds_read_b64_tr_b16 v[48:49], v16 offset:0
    s_add_u32 m0, s26, 16384
    s_nop 0
    v_mfma_f32_32x32x16_bf16 a[144:159], v[76:79], v[64:67], a[144:159]
    ds_read_b64_tr_b16 v[50:51], v16 offset:2048
    buffer_load_dwordx4 v6, s[12:15], s17 offen lds
    s_add_u32 m0, s26, 17408
    v_mfma_f32_32x32x16_bf16 a[160:175], v[80:83], v[64:67], a[160:175]
    ds_read_b64_tr_b16 v[52:53], v17 offset:0
    s_nop 0
    buffer_load_dwordx4 v7, s[12:15], s17 offen lds
    v_mfma_f32_32x32x16_bf16 a[176:191], v[84:87], v[64:67], a[176:191]
    ds_read_b64_tr_b16 v[54:55], v17 offset:2048
    s_add_u32 m0, s26, 18432
    s_nop 0
    v_mfma_f32_32x32x16_bf16 a[192:207], v[72:75], v[68:71], a[192:207]
    buffer_load_dwordx4 v8, s[12:15], s17 offen lds
    s_add_u32 m0, s26, 19456
    v_mfma_f32_32x32x16_bf16 a[208:223], v[76:79], v[68:71], a[208:223]
    s_nop 0
    buffer_load_dwordx4 v9, s[12:15], s17 offen lds
    v_mfma_f32_32x32x16_bf16 a[224:239], v[80:83], v[68:71], a[224:239]
    s_add_u32 s16, s16, s27
    s_add_u32 s17, s17, s28
    v_mfma_f32_32x32x16_bf16 a[240:255], v[84:87], v[68:71], a[240:255]
    s_add_u32 s21, s21, 4
    s_cmp_lt_u32 s21, s20
    s_cbranch_scc1 L_gemm_f2
    s_waitcnt vmcnt(0) lgkmcnt(0)
    s_nop 15
    s_barrier
    s_lshl_b32 s38, s35, 19
    s_lshl_b32 s39, s37, 10
    s_add_u32 s38, s38, s39
    s_lshl_b32 s39, s53, 22
    s_add_u32 s38, s38, s39
    s_add_u32 s38, s38, 100663296
    s_add_u32 s42, s32, s38
    s_addc_u32 s43, s33, 0
    s_lshl_b32 s25, s22, 15
    v_and_b32 v88, 31, v1
    v_lshlrev_b32 v90, 9, v88
    v_add_u32 v90, s25, v90
    v_lshrrev_b32 v89, 5, v1
    v_xor_b32 v89, v89, v88
    v_lshlrev_b32 v91, 4, v1
    v_add_u32 v91, s25, v91
    v_lshrrev_b32 v88, 5, v1
    s_lshr_b32 s23, s22, 1
    s_lshl_b32 s23, s23, 7
    v_add_u32 v92, s23, v88
    v_lshlrev_b32 v92, 11, v92
    s_and_b32 s23, s22, 1
    s_lshl_b32 s23, s23, 9
    v_add_u32 v92, s23, v92
    v_and_b32 v93, 31, v1
    v_xor_b32 v93, v93, v88
    v_accvgpr_read_b32 v24, a0
    v_accvgpr_read_b32 v25, a1
    v_accvgpr_read_b32 v26, a2
    v_accvgpr_read_b32 v27, a3
    v_accvgpr_read_b32 v28, a4
    v_accvgpr_read_b32 v29, a5
    v_accvgpr_read_b32 v30, a6
    v_accvgpr_read_b32 v31, a7
    v_accvgpr_read_b32 v32, a8
    v_accvgpr_read_b32 v33, a9
    v_accvgpr_read_b32 v34, a10
    v_accvgpr_read_b32 v35, a11
    v_accvgpr_read_b32 v36, a12
    v_accvgpr_read_b32 v37, a13
    v_accvgpr_read_b32 v38, a14
    v_accvgpr_read_b32 v39, a15
    v_xor_b32 v94, 0, v89
    v_lshl_add_u32 v94, v94, 4, v90
    ds_write_b128 v94, v[24:27] offset:0
    v_xor_b32 v94, 2, v89
    v_lshl_add_u32 v94, v94, 4, v90
    ds_write_b128 v94, v[28:31] offset:0
    v_xor_b32 v94, 4, v89
    v_lshl_add_u32 v94, v94, 4, v90
    ds_write_b128 v94, v[32:35] offset:0
    v_xor_b32 v94, 6, v89
    v_lshl_add_u32 v94, v94, 4, v90
    ds_write_b128 v94, v[36:39] offset:0
    v_accvgpr_read_b32 v40, a16
    v_accvgpr_read_b32 v41, a17
    v_accvgpr_read_b32 v42, a18
    v_accvgpr_read_b32 v43, a19
    v_accvgpr_read_b32 v44, a20
    v_accvgpr_read_b32 v45, a21
    v_accvgpr_read_b32 v46, a22
    v_accvgpr_read_b32 v47, a23
    v_accvgpr_read_b32 v48, a24
    v_accvgpr_read_b32 v49, a25
    v_accvgpr_read_b32 v50, a26
    v_accvgpr_read_b32 v51, a27
    v_accvgpr_read_b32 v52, a28
    v_accvgpr_read_b32 v53, a29
    v_accvgpr_read_b32 v54, a30
    v_accvgpr_read_b32 v55, a31
    v_xor_b32 v94, 8, v89
    v_lshl_add_u32 v94, v94, 4, v90
    ds_write_b128 v94, v[40:43] offset:0
    v_xor_b32 v94, 10, v89
    v_lshl_add_u32 v94, v94, 4, v90
    ds_write_b128 v94, v[44:47] offset:0
    v_xor_b32 v94, 12, v89
    v_lshl_add_u32 v94, v94, 4, v90
    ds_write_b128 v94, v[48:51] offset:0
    v_xor_b32 v94, 14, v89
    v_lshl_add_u32 v94, v94, 4, v90
    ds_write_b128 v94, v[52:55] offset:0
    v_accvgpr_read_b32 v24, a32
    v_accvgpr_read_b32 v25, a33
    v_accvgpr_read_b32 v26, a34
    v_accvgpr_read_b32 v27, a35
    v_accvgpr_read_b32 v28, a36
    v_accvgpr_read_b32 v29, a37
    v_accvgpr_read_b32 v30, a38
    v_accvgpr_read_b32 v31, a39
    v_accvgpr_read_b32 v32, a40
    v_accvgpr_read_b32 v33, a41
    v_accvgpr_read_b32 v34, a42
    v_accvgpr_read_b32 v35, a43
    v_accvgpr_read_b32 v36, a44
    v_accvgpr_read_b32 v37, a45
    v_accvgpr_read_b32 v38, a46
    v_accvgpr_read_b32 v39, a47
    v_xor_b32 v94, 16, v89
    v_lshl_add_u32 v94, v94, 4, v90
    ds_write_b128 v94, v[24:27] offset:0
    v_xor_b32 v94, 18, v89
    v_lshl_add_u32 v94, v94, 4, v90
    ds_write_b128 v94, v[28:31] offset:0
    v_xor_b32 v94, 20, v89
    v_lshl_add_u32 v94, v94, 4, v90
    ds_write_b128 v94, v[32:35] offset:0
    v_xor_b32 v94, 22, v89
    v_lshl_add_u32 v94, v94, 4, v90
    ds_write_b128 v94, v[36:39] offset:0
    v_accvgpr_read_b32 v40, a48
    v_accvgpr_read_b32 v41, a49
    v_accvgpr_read_b32 v42, a50
    v_accvgpr_read_b32 v43, a51
    v_accvgpr_read_b32 v44, a52
    v_accvgpr_read_b32 v45, a53
    v_accvgpr_read_b32 v46, a54
    v_accvgpr_read_b32 v47, a55
    v_accvgpr_read_b32 v48, a56
    v_accvgpr_read_b32 v49, a57
    v_accvgpr_read_b32 v50, a58
    v_accvgpr_read_b32 v51, a59
    v_accvgpr_read_b32 v52, a60
    v_accvgpr_read_b32 v53, a61
    v_accvgpr_read_b32 v54, a62
    v_accvgpr_read_b32 v55, a63
    v_xor_b32 v94, 24, v89
    v_lshl_add_u32 v94, v94, 4, v90
    ds_write_b128 v94, v[40:43] offset:0
    v_xor_b32 v94, 26, v89
    v_lshl_add_u32 v94, v94, 4, v90
    ds_write_b128 v94, v[44:47] offset:0
    v_xor_b32 v94, 28, v89
    v_lshl_add_u32 v94, v94, 4, v90
    ds_write_b128 v94, v[48:51] offset:0
    v_xor_b32 v94, 30, v89
    v_lshl_add_u32 v94, v94, 4, v90
    ds_write_b128 v94, v[52:55] offset:0
    v_accvgpr_read_b32 v24, a64
    v_accvgpr_read_b32 v25, a65
    v_accvgpr_read_b32 v26, a66
    v_accvgpr_read_b32 v27, a67
    v_accvgpr_read_b32 v28, a68
    v_accvgpr_read_b32 v29, a69
    v_accvgpr_read_b32 v30, a70
    v_accvgpr_read_b32 v31, a71
    v_accvgpr_read_b32 v32, a72
    v_accvgpr_read_b32 v33, a73
    v_accvgpr_read_b32 v34, a74
    v_accvgpr_read_b32 v35, a75
    v_accvgpr_read_b32 v36, a76
    v_accvgpr_read_b32 v37, a77
    v_accvgpr_read_b32 v38, a78
    v_accvgpr_read_b32 v39, a79
    v_xor_b32 v94, 0, v89
    v_lshl_add_u32 v94, v94, 4, v90
    ds_write_b128 v94, v[24:27] offset:16384
    v_xor_b32 v94, 2, v89
    v_lshl_add_u32 v94, v94, 4, v90
    ds_write_b128 v94, v[28:31] offset:16384
    v_xor_b32 v94, 4, v89
    v_lshl_add_u32 v94, v94, 4, v90
    ds_write_b128 v94, v[32:35] offset:16384
    v_xor_b32 v94, 6, v89
    v_lshl_add_u32 v94, v94, 4, v90
    ds_write_b128 v94, v[36:39] offset:16384
    v_accvgpr_read_b32 v40, a80
    v_accvgpr_read_b32 v41, a81
    v_accvgpr_read_b32 v42, a82
    v_accvgpr_read_b32 v43, a83
    v_accvgpr_read_b32 v44, a84
    v_accvgpr_read_b32 v45, a85
    v_accvgpr_read_b32 v46, a86
    v_accvgpr_read_b32 v47, a87
    v_accvgpr_read_b32 v48, a88
    v_accvgpr_read_b32 v49, a89
    v_accvgpr_read_b32 v50, a90
    v_accvgpr_read_b32 v51, a91
    v_accvgpr_read_b32 v52, a92
    v_accvgpr_read_b32 v53, a93
    v_accvgpr_read_b32 v54, a94
    v_accvgpr_read_b32 v55, a95
    v_xor_b32 v94, 8, v89
    v_lshl_add_u32 v94, v94, 4, v90
    ds_write_b128 v94, v[40:43] offset:16384
    v_xor_b32 v94, 10, v89
    v_lshl_add_u32 v94, v94, 4, v90
    ds_write_b128 v94, v[44:47] offset:16384
    v_xor_b32 v94, 12, v89
    v_lshl_add_u32 v94, v94, 4, v90
    ds_write_b128 v94, v[48:51] offset:16384
    v_xor_b32 v94, 14, v89
    v_lshl_add_u32 v94, v94, 4, v90
    ds_write_b128 v94, v[52:55] offset:16384
    v_accvgpr_read_b32 v24, a96
    v_accvgpr_read_b32 v25, a97
    v_accvgpr_read_b32 v26, a98
    v_accvgpr_read_b32 v27, a99
    v_accvgpr_read_b32 v28, a100
    v_accvgpr_read_b32 v29, a101
    v_accvgpr_read_b32 v30, a102
    v_accvgpr_read_b32 v31, a103
    v_accvgpr_read_b32 v32, a104
    v_accvgpr_read_b32 v33, a105
    v_accvgpr_read_b32 v34, a106
    v_accvgpr_read_b32 v35, a107
    v_accvgpr_read_b32 v36, a108
    v_accvgpr_read_b32 v37, a109
    v_accvgpr_read_b32 v38, a110
    v_accvgpr_read_b32 v39, a111
    v_xor_b32 v94, 16, v89
    v_lshl_add_u32 v94, v94, 4, v90
    ds_write_b128 v94, v[24:27] offset:16384
    v_xor_b32 v94, 18, v89
    v_lshl_add_u32 v94, v94, 4, v90
    ds_write_b128 v94, v[28:31] offset:16384
    v_xor_b32 v94, 20, v89
    v_lshl_add_u32 v94, v94, 4, v90
    ds_write_b128 v94, v[32:35] offset:16384
    v_xor_b32 v94, 22, v89
    v_lshl_add_u32 v94, v94, 4, v90
    ds_write_b128 v94, v[36:39] offset:16384
    v_accvgpr_read_b32 v40, a112
    v_accvgpr_read_b32 v41, a113
    v_accvgpr_read_b32 v42, a114
    v_accvgpr_read_b32 v43, a115
    v_accvgpr_read_b32 v44, a116
    v_accvgpr_read_b32 v45, a117
    v_accvgpr_read_b32 v46, a118
    v_accvgpr_read_b32 v47, a119
    v_accvgpr_read_b32 v48, a120
    v_accvgpr_read_b32 v49, a121
    v_accvgpr_read_b32 v50, a122
    v_accvgpr_read_b32 v51, a123
    v_accvgpr_read_b32 v52, a124
    v_accvgpr_read_b32 v53, a125
    v_accvgpr_read_b32 v54, a126
    v_accvgpr_read_b32 v55, a127
    v_xor_b32 v94, 24, v89
    v_lshl_add_u32 v94, v94, 4, v90
    ds_write_b128 v94, v[40:43] offset:16384
    v_xor_b32 v94, 26, v89
    v_lshl_add_u32 v94, v94, 4, v90
    ds_write_b128 v94, v[44:47] offset:16384
    v_xor_b32 v94, 28, v89
    v_lshl_add_u32 v94, v94, 4, v90
    ds_write_b128 v94, v[48:51] offset:16384
    v_xor_b32 v94, 30, v89
    v_lshl_add_u32 v94, v94, 4, v90
    ds_write_b128 v94, v[52:55] offset:16384
    s_waitcnt lgkmcnt(0)
    ds_read_b128 v[56:59], v91 offset:0
    ds_read_b128 v[60:63], v91 offset:1024
    ds_read_b128 v[64:67], v91 offset:2048
    ds_read_b128 v[68:71], v91 offset:3072
    v_xor_b32 v95, 0, v93
    v_lshl_add_u32 v95, v95, 4, v92
    v_add_u32 v95, 0, v95
    v_xor_b32 v96, 2, v93
    v_lshl_add_u32 v96, v96, 4, v92
    v_add_u32 v96, 4096, v96
    v_xor_b32 v97, 4, v93
    v_lshl_add_u32 v97, v97, 4, v92
    v_add_u32 v97, 8192, v97
    v_xor_b32 v98, 6, v93
    v_lshl_add_u32 v98, v98, 4, v92
    v_add_u32 v98, 12288, v98
    s_waitcnt lgkmcnt(0)
    global_store_dwordx4 v95, v[56:59], s[42:43] sc1
    global_store_dwordx4 v96, v[60:63], s[42:43] sc1
    global_store_dwordx4 v97, v[64:67], s[42:43] sc1
    global_store_dwordx4 v98, v[68:71], s[42:43] sc1
    ds_read_b128 v[56:59], v91 offset:4096
    ds_read_b128 v[60:63], v91 offset:5120
    ds_read_b128 v[64:67], v91 offset:6144
    ds_read_b128 v[68:71], v91 offset:7168
    v_xor_b32 v95, 8, v93
    v_lshl_add_u32 v95, v95, 4, v92
    v_add_u32 v95, 16384, v95
    v_xor_b32 v96, 10, v93
    v_lshl_add_u32 v96, v96, 4, v92
    v_add_u32 v96, 20480, v96
    v_xor_b32 v97, 12, v93
    v_lshl_add_u32 v97, v97, 4, v92
    v_add_u32 v97, 24576, v97
    v_xor_b32 v98, 14, v93
    v_lshl_add_u32 v98, v98, 4, v92
    v_add_u32 v98, 28672, v98
    s_waitcnt lgkmcnt(0)
    global_store_dwordx4 v95, v[56:59], s[42:43] sc1
    global_store_dwordx4 v96, v[60:63], s[42:43] sc1
    global_store_dwordx4 v97, v[64:67], s[42:43] sc1
    global_store_dwordx4 v98, v[68:71], s[42:43] sc1
    ds_read_b128 v[56:59], v91 offset:8192
    ds_read_b128 v[60:63], v91 offset:9216
    ds_read_b128 v[64:67], v91 offset:10240
    ds_read_b128 v[68:71], v91 offset:11264
    v_xor_b32 v95, 16, v93
    v_lshl_add_u32 v95, v95, 4, v92
    v_add_u32 v95, 32768, v95
    v_xor_b32 v96, 18, v93
    v_lshl_add_u32 v96, v96, 4, v92
    v_add_u32 v96, 36864, v96
    v_xor_b32 v97, 20, v93
    v_lshl_add_u32 v97, v97, 4, v92
    v_add_u32 v97, 40960, v97
    v_xor_b32 v98, 22, v93
    v_lshl_add_u32 v98, v98, 4, v92
    v_add_u32 v98, 45056, v98
    s_waitcnt lgkmcnt(0)
    global_store_dwordx4 v95, v[56:59], s[42:43] sc1
    global_store_dwordx4 v96, v[60:63], s[42:43] sc1
    global_store_dwordx4 v97, v[64:67], s[42:43] sc1
    global_store_dwordx4 v98, v[68:71], s[42:43] sc1
    ds_read_b128 v[56:59], v91 offset:12288
    ds_read_b128 v[60:63], v91 offset:13312
    ds_read_b128 v[64:67], v91 offset:14336
    ds_read_b128 v[68:71], v91 offset:15360
    v_xor_b32 v95, 24, v93
    v_lshl_add_u32 v95, v95, 4, v92
    v_add_u32 v95, 49152, v95
    v_xor_b32 v96, 26, v93
    v_lshl_add_u32 v96, v96, 4, v92
    v_add_u32 v96, 53248, v96
    v_xor_b32 v97, 28, v93
    v_lshl_add_u32 v97, v97, 4, v92
    v_add_u32 v97, 57344, v97
    v_xor_b32 v98, 30, v93
    v_lshl_add_u32 v98, v98, 4, v92
    v_add_u32 v98, 61440, v98
    s_waitcnt lgkmcnt(0)
    global_store_dwordx4 v95, v[56:59], s[42:43] sc1
    global_store_dwordx4 v96, v[60:63], s[42:43] sc1
    global_store_dwordx4 v97, v[64:67], s[42:43] sc1
    global_store_dwordx4 v98, v[68:71], s[42:43] sc1
    ds_read_b128 v[56:59], v91 offset:16384
    ds_read_b128 v[60:63], v91 offset:17408
    ds_read_b128 v[64:67], v91 offset:18432
    ds_read_b128 v[68:71], v91 offset:19456
    v_xor_b32 v95, 0, v93
    v_lshl_add_u32 v95, v95, 4, v92
    v_add_u32 v95, 65536, v95
    v_xor_b32 v96, 2, v93
    v_lshl_add_u32 v96, v96, 4, v92
    v_add_u32 v96, 69632, v96
    v_xor_b32 v97, 4, v93
    v_lshl_add_u32 v97, v97, 4, v92
    v_add_u32 v97, 73728, v97
    v_xor_b32 v98, 6, v93
    v_lshl_add_u32 v98, v98, 4, v92
    v_add_u32 v98, 77824, v98
    s_waitcnt lgkmcnt(0)
    global_store_dwordx4 v95, v[56:59], s[42:43] sc1
    global_store_dwordx4 v96, v[60:63], s[42:43] sc1
    global_store_dwordx4 v97, v[64:67], s[42:43] sc1
    global_store_dwordx4 v98, v[68:71], s[42:43] sc1
    ds_read_b128 v[56:59], v91 offset:20480
    ds_read_b128 v[60:63], v91 offset:21504
    ds_read_b128 v[64:67], v91 offset:22528
    ds_read_b128 v[68:71], v91 offset:23552
    v_xor_b32 v95, 8, v93
    v_lshl_add_u32 v95, v95, 4, v92
    v_add_u32 v95, 81920, v95
    v_xor_b32 v96, 10, v93
    v_lshl_add_u32 v96, v96, 4, v92
    v_add_u32 v96, 86016, v96
    v_xor_b32 v97, 12, v93
    v_lshl_add_u32 v97, v97, 4, v92
    v_add_u32 v97, 90112, v97
    v_xor_b32 v98, 14, v93
    v_lshl_add_u32 v98, v98, 4, v92
    v_add_u32 v98, 94208, v98
    s_waitcnt lgkmcnt(0)
    global_store_dwordx4 v95, v[56:59], s[42:43] sc1
    global_store_dwordx4 v96, v[60:63], s[42:43] sc1
    global_store_dwordx4 v97, v[64:67], s[42:43] sc1
    global_store_dwordx4 v98, v[68:71], s[42:43] sc1
    ds_read_b128 v[56:59], v91 offset:24576
    ds_read_b128 v[60:63], v91 offset:25600
    ds_read_b128 v[64:67], v91 offset:26624
    ds_read_b128 v[68:71], v91 offset:27648
    v_xor_b32 v95, 16, v93
    v_lshl_add_u32 v95, v95, 4, v92
    v_add_u32 v95, 98304, v95
    v_xor_b32 v96, 18, v93
    v_lshl_add_u32 v96, v96, 4, v92
    v_add_u32 v96, 102400, v96
    v_xor_b32 v97, 20, v93
    v_lshl_add_u32 v97, v97, 4, v92
    v_add_u32 v97, 106496, v97
    v_xor_b32 v98, 22, v93
    v_lshl_add_u32 v98, v98, 4, v92
    v_add_u32 v98, 110592, v98
    s_waitcnt lgkmcnt(0)
    global_store_dwordx4 v95, v[56:59], s[42:43] sc1
    global_store_dwordx4 v96, v[60:63], s[42:43] sc1
    global_store_dwordx4 v97, v[64:67], s[42:43] sc1
    global_store_dwordx4 v98, v[68:71], s[42:43] sc1
    ds_read_b128 v[56:59], v91 offset:28672
    ds_read_b128 v[60:63], v91 offset:29696
    ds_read_b128 v[64:67], v91 offset:30720
    ds_read_b128 v[68:71], v91 offset:31744
    v_xor_b32 v95, 24, v93
    v_lshl_add_u32 v95, v95, 4, v92
    v_add_u32 v95, 114688, v95
    v_xor_b32 v96, 26, v93
    v_lshl_add_u32 v96, v96, 4, v92
    v_add_u32 v96, 118784, v96
    v_xor_b32 v97, 28, v93
    v_lshl_add_u32 v97, v97, 4, v92
    v_add_u32 v97, 122880, v97
    v_xor_b32 v98, 30, v93
    v_lshl_add_u32 v98, v98, 4, v92
    v_add_u32 v98, 126976, v98
    s_waitcnt lgkmcnt(0)
    global_store_dwordx4 v95, v[56:59], s[42:43] sc1
    global_store_dwordx4 v96, v[60:63], s[42:43] sc1
    global_store_dwordx4 v97, v[64:67], s[42:43] sc1
    global_store_dwordx4 v98, v[68:71], s[42:43] sc1
    s_nop 1
    v_accvgpr_read_b32 v24, a128
    v_accvgpr_read_b32 v25, a129
    v_accvgpr_read_b32 v26, a130
    v_accvgpr_read_b32 v27, a131
    v_accvgpr_read_b32 v28, a132
    v_accvgpr_read_b32 v29, a133
    v_accvgpr_read_b32 v30, a134
    v_accvgpr_read_b32 v31, a135
    v_accvgpr_read_b32 v32, a136
    v_accvgpr_read_b32 v33, a137
    v_accvgpr_read_b32 v34, a138
    v_accvgpr_read_b32 v35, a139
    v_accvgpr_read_b32 v36, a140
    v_accvgpr_read_b32 v37, a141
    v_accvgpr_read_b32 v38, a142
    v_accvgpr_read_b32 v39, a143
    v_xor_b32 v94, 0, v89
    v_lshl_add_u32 v94, v94, 4, v90
    ds_write_b128 v94, v[24:27] offset:0
    v_xor_b32 v94, 2, v89
    v_lshl_add_u32 v94, v94, 4, v90
    ds_write_b128 v94, v[28:31] offset:0
    v_xor_b32 v94, 4, v89
    v_lshl_add_u32 v94, v94, 4, v90
    ds_write_b128 v94, v[32:35] offset:0
    v_xor_b32 v94, 6, v89
    v_lshl_add_u32 v94, v94, 4, v90
    ds_write_b128 v94, v[36:39] offset:0
    v_accvgpr_read_b32 v40, a144
    v_accvgpr_read_b32 v41, a145
    v_accvgpr_read_b32 v42, a146
    v_accvgpr_read_b32 v43, a147
    v_accvgpr_read_b32 v44, a148
    v_accvgpr_read_b32 v45, a149
    v_accvgpr_read_b32 v46, a150
    v_accvgpr_read_b32 v47, a151
    v_accvgpr_read_b32 v48, a152
    v_accvgpr_read_b32 v49, a153
    v_accvgpr_read_b32 v50, a154
    v_accvgpr_read_b32 v51, a155
    v_accvgpr_read_b32 v52, a156
    v_accvgpr_read_b32 v53, a157
    v_accvgpr_read_b32 v54, a158
    v_accvgpr_read_b32 v55, a159
    v_xor_b32 v94, 8, v89
    v_lshl_add_u32 v94, v94, 4, v90
    ds_write_b128 v94, v[40:43] offset:0
    v_xor_b32 v94, 10, v89
    v_lshl_add_u32 v94, v94, 4, v90
    ds_write_b128 v94, v[44:47] offset:0
    v_xor_b32 v94, 12, v89
    v_lshl_add_u32 v94, v94, 4, v90
    ds_write_b128 v94, v[48:51] offset:0
    v_xor_b32 v94, 14, v89
    v_lshl_add_u32 v94, v94, 4, v90
    ds_write_b128 v94, v[52:55] offset:0
    v_accvgpr_read_b32 v24, a160
    v_accvgpr_read_b32 v25, a161
    v_accvgpr_read_b32 v26, a162
    v_accvgpr_read_b32 v27, a163
    v_accvgpr_read_b32 v28, a164
    v_accvgpr_read_b32 v29, a165
    v_accvgpr_read_b32 v30, a166
    v_accvgpr_read_b32 v31, a167
    v_accvgpr_read_b32 v32, a168
    v_accvgpr_read_b32 v33, a169
    v_accvgpr_read_b32 v34, a170
    v_accvgpr_read_b32 v35, a171
    v_accvgpr_read_b32 v36, a172
    v_accvgpr_read_b32 v37, a173
    v_accvgpr_read_b32 v38, a174
    v_accvgpr_read_b32 v39, a175
    v_xor_b32 v94, 16, v89
    v_lshl_add_u32 v94, v94, 4, v90
    ds_write_b128 v94, v[24:27] offset:0
    v_xor_b32 v94, 18, v89
    v_lshl_add_u32 v94, v94, 4, v90
    ds_write_b128 v94, v[28:31] offset:0
    v_xor_b32 v94, 20, v89
    v_lshl_add_u32 v94, v94, 4, v90
    ds_write_b128 v94, v[32:35] offset:0
    v_xor_b32 v94, 22, v89
    v_lshl_add_u32 v94, v94, 4, v90
    ds_write_b128 v94, v[36:39] offset:0
    v_accvgpr_read_b32 v40, a176
    v_accvgpr_read_b32 v41, a177
    v_accvgpr_read_b32 v42, a178
    v_accvgpr_read_b32 v43, a179
    v_accvgpr_read_b32 v44, a180
    v_accvgpr_read_b32 v45, a181
    v_accvgpr_read_b32 v46, a182
    v_accvgpr_read_b32 v47, a183
    v_accvgpr_read_b32 v48, a184
    v_accvgpr_read_b32 v49, a185
    v_accvgpr_read_b32 v50, a186
    v_accvgpr_read_b32 v51, a187
    v_accvgpr_read_b32 v52, a188
    v_accvgpr_read_b32 v53, a189
    v_accvgpr_read_b32 v54, a190
    v_accvgpr_read_b32 v55, a191
    v_xor_b32 v94, 24, v89
    v_lshl_add_u32 v94, v94, 4, v90
    ds_write_b128 v94, v[40:43] offset:0
    v_xor_b32 v94, 26, v89
    v_lshl_add_u32 v94, v94, 4, v90
    ds_write_b128 v94, v[44:47] offset:0
    v_xor_b32 v94, 28, v89
    v_lshl_add_u32 v94, v94, 4, v90
    ds_write_b128 v94, v[48:51] offset:0
    v_xor_b32 v94, 30, v89
    v_lshl_add_u32 v94, v94, 4, v90
    ds_write_b128 v94, v[52:55] offset:0
    v_accvgpr_read_b32 v24, a192
    v_accvgpr_read_b32 v25, a193
    v_accvgpr_read_b32 v26, a194
    v_accvgpr_read_b32 v27, a195
    v_accvgpr_read_b32 v28, a196
    v_accvgpr_read_b32 v29, a197
    v_accvgpr_read_b32 v30, a198
    v_accvgpr_read_b32 v31, a199
    v_accvgpr_read_b32 v32, a200
    v_accvgpr_read_b32 v33, a201
    v_accvgpr_read_b32 v34, a202
    v_accvgpr_read_b32 v35, a203
    v_accvgpr_read_b32 v36, a204
    v_accvgpr_read_b32 v37, a205
    v_accvgpr_read_b32 v38, a206
    v_accvgpr_read_b32 v39, a207
    v_xor_b32 v94, 0, v89
    v_lshl_add_u32 v94, v94, 4, v90
    ds_write_b128 v94, v[24:27] offset:16384
    v_xor_b32 v94, 2, v89
    v_lshl_add_u32 v94, v94, 4, v90
    ds_write_b128 v94, v[28:31] offset:16384
    v_xor_b32 v94, 4, v89
    v_lshl_add_u32 v94, v94, 4, v90
    ds_write_b128 v94, v[32:35] offset:16384
    v_xor_b32 v94, 6, v89
    v_lshl_add_u32 v94, v94, 4, v90
    ds_write_b128 v94, v[36:39] offset:16384
    v_accvgpr_read_b32 v40, a208
    v_accvgpr_read_b32 v41, a209
    v_accvgpr_read_b32 v42, a210
    v_accvgpr_read_b32 v43, a211
    v_accvgpr_read_b32 v44, a212
    v_accvgpr_read_b32 v45, a213
    v_accvgpr_read_b32 v46, a214
    v_accvgpr_read_b32 v47, a215
    v_accvgpr_read_b32 v48, a216
    v_accvgpr_read_b32 v49, a217
    v_accvgpr_read_b32 v50, a218
    v_accvgpr_read_b32 v51, a219
    v_accvgpr_read_b32 v52, a220
    v_accvgpr_read_b32 v53, a221
    v_accvgpr_read_b32 v54, a222
    v_accvgpr_read_b32 v55, a223
    v_xor_b32 v94, 8, v89
    v_lshl_add_u32 v94, v94, 4, v90
    ds_write_b128 v94, v[40:43] offset:16384
    v_xor_b32 v94, 10, v89
    v_lshl_add_u32 v94, v94, 4, v90
    ds_write_b128 v94, v[44:47] offset:16384
    v_xor_b32 v94, 12, v89
    v_lshl_add_u32 v94, v94, 4, v90
    ds_write_b128 v94, v[48:51] offset:16384
    v_xor_b32 v94, 14, v89
    v_lshl_add_u32 v94, v94, 4, v90
    ds_write_b128 v94, v[52:55] offset:16384
    v_accvgpr_read_b32 v24, a224
    v_accvgpr_read_b32 v25, a225
    v_accvgpr_read_b32 v26, a226
    v_accvgpr_read_b32 v27, a227
    v_accvgpr_read_b32 v28, a228
    v_accvgpr_read_b32 v29, a229
    v_accvgpr_read_b32 v30, a230
    v_accvgpr_read_b32 v31, a231
    v_accvgpr_read_b32 v32, a232
    v_accvgpr_read_b32 v33, a233
    v_accvgpr_read_b32 v34, a234
    v_accvgpr_read_b32 v35, a235
    v_accvgpr_read_b32 v36, a236
    v_accvgpr_read_b32 v37, a237
    v_accvgpr_read_b32 v38, a238
    v_accvgpr_read_b32 v39, a239
    v_xor_b32 v94, 16, v89
    v_lshl_add_u32 v94, v94, 4, v90
    ds_write_b128 v94, v[24:27] offset:16384
    v_xor_b32 v94, 18, v89
    v_lshl_add_u32 v94, v94, 4, v90
    ds_write_b128 v94, v[28:31] offset:16384
    v_xor_b32 v94, 20, v89
    v_lshl_add_u32 v94, v94, 4, v90
    ds_write_b128 v94, v[32:35] offset:16384
    v_xor_b32 v94, 22, v89
    v_lshl_add_u32 v94, v94, 4, v90
    ds_write_b128 v94, v[36:39] offset:16384
    v_accvgpr_read_b32 v40, a240
    v_accvgpr_read_b32 v41, a241
    v_accvgpr_read_b32 v42, a242
    v_accvgpr_read_b32 v43, a243
    v_accvgpr_read_b32 v44, a244
    v_accvgpr_read_b32 v45, a245
    v_accvgpr_read_b32 v46, a246
    v_accvgpr_read_b32 v47, a247
    v_accvgpr_read_b32 v48, a248
    v_accvgpr_read_b32 v49, a249
    v_accvgpr_read_b32 v50, a250
    v_accvgpr_read_b32 v51, a251
    v_accvgpr_read_b32 v52, a252
    v_accvgpr_read_b32 v53, a253
    v_accvgpr_read_b32 v54, a254
    v_accvgpr_read_b32 v55, a255
    v_xor_b32 v94, 24, v89
    v_lshl_add_u32 v94, v94, 4, v90
    ds_write_b128 v94, v[40:43] offset:16384
    v_xor_b32 v94, 26, v89
    v_lshl_add_u32 v94, v94, 4, v90
    ds_write_b128 v94, v[44:47] offset:16384
    v_xor_b32 v94, 28, v89
    v_lshl_add_u32 v94, v94, 4, v90
    ds_write_b128 v94, v[48:51] offset:16384
    v_xor_b32 v94, 30, v89
    v_lshl_add_u32 v94, v94, 4, v90
    ds_write_b128 v94, v[52:55] offset:16384
    s_waitcnt lgkmcnt(0)
    ds_read_b128 v[56:59], v91 offset:0
    ds_read_b128 v[60:63], v91 offset:1024
    ds_read_b128 v[64:67], v91 offset:2048
    ds_read_b128 v[68:71], v91 offset:3072
    v_xor_b32 v95, 0, v93
    v_lshl_add_u32 v95, v95, 4, v92
    v_add_u32 v95, 131072, v95
    v_xor_b32 v96, 2, v93
    v_lshl_add_u32 v96, v96, 4, v92
    v_add_u32 v96, 135168, v96
    v_xor_b32 v97, 4, v93
    v_lshl_add_u32 v97, v97, 4, v92
    v_add_u32 v97, 139264, v97
    v_xor_b32 v98, 6, v93
    v_lshl_add_u32 v98, v98, 4, v92
    v_add_u32 v98, 143360, v98
    s_waitcnt lgkmcnt(0)
    global_store_dwordx4 v95, v[56:59], s[42:43] sc1
    global_store_dwordx4 v96, v[60:63], s[42:43] sc1
    global_store_dwordx4 v97, v[64:67], s[42:43] sc1
    global_store_dwordx4 v98, v[68:71], s[42:43] sc1
    ds_read_b128 v[56:59], v91 offset:4096
    ds_read_b128 v[60:63], v91 offset:5120
    ds_read_b128 v[64:67], v91 offset:6144
    ds_read_b128 v[68:71], v91 offset:7168
    v_xor_b32 v95, 8, v93
    v_lshl_add_u32 v95, v95, 4, v92
    v_add_u32 v95, 147456, v95
    v_xor_b32 v96, 10, v93
    v_lshl_add_u32 v96, v96, 4, v92
    v_add_u32 v96, 151552, v96
    v_xor_b32 v97, 12, v93
    v_lshl_add_u32 v97, v97, 4, v92
    v_add_u32 v97, 155648, v97
    v_xor_b32 v98, 14, v93
    v_lshl_add_u32 v98, v98, 4, v92
    v_add_u32 v98, 159744, v98
    s_waitcnt lgkmcnt(0)
    global_store_dwordx4 v95, v[56:59], s[42:43] sc1
    global_store_dwordx4 v96, v[60:63], s[42:43] sc1
    global_store_dwordx4 v97, v[64:67], s[42:43] sc1
    global_store_dwordx4 v98, v[68:71], s[42:43] sc1
    ds_read_b128 v[56:59], v91 offset:8192
    ds_read_b128 v[60:63], v91 offset:9216
    ds_read_b128 v[64:67], v91 offset:10240
    ds_read_b128 v[68:71], v91 offset:11264
    v_xor_b32 v95, 16, v93
    v_lshl_add_u32 v95, v95, 4, v92
    v_add_u32 v95, 163840, v95
    v_xor_b32 v96, 18, v93
    v_lshl_add_u32 v96, v96, 4, v92
    v_add_u32 v96, 167936, v96
    v_xor_b32 v97, 20, v93
    v_lshl_add_u32 v97, v97, 4, v92
    v_add_u32 v97, 172032, v97
    v_xor_b32 v98, 22, v93
    v_lshl_add_u32 v98, v98, 4, v92
    v_add_u32 v98, 176128, v98
    s_waitcnt lgkmcnt(0)
    global_store_dwordx4 v95, v[56:59], s[42:43] sc1
    global_store_dwordx4 v96, v[60:63], s[42:43] sc1
    global_store_dwordx4 v97, v[64:67], s[42:43] sc1
    global_store_dwordx4 v98, v[68:71], s[42:43] sc1
    ds_read_b128 v[56:59], v91 offset:12288
    ds_read_b128 v[60:63], v91 offset:13312
    ds_read_b128 v[64:67], v91 offset:14336
    ds_read_b128 v[68:71], v91 offset:15360
    v_xor_b32 v95, 24, v93
    v_lshl_add_u32 v95, v95, 4, v92
    v_add_u32 v95, 180224, v95
    v_xor_b32 v96, 26, v93
    v_lshl_add_u32 v96, v96, 4, v92
    v_add_u32 v96, 184320, v96
    v_xor_b32 v97, 28, v93
    v_lshl_add_u32 v97, v97, 4, v92
    v_add_u32 v97, 188416, v97
    v_xor_b32 v98, 30, v93
    v_lshl_add_u32 v98, v98, 4, v92
    v_add_u32 v98, 192512, v98
    s_waitcnt lgkmcnt(0)
    global_store_dwordx4 v95, v[56:59], s[42:43] sc1
    global_store_dwordx4 v96, v[60:63], s[42:43] sc1
    global_store_dwordx4 v97, v[64:67], s[42:43] sc1
    global_store_dwordx4 v98, v[68:71], s[42:43] sc1
    ds_read_b128 v[56:59], v91 offset:16384
    ds_read_b128 v[60:63], v91 offset:17408
    ds_read_b128 v[64:67], v91 offset:18432
    ds_read_b128 v[68:71], v91 offset:19456
    v_xor_b32 v95, 0, v93
    v_lshl_add_u32 v95, v95, 4, v92
    v_add_u32 v95, 196608, v95
    v_xor_b32 v96, 2, v93
    v_lshl_add_u32 v96, v96, 4, v92
    v_add_u32 v96, 200704, v96
    v_xor_b32 v97, 4, v93
    v_lshl_add_u32 v97, v97, 4, v92
    v_add_u32 v97, 204800, v97
    v_xor_b32 v98, 6, v93
    v_lshl_add_u32 v98, v98, 4, v92
    v_add_u32 v98, 208896, v98
    s_waitcnt lgkmcnt(0)
    global_store_dwordx4 v95, v[56:59], s[42:43] sc1
    global_store_dwordx4 v96, v[60:63], s[42:43] sc1
    global_store_dwordx4 v97, v[64:67], s[42:43] sc1
    global_store_dwordx4 v98, v[68:71], s[42:43] sc1
    ds_read_b128 v[56:59], v91 offset:20480
    ds_read_b128 v[60:63], v91 offset:21504
    ds_read_b128 v[64:67], v91 offset:22528
    ds_read_b128 v[68:71], v91 offset:23552
    v_xor_b32 v95, 8, v93
    v_lshl_add_u32 v95, v95, 4, v92
    v_add_u32 v95, 212992, v95
    v_xor_b32 v96, 10, v93
    v_lshl_add_u32 v96, v96, 4, v92
    v_add_u32 v96, 217088, v96
    v_xor_b32 v97, 12, v93
    v_lshl_add_u32 v97, v97, 4, v92
    v_add_u32 v97, 221184, v97
    v_xor_b32 v98, 14, v93
    v_lshl_add_u32 v98, v98, 4, v92
    v_add_u32 v98, 225280, v98
    s_waitcnt lgkmcnt(0)
    global_store_dwordx4 v95, v[56:59], s[42:43] sc1
    global_store_dwordx4 v96, v[60:63], s[42:43] sc1
    global_store_dwordx4 v97, v[64:67], s[42:43] sc1
    global_store_dwordx4 v98, v[68:71], s[42:43] sc1
    ds_read_b128 v[56:59], v91 offset:24576
    ds_read_b128 v[60:63], v91 offset:25600
    ds_read_b128 v[64:67], v91 offset:26624
    ds_read_b128 v[68:71], v91 offset:27648
    v_xor_b32 v95, 16, v93
    v_lshl_add_u32 v95, v95, 4, v92
    v_add_u32 v95, 229376, v95
    v_xor_b32 v96, 18, v93
    v_lshl_add_u32 v96, v96, 4, v92
    v_add_u32 v96, 233472, v96
    v_xor_b32 v97, 20, v93
    v_lshl_add_u32 v97, v97, 4, v92
    v_add_u32 v97, 237568, v97
    v_xor_b32 v98, 22, v93
    v_lshl_add_u32 v98, v98, 4, v92
    v_add_u32 v98, 241664, v98
    s_waitcnt lgkmcnt(0)
    global_store_dwordx4 v95, v[56:59], s[42:43] sc1
    global_store_dwordx4 v96, v[60:63], s[42:43] sc1
    global_store_dwordx4 v97, v[64:67], s[42:43] sc1
    global_store_dwordx4 v98, v[68:71], s[42:43] sc1
    ds_read_b128 v[56:59], v91 offset:28672
    ds_read_b128 v[60:63], v91 offset:29696
    ds_read_b128 v[64:67], v91 offset:30720
    ds_read_b128 v[68:71], v91 offset:31744
    v_xor_b32 v95, 24, v93
    v_lshl_add_u32 v95, v95, 4, v92
    v_add_u32 v95, 245760, v95
    v_xor_b32 v96, 26, v93
    v_lshl_add_u32 v96, v96, 4, v92
    v_add_u32 v96, 249856, v96
    v_xor_b32 v97, 28, v93
    v_lshl_add_u32 v97, v97, 4, v92
    v_add_u32 v97, 253952, v97
    v_xor_b32 v98, 30, v93
    v_lshl_add_u32 v98, v98, 4, v92
    v_add_u32 v98, 258048, v98
    s_waitcnt lgkmcnt(0)
    global_store_dwordx4 v95, v[56:59], s[42:43] sc1
    global_store_dwordx4 v96, v[60:63], s[42:43] sc1
    global_store_dwordx4 v97, v[64:67], s[42:43] sc1
    global_store_dwordx4 v98, v[68:71], s[42:43] sc1
    s_nop 1
    s_add_u32 s51, s51, 384
    s_cmp_eq_u32 s64, 1
    s_cbranch_scc1 L_ei_sf2
    s_mov_b32 s65, 200
    s_cmp_eq_u32 s22, 0
    s_cbranch_scc0 L_wfd_eisf2
    v_mov_b32 v3, s65
    s_mov_b32 s14, 0
L_wf_eisf2:
    global_load_dword v4, v3, s[6:7] sc1
    s_waitcnt vmcnt(0)
    v_readfirstlane_b32 s15, v4
    s_add_u32 s14, s14, 1
    s_cmp_gt_u32 s14, 400000
    s_cbranch_scc1 L_wfd_eisf2
    s_cmp_ge_u32 s15, 1
    s_cbranch_scc1 L_wfd_eisf2
    s_sleep 4
    s_branch L_wf_eisf2
L_wfd_eisf2:
    s_barrier
    s_mov_b32 s64, 1
L_ei_sf2:
    s_waitcnt vmcnt(0)
    s_barrier
    v_cmp_eq_u32 vcc, 0, v0
    s_and_saveexec_b64 s[12:13], vcc
    s_cbranch_execz L_sg_f2
    v_mov_b32 v3, s51
    v_mov_b32 v4, 1
    global_atomic_add v3, v4, s[66:67]
L_sg_f2:
    s_mov_b64 exec, s[12:13]
    s_branch L_task
L_phase2:
    s_mov_b32 s65, 200
    s_cmp_eq_u32 s64, 1
    s_cbranch_scc1 L_init_seen2
    s_cmp_eq_u32 s22, 0
    s_cbranch_scc0 L_wfd_init2
    v_mov_b32 v3, s65
    s_mov_b32 s14, 0
L_wf_init2:
    global_load_dword v4, v3, s[6:7] sc1
    s_waitcnt vmcnt(0)
    v_readfirstlane_b32 s15, v4
    s_add_u32 s14, s14, 1
    s_cmp_gt_u32 s14, 400000
    s_cbranch_scc1 L_wfd_init2
    s_cmp_ge_u32 s15, 1
    s_cbranch_scc1 L_wfd_init2
    s_sleep 4
    s_branch L_wf_init2
L_wfd_init2:
    s_barrier
L_init_seen2:
L_p2_wait:
    s_cmp_eq_u32 s22, 0
    s_cbranch_scc0 L_p2_bar
    s_mov_b32 s14, 0
L_p2_poll:
    v_mov_b32 v3, 128
    v_mov_b32 v4, 0
    v_mov_b32 v5, 192
    global_load_dword v7, v3, s[6:7] sc1
    s_waitcnt vmcnt(0)
    v_readfirstlane_b32 s15, v7
    s_mov_b32 s18, 0
    s_mov_b32 s16, 32
    s_cmp_ge_u32 s15, 32
    s_cbranch_scc1 L_p2_dec
    global_load_dword v8, v4, s[6:7] sc1
    global_load_dword v9, v5, s[6:7] sc1
    s_waitcnt vmcnt(0)
    v_readfirstlane_b32 s15, v7
    v_readfirstlane_b32 s16, v8
    v_readfirstlane_b32 s17, v9
    s_min_u32 s16, s16, 32
    s_mov_b32 s18, 0
    s_cmp_ge_u32 s15, 32
    s_cbranch_scc1 L_p2_dec
    s_add_u32 s14, s14, 1
    s_cmp_gt_u32 s14, 400000
    s_cbranch_scc1 L_p2_dec
    s_cmp_lt_u32 s17, 256
    s_cbranch_scc1 L_p2_sleep
    s_cmp_ge_u32 s16, 32
    s_cbranch_scc1 L_p2_sleep
    s_cmp_eq_u32 s45, 1
    s_cbranch_scc1 L_p2_sleep
    s_mov_b32 s18, 1
    s_branch L_p2_dec
L_p2_sleep:
    s_sleep 64
    s_branch L_p2_poll
L_p2_dec:
    v_mov_b32 v3, 4
    v_mov_b32 v4, s18
    v_mov_b32 v5, s16
    ds_write_b64 v3, v[4:5]
    s_waitcnt lgkmcnt(0)
L_p2_bar:
    s_barrier
    v_mov_b32 v3, 4
    ds_read_b64 v[4:5], v3
    s_waitcnt lgkmcnt(0)
    v_readfirstlane_b32 s18, v4
    v_readfirstlane_b32 s16, v5
    s_barrier
    s_cmp_eq_u32 s18, 0
    s_cbranch_scc1 L_p2_go
    s_mov_b32 s45, 1
    s_mov_b32 s46, s16
    v_cmp_eq_u32 vcc, 0, v0
    s_and_saveexec_b64 s[12:13], vcc
    s_cbranch_execz L_ba_fb
    v_mov_b32 v3, 84
    v_mov_b32 v4, 1
    global_atomic_add v5, v3, v4, s[6:7] sc0
    s_waitcnt vmcnt(0)
    v_mov_b32 v6, 0
    ds_write_b32 v6, v5
    s_waitcnt lgkmcnt(0)
L_ba_fb:
    s_mov_b64 exec, s[12:13]
    s_barrier
    v_mov_b32 v6, 0
    ds_read_b32 v5, v6
    s_waitcnt lgkmcnt(0)
    v_readfirstlane_b32 s34, v5
    s_barrier
    s_add_u32 s34, s34, s46
    s_cmp_lt_u32 s34, 32
    s_cbranch_scc1 L_chain
    s_branch L_p2_wait
L_p2_go:
    s_getreg_b32 s20, hwreg(HW_REG_XCC_ID, 0, 4)
    s_sub_u32 s21, s20, 1
    s_cmp_lt_u32 s21, 4
    s_cbranch_scc0 L_att0
    s_lshl_b32 s38, s21, 2
    s_add_u32 s38, s38, 160
    v_cmp_eq_u32 vcc, 0, v0
    s_and_saveexec_b64 s[12:13], vcc
    s_cbranch_execz L_ba_r
    v_mov_b32 v3, s38
    v_mov_b32 v4, 1
    global_atomic_add v5, v3, v4, s[6:7] sc0
    s_waitcnt vmcnt(0)
    v_mov_b32 v6, 0
    ds_write_b32 v6, v5
    s_waitcnt lgkmcnt(0)
L_ba_r:
    s_mov_b64 exec, s[12:13]
    s_barrier
    v_mov_b32 v6, 0
    ds_read_b32 v5, v6
    s_waitcnt lgkmcnt(0)
    v_readfirstlane_b32 s34, v5
    s_barrier
    s_cmp_lt_u32 s34, 32
    s_cbranch_scc0 L_att0
    s_lshl_b32 s21, s21, 5
    s_add_u32 s34, s34, s21
    s_mov_b32 s46, 0
    s_branch L_proj
L_att0:
    s_mov_b32 s43, -1
L_att:
    v_cmp_eq_u32 vcc, 0, v0
    s_and_saveexec_b64 s[12:13], vcc
    s_cbranch_execz L_ba_a
    v_mov_b32 v3, 80
    v_mov_b32 v4, 1
    global_atomic_add v5, v3, v4, s[6:7] sc0
    s_waitcnt vmcnt(0)
    v_mov_b32 v6, 0
    ds_write_b32 v6, v5
    s_waitcnt lgkmcnt(0)
L_ba_a:
    s_mov_b64 exec, s[12:13]
    s_barrier
    v_mov_b32 v6, 0
    ds_read_b32 v5, v6
    s_waitcnt lgkmcnt(0)
    v_readfirstlane_b32 s34, v5
    s_barrier
    s_cmp_ge_u32 s34, 512
    s_cbranch_scc1 L_left
    v_and_b32 v1, 63, v0
    s_lshr_b32 s35, s34, 3
    s_and_b32 s36, s34, 7
    s_lshl_b32 s36, s36, 2
    s_add_u32 s36, s36, s22
    s_lshr_b32 s37, s35, 3
    s_lshl_b32 s37, s37, 9
    s_cmp_eq_u32 s37, s43
    s_cbranch_scc1 L_qkvok
    s_mov_b32 s43, s37
    s_add_u32 s40, s32, 89141248
    s_addc_u32 s41, s33, 0
    s_cmp_eq_u32 s22, 0
    s_cbranch_scc0 L_wfd_kvw
    v_mov_b32 v3, s37
    s_mov_b32 s14, 0
L_wf_kvw:
    global_load_dword v4, v3, s[40:41] sc1
    s_waitcnt vmcnt(0)
    v_readfirstlane_b32 s15, v4
    s_add_u32 s14, s14, 1
    s_cmp_gt_u32 s14, 400000
    s_cbranch_scc1 L_wfd_kvw
    s_cmp_eq_u32 s15, 64
    s_cbranch_scc1 L_wfd_kvw
    s_sleep 32
    s_branch L_wf_kvw
L_wfd_kvw:
    s_barrier
    s_add_u32 s37, s37, 128
    s_cmp_eq_u32 s22, 0
    s_cbranch_scc0 L_wfd_qw
    v_mov_b32 v3, s37
    s_mov_b32 s14, 0
L_wf_qw:
    global_load_dword v4, v3, s[40:41] sc1
    s_waitcnt vmcnt(0)
    v_readfirstlane_b32 s15, v4
    s_add_u32 s14, s14, 1
    s_cmp_gt_u32 s14, 400000
    s_cbranch_scc1 L_wfd_qw
    s_cmp_eq_u32 s15, 32
    s_cbranch_scc1 L_wfd_qw
    s_sleep 32
    s_branch L_wf_qw
L_wfd_qw:
    s_barrier
L_qkvok:
    v_and_b32 v2, 15, v1
    v_lshrrev_b32 v3, 4, v1
    s_lshl_b32 s60, s35, 18
    s_lshl_b32 s61, s36, 13
    s_add_u32 s60, s60, s61
    s_add_u32 s62, s32, s60
    s_addc_u32 s63, s33, 0
    s_add_u32 s64, s62, 16777216
    s_addc_u32 s65, s63, 0
    s_add_u32 s66, s62, 50331648
    s_addc_u32 s67, s63, 0
    s_lshl_b32 s60, s35, 5
    s_add_u32 s60, s60, s36
    s_lshl_b32 s61, s60, 13
    s_add_u32 s61, s61, 33554432
    s_add_u32 s68, s32, s61
    s_addc_u32 s69, s33, 0
    s_lshl_b32 s61, s60, 11
    s_add_u32 s70, s61, 67108864
    s_add_u32 s70, s32, s70
    s_addc_u32 s71, s33, 0
    s_add_u32 s72, s61, 71303168
    s_add_u32 s72, s32, s72
    s_addc_u32 s73, s33, 0
    v_lshlrev_b32 v7, 4, v1
    v_add_u32 v8, 4096, v7
    v_lshlrev_b32 v9, 4, v1
    s_lshl_b32 s74, s22, 11
    global_load_dwordx4 v[24:27], v7, s[62:63] offset:0
    global_load_dwordx4 v[28:31], v7, s[62:63] offset:1024
    global_load_dwordx4 v[32:35], v7, s[62:63] offset:2048
    global_load_dwordx4 v[36:39], v7, s[62:63] offset:3072
    global_load_dwordx4 v[40:43], v8, s[62:63] offset:0
    global_load_dwordx4 v[44:47], v8, s[62:63] offset:1024
    global_load_dwordx4 v[48:51], v8, s[62:63] offset:2048
    global_load_dwordx4 v[52:55], v8, s[62:63] offset:3072
    global_load_dwordx4 v[56:59], v7, s[64:65] offset:0
    global_load_dwordx4 v[60:63], v7, s[64:65] offset:1024
    global_load_dwordx4 v[64:67], v7, s[64:65] offset:2048
    global_load_dwordx4 v[68:71], v7, s[64:65] offset:3072
    global_load_dwordx4 v[72:75], v8, s[64:65] offset:0
    global_load_dwordx4 v[76:79], v8, s[64:65] offset:1024
    global_load_dwordx4 v[80:83], v8, s[64:65] offset:2048
    global_load_dwordx4 v[84:87], v8, s[64:65] offset:3072
    v_lshlrev_b32 v11, 6, v2
    v_lshl_add_u32 v11, v3, 4, v11
    v_add_u32 v4, 4096, v11
    global_load_dwordx4 v[128:131], v11, s[68:69] offset:0
    global_load_dwordx4 v[132:135], v11, s[68:69] offset:1024
    global_load_dwordx4 v[136:139], v11, s[68:69] offset:2048
    global_load_dwordx4 v[140:143], v11, s[68:69] offset:3072
    global_load_dwordx4 v[144:147], v4, s[68:69] offset:0
    global_load_dwordx4 v[148:151], v4, s[68:69] offset:1024
    global_load_dwordx4 v[152:155], v4, s[68:69] offset:2048
    global_load_dwordx4 v[156:159], v4, s[68:69] offset:3072
    s_lshl_b32 s37, s36, 7
    s_add_u32 s38, s35, 1
    s_add_u32 s40, s32, 89137152
    s_addc_u32 s41, s33, 0
    v_mov_b32 v200, s37
    s_mov_b32 s14, 0
L_wf_prg:
    global_load_dword v201, v200, s[40:41] sc1
    s_waitcnt vmcnt(0)
    v_readfirstlane_b32 s15, v201
    s_add_u32 s14, s14, 1
    s_cmp_gt_u32 s14, 400000
    s_cbranch_scc1 L_wfd_prg
    s_cmp_ge_u32 s15, s38
    s_cbranch_scc1 L_wfd_prg
    s_add_u32 s15, s15, 2
    s_cmp_le_u32 s15, s38
    s_cbranch_scc0 L_wfs_prg
    s_sleep 48
    s_branch L_wf_prg
L_wfs_prg:
    s_sleep 4
    s_branch L_wf_prg
L_wfd_prg:
    global_load_dwordx4 v[88:91], v9, s[70:71]
    global_load_dwordx4 v[92:95], v9, s[70:71] offset:1024
    v_and_b32 v5, 1, v3
    v_lshlrev_b32 v12, 4, v2
    v_lshl_add_u32 v12, v5, 3, v12
    global_load_dwordx2 v[160:161], v12, s[72:73] offset:0
    global_load_dwordx2 v[162:163], v12, s[72:73] offset:256
    global_load_dwordx2 v[164:165], v12, s[72:73] offset:512
    global_load_dwordx2 v[166:167], v12, s[72:73] offset:768
    global_load_dwordx2 v[168:169], v12, s[72:73] offset:1024
    global_load_dwordx2 v[170:171], v12, s[72:73] offset:1280
    global_load_dwordx2 v[172:173], v12, s[72:73] offset:1536
    global_load_dwordx2 v[174:175], v12, s[72:73] offset:1792
    v_add_u32 v4, s74, v9
    s_waitcnt vmcnt(8)
    ds_write_b128 v4, v[88:91]
    ds_write_b128 v4, v[92:95] offset:1024
    v_bfe_u32 v5, v1, 2, 2
    v_lshl_add_u32 v5, v3, 3, v5
    v_lshlrev_b32 v5, 4, v5
    v_and_b32 v6, 1, v1
    v_lshl_add_u32 v5, v6, 3, v5
    v_add_u32 v10, s74, v5
    s_waitcnt lgkmcnt(0)
    ds_read_b64_tr_b16 v[88:89], v10 offset:0
    ds_read_b64_tr_b16 v[90:91], v10 offset:64
    ds_read_b64_tr_b16 v[92:93], v10 offset:512
    ds_read_b64_tr_b16 v[94:95], v10 offset:576
    ds_read_b64_tr_b16 v[96:97], v10 offset:1024
    ds_read_b64_tr_b16 v[98:99], v10 offset:1088
    ds_read_b64_tr_b16 v[100:101], v10 offset:1536
    ds_read_b64_tr_b16 v[102:103], v10 offset:1600
    s_waitcnt lgkmcnt(0)
    v_mfma_f32_16x16x32_bf16 v[104:107], v[56:59], v[24:27], 0
    v_mfma_f32_16x16x32_bf16 v[104:107], v[60:63], v[28:31], v[104:107]
    v_mfma_f32_16x16x32_bf16 v[104:107], v[64:67], v[32:35], v[104:107]
    v_mfma_f32_16x16x32_bf16 v[104:107], v[68:71], v[36:39], v[104:107]
    v_mfma_f32_16x16x32_bf16 v[108:111], v[72:75], v[24:27], 0
    v_mfma_f32_16x16x32_bf16 v[108:111], v[76:79], v[28:31], v[108:111]
    v_mfma_f32_16x16x32_bf16 v[108:111], v[80:83], v[32:35], v[108:111]
    v_mfma_f32_16x16x32_bf16 v[108:111], v[84:87], v[36:39], v[108:111]
    v_mfma_f32_16x16x32_bf16 v[112:115], v[88:91], v[24:27], 0
    v_mfma_f32_16x16x32_bf16 v[112:115], v[92:95], v[28:31], v[112:115]
    v_mfma_f32_16x16x32_bf16 v[112:115], v[96:99], v[32:35], v[112:115]
    v_mfma_f32_16x16x32_bf16 v[112:115], v[100:103], v[36:39], v[112:115]
    v_mfma_f32_16x16x32_bf16 v[116:119], v[56:59], v[40:43], 0
    v_mfma_f32_16x16x32_bf16 v[116:119], v[60:63], v[44:47], v[116:119]
    v_mfma_f32_16x16x32_bf16 v[116:119], v[64:67], v[48:51], v[116:119]
    v_mfma_f32_16x16x32_bf16 v[116:119], v[68:71], v[52:55], v[116:119]
    v_mfma_f32_16x16x32_bf16 v[120:123], v[72:75], v[40:43], 0
    v_mfma_f32_16x16x32_bf16 v[120:123], v[76:79], v[44:47], v[120:123]
    v_mfma_f32_16x16x32_bf16 v[120:123], v[80:83], v[48:51], v[120:123]
    v_mfma_f32_16x16x32_bf16 v[120:123], v[84:87], v[52:55], v[120:123]
    v_mfma_f32_16x16x32_bf16 v[124:127], v[88:91], v[40:43], 0
    v_mfma_f32_16x16x32_bf16 v[124:127], v[92:95], v[44:47], v[124:127]
    v_mfma_f32_16x16x32_bf16 v[124:127], v[96:99], v[48:51], v[124:127]
    v_mfma_f32_16x16x32_bf16 v[124:127], v[100:103], v[52:55], v[124:127]
    s_nop 7
    s_mov_b32 s75, 0x3e0293ee
    s_mov_b32 s76, 0xbe0293ee
    v_mov_b32 v14, 0xff800000
    v_lshlrev_b32 v6, 2, v3
    v_add_u32 v4, 0, v6
    v_cmp_le_i32 vcc, v4, v2
    s_nop 1
    v_cndmask_b32 v104, v14, v104, vcc
    v_add_u32 v4, 1, v6
    v_cmp_le_i32 vcc, v4, v2
    s_nop 1
    v_cndmask_b32 v105, v14, v105, vcc
    v_add_u32 v4, 2, v6
    v_cmp_le_i32 vcc, v4, v2
    s_nop 1
    v_cndmask_b32 v106, v14, v106, vcc
    v_add_u32 v4, 3, v6
    v_cmp_le_i32 vcc, v4, v2
    s_nop 1
    v_cndmask_b32 v107, v14, v107, vcc
    v_mov_b32 v108, v14
    v_mov_b32 v109, v14
    v_mov_b32 v110, v14
    v_mov_b32 v111, v14
    v_cmp_gt_u32 vcc, 2, v3
    s_nop 1
    v_cndmask_b32 v112, v14, v112, vcc
    v_cndmask_b32 v113, v14, v113, vcc
    v_cndmask_b32 v114, v14, v114, vcc
    v_cndmask_b32 v115, v14, v115, vcc
    v_max3_f32 v4, v104, v105, v106
    v_max3_f32 v4, v4, v107, v108
    v_max3_f32 v4, v4, v109, v110
    v_max3_f32 v4, v4, v111, v112
    v_max3_f32 v4, v4, v113, v114
    v_max_f32 v4, v4, v115
    v_mov_b32 v5, v4
    s_nop 1
    v_permlane32_swap_b32 v4, v5
    v_max_f32 v4, v4, v5
    v_mov_b32 v5, v4
    s_nop 1
    v_permlane16_swap_b32 v4, v5
    v_max_f32 v4, v4, v5
    v_mul_f32 v4, s76, v4
    v_fma_f32 v104, v104, s75, v4
    v_fma_f32 v105, v105, s75, v4
    v_fma_f32 v106, v106, s75, v4
    v_fma_f32 v107, v107, s75, v4
    v_fma_f32 v108, v108, s75, v4
    v_fma_f32 v109, v109, s75, v4
    v_fma_f32 v110, v110, s75, v4
    v_fma_f32 v111, v111, s75, v4
    v_fma_f32 v112, v112, s75, v4
    v_fma_f32 v113, v113, s75, v4
    v_fma_f32 v114, v114, s75, v4
    v_fma_f32 v115, v115, s75, v4
    v_exp_f32 v104, v104
    v_exp_f32 v105, v105
    v_exp_f32 v106, v106
    v_exp_f32 v107, v107
    v_exp_f32 v108, v108
    v_exp_f32 v109, v109
    v_exp_f32 v110, v110
    v_exp_f32 v111, v111
    v_exp_f32 v112, v112
    v_exp_f32 v113, v113
    v_exp_f32 v114, v114
    v_exp_f32 v115, v115
    s_nop 0
    v_cvt_pk_bf16_f32 v176, v104, v105
    v_cvt_pk_bf16_f32 v177, v106, v107
    v_cvt_pk_bf16_f32 v178, v108, v109
    v_cvt_pk_bf16_f32 v179, v110, v111
    v_cvt_pk_bf16_f32 v180, v112, v113
    v_cvt_pk_bf16_f32 v181, v114, v115
    v_add_u32 v4, 0, v6
    v_cmp_le_i32 vcc, v4, v2
    s_nop 1
    v_cndmask_b32 v120, v14, v120, vcc
    v_add_u32 v4, 1, v6
    v_cmp_le_i32 vcc, v4, v2
    s_nop 1
    v_cndmask_b32 v121, v14, v121, vcc
    v_add_u32 v4, 2, v6
    v_cmp_le_i32 vcc, v4, v2
    s_nop 1
    v_cndmask_b32 v122, v14, v122, vcc
    v_add_u32 v4, 3, v6
    v_cmp_le_i32 vcc, v4, v2
    s_nop 1
    v_cndmask_b32 v123, v14, v123, vcc
    v_cmp_gt_u32 vcc, 2, v3
    s_nop 1
    v_cndmask_b32 v124, v14, v124, vcc
    v_cndmask_b32 v125, v14, v125, vcc
    v_cndmask_b32 v126, v14, v126, vcc
    v_cndmask_b32 v127, v14, v127, vcc
    v_max3_f32 v4, v116, v117, v118
    v_max3_f32 v4, v4, v119, v120
    v_max3_f32 v4, v4, v121, v122
    v_max3_f32 v4, v4, v123, v124
    v_max3_f32 v4, v4, v125, v126
    v_max_f32 v4, v4, v127
    v_mov_b32 v5, v4
    s_nop 1
    v_permlane32_swap_b32 v4, v5
    v_max_f32 v4, v4, v5
    v_mov_b32 v5, v4
    s_nop 1
    v_permlane16_swap_b32 v4, v5
    v_max_f32 v4, v4, v5
    v_mul_f32 v4, s76, v4
    v_fma_f32 v116, v116, s75, v4
    v_fma_f32 v117, v117, s75, v4
    v_fma_f32 v118, v118, s75, v4
    v_fma_f32 v119, v119, s75, v4
    v_fma_f32 v120, v120, s75, v4
    v_fma_f32 v121, v121, s75, v4
    v_fma_f32 v122, v122, s75, v4
    v_fma_f32 v123, v123, s75, v4
    v_fma_f32 v124, v124, s75, v4
    v_fma_f32 v125, v125, s75, v4
    v_fma_f32 v126, v126, s75, v4
    v_fma_f32 v127, v127, s75, v4
    v_exp_f32 v116, v116
    v_exp_f32 v117, v117
    v_exp_f32 v118, v118
    v_exp_f32 v119, v119
    v_exp_f32 v120, v120
    v_exp_f32 v121, v121
    v_exp_f32 v122, v122
    v_exp_f32 v123, v123
    v_exp_f32 v124, v124
    v_exp_f32 v125, v125
    v_exp_f32 v126, v126
    v_exp_f32 v127, v127
    s_nop 0
    v_cvt_pk_bf16_f32 v182, v116, v117
    v_cvt_pk_bf16_f32 v183, v118, v119
    v_cvt_pk_bf16_f32 v184, v120, v121
    v_cvt_pk_bf16_f32 v185, v122, v123
    v_cvt_pk_bf16_f32 v186, v124, v125
    v_cvt_pk_bf16_f32 v187, v126, v127
    v_mov_b32 v16, 0x3f803f80
    v_mov_b32 v17, 0x3f803f80
    v_mov_b32 v18, 0x3f803f80
    v_mov_b32 v19, 0x3f803f80
    s_waitcnt vmcnt(0)
    v_lshrrev_b32 v5, 1, v3
    v_lshlrev_b32 v13, 8, v5
    v_lshl_add_u32 v13, v2, 4, v13
    v_and_b32 v5, 1, v3
    v_lshl_add_u32 v13, v5, 3, v13
    v_add_u32 v15, 4096, v13
    v_mfma_f32_16x16x32_bf16 v[188:191], v[16:19], v[176:179], 0
    v_mfma_f32_16x16x32_bf16 v[192:195], v[128:131], v[176:179], 0
    v_mfma_f32_16x16x32_bf16 v[196:199], v[132:135], v[176:179], 0
    v_mfma_f32_16x16x32_bf16 v[200:203], v[136:139], v[176:179], 0
    v_mfma_f32_16x16x32_bf16 v[204:207], v[140:143], v[176:179], 0
    v_mfma_f32_16x16x32_bf16 v[208:211], v[144:147], v[176:179], 0
    v_mfma_f32_16x16x32_bf16 v[212:215], v[148:151], v[176:179], 0
    v_mfma_f32_16x16x32_bf16 v[216:219], v[152:155], v[176:179], 0
    v_mfma_f32_16x16x32_bf16 v[220:223], v[156:159], v[176:179], 0
    v_mfma_f32_16x16x16_bf16 v[188:191], v[16:17], v[180:181], v[188:191]
    v_mfma_f32_16x16x16_bf16 v[192:195], v[160:161], v[180:181], v[192:195]
    v_mfma_f32_16x16x16_bf16 v[196:199], v[162:163], v[180:181], v[196:199]
    v_mfma_f32_16x16x16_bf16 v[200:203], v[164:165], v[180:181], v[200:203]
    v_mfma_f32_16x16x16_bf16 v[204:207], v[166:167], v[180:181], v[204:207]
    v_mfma_f32_16x16x16_bf16 v[208:211], v[168:169], v[180:181], v[208:211]
    v_mfma_f32_16x16x16_bf16 v[212:215], v[170:171], v[180:181], v[212:215]
    v_mfma_f32_16x16x16_bf16 v[216:219], v[172:173], v[180:181], v[216:219]
    v_mfma_f32_16x16x16_bf16 v[220:223], v[174:175], v[180:181], v[220:223]
    s_nop 7
    v_rcp_f32 v4, v188
    s_nop 0
    v_mul_f32 v192, v192, v4
    v_mul_f32 v193, v193, v4
    v_mul_f32 v194, v194, v4
    v_mul_f32 v195, v195, v4
    v_cvt_pk_bf16_f32 v192, v192, v193
    v_cvt_pk_bf16_f32 v193, v194, v195
    global_store_dwordx2 v13, v[192:193], s[66:67] offset:0 sc1
    v_mul_f32 v196, v196, v4
    v_mul_f32 v197, v197, v4
    v_mul_f32 v198, v198, v4
    v_mul_f32 v199, v199, v4
    v_cvt_pk_bf16_f32 v196, v196, v197
    v_cvt_pk_bf16_f32 v197, v198, v199
    global_store_dwordx2 v13, v[196:197], s[66:67] offset:512 sc1
    v_mul_f32 v200, v200, v4
    v_mul_f32 v201, v201, v4
    v_mul_f32 v202, v202, v4
    v_mul_f32 v203, v203, v4
    v_cvt_pk_bf16_f32 v200, v200, v201
    v_cvt_pk_bf16_f32 v201, v202, v203
    global_store_dwordx2 v13, v[200:201], s[66:67] offset:2048 sc1
    v_mul_f32 v204, v204, v4
    v_mul_f32 v205, v205, v4
    v_mul_f32 v206, v206, v4
    v_mul_f32 v207, v207, v4
    v_cvt_pk_bf16_f32 v204, v204, v205
    v_cvt_pk_bf16_f32 v205, v206, v207
    global_store_dwordx2 v13, v[204:205], s[66:67] offset:2560 sc1
    v_mul_f32 v208, v208, v4
    v_mul_f32 v209, v209, v4
    v_mul_f32 v210, v210, v4
    v_mul_f32 v211, v211, v4
    v_cvt_pk_bf16_f32 v208, v208, v209
    v_cvt_pk_bf16_f32 v209, v210, v211
    global_store_dwordx2 v15, v[208:209], s[66:67] offset:0 sc1
    v_mul_f32 v212, v212, v4
    v_mul_f32 v213, v213, v4
    v_mul_f32 v214, v214, v4
    v_mul_f32 v215, v215, v4
    v_cvt_pk_bf16_f32 v212, v212, v213
    v_cvt_pk_bf16_f32 v213, v214, v215
    global_store_dwordx2 v15, v[212:213], s[66:67] offset:512 sc1
    v_mul_f32 v216, v216, v4
    v_mul_f32 v217, v217, v4
    v_mul_f32 v218, v218, v4
    v_mul_f32 v219, v219, v4
    v_cvt_pk_bf16_f32 v216, v216, v217
    v_cvt_pk_bf16_f32 v217, v218, v219
    global_store_dwordx2 v15, v[216:217], s[66:67] offset:2048 sc1
    v_mul_f32 v220, v220, v4
    v_mul_f32 v221, v221, v4
    v_mul_f32 v222, v222, v4
    v_mul_f32 v223, v223, v4
    v_cvt_pk_bf16_f32 v220, v220, v221
    v_cvt_pk_bf16_f32 v221, v222, v223
    global_store_dwordx2 v15, v[220:221], s[66:67] offset:2560 sc1
    v_mfma_f32_16x16x32_bf16 v[188:191], v[16:19], v[182:185], 0
    v_mfma_f32_16x16x32_bf16 v[224:227], v[128:131], v[182:185], 0
    v_mfma_f32_16x16x32_bf16 v[228:231], v[132:135], v[182:185], 0
    v_mfma_f32_16x16x32_bf16 v[232:235], v[136:139], v[182:185], 0
    v_mfma_f32_16x16x32_bf16 v[236:239], v[140:143], v[182:185], 0
    v_mfma_f32_16x16x32_bf16 v[240:243], v[144:147], v[182:185], 0
    v_mfma_f32_16x16x32_bf16 v[244:247], v[148:151], v[182:185], 0
    v_mfma_f32_16x16x32_bf16 v[248:251], v[152:155], v[182:185], 0
    v_mfma_f32_16x16x32_bf16 v[252:255], v[156:159], v[182:185], 0
    v_mfma_f32_16x16x16_bf16 v[188:191], v[16:17], v[186:187], v[188:191]
    v_mfma_f32_16x16x16_bf16 v[224:227], v[160:161], v[186:187], v[224:227]
    v_mfma_f32_16x16x16_bf16 v[228:231], v[162:163], v[186:187], v[228:231]
    v_mfma_f32_16x16x16_bf16 v[232:235], v[164:165], v[186:187], v[232:235]
    v_mfma_f32_16x16x16_bf16 v[236:239], v[166:167], v[186:187], v[236:239]
    v_mfma_f32_16x16x16_bf16 v[240:243], v[168:169], v[186:187], v[240:243]
    v_mfma_f32_16x16x16_bf16 v[244:247], v[170:171], v[186:187], v[244:247]
    v_mfma_f32_16x16x16_bf16 v[248:251], v[172:173], v[186:187], v[248:251]
    v_mfma_f32_16x16x16_bf16 v[252:255], v[174:175], v[186:187], v[252:255]
    s_nop 7
    v_rcp_f32 v4, v188
    s_nop 0
    v_mul_f32 v224, v224, v4
    v_mul_f32 v225, v225, v4
    v_mul_f32 v226, v226, v4
    v_mul_f32 v227, v227, v4
    v_cvt_pk_bf16_f32 v224, v224, v225
    v_cvt_pk_bf16_f32 v225, v226, v227
    global_store_dwordx2 v13, v[224:225], s[66:67] offset:1024 sc1
    v_mul_f32 v228, v228, v4
    v_mul_f32 v229, v229, v4
    v_mul_f32 v230, v230, v4
    v_mul_f32 v231, v231, v4
    v_cvt_pk_bf16_f32 v228, v228, v229
    v_cvt_pk_bf16_f32 v229, v230, v231
    global_store_dwordx2 v13, v[228:229], s[66:67] offset:1536 sc1
    v_mul_f32 v232, v232, v4
    v_mul_f32 v233, v233, v4
    v_mul_f32 v234, v234, v4
    v_mul_f32 v235, v235, v4
    v_cvt_pk_bf16_f32 v232, v232, v233
    v_cvt_pk_bf16_f32 v233, v234, v235
    global_store_dwordx2 v13, v[232:233], s[66:67] offset:3072 sc1
    v_mul_f32 v236, v236, v4
    v_mul_f32 v237, v237, v4
    v_mul_f32 v238, v238, v4
    v_mul_f32 v239, v239, v4
    v_cvt_pk_bf16_f32 v236, v236, v237
    v_cvt_pk_bf16_f32 v237, v238, v239
    global_store_dwordx2 v13, v[236:237], s[66:67] offset:3584 sc1
    v_mul_f32 v240, v240, v4
    v_mul_f32 v241, v241, v4
    v_mul_f32 v242, v242, v4
    v_mul_f32 v243, v243, v4
    v_cvt_pk_bf16_f32 v240, v240, v241
    v_cvt_pk_bf16_f32 v241, v242, v243
    global_store_dwordx2 v15, v[240:241], s[66:67] offset:1024 sc1
    v_mul_f32 v244, v244, v4
    v_mul_f32 v245, v245, v4
    v_mul_f32 v246, v246, v4
    v_mul_f32 v247, v247, v4
    v_cvt_pk_bf16_f32 v244, v244, v245
    v_cvt_pk_bf16_f32 v245, v246, v247
    global_store_dwordx2 v15, v[244:245], s[66:67] offset:1536 sc1
    v_mul_f32 v248, v248, v4
    v_mul_f32 v249, v249, v4
    v_mul_f32 v250, v250, v4
    v_mul_f32 v251, v251, v4
    v_cvt_pk_bf16_f32 v248, v248, v249
    v_cvt_pk_bf16_f32 v249, v250, v251
    global_store_dwordx2 v15, v[248:249], s[66:67] offset:3072 sc1
    v_mul_f32 v252, v252, v4
    v_mul_f32 v253, v253, v4
    v_mul_f32 v254, v254, v4
    v_mul_f32 v255, v255, v4
    v_cvt_pk_bf16_f32 v252, v252, v253
    v_cvt_pk_bf16_f32 v253, v254, v255
    global_store_dwordx2 v15, v[252:253], s[66:67] offset:3584 sc1
    s_lshl_b32 s37, s35, 7
    s_add_u32 s40, s32, 89128960
    s_addc_u32 s41, s33, 0
    s_waitcnt vmcnt(0)
    s_barrier
    v_cmp_eq_u32 vcc, 0, v0
    s_and_saveexec_b64 s[12:13], vcc
    s_cbranch_execz L_sg_o
    v_mov_b32 v3, s37
    v_mov_b32 v4, 1
    global_atomic_add v3, v4, s[40:41]
L_sg_o:
    s_mov_b64 exec, s[12:13]
    s_branch L_att
L_proj:
    v_and_b32 v1, 63, v0
    s_load_dwordx2 s[30:31], s[0:1], 40
    s_load_dwordx2 s[28:29], s[0:1], 88
    s_and_b32 s36, s34, 31
    s_lshr_b32 s35, s34, 6
    s_bfe_u32 s39, s34, 0x10005
    s_add_u32 s40, s32, 89128960
    s_addc_u32 s41, s33, 0
    s_waitcnt lgkmcnt(0)
    v_lshrrev_b32 v4, 1, v1
    v_lshlrev_b32 v4, 10, v4
    v_and_b32 v5, 1, v1
    v_lshl_add_u32 v4, v5, 4, v4
    s_lshl_b32 s60, s36, 5
    s_lshl_b32 s61, s22, 20
    s_add_u32 s60, s60, s61
    s_add_u32 s62, s30, s60
    s_addc_u32 s63, s31, 0
    s_lshl_b32 s64, s22, 15
    s_mov_b32 m0, s64
    s_nop 0
    global_load_lds_dwordx4 v4, s[62:63]
    s_add_u32 s62, s62, 32768
    s_addc_u32 s63, s63, 0
    s_add_u32 s64, s64, 1024
    s_mov_b32 m0, s64
    s_nop 0
    global_load_lds_dwordx4 v4, s[62:63]
    s_add_u32 s62, s62, 32768
    s_addc_u32 s63, s63, 0
    s_add_u32 s64, s64, 1024
    s_mov_b32 m0, s64
    s_nop 0
    global_load_lds_dwordx4 v4, s[62:63]
    s_add_u32 s62, s62, 32768
    s_addc_u32 s63, s63, 0
    s_add_u32 s64, s64, 1024
    s_mov_b32 m0, s64
    s_nop 0
    global_load_lds_dwordx4 v4, s[62:63]
    s_add_u32 s62, s62, 32768
    s_addc_u32 s63, s63, 0
    s_add_u32 s64, s64, 1024
    s_mov_b32 m0, s64
    s_nop 0
    global_load_lds_dwordx4 v4, s[62:63]
    s_add_u32 s62, s62, 32768
    s_addc_u32 s63, s63, 0
    s_add_u32 s64, s64, 1024
    s_mov_b32 m0, s64
    s_nop 0
    global_load_lds_dwordx4 v4, s[62:63]
    s_add_u32 s62, s62, 32768
    s_addc_u32 s63, s63, 0
    s_add_u32 s64, s64, 1024
    s_mov_b32 m0, s64
    s_nop 0
    global_load_lds_dwordx4 v4, s[62:63]
    s_add_u32 s62, s62, 32768
    s_addc_u32 s63, s63, 0
    s_add_u32 s64, s64, 1024
    s_mov_b32 m0, s64
    s_nop 0
    global_load_lds_dwordx4 v4, s[62:63]
    s_add_u32 s62, s62, 32768
    s_addc_u32 s63, s63, 0
    s_add_u32 s64, s64, 1024
    s_mov_b32 m0, s64
    s_nop 0
    global_load_lds_dwordx4 v4, s[62:63]
    s_add_u32 s62, s62, 32768
    s_addc_u32 s63, s63, 0
    s_add_u32 s64, s64, 1024
    s_mov_b32 m0, s64
    s_nop 0
    global_load_lds_dwordx4 v4, s[62:63]
    s_add_u32 s62, s62, 32768
    s_addc_u32 s63, s63, 0
    s_add_u32 s64, s64, 1024
    s_mov_b32 m0, s64
    s_nop 0
    global_load_lds_dwordx4 v4, s[62:63]
    s_add_u32 s62, s62, 32768
    s_addc_u32 s63, s63, 0
    s_add_u32 s64, s64, 1024
    s_mov_b32 m0, s64
    s_nop 0
    global_load_lds_dwordx4 v4, s[62:63]
    s_add_u32 s62, s62, 32768
    s_addc_u32 s63, s63, 0
    s_add_u32 s64, s64, 1024
    s_mov_b32 m0, s64
    s_nop 0
    global_load_lds_dwordx4 v4, s[62:63]
    s_add_u32 s62, s62, 32768
    s_addc_u32 s63, s63, 0
    s_add_u32 s64, s64, 1024
    s_mov_b32 m0, s64
    s_nop 0
    global_load_lds_dwordx4 v4, s[62:63]
    s_add_u32 s62, s62, 32768
    s_addc_u32 s63, s63, 0
    s_add_u32 s64, s64, 1024
    s_mov_b32 m0, s64
    s_nop 0
    global_load_lds_dwordx4 v4, s[62:63]
    s_add_u32 s62, s62, 32768
    s_addc_u32 s63, s63, 0
    s_add_u32 s64, s64, 1024
    s_mov_b32 m0, s64
    s_nop 0
    global_load_lds_dwordx4 v4, s[62:63]
    s_add_u32 s62, s62, 32768
    s_addc_u32 s63, s63, 0
    s_add_u32 s64, s64, 1024
    s_mov_b32 m0, s64
    s_nop 0
    global_load_lds_dwordx4 v4, s[62:63]
    s_add_u32 s62, s62, 32768
    s_addc_u32 s63, s63, 0
    s_add_u32 s64, s64, 1024
    s_mov_b32 m0, s64
    s_nop 0
    global_load_lds_dwordx4 v4, s[62:63]
    s_add_u32 s62, s62, 32768
    s_addc_u32 s63, s63, 0
    s_add_u32 s64, s64, 1024
    s_mov_b32 m0, s64
    s_nop 0
    global_load_lds_dwordx4 v4, s[62:63]
    s_add_u32 s62, s62, 32768
    s_addc_u32 s63, s63, 0
    s_add_u32 s64, s64, 1024
    s_mov_b32 m0, s64
    s_nop 0
    global_load_lds_dwordx4 v4, s[62:63]
    s_add_u32 s62, s62, 32768
    s_addc_u32 s63, s63, 0
    s_add_u32 s64, s64, 1024
    s_mov_b32 m0, s64
    s_nop 0
    global_load_lds_dwordx4 v4, s[62:63]
    s_add_u32 s62, s62, 32768
    s_addc_u32 s63, s63, 0
    s_add_u32 s64, s64, 1024
    s_mov_b32 m0, s64
    s_nop 0
    global_load_lds_dwordx4 v4, s[62:63]
    s_add_u32 s62, s62, 32768
    s_addc_u32 s63, s63, 0
    s_add_u32 s64, s64, 1024
    s_mov_b32 m0, s64
    s_nop 0
    global_load_lds_dwordx4 v4, s[62:63]
    s_add_u32 s62, s62, 32768
    s_addc_u32 s63, s63, 0
    s_add_u32 s64, s64, 1024
    s_mov_b32 m0, s64
    s_nop 0
    global_load_lds_dwordx4 v4, s[62:63]
    s_add_u32 s62, s62, 32768
    s_addc_u32 s63, s63, 0
    s_add_u32 s64, s64, 1024
    s_mov_b32 m0, s64
    s_nop 0
    global_load_lds_dwordx4 v4, s[62:63]
    s_add_u32 s62, s62, 32768
    s_addc_u32 s63, s63, 0
    s_add_u32 s64, s64, 1024
    s_mov_b32 m0, s64
    s_nop 0
    global_load_lds_dwordx4 v4, s[62:63]
    s_add_u32 s62, s62, 32768
    s_addc_u32 s63, s63, 0
    s_add_u32 s64, s64, 1024
    s_mov_b32 m0, s64
    s_nop 0
    global_load_lds_dwordx4 v4, s[62:63]
    s_add_u32 s62, s62, 32768
    s_addc_u32 s63, s63, 0
    s_add_u32 s64, s64, 1024
    s_mov_b32 m0, s64
    s_nop 0
    global_load_lds_dwordx4 v4, s[62:63]
    s_add_u32 s62, s62, 32768
    s_addc_u32 s63, s63, 0
    s_add_u32 s64, s64, 1024
    s_mov_b32 m0, s64
    s_nop 0
    global_load_lds_dwordx4 v4, s[62:63]
    s_add_u32 s62, s62, 32768
    s_addc_u32 s63, s63, 0
    s_add_u32 s64, s64, 1024
    s_mov_b32 m0, s64
    s_nop 0
    global_load_lds_dwordx4 v4, s[62:63]
    s_add_u32 s62, s62, 32768
    s_addc_u32 s63, s63, 0
    s_add_u32 s64, s64, 1024
    s_mov_b32 m0, s64
    s_nop 0
    global_load_lds_dwordx4 v4, s[62:63]
    s_add_u32 s62, s62, 32768
    s_addc_u32 s63, s63, 0
    s_add_u32 s64, s64, 1024
    s_mov_b32 m0, s64
    s_nop 0
    global_load_lds_dwordx4 v4, s[62:63]
    v_lshrrev_b32 v2, 4, v1
    v_and_b32 v3, 15, v1
    v_bfe_u32 v4, v1, 2, 2
    v_lshl_add_u32 v4, v2, 3, v4
    v_lshlrev_b32 v4, 5, v4
    v_and_b32 v5, 3, v1
    v_lshl_add_u32 v4, v5, 3, v4
    s_lshl_b32 s60, s22, 15
    v_add_u32 v6, s60, v4
    v_lshlrev_b32 v7, 4, v1
    s_lshl_b32 s60, s22, 16
    v_add_u32 v7, s60, v7
    v_lshlrev_b32 v11, 4, v1
    s_lshl_b32 s60, s22, 11
    s_add_u32 s60, s60, 131072
    v_add_u32 v9, s60, v11
    v_add_u32 v10, 131072, v11
    s_lshl_b32 s60, s39, 10
    v_add_u32 v7, s60, v7
    s_waitcnt vmcnt(0)
    s_barrier
    s_mov_b32 s42, -1
    s_mov_b32 s44, 0
L_proj_loop:
    s_lshr_b32 s37, s35, 3
    s_cmp_eq_u32 s37, s42
    s_cbranch_scc1 L_f2ok
    s_mov_b32 s42, s37
    s_lshl_b32 s37, s37, 9
    s_add_u32 s37, s37, 12672
    s_cmp_eq_u32 s22, 0
    s_cbranch_scc0 L_wfd_f2w
    v_mov_b32 v3, s37
    s_mov_b32 s14, 0
L_wf_f2w:
    global_load_dword v4, v3, s[40:41] sc1
    s_waitcnt vmcnt(0)
    v_readfirstlane_b32 s15, v4
    s_add_u32 s14, s14, 1
    s_cmp_gt_u32 s14, 400000
    s_cbranch_scc1 L_wfd_f2w
    s_cmp_eq_u32 s15, 9
    s_cbranch_scc1 L_wfd_f2w
    s_sleep 32
    s_branch L_wf_f2w
L_wfd_f2w:
    s_barrier
L_f2ok:
    s_cmp_eq_u32 s44, 8
    s_cbranch_scc1 L_ordy_ok
    s_lshl_b32 s37, s35, 7
    v_mov_b32 v3, s37
    s_mov_b32 s14, 0
L_wf_ordy:
    global_load_dword v4, v3, s[40:41] sc1
    s_waitcnt vmcnt(0)
    v_readfirstlane_b32 s15, v4
    s_add_u32 s14, s14, 1
    s_cmp_gt_u32 s14, 400000
    s_cbranch_scc1 L_wfd_ordy
    s_cmp_eq_u32 s15, 8
    s_cbranch_scc1 L_wfd_ordy
    s_add_u32 s15, s15, 8
    s_cmp_le_u32 s15, 8
    s_cbranch_scc0 L_wfs_ordy
    s_sleep 12
    s_branch L_wf_ordy
L_wfs_ordy:
    s_sleep 4
    s_branch L_wf_ordy
L_wfd_ordy:
L_ordy_ok:
    v_lshrrev_b32 v2, 4, v1
    v_and_b32 v3, 15, v1
    s_lshl_b32 s60, s35, 18
    s_add_u32 s60, s60, 50331648
    s_add_u32 s62, s32, s60
    s_addc_u32 s63, s33, 0
    v_add_u32 v8, 0, v7
    global_load_dwordx4 a[0:3], v8, s[62:63] offset:0
    global_load_dwordx4 a[4:7], v8, s[62:63] offset:2048
    v_add_u32 v8, 4096, v7
    global_load_dwordx4 a[8:11], v8, s[62:63] offset:0
    global_load_dwordx4 a[12:15], v8, s[62:63] offset:2048
    v_add_u32 v8, 8192, v7
    global_load_dwordx4 a[16:19], v8, s[62:63] offset:0
    global_load_dwordx4 a[20:23], v8, s[62:63] offset:2048
    v_add_u32 v8, 12288, v7
    global_load_dwordx4 a[24:27], v8, s[62:63] offset:0
    global_load_dwordx4 a[28:31], v8, s[62:63] offset:2048
    v_add_u32 v8, 16384, v7
    global_load_dwordx4 a[32:35], v8, s[62:63] offset:0
    global_load_dwordx4 a[36:39], v8, s[62:63] offset:2048
    v_add_u32 v8, 20480, v7
    global_load_dwordx4 a[40:43], v8, s[62:63] offset:0
    global_load_dwordx4 a[44:47], v8, s[62:63] offset:2048
    v_add_u32 v8, 24576, v7
    global_load_dwordx4 a[48:51], v8, s[62:63] offset:0
    global_load_dwordx4 a[52:55], v8, s[62:63] offset:2048
    v_add_u32 v8, 28672, v7
    global_load_dwordx4 a[56:59], v8, s[62:63] offset:0
    global_load_dwordx4 a[60:63], v8, s[62:63] offset:2048
    v_add_u32 v8, 32768, v7
    global_load_dwordx4 a[64:67], v8, s[62:63] offset:0
    global_load_dwordx4 a[68:71], v8, s[62:63] offset:2048
    v_add_u32 v8, 36864, v7
    global_load_dwordx4 a[72:75], v8, s[62:63] offset:0
    global_load_dwordx4 a[76:79], v8, s[62:63] offset:2048
    v_add_u32 v8, 40960, v7
    global_load_dwordx4 a[80:83], v8, s[62:63] offset:0
    global_load_dwordx4 a[84:87], v8, s[62:63] offset:2048
    v_add_u32 v8, 45056, v7
    global_load_dwordx4 a[88:91], v8, s[62:63] offset:0
    global_load_dwordx4 a[92:95], v8, s[62:63] offset:2048
    v_add_u32 v8, 49152, v7
    global_load_dwordx4 a[96:99], v8, s[62:63] offset:0
    global_load_dwordx4 a[100:103], v8, s[62:63] offset:2048
    v_add_u32 v8, 53248, v7
    global_load_dwordx4 a[104:107], v8, s[62:63] offset:0
    global_load_dwordx4 a[108:111], v8, s[62:63] offset:2048
    v_add_u32 v8, 57344, v7
    global_load_dwordx4 a[112:115], v8, s[62:63] offset:0
    global_load_dwordx4 a[116:119], v8, s[62:63] offset:2048
    v_add_u32 v8, 61440, v7
    global_load_dwordx4 a[120:123], v8, s[62:63] offset:0
    global_load_dwordx4 a[124:127], v8, s[62:63] offset:2048
    s_lshl_b32 s60, s35, 5
    s_lshl_b32 s61, s39, 4
    s_add_u32 s60, s60, s61
    v_add_u32 v12, s60, v3
    v_lshlrev_b32 v13, 2, v12
    s_lshl_b32 s61, s36, 6
    v_lshlrev_b32 v14, 11, v12
    v_lshl_add_u32 v14, v2, 4, v14
    v_add_u32 v14, s61, v14
    s_add_u32 s64, s32, 88080384
    s_addc_u32 s65, s33, 0
    global_load_dword v15, v13, s[64:65]
    s_add_u32 s66, s32, 100663296
    s_addc_u32 s67, s33, 0
    global_load_dwordx4 v[48:51], v14, s[66:67]
    s_add_u32 s66, s32, 104857600
    s_addc_u32 s67, s33, 0
    global_load_dwordx4 v[52:55], v14, s[66:67]
    s_add_u32 s66, s32, 109051904
    s_addc_u32 s67, s33, 0
    global_load_dwordx4 v[56:59], v14, s[66:67]
    s_add_u32 s66, s32, 113246208
    s_addc_u32 s67, s33, 0
    global_load_dwordx4 v[60:63], v14, s[66:67]
    s_add_u32 s37, s35, 2
    s_min_u32 s37, s37, 63
    s_lshl_b32 s37, s37, 7
    v_mov_b32 v230, s37
    global_load_dword v231, v230, s[40:41] sc1
    ds_read_b64_tr_b16 v[160:161], v6 offset:0
    ds_read_b64_tr_b16 v[162:163], v6 offset:128
    ds_read_b64_tr_b16 v[164:165], v6 offset:1024
    ds_read_b64_tr_b16 v[166:167], v6 offset:1152
    ds_read_b64_tr_b16 v[168:169], v6 offset:2048
    ds_read_b64_tr_b16 v[170:171], v6 offset:2176
    ds_read_b64_tr_b16 v[172:173], v6 offset:3072
    ds_read_b64_tr_b16 v[174:175], v6 offset:3200
    ds_read_b64_tr_b16 v[176:177], v6 offset:4096
    ds_read_b64_tr_b16 v[178:179], v6 offset:4224
    ds_read_b64_tr_b16 v[180:181], v6 offset:5120
    ds_read_b64_tr_b16 v[182:183], v6 offset:5248
    ds_read_b64_tr_b16 v[184:185], v6 offset:6144
    ds_read_b64_tr_b16 v[186:187], v6 offset:6272
    ds_read_b64_tr_b16 v[188:189], v6 offset:7168
    ds_read_b64_tr_b16 v[190:191], v6 offset:7296
    s_waitcnt lgkmcnt(0)
    ds_read_b64_tr_b16 v[192:193], v6 offset:8192
    ds_read_b64_tr_b16 v[194:195], v6 offset:8320
    ds_read_b64_tr_b16 v[196:197], v6 offset:9216
    ds_read_b64_tr_b16 v[198:199], v6 offset:9344
    ds_read_b64_tr_b16 v[200:201], v6 offset:10240
    ds_read_b64_tr_b16 v[202:203], v6 offset:10368
    ds_read_b64_tr_b16 v[204:205], v6 offset:11264
    ds_read_b64_tr_b16 v[206:207], v6 offset:11392
    ds_read_b64_tr_b16 v[208:209], v6 offset:12288
    ds_read_b64_tr_b16 v[210:211], v6 offset:12416
    ds_read_b64_tr_b16 v[212:213], v6 offset:13312
    ds_read_b64_tr_b16 v[214:215], v6 offset:13440
    ds_read_b64_tr_b16 v[216:217], v6 offset:14336
    ds_read_b64_tr_b16 v[218:219], v6 offset:14464
    ds_read_b64_tr_b16 v[220:221], v6 offset:15360
    ds_read_b64_tr_b16 v[222:223], v6 offset:15488
    s_waitcnt vmcnt(36)
    v_mfma_f32_16x16x32_bf16 v[16:19], v[160:163], a[0:3], 0
    v_mfma_f32_16x16x32_bf16 v[20:23], v[164:167], a[4:7], 0
    s_waitcnt vmcnt(34)
    v_mfma_f32_16x16x32_bf16 v[16:19], v[168:171], a[8:11], v[16:19]
    v_mfma_f32_16x16x32_bf16 v[20:23], v[172:175], a[12:15], v[20:23]
    s_waitcnt vmcnt(32)
    v_mfma_f32_16x16x32_bf16 v[16:19], v[176:179], a[16:19], v[16:19]
    v_mfma_f32_16x16x32_bf16 v[20:23], v[180:183], a[20:23], v[20:23]
    s_waitcnt vmcnt(30)
    v_mfma_f32_16x16x32_bf16 v[16:19], v[184:187], a[24:27], v[16:19]
    v_mfma_f32_16x16x32_bf16 v[20:23], v[188:191], a[28:31], v[20:23]
    s_waitcnt lgkmcnt(0)
    ds_read_b64_tr_b16 v[160:161], v6 offset:16384
    ds_read_b64_tr_b16 v[162:163], v6 offset:16512
    ds_read_b64_tr_b16 v[164:165], v6 offset:17408
    ds_read_b64_tr_b16 v[166:167], v6 offset:17536
    ds_read_b64_tr_b16 v[168:169], v6 offset:18432
    ds_read_b64_tr_b16 v[170:171], v6 offset:18560
    ds_read_b64_tr_b16 v[172:173], v6 offset:19456
    ds_read_b64_tr_b16 v[174:175], v6 offset:19584
    ds_read_b64_tr_b16 v[176:177], v6 offset:20480
    ds_read_b64_tr_b16 v[178:179], v6 offset:20608
    ds_read_b64_tr_b16 v[180:181], v6 offset:21504
    ds_read_b64_tr_b16 v[182:183], v6 offset:21632
    ds_read_b64_tr_b16 v[184:185], v6 offset:22528
    ds_read_b64_tr_b16 v[186:187], v6 offset:22656
    ds_read_b64_tr_b16 v[188:189], v6 offset:23552
    ds_read_b64_tr_b16 v[190:191], v6 offset:23680
    s_waitcnt vmcnt(28)
    v_mfma_f32_16x16x32_bf16 v[16:19], v[192:195], a[32:35], v[16:19]
    v_mfma_f32_16x16x32_bf16 v[20:23], v[196:199], a[36:39], v[20:23]
    s_waitcnt vmcnt(26)
    v_mfma_f32_16x16x32_bf16 v[16:19], v[200:203], a[40:43], v[16:19]
    v_mfma_f32_16x16x32_bf16 v[20:23], v[204:207], a[44:47], v[20:23]
    s_waitcnt vmcnt(24)
    v_mfma_f32_16x16x32_bf16 v[16:19], v[208:211], a[48:51], v[16:19]
    v_mfma_f32_16x16x32_bf16 v[20:23], v[212:215], a[52:55], v[20:23]
    s_waitcnt vmcnt(22)
    v_mfma_f32_16x16x32_bf16 v[16:19], v[216:219], a[56:59], v[16:19]
    v_mfma_f32_16x16x32_bf16 v[20:23], v[220:223], a[60:63], v[20:23]
    s_waitcnt lgkmcnt(0)
    ds_read_b64_tr_b16 v[192:193], v6 offset:24576
    ds_read_b64_tr_b16 v[194:195], v6 offset:24704
    ds_read_b64_tr_b16 v[196:197], v6 offset:25600
    ds_read_b64_tr_b16 v[198:199], v6 offset:25728
    ds_read_b64_tr_b16 v[200:201], v6 offset:26624
    ds_read_b64_tr_b16 v[202:203], v6 offset:26752
    ds_read_b64_tr_b16 v[204:205], v6 offset:27648
    ds_read_b64_tr_b16 v[206:207], v6 offset:27776
    ds_read_b64_tr_b16 v[208:209], v6 offset:28672
    ds_read_b64_tr_b16 v[210:211], v6 offset:28800
    ds_read_b64_tr_b16 v[212:213], v6 offset:29696
    ds_read_b64_tr_b16 v[214:215], v6 offset:29824
    ds_read_b64_tr_b16 v[216:217], v6 offset:30720
    ds_read_b64_tr_b16 v[218:219], v6 offset:30848
    ds_read_b64_tr_b16 v[220:221], v6 offset:31744
    ds_read_b64_tr_b16 v[222:223], v6 offset:31872
    s_waitcnt vmcnt(20)
    v_mfma_f32_16x16x32_bf16 v[16:19], v[160:163], a[64:67], v[16:19]
    v_mfma_f32_16x16x32_bf16 v[20:23], v[164:167], a[68:71], v[20:23]
    s_waitcnt vmcnt(18)
    v_mfma_f32_16x16x32_bf16 v[16:19], v[168:171], a[72:75], v[16:19]
    v_mfma_f32_16x16x32_bf16 v[20:23], v[172:175], a[76:79], v[20:23]
    s_waitcnt vmcnt(16)
    v_mfma_f32_16x16x32_bf16 v[16:19], v[176:179], a[80:83], v[16:19]
    v_mfma_f32_16x16x32_bf16 v[20:23], v[180:183], a[84:87], v[20:23]
    s_waitcnt vmcnt(14)
    v_mfma_f32_16x16x32_bf16 v[16:19], v[184:187], a[88:91], v[16:19]
    v_mfma_f32_16x16x32_bf16 v[20:23], v[188:191], a[92:95], v[20:23]
    s_waitcnt lgkmcnt(0)
    s_waitcnt vmcnt(12)
    v_mfma_f32_16x16x32_bf16 v[16:19], v[192:195], a[96:99], v[16:19]
    v_mfma_f32_16x16x32_bf16 v[20:23], v[196:199], a[100:103], v[20:23]
    s_waitcnt vmcnt(10)
    v_mfma_f32_16x16x32_bf16 v[16:19], v[200:203], a[104:107], v[16:19]
    v_mfma_f32_16x16x32_bf16 v[20:23], v[204:207], a[108:111], v[20:23]
    s_waitcnt vmcnt(8)
    v_mfma_f32_16x16x32_bf16 v[16:19], v[208:211], a[112:115], v[16:19]
    v_mfma_f32_16x16x32_bf16 v[20:23], v[212:215], a[116:119], v[20:23]
    s_waitcnt vmcnt(6)
    v_mfma_f32_16x16x32_bf16 v[16:19], v[216:219], a[120:123], v[16:19]
    v_mfma_f32_16x16x32_bf16 v[20:23], v[220:223], a[124:127], v[20:23]
    s_nop 7
    v_add_f32 v16, v16, v20
    v_add_f32 v17, v17, v21
    v_add_f32 v18, v18, v22
    v_add_f32 v19, v19, v23
    ds_write_b128 v9, v[16:19]
    s_waitcnt vmcnt(0) lgkmcnt(0)
    v_readfirstlane_b32 s44, v231
    s_barrier
    s_cmp_lg_u32 s22, 0
    s_cbranch_scc1 L_k4_skip_p
    ds_read_b128 v[32:35], v10 offset:0
    ds_read_b128 v[36:39], v10 offset:2048
    ds_read_b128 v[40:43], v10 offset:4096
    ds_read_b128 v[44:47], v10 offset:6144
    s_lshl_b32 s61, s36, 5
    v_lshlrev_b32 v14, 10, v12
    v_lshl_add_u32 v14, v2, 3, v14
    v_add_u32 v14, s61, v14
    s_waitcnt lgkmcnt(0)
    v_add_f32 v32, v32, v36
    v_add_f32 v40, v40, v44
    v_add_f32 v32, v32, v40
    v_add_f32 v33, v33, v37
    v_add_f32 v41, v41, v45
    v_add_f32 v33, v33, v41
    v_add_f32 v34, v34, v38
    v_add_f32 v42, v42, v46
    v_add_f32 v34, v34, v42
    v_add_f32 v35, v35, v39
    v_add_f32 v43, v43, v47
    v_add_f32 v35, v35, v43
    s_waitcnt vmcnt(0)
    v_add_f32 v48, v48, v52
    v_add_f32 v49, v49, v53
    v_add_f32 v50, v50, v54
    v_add_f32 v51, v51, v55
    v_add_f32 v48, v48, v56
    v_add_f32 v49, v49, v57
    v_add_f32 v50, v50, v58
    v_add_f32 v51, v51, v59
    v_add_f32 v48, v48, v60
    v_add_f32 v49, v49, v61
    v_add_f32 v50, v50, v62
    v_add_f32 v51, v51, v63
    v_sub_f32 v32, v32, v48
    v_sub_f32 v33, v33, v49
    v_sub_f32 v34, v34, v50
    v_sub_f32 v35, v35, v51
    v_fma_f32 v32, v32, v15, v48
    v_fma_f32 v33, v33, v15, v49
    v_fma_f32 v34, v34, v15, v50
    v_fma_f32 v35, v35, v15, v51
    v_cvt_pk_bf16_f32 v32, v32, v33
    v_cvt_pk_bf16_f32 v33, v34, v35
    global_store_dwordx2 v14, v[32:33], s[28:29]
L_k4_skip_p:
    s_barrier
    s_add_u32 s35, s35, 2
    s_cmp_lt_u32 s35, 64
    s_cbranch_scc1 L_proj_loop
    s_cmp_eq_u32 s46, 0
    s_cbranch_scc1 L_done
L_left:
    v_mov_b32 v3, 160
    global_load_dwordx4 v[4:7], v3, s[6:7] sc1
    s_waitcnt vmcnt(0)
    v_min_u32 v4, v4, v5
    v_min_u32 v6, v6, v7
    v_min_u32 v4, v4, v6
    s_nop 0
    v_readfirstlane_b32 s47, v4
    v_mov_b32 v3, 4
    s_cmp_eq_u32 s22, 0
    s_cbranch_scc0 L_left_b
    v_mov_b32 v4, s47
    ds_write_b32 v3, v4
    s_waitcnt lgkmcnt(0)
L_left_b:
    s_barrier
    ds_read_b32 v4, v3
    s_waitcnt lgkmcnt(0)
    v_readfirstlane_b32 s47, v4
    s_barrier
    s_cmp_ge_u32 s47, 32
    s_cbranch_scc1 L_done
    s_mov_b32 s47, 0
L_left_loop:
    s_lshl_b32 s38, s47, 2
    s_add_u32 s38, s38, 160
    v_cmp_eq_u32 vcc, 0, v0
    s_and_saveexec_b64 s[12:13], vcc
    s_cbranch_execz L_ba_l
    v_mov_b32 v3, s38
    v_mov_b32 v4, 1
    global_atomic_add v5, v3, v4, s[6:7] sc0
    s_waitcnt vmcnt(0)
    v_mov_b32 v6, 0
    ds_write_b32 v6, v5
    s_waitcnt lgkmcnt(0)
L_ba_l:
    s_mov_b64 exec, s[12:13]
    s_barrier
    v_mov_b32 v6, 0
    ds_read_b32 v5, v6
    s_waitcnt lgkmcnt(0)
    v_readfirstlane_b32 s34, v5
    s_barrier
    s_cmp_lt_u32 s34, 32
    s_cbranch_scc1 L_left_take
    s_add_u32 s47, s47, 1
    s_cmp_lt_u32 s47, 4
    s_cbranch_scc1 L_left_loop
    s_branch L_done
L_left_take:
    s_lshl_b32 s47, s47, 5
    s_add_u32 s34, s34, s47
    s_mov_b32 s46, 1
    s_branch L_proj
L_chain:
    s_mov_b32 s8, s34
    s_mov_b32 s9, s22
    s_mov_b32 s4, s32
    s_mov_b32 s5, s33
    v_and_b32 v92, 63, v0
    v_and_b32 v93, 15, v92
    v_lshrrev_b32 v94, 4, v92
    v_bfe_u32 v95, v92, 2, 2
    v_and_b32 v96, 3, v92
    v_lshlrev_b32 v5, 4, v92
    s_load_dwordx4 s[64:67], s[0:1], 16
    s_load_dwordx4 s[68:71], s[0:1], 32
    s_lshl_b32 s11, s9, 2
    v_and_b32 v98, 1, v94
    v_lshlrev_b32 v98, 1, v98
    v_add_u32 v98, s11, v98
    v_xor_b32 v98, v93, v98
    v_lshlrev_b32 v98, 4, v98
    v_lshlrev_b32 v102, 13, v94
    v_add_u32 v102, v102, v98
    v_and_b32 v98, 1, v95
    v_and_b32 v99, 1, v94
    v_lshrrev_b32 v100, 1, v95
    v_lshlrev_b32 v97, 1, v98
    v_lshl_add_u32 v97, v99, 2, v97
    v_lshl_add_u32 v97, v100, 3, v97
    v_lshrrev_b32 v101, 1, v94
    v_lshlrev_b32 v103, 4, v101
    v_lshl_add_u32 v103, v99, 2, v103
    v_add_u32 v103, v103, v98
    v_lshl_add_u32 v103, v100, 3, v103
    v_lshrrev_b32 v98, 1, v96
    s_lshl_b32 s11, s9, 2
    s_add_u32 s11, s11, 0
    v_add_u32 v98, s11, v98
    v_xor_b32 v98, v98, v97
    v_lshlrev_b32 v98, 4, v98
    v_and_b32 v99, 1, v96
    v_lshl_add_u32 v98, v99, 3, v98
    v_lshl_add_u32 v98, v103, 8, v98
    v_add_u32 v104, 32768, v98
    v_lshrrev_b32 v98, 1, v96
    s_lshl_b32 s11, s9, 2
    s_add_u32 s11, s11, 2
    v_add_u32 v98, s11, v98
    v_xor_b32 v98, v98, v97
    v_lshlrev_b32 v98, 4, v98
    v_and_b32 v99, 1, v96
    v_lshl_add_u32 v98, v99, 3, v98
    v_lshl_add_u32 v98, v103, 8, v98
    v_add_u32 v105, 32768, v98
    v_lshrrev_b32 v98, 1, v96
    s_lshl_b32 s11, s9, 1
    s_add_u32 s11, s11, 0
    v_add_u32 v98, s11, v98
    v_xor_b32 v98, v98, v97
    v_lshlrev_b32 v98, 4, v98
    v_and_b32 v99, 1, v96
    v_lshl_add_u32 v98, v99, 3, v98
    v_lshl_add_u32 v98, v103, 10, v98
    v_add_u32 v106, 32768, v98
    v_lshrrev_b32 v98, 1, v96
    s_lshl_b32 s11, s9, 1
    s_add_u32 s11, s11, 8
    v_add_u32 v98, s11, v98
    v_xor_b32 v98, v98, v97
    v_lshlrev_b32 v98, 4, v98
    v_and_b32 v99, 1, v96
    v_lshl_add_u32 v98, v99, 3, v98
    v_lshl_add_u32 v98, v103, 10, v98
    v_add_u32 v107, 32768, v98
    s_waitcnt lgkmcnt(0)
    s_lshl_b32 s11, s8, 8
    s_add_u32 s64, s64, s11
    s_addc_u32 s65, s65, 0
    s_add_u32 s66, s66, s11
    s_addc_u32 s67, s67, 0
    s_add_u32 s68, s68, s11
    s_addc_u32 s69, s69, 0
    s_lshl_b32 s11, s8, 17
    s_add_u32 s70, s70, s11
    s_addc_u32 s71, s71, 0
    s_lshl_b32 s11, s9, 15
    s_add_u32 s11, s11, 0
    s_add_u32 s12, s64, s11
    s_addc_u32 s13, s65, 0
    s_lshl_b32 s54, s9, 10
    s_add_u32 s54, s54, 32768
    s_mov_b32 m0, s54
    s_nop 0
    global_load_lds_dwordx4 v102, s[12:13]
    s_add_u32 s12, s12, 131072
    s_addc_u32 s13, s13, 0
    s_add_u32 s54, s54, 4096
    s_mov_b32 m0, s54
    s_nop 0
    global_load_lds_dwordx4 v102, s[12:13]
    s_add_u32 s12, s12, 131072
    s_addc_u32 s13, s13, 0
    s_add_u32 s54, s54, 4096
    s_mov_b32 m0, s54
    s_nop 0
    global_load_lds_dwordx4 v102, s[12:13]
    s_add_u32 s12, s12, 131072
    s_addc_u32 s13, s13, 0
    s_add_u32 s54, s54, 4096
    s_mov_b32 m0, s54
    s_nop 0
    global_load_lds_dwordx4 v102, s[12:13]
    s_add_u32 s12, s12, 131072
    s_addc_u32 s13, s13, 0
    s_add_u32 s54, s54, 4096
    s_mov_b32 m0, s54
    s_nop 0
    global_load_lds_dwordx4 v102, s[12:13]
    s_add_u32 s12, s12, 131072
    s_addc_u32 s13, s13, 0
    s_add_u32 s54, s54, 4096
    s_mov_b32 m0, s54
    s_nop 0
    global_load_lds_dwordx4 v102, s[12:13]
    s_add_u32 s12, s12, 131072
    s_addc_u32 s13, s13, 0
    s_add_u32 s54, s54, 4096
    s_mov_b32 m0, s54
    s_nop 0
    global_load_lds_dwordx4 v102, s[12:13]
    s_add_u32 s12, s12, 131072
    s_addc_u32 s13, s13, 0
    s_add_u32 s54, s54, 4096
    s_mov_b32 m0, s54
    s_nop 0
    global_load_lds_dwordx4 v102, s[12:13]
    s_add_u32 s12, s12, 131072
    s_addc_u32 s13, s13, 0
    s_add_u32 s54, s54, 4096
    s_mov_b32 m0, s54
    s_nop 0
    global_load_lds_dwordx4 v102, s[12:13]
    s_add_u32 s12, s12, 131072
    s_addc_u32 s13, s13, 0
    s_add_u32 s54, s54, 4096
    s_mov_b32 m0, s54
    s_nop 0
    global_load_lds_dwordx4 v102, s[12:13]
    s_add_u32 s12, s12, 131072
    s_addc_u32 s13, s13, 0
    s_add_u32 s54, s54, 4096
    s_mov_b32 m0, s54
    s_nop 0
    global_load_lds_dwordx4 v102, s[12:13]
    s_add_u32 s12, s12, 131072
    s_addc_u32 s13, s13, 0
    s_add_u32 s54, s54, 4096
    s_mov_b32 m0, s54
    s_nop 0
    global_load_lds_dwordx4 v102, s[12:13]
    s_add_u32 s12, s12, 131072
    s_addc_u32 s13, s13, 0
    s_add_u32 s54, s54, 4096
    s_mov_b32 m0, s54
    s_nop 0
    global_load_lds_dwordx4 v102, s[12:13]
    s_add_u32 s12, s12, 131072
    s_addc_u32 s13, s13, 0
    s_add_u32 s54, s54, 4096
    s_mov_b32 m0, s54
    s_nop 0
    global_load_lds_dwordx4 v102, s[12:13]
    s_add_u32 s12, s12, 131072
    s_addc_u32 s13, s13, 0
    s_add_u32 s54, s54, 4096
    s_mov_b32 m0, s54
    s_nop 0
    global_load_lds_dwordx4 v102, s[12:13]
    s_add_u32 s12, s12, 131072
    s_addc_u32 s13, s13, 0
    s_add_u32 s54, s54, 4096
    s_mov_b32 m0, s54
    s_nop 0
    global_load_lds_dwordx4 v102, s[12:13]
    s_lshl_b32 s11, s9, 15
    s_add_u32 s11, s11, 2097152
    s_add_u32 s12, s64, s11
    s_addc_u32 s13, s65, 0
    s_lshl_b32 s54, s9, 10
    s_add_u32 s54, s54, 98304
    s_mov_b32 m0, s54
    s_nop 0
    global_load_lds_dwordx4 v102, s[12:13]
    s_add_u32 s12, s12, 131072
    s_addc_u32 s13, s13, 0
    s_add_u32 s54, s54, 4096
    s_mov_b32 m0, s54
    s_nop 0
    global_load_lds_dwordx4 v102, s[12:13]
    s_add_u32 s12, s12, 131072
    s_addc_u32 s13, s13, 0
    s_add_u32 s54, s54, 4096
    s_mov_b32 m0, s54
    s_nop 0
    global_load_lds_dwordx4 v102, s[12:13]
    s_add_u32 s12, s12, 131072
    s_addc_u32 s13, s13, 0
    s_add_u32 s54, s54, 4096
    s_mov_b32 m0, s54
    s_nop 0
    global_load_lds_dwordx4 v102, s[12:13]
    s_add_u32 s12, s12, 131072
    s_addc_u32 s13, s13, 0
    s_add_u32 s54, s54, 4096
    s_mov_b32 m0, s54
    s_nop 0
    global_load_lds_dwordx4 v102, s[12:13]
    s_add_u32 s12, s12, 131072
    s_addc_u32 s13, s13, 0
    s_add_u32 s54, s54, 4096
    s_mov_b32 m0, s54
    s_nop 0
    global_load_lds_dwordx4 v102, s[12:13]
    s_add_u32 s12, s12, 131072
    s_addc_u32 s13, s13, 0
    s_add_u32 s54, s54, 4096
    s_mov_b32 m0, s54
    s_nop 0
    global_load_lds_dwordx4 v102, s[12:13]
    s_add_u32 s12, s12, 131072
    s_addc_u32 s13, s13, 0
    s_add_u32 s54, s54, 4096
    s_mov_b32 m0, s54
    s_nop 0
    global_load_lds_dwordx4 v102, s[12:13]
    s_add_u32 s12, s12, 131072
    s_addc_u32 s13, s13, 0
    s_add_u32 s54, s54, 4096
    s_mov_b32 m0, s54
    s_nop 0
    global_load_lds_dwordx4 v102, s[12:13]
    s_add_u32 s12, s12, 131072
    s_addc_u32 s13, s13, 0
    s_add_u32 s54, s54, 4096
    s_mov_b32 m0, s54
    s_nop 0
    global_load_lds_dwordx4 v102, s[12:13]
    s_add_u32 s12, s12, 131072
    s_addc_u32 s13, s13, 0
    s_add_u32 s54, s54, 4096
    s_mov_b32 m0, s54
    s_nop 0
    global_load_lds_dwordx4 v102, s[12:13]
    s_add_u32 s12, s12, 131072
    s_addc_u32 s13, s13, 0
    s_add_u32 s54, s54, 4096
    s_mov_b32 m0, s54
    s_nop 0
    global_load_lds_dwordx4 v102, s[12:13]
    s_add_u32 s12, s12, 131072
    s_addc_u32 s13, s13, 0
    s_add_u32 s54, s54, 4096
    s_mov_b32 m0, s54
    s_nop 0
    global_load_lds_dwordx4 v102, s[12:13]
    s_add_u32 s12, s12, 131072
    s_addc_u32 s13, s13, 0
    s_add_u32 s54, s54, 4096
    s_mov_b32 m0, s54
    s_nop 0
    global_load_lds_dwordx4 v102, s[12:13]
    s_add_u32 s12, s12, 131072
    s_addc_u32 s13, s13, 0
    s_add_u32 s54, s54, 4096
    s_mov_b32 m0, s54
    s_nop 0
    global_load_lds_dwordx4 v102, s[12:13]
    s_add_u32 s12, s12, 131072
    s_addc_u32 s13, s13, 0
    s_add_u32 s54, s54, 4096
    s_mov_b32 m0, s54
    s_nop 0
    global_load_lds_dwordx4 v102, s[12:13]
    v_and_b32 v98, 1, v92
    v_mov_b32 v99, 0x4444
    v_mov_b32 v100, 0xeeee
    v_cmp_eq_u32 vcc, 1, v98
    s_nop 1
    v_cndmask_b32 v0, v99, v100, vcc
    s_xor_b32 s11, s9, 0
    s_lshl_b32 s11, s11, 10
    v_add_u32 v1, s11, v5
    s_xor_b32 s11, s9, 1
    s_lshl_b32 s11, s11, 10
    v_add_u32 v2, s11, v5
    s_xor_b32 s11, s9, 2
    s_lshl_b32 s11, s11, 10
    v_add_u32 v3, s11, v5
    s_xor_b32 s11, s9, 3
    s_lshl_b32 s11, s11, 10
    v_add_u32 v4, s11, v5
    s_lshl_b32 s11, s9, 5
    v_add_u32 v98, s11, v93
    v_lshlrev_b32 v6, 4, v98
    v_lshl_add_u32 v6, v94, 2, v6
    v_add_u32 v6, 8192, v6
    v_lshlrev_b32 v7, 5, v98
    v_lshl_add_u32 v7, v94, 3, v7
    v_add_u32 v7, 10240, v7
    v_lshlrev_b32 v17, 6, v98
    v_lshl_add_u32 v17, v94, 4, v17
    v_lshl_add_u32 v98, v94, 3, v95
    v_and_b32 v99, 1, v96
    v_lshlrev_b32 v99, 3, v99
    v_lshl_add_u32 v8, v98, 4, v99
    v_add_u32 v8, 8192, v8
    v_lshlrev_b32 v99, 3, v96
    v_lshl_add_u32 v9, v98, 5, v99
    v_add_u32 v9, 10240, v9
    s_lshl_b32 s11, s9, 14
    s_add_u32 s11, s11, 32768
    v_add_u32 v10, s11, v5
    v_add_u32 v11, 0x10000, v10
    s_lshl_b32 s11, s9, 9
    s_add_u32 s11, s11, 14336
    v_and_b32 v98, 7, v93
    v_lshlrev_b32 v98, 5, v98
    v_lshl_add_u32 v98, v94, 3, v98
    v_add_u32 v12, s11, v98
    s_lshl_b32 s11, s9, 2
    v_add_u32 v98, s11, v94
    v_lshlrev_b32 v98, 11, v98
    v_lshl_add_u32 v98, v93, 2, v98
    s_lshl_b32 s11, s8, 6
    v_add_u32 v13, s11, v98
    s_lshl_b32 s11, s8, 2
    s_add_u32 s11, s11, s9
    s_lshl_b32 s11, s11, 11
    v_lshlrev_b32 v98, 2, v92
    v_add_u32 v14, s11, v98
    s_lshl_b32 s11, s8, 8
    s_lshl_b32 s54, s9, 6
    s_add_u32 s11, s11, s54
    v_and_b32 v98, 1, v93
    v_lshlrev_b32 v98, 5, v98
    v_lshl_add_u32 v98, v94, 3, v98
    v_add_u32 v15, s11, v98
    s_lshl_b32 s11, s9, 11
    v_add_u32 v16, s11, v5
    v_mov_b32 v18, -1
    v_mov_b32 v19, -1
    v_mov_b32 v98, 0
    v_mov_b32 v99, 0x3f80
    v_mov_b32 v100, 0x3f800000
    v_cmp_eq_u32 vcc, 0, v93
    s_nop 1
    v_cndmask_b32 v20, v98, v99, vcc
    v_cmp_eq_u32 vcc, 1, v93
    s_nop 1
    v_cndmask_b32 v20, v20, v100, vcc
    v_mov_b32 v21, v20
    v_mov_b32 v22, v20
    v_mov_b32 v23, v20
    v_mov_b32 v24, 0x3f803f80
    v_mov_b32 v25, 0x3f803f80
    v_mov_b32 v26, 0x3f803f80
    v_mov_b32 v27, 0x3f803f80
    s_mov_b32 s58, 0x00030003
    s_mov_b32 s59, 0x00030003
    s_mov_b32 s48, 0x3e0293ee
    s_mov_b32 s49, 0xbe0293ee
    v_mov_b32 v108, 0
    v_mov_b32 v109, 0
    v_mov_b32 v110, 0
    v_mov_b32 v111, 0
    s_lshl_b32 s11, s9, 10
    s_add_u32 s11, s11, 10240
    v_add_u32 v98, s11, v5
    ds_write_b128 v98, v[108:111]
    s_add_u32 s22, s4, 92274688
    s_addc_u32 s23, s5, 0
    s_add_u32 s50, s4, 92798976
    s_addc_u32 s51, s5, 0
    s_add_u32 s24, s22, 0
    s_addc_u32 s25, s23, 0
    s_add_u32 s26, s22, 32768
    s_addc_u32 s27, s23, 0
    s_add_u32 s28, s22, 65536
    s_addc_u32 s29, s23, 0
    s_add_u32 s30, s22, 98304
    s_addc_u32 s31, s23, 0
    s_add_u32 s32, s22, 131072
    s_addc_u32 s33, s23, 0
    s_add_u32 s34, s22, 163840
    s_addc_u32 s35, s23, 0
    s_add_u32 s36, s22, 196608
    s_addc_u32 s37, s23, 0
    s_add_u32 s38, s22, 229376
    s_addc_u32 s39, s23, 0
    s_lshl_b32 s11, s8, 13
    s_add_u32 s40, s4, s11
    s_addc_u32 s41, s5, 0
    s_add_u32 s40, s40, 16777216
    s_addc_u32 s41, s41, 0
    s_lshl_b32 s11, s8, 13
    s_add_u32 s42, s4, s11
    s_addc_u32 s43, s5, 0
    s_add_u32 s42, s42, 33554432
    s_addc_u32 s43, s43, 0
    s_lshl_b32 s11, s8, 11
    s_add_u32 s44, s4, s11
    s_addc_u32 s45, s5, 0
    s_add_u32 s44, s44, 67100672
    s_addc_u32 s45, s45, 0
    s_add_u32 s46, s4, s11
    s_addc_u32 s47, s5, 0
    s_add_u32 s46, s46, 71294976
    s_addc_u32 s47, s47, 0
    s_load_dwordx2 s[72:73], s[0:1], 8
    v_add_u32 v98, 0, v14
    global_store_dword v98, v18, s[22:23] offset:0 sc1
    global_store_dword v98, v18, s[22:23] offset:256 sc1
    global_store_dword v98, v18, s[22:23] offset:512 sc1
    global_store_dword v98, v18, s[22:23] offset:768 sc1
    global_store_dword v98, v18, s[22:23] offset:1024 sc1
    global_store_dword v98, v18, s[22:23] offset:1280 sc1
    global_store_dword v98, v18, s[22:23] offset:1536 sc1
    global_store_dword v98, v18, s[22:23] offset:1792 sc1
    v_add_u32 v98, 262144, v14
    global_store_dword v98, v18, s[22:23] offset:0 sc1
    global_store_dword v98, v18, s[22:23] offset:256 sc1
    global_store_dword v98, v18, s[22:23] offset:512 sc1
    global_store_dword v98, v18, s[22:23] offset:768 sc1
    global_store_dword v98, v18, s[22:23] offset:1024 sc1
    global_store_dword v98, v18, s[22:23] offset:1280 sc1
    global_store_dword v98, v18, s[22:23] offset:1536 sc1
    global_store_dword v98, v18, s[22:23] offset:1792 sc1
    s_mov_b64 exec, s[58:59]
    v_add_u32 v98, 8192, v15
    global_store_dwordx2 v98, v[18:19], s[50:51] sc1
    v_add_u32 v98, 16384, v15
    global_store_dwordx2 v98, v[18:19], s[50:51] sc1
    v_add_u32 v98, 24576, v15
    global_store_dwordx2 v98, v[18:19], s[50:51] sc1
    s_mov_b64 exec, -1
    v_and_b32 v98, 1, v93
    s_lshl_b32 s11, s9, 1
    v_add_u32 v98, s11, v98
    v_lshlrev_b32 v98, 10, v98
    v_lshl_add_u32 v98, v94, 3, v98
    s_lshl_b32 s11, s8, 5
    v_add_u32 v98, s11, v98
    v_mov_b32 v99, 200
    s_waitcnt lgkmcnt(0)
    global_load_dwordx2 v[108:109], v98, s[72:73]
    global_load_dword v110, v99, s[6:7] sc1
    s_waitcnt vmcnt(37)
    s_barrier
    s_xor_b32 s11, s9, 0
    s_lshl_b32 s11, s11, 14
    s_add_u32 s11, s11, 0
    v_add_u32 v98, s11, v104
    v_add_u32 v99, s11, v105
    ds_read_b64_tr_b16 a[0:1], v98 offset:0
    ds_read_b64_tr_b16 a[2:3], v98 offset:512
    ds_read_b64_tr_b16 a[4:5], v98 offset:8192
    ds_read_b64_tr_b16 a[6:7], v98 offset:8704
    ds_read_b64_tr_b16 a[8:9], v99 offset:0
    ds_read_b64_tr_b16 a[10:11], v99 offset:512
    ds_read_b64_tr_b16 a[12:13], v99 offset:8192
    ds_read_b64_tr_b16 a[14:15], v99 offset:8704
    s_waitcnt lgkmcnt(0)
    s_xor_b32 s11, s9, 1
    s_lshl_b32 s11, s11, 14
    s_add_u32 s11, s11, 0
    v_add_u32 v98, s11, v104
    v_add_u32 v99, s11, v105
    ds_read_b64_tr_b16 a[16:17], v98 offset:0
    ds_read_b64_tr_b16 a[18:19], v98 offset:512
    ds_read_b64_tr_b16 a[20:21], v98 offset:8192
    ds_read_b64_tr_b16 a[22:23], v98 offset:8704
    ds_read_b64_tr_b16 a[24:25], v99 offset:0
    ds_read_b64_tr_b16 a[26:27], v99 offset:512
    ds_read_b64_tr_b16 a[28:29], v99 offset:8192
    ds_read_b64_tr_b16 a[30:31], v99 offset:8704
    s_waitcnt lgkmcnt(0)
    s_xor_b32 s11, s9, 2
    s_lshl_b32 s11, s11, 14
    s_add_u32 s11, s11, 0
    v_add_u32 v98, s11, v104
    v_add_u32 v99, s11, v105
    ds_read_b64_tr_b16 a[32:33], v98 offset:0
    ds_read_b64_tr_b16 a[34:35], v98 offset:512
    ds_read_b64_tr_b16 a[36:37], v98 offset:8192
    ds_read_b64_tr_b16 a[38:39], v98 offset:8704
    ds_read_b64_tr_b16 a[40:41], v99 offset:0
    ds_read_b64_tr_b16 a[42:43], v99 offset:512
    ds_read_b64_tr_b16 a[44:45], v99 offset:8192
    ds_read_b64_tr_b16 a[46:47], v99 offset:8704
    s_waitcnt lgkmcnt(0)
    s_xor_b32 s11, s9, 3
    s_lshl_b32 s11, s11, 14
    s_add_u32 s11, s11, 0
    v_add_u32 v98, s11, v104
    v_add_u32 v99, s11, v105
    ds_read_b64_tr_b16 a[48:49], v98 offset:0
    ds_read_b64_tr_b16 a[50:51], v98 offset:512
    ds_read_b64_tr_b16 a[52:53], v98 offset:8192
    ds_read_b64_tr_b16 a[54:55], v98 offset:8704
    ds_read_b64_tr_b16 a[56:57], v99 offset:0
    ds_read_b64_tr_b16 a[58:59], v99 offset:512
    ds_read_b64_tr_b16 a[60:61], v99 offset:8192
    ds_read_b64_tr_b16 a[62:63], v99 offset:8704
    s_waitcnt lgkmcnt(0)
    s_barrier
    s_lshl_b32 s11, s9, 15
    s_add_u32 s11, s11, 0
    s_add_u32 s12, s66, s11
    s_addc_u32 s13, s67, 0
    s_lshl_b32 s54, s9, 10
    s_add_u32 s54, s54, 32768
    s_mov_b32 m0, s54
    s_nop 0
    global_load_lds_dwordx4 v102, s[12:13]
    s_add_u32 s12, s12, 131072
    s_addc_u32 s13, s13, 0
    s_add_u32 s54, s54, 4096
    s_mov_b32 m0, s54
    s_nop 0
    global_load_lds_dwordx4 v102, s[12:13]
    s_add_u32 s12, s12, 131072
    s_addc_u32 s13, s13, 0
    s_add_u32 s54, s54, 4096
    s_mov_b32 m0, s54
    s_nop 0
    global_load_lds_dwordx4 v102, s[12:13]
    s_add_u32 s12, s12, 131072
    s_addc_u32 s13, s13, 0
    s_add_u32 s54, s54, 4096
    s_mov_b32 m0, s54
    s_nop 0
    global_load_lds_dwordx4 v102, s[12:13]
    s_add_u32 s12, s12, 131072
    s_addc_u32 s13, s13, 0
    s_add_u32 s54, s54, 4096
    s_mov_b32 m0, s54
    s_nop 0
    global_load_lds_dwordx4 v102, s[12:13]
    s_add_u32 s12, s12, 131072
    s_addc_u32 s13, s13, 0
    s_add_u32 s54, s54, 4096
    s_mov_b32 m0, s54
    s_nop 0
    global_load_lds_dwordx4 v102, s[12:13]
    s_add_u32 s12, s12, 131072
    s_addc_u32 s13, s13, 0
    s_add_u32 s54, s54, 4096
    s_mov_b32 m0, s54
    s_nop 0
    global_load_lds_dwordx4 v102, s[12:13]
    s_add_u32 s12, s12, 131072
    s_addc_u32 s13, s13, 0
    s_add_u32 s54, s54, 4096
    s_mov_b32 m0, s54
    s_nop 0
    global_load_lds_dwordx4 v102, s[12:13]
    s_add_u32 s12, s12, 131072
    s_addc_u32 s13, s13, 0
    s_add_u32 s54, s54, 4096
    s_mov_b32 m0, s54
    s_nop 0
    global_load_lds_dwordx4 v102, s[12:13]
    s_add_u32 s12, s12, 131072
    s_addc_u32 s13, s13, 0
    s_add_u32 s54, s54, 4096
    s_mov_b32 m0, s54
    s_nop 0
    global_load_lds_dwordx4 v102, s[12:13]
    s_add_u32 s12, s12, 131072
    s_addc_u32 s13, s13, 0
    s_add_u32 s54, s54, 4096
    s_mov_b32 m0, s54
    s_nop 0
    global_load_lds_dwordx4 v102, s[12:13]
    s_add_u32 s12, s12, 131072
    s_addc_u32 s13, s13, 0
    s_add_u32 s54, s54, 4096
    s_mov_b32 m0, s54
    s_nop 0
    global_load_lds_dwordx4 v102, s[12:13]
    s_add_u32 s12, s12, 131072
    s_addc_u32 s13, s13, 0
    s_add_u32 s54, s54, 4096
    s_mov_b32 m0, s54
    s_nop 0
    global_load_lds_dwordx4 v102, s[12:13]
    s_add_u32 s12, s12, 131072
    s_addc_u32 s13, s13, 0
    s_add_u32 s54, s54, 4096
    s_mov_b32 m0, s54
    s_nop 0
    global_load_lds_dwordx4 v102, s[12:13]
    s_add_u32 s12, s12, 131072
    s_addc_u32 s13, s13, 0
    s_add_u32 s54, s54, 4096
    s_mov_b32 m0, s54
    s_nop 0
    global_load_lds_dwordx4 v102, s[12:13]
    s_add_u32 s12, s12, 131072
    s_addc_u32 s13, s13, 0
    s_add_u32 s54, s54, 4096
    s_mov_b32 m0, s54
    s_nop 0
    global_load_lds_dwordx4 v102, s[12:13]
    s_waitcnt vmcnt(37)
    s_barrier
    s_xor_b32 s11, s9, 0
    s_lshl_b32 s11, s11, 14
    s_add_u32 s11, s11, 65536
    v_add_u32 v98, s11, v104
    v_add_u32 v99, s11, v105
    ds_read_b64_tr_b16 a[64:65], v98 offset:0
    ds_read_b64_tr_b16 a[66:67], v98 offset:512
    ds_read_b64_tr_b16 a[68:69], v98 offset:8192
    ds_read_b64_tr_b16 a[70:71], v98 offset:8704
    ds_read_b64_tr_b16 a[72:73], v99 offset:0
    ds_read_b64_tr_b16 a[74:75], v99 offset:512
    ds_read_b64_tr_b16 a[76:77], v99 offset:8192
    ds_read_b64_tr_b16 a[78:79], v99 offset:8704
    s_waitcnt lgkmcnt(0)
    s_xor_b32 s11, s9, 1
    s_lshl_b32 s11, s11, 14
    s_add_u32 s11, s11, 65536
    v_add_u32 v98, s11, v104
    v_add_u32 v99, s11, v105
    ds_read_b64_tr_b16 a[80:81], v98 offset:0
    ds_read_b64_tr_b16 a[82:83], v98 offset:512
    ds_read_b64_tr_b16 a[84:85], v98 offset:8192
    ds_read_b64_tr_b16 a[86:87], v98 offset:8704
    ds_read_b64_tr_b16 a[88:89], v99 offset:0
    ds_read_b64_tr_b16 a[90:91], v99 offset:512
    ds_read_b64_tr_b16 a[92:93], v99 offset:8192
    ds_read_b64_tr_b16 a[94:95], v99 offset:8704
    s_waitcnt lgkmcnt(0)
    s_xor_b32 s11, s9, 2
    s_lshl_b32 s11, s11, 14
    s_add_u32 s11, s11, 65536
    v_add_u32 v98, s11, v104
    v_add_u32 v99, s11, v105
    ds_read_b64_tr_b16 a[96:97], v98 offset:0
    ds_read_b64_tr_b16 a[98:99], v98 offset:512
    ds_read_b64_tr_b16 a[100:101], v98 offset:8192
    ds_read_b64_tr_b16 a[102:103], v98 offset:8704
    ds_read_b64_tr_b16 a[104:105], v99 offset:0
    ds_read_b64_tr_b16 a[106:107], v99 offset:512
    ds_read_b64_tr_b16 a[108:109], v99 offset:8192
    ds_read_b64_tr_b16 a[110:111], v99 offset:8704
    s_waitcnt lgkmcnt(0)
    s_xor_b32 s11, s9, 3
    s_lshl_b32 s11, s11, 14
    s_add_u32 s11, s11, 65536
    v_add_u32 v98, s11, v104
    v_add_u32 v99, s11, v105
    ds_read_b64_tr_b16 a[112:113], v98 offset:0
    ds_read_b64_tr_b16 a[114:115], v98 offset:512
    ds_read_b64_tr_b16 a[116:117], v98 offset:8192
    ds_read_b64_tr_b16 a[118:119], v98 offset:8704
    ds_read_b64_tr_b16 a[120:121], v99 offset:0
    ds_read_b64_tr_b16 a[122:123], v99 offset:512
    ds_read_b64_tr_b16 a[124:125], v99 offset:8192
    ds_read_b64_tr_b16 a[126:127], v99 offset:8704
    s_waitcnt lgkmcnt(0)
    s_barrier
    s_lshl_b32 s11, s9, 15
    s_add_u32 s11, s11, 2097152
    s_add_u32 s12, s66, s11
    s_addc_u32 s13, s67, 0
    s_lshl_b32 s54, s9, 10
    s_add_u32 s54, s54, 98304
    s_mov_b32 m0, s54
    s_nop 0
    global_load_lds_dwordx4 v102, s[12:13]
    s_add_u32 s12, s12, 131072
    s_addc_u32 s13, s13, 0
    s_add_u32 s54, s54, 4096
    s_mov_b32 m0, s54
    s_nop 0
    global_load_lds_dwordx4 v102, s[12:13]
    s_add_u32 s12, s12, 131072
    s_addc_u32 s13, s13, 0
    s_add_u32 s54, s54, 4096
    s_mov_b32 m0, s54
    s_nop 0
    global_load_lds_dwordx4 v102, s[12:13]
    s_add_u32 s12, s12, 131072
    s_addc_u32 s13, s13, 0
    s_add_u32 s54, s54, 4096
    s_mov_b32 m0, s54
    s_nop 0
    global_load_lds_dwordx4 v102, s[12:13]
    s_add_u32 s12, s12, 131072
    s_addc_u32 s13, s13, 0
    s_add_u32 s54, s54, 4096
    s_mov_b32 m0, s54
    s_nop 0
    global_load_lds_dwordx4 v102, s[12:13]
    s_add_u32 s12, s12, 131072
    s_addc_u32 s13, s13, 0
    s_add_u32 s54, s54, 4096
    s_mov_b32 m0, s54
    s_nop 0
    global_load_lds_dwordx4 v102, s[12:13]
    s_add_u32 s12, s12, 131072
    s_addc_u32 s13, s13, 0
    s_add_u32 s54, s54, 4096
    s_mov_b32 m0, s54
    s_nop 0
    global_load_lds_dwordx4 v102, s[12:13]
    s_add_u32 s12, s12, 131072
    s_addc_u32 s13, s13, 0
    s_add_u32 s54, s54, 4096
    s_mov_b32 m0, s54
    s_nop 0
    global_load_lds_dwordx4 v102, s[12:13]
    s_add_u32 s12, s12, 131072
    s_addc_u32 s13, s13, 0
    s_add_u32 s54, s54, 4096
    s_mov_b32 m0, s54
    s_nop 0
    global_load_lds_dwordx4 v102, s[12:13]
    s_add_u32 s12, s12, 131072
    s_addc_u32 s13, s13, 0
    s_add_u32 s54, s54, 4096
    s_mov_b32 m0, s54
    s_nop 0
    global_load_lds_dwordx4 v102, s[12:13]
    s_add_u32 s12, s12, 131072
    s_addc_u32 s13, s13, 0
    s_add_u32 s54, s54, 4096
    s_mov_b32 m0, s54
    s_nop 0
    global_load_lds_dwordx4 v102, s[12:13]
    s_add_u32 s12, s12, 131072
    s_addc_u32 s13, s13, 0
    s_add_u32 s54, s54, 4096
    s_mov_b32 m0, s54
    s_nop 0
    global_load_lds_dwordx4 v102, s[12:13]
    s_add_u32 s12, s12, 131072
    s_addc_u32 s13, s13, 0
    s_add_u32 s54, s54, 4096
    s_mov_b32 m0, s54
    s_nop 0
    global_load_lds_dwordx4 v102, s[12:13]
    s_add_u32 s12, s12, 131072
    s_addc_u32 s13, s13, 0
    s_add_u32 s54, s54, 4096
    s_mov_b32 m0, s54
    s_nop 0
    global_load_lds_dwordx4 v102, s[12:13]
    s_add_u32 s12, s12, 131072
    s_addc_u32 s13, s13, 0
    s_add_u32 s54, s54, 4096
    s_mov_b32 m0, s54
    s_nop 0
    global_load_lds_dwordx4 v102, s[12:13]
    s_add_u32 s12, s12, 131072
    s_addc_u32 s13, s13, 0
    s_add_u32 s54, s54, 4096
    s_mov_b32 m0, s54
    s_nop 0
    global_load_lds_dwordx4 v102, s[12:13]
    s_waitcnt vmcnt(16)
    s_barrier
    s_xor_b32 s11, s9, 0
    s_lshl_b32 s11, s11, 14
    s_add_u32 s11, s11, 0
    v_add_u32 v98, s11, v104
    v_add_u32 v99, s11, v105
    ds_read_b64_tr_b16 a[128:129], v98 offset:0
    ds_read_b64_tr_b16 a[130:131], v98 offset:512
    ds_read_b64_tr_b16 a[132:133], v98 offset:8192
    ds_read_b64_tr_b16 a[134:135], v98 offset:8704
    ds_read_b64_tr_b16 a[136:137], v99 offset:0
    ds_read_b64_tr_b16 a[138:139], v99 offset:512
    ds_read_b64_tr_b16 a[140:141], v99 offset:8192
    ds_read_b64_tr_b16 a[142:143], v99 offset:8704
    s_waitcnt lgkmcnt(0)
    s_xor_b32 s11, s9, 1
    s_lshl_b32 s11, s11, 14
    s_add_u32 s11, s11, 0
    v_add_u32 v98, s11, v104
    v_add_u32 v99, s11, v105
    ds_read_b64_tr_b16 a[144:145], v98 offset:0
    ds_read_b64_tr_b16 a[146:147], v98 offset:512
    ds_read_b64_tr_b16 a[148:149], v98 offset:8192
    ds_read_b64_tr_b16 a[150:151], v98 offset:8704
    ds_read_b64_tr_b16 a[152:153], v99 offset:0
    ds_read_b64_tr_b16 a[154:155], v99 offset:512
    ds_read_b64_tr_b16 a[156:157], v99 offset:8192
    ds_read_b64_tr_b16 a[158:159], v99 offset:8704
    s_waitcnt lgkmcnt(0)
    s_xor_b32 s11, s9, 2
    s_lshl_b32 s11, s11, 14
    s_add_u32 s11, s11, 0
    v_add_u32 v98, s11, v104
    v_add_u32 v99, s11, v105
    ds_read_b64_tr_b16 a[160:161], v98 offset:0
    ds_read_b64_tr_b16 a[162:163], v98 offset:512
    ds_read_b64_tr_b16 a[164:165], v98 offset:8192
    ds_read_b64_tr_b16 a[166:167], v98 offset:8704
    ds_read_b64_tr_b16 a[168:169], v99 offset:0
    ds_read_b64_tr_b16 a[170:171], v99 offset:512
    ds_read_b64_tr_b16 a[172:173], v99 offset:8192
    ds_read_b64_tr_b16 a[174:175], v99 offset:8704
    s_waitcnt lgkmcnt(0)
    s_xor_b32 s11, s9, 3
    s_lshl_b32 s11, s11, 14
    s_add_u32 s11, s11, 0
    v_add_u32 v98, s11, v104
    v_add_u32 v99, s11, v105
    ds_read_b64_tr_b16 a[176:177], v98 offset:0
    ds_read_b64_tr_b16 a[178:179], v98 offset:512
    ds_read_b64_tr_b16 a[180:181], v98 offset:8192
    ds_read_b64_tr_b16 a[182:183], v98 offset:8704
    ds_read_b64_tr_b16 a[184:185], v99 offset:0
    ds_read_b64_tr_b16 a[186:187], v99 offset:512
    ds_read_b64_tr_b16 a[188:189], v99 offset:8192
    ds_read_b64_tr_b16 a[190:191], v99 offset:8704
    s_waitcnt lgkmcnt(0)
    s_barrier
    s_mov_b64 exec, s[58:59]
    global_store_dwordx2 v15, v[108:109], s[50:51] sc1
    s_mov_b64 exec, -1
    v_readfirstlane_b32 s11, v110
    s_mov_b32 s52, 0
L_init:
    s_cmp_lg_u32 s11, 0
    s_cbranch_scc1 L_initok
    v_mov_b32 v99, 200
    global_load_dword v110, v99, s[6:7] sc1
    s_waitcnt vmcnt(0)
    v_readfirstlane_b32 s11, v110
    s_add_u32 s52, s52, 1
    s_cmp_lt_u32 s52, 200000
    s_cbranch_scc1 L_init
L_initok:
    s_lshl_b32 s11, s9, 14
    s_add_u32 s54, s11, 32768
    s_add_u32 s11, s11, 0
    s_add_u32 s12, s70, s11
    s_addc_u32 s13, s71, 0
    v_xor_b32 v98, 0, v5
    s_mov_b32 m0, s54
    s_nop 0
    global_load_lds_dwordx4 v98, s[12:13]
    s_add_u32 s12, s12, 1024
    s_addc_u32 s13, s13, 0
    s_add_u32 s54, s54, 1024
    v_xor_b32 v98, 32, v5
    s_mov_b32 m0, s54
    s_nop 0
    global_load_lds_dwordx4 v98, s[12:13]
    s_add_u32 s12, s12, 1024
    s_addc_u32 s13, s13, 0
    s_add_u32 s54, s54, 1024
    v_xor_b32 v98, 0, v5
    s_mov_b32 m0, s54
    s_nop 0
    global_load_lds_dwordx4 v98, s[12:13]
    s_add_u32 s12, s12, 1024
    s_addc_u32 s13, s13, 0
    s_add_u32 s54, s54, 1024
    v_xor_b32 v98, 32, v5
    s_mov_b32 m0, s54
    s_nop 0
    global_load_lds_dwordx4 v98, s[12:13]
    s_add_u32 s12, s12, 1024
    s_addc_u32 s13, s13, 0
    s_add_u32 s54, s54, 1024
    v_xor_b32 v98, 64, v5
    s_mov_b32 m0, s54
    s_nop 0
    global_load_lds_dwordx4 v98, s[12:13]
    s_add_u32 s12, s12, 1024
    s_addc_u32 s13, s13, 0
    s_add_u32 s54, s54, 1024
    v_xor_b32 v98, 96, v5
    s_mov_b32 m0, s54
    s_nop 0
    global_load_lds_dwordx4 v98, s[12:13]
    s_add_u32 s12, s12, 1024
    s_addc_u32 s13, s13, 0
    s_add_u32 s54, s54, 1024
    v_xor_b32 v98, 64, v5
    s_mov_b32 m0, s54
    s_nop 0
    global_load_lds_dwordx4 v98, s[12:13]
    s_add_u32 s12, s12, 1024
    s_addc_u32 s13, s13, 0
    s_add_u32 s54, s54, 1024
    v_xor_b32 v98, 96, v5
    s_mov_b32 m0, s54
    s_nop 0
    global_load_lds_dwordx4 v98, s[12:13]
    s_add_u32 s12, s12, 1024
    s_addc_u32 s13, s13, 0
    s_add_u32 s54, s54, 1024
    v_xor_b32 v98, 128, v5
    s_mov_b32 m0, s54
    s_nop 0
    global_load_lds_dwordx4 v98, s[12:13]
    s_add_u32 s12, s12, 1024
    s_addc_u32 s13, s13, 0
    s_add_u32 s54, s54, 1024
    v_xor_b32 v98, 160, v5
    s_mov_b32 m0, s54
    s_nop 0
    global_load_lds_dwordx4 v98, s[12:13]
    s_add_u32 s12, s12, 1024
    s_addc_u32 s13, s13, 0
    s_add_u32 s54, s54, 1024
    v_xor_b32 v98, 128, v5
    s_mov_b32 m0, s54
    s_nop 0
    global_load_lds_dwordx4 v98, s[12:13]
    s_add_u32 s12, s12, 1024
    s_addc_u32 s13, s13, 0
    s_add_u32 s54, s54, 1024
    v_xor_b32 v98, 160, v5
    s_mov_b32 m0, s54
    s_nop 0
    global_load_lds_dwordx4 v98, s[12:13]
    s_add_u32 s12, s12, 1024
    s_addc_u32 s13, s13, 0
    s_add_u32 s54, s54, 1024
    v_xor_b32 v98, 192, v5
    s_mov_b32 m0, s54
    s_nop 0
    global_load_lds_dwordx4 v98, s[12:13]
    s_add_u32 s12, s12, 1024
    s_addc_u32 s13, s13, 0
    s_add_u32 s54, s54, 1024
    v_xor_b32 v98, 224, v5
    s_mov_b32 m0, s54
    s_nop 0
    global_load_lds_dwordx4 v98, s[12:13]
    s_add_u32 s12, s12, 1024
    s_addc_u32 s13, s13, 0
    s_add_u32 s54, s54, 1024
    v_xor_b32 v98, 192, v5
    s_mov_b32 m0, s54
    s_nop 0
    global_load_lds_dwordx4 v98, s[12:13]
    s_add_u32 s12, s12, 1024
    s_addc_u32 s13, s13, 0
    s_add_u32 s54, s54, 1024
    v_xor_b32 v98, 224, v5
    s_mov_b32 m0, s54
    s_nop 0
    global_load_lds_dwordx4 v98, s[12:13]
    s_waitcnt vmcnt(16)
    s_barrier
    s_cmp_eq_u32 s9, 0
    s_cbranch_scc0 L_arr_skip
    s_mov_b64 exec, 1
    v_mov_b32 v98, 128
    v_mov_b32 v99, 1
    global_atomic_add v98, v99, s[6:7]
    s_mov_b64 exec, -1
L_arr_skip:
    s_xor_b32 s11, s9, 0
    s_lshl_b32 s11, s11, 14
    s_add_u32 s11, s11, 65536
    v_add_u32 v98, s11, v104
    v_add_u32 v99, s11, v105
    ds_read_b64_tr_b16 a[192:193], v98 offset:0
    ds_read_b64_tr_b16 a[194:195], v98 offset:512
    ds_read_b64_tr_b16 a[196:197], v98 offset:8192
    ds_read_b64_tr_b16 a[198:199], v98 offset:8704
    ds_read_b64_tr_b16 a[200:201], v99 offset:0
    ds_read_b64_tr_b16 a[202:203], v99 offset:512
    ds_read_b64_tr_b16 a[204:205], v99 offset:8192
    ds_read_b64_tr_b16 a[206:207], v99 offset:8704
    s_waitcnt lgkmcnt(0)
    s_xor_b32 s11, s9, 1
    s_lshl_b32 s11, s11, 14
    s_add_u32 s11, s11, 65536
    v_add_u32 v98, s11, v104
    v_add_u32 v99, s11, v105
    ds_read_b64_tr_b16 a[208:209], v98 offset:0
    ds_read_b64_tr_b16 a[210:211], v98 offset:512
    ds_read_b64_tr_b16 a[212:213], v98 offset:8192
    ds_read_b64_tr_b16 a[214:215], v98 offset:8704
    ds_read_b64_tr_b16 a[216:217], v99 offset:0
    ds_read_b64_tr_b16 a[218:219], v99 offset:512
    ds_read_b64_tr_b16 a[220:221], v99 offset:8192
    ds_read_b64_tr_b16 a[222:223], v99 offset:8704
    s_waitcnt lgkmcnt(0)
    s_xor_b32 s11, s9, 2
    s_lshl_b32 s11, s11, 14
    s_add_u32 s11, s11, 65536
    v_add_u32 v98, s11, v104
    v_add_u32 v99, s11, v105
    ds_read_b64_tr_b16 a[224:225], v98 offset:0
    ds_read_b64_tr_b16 a[226:227], v98 offset:512
    ds_read_b64_tr_b16 a[228:229], v98 offset:8192
    ds_read_b64_tr_b16 a[230:231], v98 offset:8704
    ds_read_b64_tr_b16 a[232:233], v99 offset:0
    ds_read_b64_tr_b16 a[234:235], v99 offset:512
    ds_read_b64_tr_b16 a[236:237], v99 offset:8192
    ds_read_b64_tr_b16 a[238:239], v99 offset:8704
    s_waitcnt lgkmcnt(0)
    s_xor_b32 s11, s9, 3
    s_lshl_b32 s11, s11, 14
    s_add_u32 s11, s11, 65536
    v_add_u32 v98, s11, v104
    v_add_u32 v99, s11, v105
    ds_read_b64_tr_b16 a[240:241], v98 offset:0
    ds_read_b64_tr_b16 a[242:243], v98 offset:512
    ds_read_b64_tr_b16 a[244:245], v98 offset:8192
    ds_read_b64_tr_b16 a[246:247], v98 offset:8704
    ds_read_b64_tr_b16 a[248:249], v99 offset:0
    ds_read_b64_tr_b16 a[250:251], v99 offset:512
    ds_read_b64_tr_b16 a[252:253], v99 offset:8192
    ds_read_b64_tr_b16 a[254:255], v99 offset:8704
    s_waitcnt lgkmcnt(0)
    s_barrier
    s_lshl_b32 s11, s9, 14
    s_add_u32 s54, s11, 98304
    s_add_u32 s11, s11, 65536
    s_add_u32 s12, s70, s11
    s_addc_u32 s13, s71, 0
    v_xor_b32 v98, 0, v5
    s_mov_b32 m0, s54
    s_nop 0
    global_load_lds_dwordx4 v98, s[12:13]
    s_add_u32 s12, s12, 1024
    s_addc_u32 s13, s13, 0
    s_add_u32 s54, s54, 1024
    v_xor_b32 v98, 32, v5
    s_mov_b32 m0, s54
    s_nop 0
    global_load_lds_dwordx4 v98, s[12:13]
    s_add_u32 s12, s12, 1024
    s_addc_u32 s13, s13, 0
    s_add_u32 s54, s54, 1024
    v_xor_b32 v98, 0, v5
    s_mov_b32 m0, s54
    s_nop 0
    global_load_lds_dwordx4 v98, s[12:13]
    s_add_u32 s12, s12, 1024
    s_addc_u32 s13, s13, 0
    s_add_u32 s54, s54, 1024
    v_xor_b32 v98, 32, v5
    s_mov_b32 m0, s54
    s_nop 0
    global_load_lds_dwordx4 v98, s[12:13]
    s_add_u32 s12, s12, 1024
    s_addc_u32 s13, s13, 0
    s_add_u32 s54, s54, 1024
    v_xor_b32 v98, 64, v5
    s_mov_b32 m0, s54
    s_nop 0
    global_load_lds_dwordx4 v98, s[12:13]
    s_add_u32 s12, s12, 1024
    s_addc_u32 s13, s13, 0
    s_add_u32 s54, s54, 1024
    v_xor_b32 v98, 96, v5
    s_mov_b32 m0, s54
    s_nop 0
    global_load_lds_dwordx4 v98, s[12:13]
    s_add_u32 s12, s12, 1024
    s_addc_u32 s13, s13, 0
    s_add_u32 s54, s54, 1024
    v_xor_b32 v98, 64, v5
    s_mov_b32 m0, s54
    s_nop 0
    global_load_lds_dwordx4 v98, s[12:13]
    s_add_u32 s12, s12, 1024
    s_addc_u32 s13, s13, 0
    s_add_u32 s54, s54, 1024
    v_xor_b32 v98, 96, v5
    s_mov_b32 m0, s54
    s_nop 0
    global_load_lds_dwordx4 v98, s[12:13]
    s_add_u32 s12, s12, 1024
    s_addc_u32 s13, s13, 0
    s_add_u32 s54, s54, 1024
    v_xor_b32 v98, 128, v5
    s_mov_b32 m0, s54
    s_nop 0
    global_load_lds_dwordx4 v98, s[12:13]
    s_add_u32 s12, s12, 1024
    s_addc_u32 s13, s13, 0
    s_add_u32 s54, s54, 1024
    v_xor_b32 v98, 160, v5
    s_mov_b32 m0, s54
    s_nop 0
    global_load_lds_dwordx4 v98, s[12:13]
    s_add_u32 s12, s12, 1024
    s_addc_u32 s13, s13, 0
    s_add_u32 s54, s54, 1024
    v_xor_b32 v98, 128, v5
    s_mov_b32 m0, s54
    s_nop 0
    global_load_lds_dwordx4 v98, s[12:13]
    s_add_u32 s12, s12, 1024
    s_addc_u32 s13, s13, 0
    s_add_u32 s54, s54, 1024
    v_xor_b32 v98, 160, v5
    s_mov_b32 m0, s54
    s_nop 0
    global_load_lds_dwordx4 v98, s[12:13]
    s_add_u32 s12, s12, 1024
    s_addc_u32 s13, s13, 0
    s_add_u32 s54, s54, 1024
    v_xor_b32 v98, 192, v5
    s_mov_b32 m0, s54
    s_nop 0
    global_load_lds_dwordx4 v98, s[12:13]
    s_add_u32 s12, s12, 1024
    s_addc_u32 s13, s13, 0
    s_add_u32 s54, s54, 1024
    v_xor_b32 v98, 224, v5
    s_mov_b32 m0, s54
    s_nop 0
    global_load_lds_dwordx4 v98, s[12:13]
    s_add_u32 s12, s12, 1024
    s_addc_u32 s13, s13, 0
    s_add_u32 s54, s54, 1024
    v_xor_b32 v98, 192, v5
    s_mov_b32 m0, s54
    s_nop 0
    global_load_lds_dwordx4 v98, s[12:13]
    s_add_u32 s12, s12, 1024
    s_addc_u32 s13, s13, 0
    s_add_u32 s54, s54, 1024
    v_xor_b32 v98, 224, v5
    s_mov_b32 m0, s54
    s_nop 0
    global_load_lds_dwordx4 v98, s[12:13]
    s_waitcnt vmcnt(16)
    s_barrier
    v_add_u32 v98, 0, v106
    v_add_u32 v99, 0, v107
    ds_read_b64_tr_b16 v[28:29], v98 offset:0
    ds_read_b64_tr_b16 v[30:31], v98 offset:2048
    ds_read_b64_tr_b16 v[32:33], v98 offset:32768
    ds_read_b64_tr_b16 v[34:35], v98 offset:34816
    ds_read_b64_tr_b16 v[44:45], v99 offset:0
    ds_read_b64_tr_b16 v[46:47], v99 offset:2048
    ds_read_b64_tr_b16 v[48:49], v99 offset:32768
    ds_read_b64_tr_b16 v[50:51], v99 offset:34816
    s_waitcnt lgkmcnt(0)
    ds_read_b64_tr_b16 v[60:61], v98 offset:256
    ds_read_b64_tr_b16 v[62:63], v98 offset:2304
    ds_read_b64_tr_b16 v[64:65], v98 offset:33024
    ds_read_b64_tr_b16 v[66:67], v98 offset:35072
    ds_read_b64_tr_b16 v[76:77], v99 offset:256
    ds_read_b64_tr_b16 v[78:79], v99 offset:2304
    ds_read_b64_tr_b16 v[80:81], v99 offset:33024
    ds_read_b64_tr_b16 v[82:83], v99 offset:35072
    s_waitcnt lgkmcnt(0)
    ds_read_b64_tr_b16 v[192:193], v98 offset:512
    ds_read_b64_tr_b16 v[194:195], v98 offset:2560
    ds_read_b64_tr_b16 v[196:197], v98 offset:33280
    ds_read_b64_tr_b16 v[198:199], v98 offset:35328
    ds_read_b64_tr_b16 v[208:209], v99 offset:512
    ds_read_b64_tr_b16 v[210:211], v99 offset:2560
    ds_read_b64_tr_b16 v[212:213], v99 offset:33280
    ds_read_b64_tr_b16 v[214:215], v99 offset:35328
    s_waitcnt lgkmcnt(0)
    ds_read_b64_tr_b16 v[224:225], v98 offset:768
    ds_read_b64_tr_b16 v[226:227], v98 offset:2816
    ds_read_b64_tr_b16 v[228:229], v98 offset:33536
    ds_read_b64_tr_b16 v[230:231], v98 offset:35584
    ds_read_b64_tr_b16 v[240:241], v99 offset:768
    ds_read_b64_tr_b16 v[242:243], v99 offset:2816
    ds_read_b64_tr_b16 v[244:245], v99 offset:33536
    ds_read_b64_tr_b16 v[246:247], v99 offset:35584
    s_waitcnt lgkmcnt(0)
    s_barrier
    s_lshl_b32 s11, s9, 15
    s_add_u32 s11, s11, 0
    s_add_u32 s12, s68, s11
    s_addc_u32 s13, s69, 0
    s_lshl_b32 s54, s9, 10
    s_add_u32 s54, s54, 32768
    s_mov_b32 m0, s54
    s_nop 0
    global_load_lds_dwordx4 v102, s[12:13]
    s_add_u32 s12, s12, 131072
    s_addc_u32 s13, s13, 0
    s_add_u32 s54, s54, 4096
    s_mov_b32 m0, s54
    s_nop 0
    global_load_lds_dwordx4 v102, s[12:13]
    s_add_u32 s12, s12, 131072
    s_addc_u32 s13, s13, 0
    s_add_u32 s54, s54, 4096
    s_mov_b32 m0, s54
    s_nop 0
    global_load_lds_dwordx4 v102, s[12:13]
    s_add_u32 s12, s12, 131072
    s_addc_u32 s13, s13, 0
    s_add_u32 s54, s54, 4096
    s_mov_b32 m0, s54
    s_nop 0
    global_load_lds_dwordx4 v102, s[12:13]
    s_add_u32 s12, s12, 131072
    s_addc_u32 s13, s13, 0
    s_add_u32 s54, s54, 4096
    s_mov_b32 m0, s54
    s_nop 0
    global_load_lds_dwordx4 v102, s[12:13]
    s_add_u32 s12, s12, 131072
    s_addc_u32 s13, s13, 0
    s_add_u32 s54, s54, 4096
    s_mov_b32 m0, s54
    s_nop 0
    global_load_lds_dwordx4 v102, s[12:13]
    s_add_u32 s12, s12, 131072
    s_addc_u32 s13, s13, 0
    s_add_u32 s54, s54, 4096
    s_mov_b32 m0, s54
    s_nop 0
    global_load_lds_dwordx4 v102, s[12:13]
    s_add_u32 s12, s12, 131072
    s_addc_u32 s13, s13, 0
    s_add_u32 s54, s54, 4096
    s_mov_b32 m0, s54
    s_nop 0
    global_load_lds_dwordx4 v102, s[12:13]
    s_add_u32 s12, s12, 131072
    s_addc_u32 s13, s13, 0
    s_add_u32 s54, s54, 4096
    s_mov_b32 m0, s54
    s_nop 0
    global_load_lds_dwordx4 v102, s[12:13]
    s_add_u32 s12, s12, 131072
    s_addc_u32 s13, s13, 0
    s_add_u32 s54, s54, 4096
    s_mov_b32 m0, s54
    s_nop 0
    global_load_lds_dwordx4 v102, s[12:13]
    s_add_u32 s12, s12, 131072
    s_addc_u32 s13, s13, 0
    s_add_u32 s54, s54, 4096
    s_mov_b32 m0, s54
    s_nop 0
    global_load_lds_dwordx4 v102, s[12:13]
    s_add_u32 s12, s12, 131072
    s_addc_u32 s13, s13, 0
    s_add_u32 s54, s54, 4096
    s_mov_b32 m0, s54
    s_nop 0
    global_load_lds_dwordx4 v102, s[12:13]
    s_add_u32 s12, s12, 131072
    s_addc_u32 s13, s13, 0
    s_add_u32 s54, s54, 4096
    s_mov_b32 m0, s54
    s_nop 0
    global_load_lds_dwordx4 v102, s[12:13]
    s_add_u32 s12, s12, 131072
    s_addc_u32 s13, s13, 0
    s_add_u32 s54, s54, 4096
    s_mov_b32 m0, s54
    s_nop 0
    global_load_lds_dwordx4 v102, s[12:13]
    s_add_u32 s12, s12, 131072
    s_addc_u32 s13, s13, 0
    s_add_u32 s54, s54, 4096
    s_mov_b32 m0, s54
    s_nop 0
    global_load_lds_dwordx4 v102, s[12:13]
    s_add_u32 s12, s12, 131072
    s_addc_u32 s13, s13, 0
    s_add_u32 s54, s54, 4096
    s_mov_b32 m0, s54
    s_nop 0
    global_load_lds_dwordx4 v102, s[12:13]
    s_waitcnt vmcnt(16)
    s_barrier
    v_add_u32 v98, 65536, v106
    v_add_u32 v99, 65536, v107
    ds_read_b64_tr_b16 v[36:37], v98 offset:0
    ds_read_b64_tr_b16 v[38:39], v98 offset:2048
    ds_read_b64_tr_b16 v[40:41], v98 offset:32768
    ds_read_b64_tr_b16 v[42:43], v98 offset:34816
    ds_read_b64_tr_b16 v[52:53], v99 offset:0
    ds_read_b64_tr_b16 v[54:55], v99 offset:2048
    ds_read_b64_tr_b16 v[56:57], v99 offset:32768
    ds_read_b64_tr_b16 v[58:59], v99 offset:34816
    s_waitcnt lgkmcnt(0)
    ds_read_b64_tr_b16 v[68:69], v98 offset:256
    ds_read_b64_tr_b16 v[70:71], v98 offset:2304
    ds_read_b64_tr_b16 v[72:73], v98 offset:33024
    ds_read_b64_tr_b16 v[74:75], v98 offset:35072
    ds_read_b64_tr_b16 v[84:85], v99 offset:256
    ds_read_b64_tr_b16 v[86:87], v99 offset:2304
    ds_read_b64_tr_b16 v[88:89], v99 offset:33024
    ds_read_b64_tr_b16 v[90:91], v99 offset:35072
    s_waitcnt lgkmcnt(0)
    ds_read_b64_tr_b16 v[200:201], v98 offset:512
    ds_read_b64_tr_b16 v[202:203], v98 offset:2560
    ds_read_b64_tr_b16 v[204:205], v98 offset:33280
    ds_read_b64_tr_b16 v[206:207], v98 offset:35328
    ds_read_b64_tr_b16 v[216:217], v99 offset:512
    ds_read_b64_tr_b16 v[218:219], v99 offset:2560
    ds_read_b64_tr_b16 v[220:221], v99 offset:33280
    ds_read_b64_tr_b16 v[222:223], v99 offset:35328
    s_waitcnt lgkmcnt(0)
    ds_read_b64_tr_b16 v[232:233], v98 offset:768
    ds_read_b64_tr_b16 v[234:235], v98 offset:2816
    ds_read_b64_tr_b16 v[236:237], v98 offset:33536
    ds_read_b64_tr_b16 v[238:239], v98 offset:35584
    ds_read_b64_tr_b16 v[248:249], v99 offset:768
    ds_read_b64_tr_b16 v[250:251], v99 offset:2816
    ds_read_b64_tr_b16 v[252:253], v99 offset:33536
    ds_read_b64_tr_b16 v[254:255], v99 offset:35584
    s_waitcnt lgkmcnt(0)
    s_barrier
    s_lshl_b32 s11, s9, 14
    s_add_u32 s11, s11, 98304
    v_add_u32 v98, s11, v5
    ds_write_b128 v98, v[28:31] offset:0
    ds_write_b128 v98, v[32:35] offset:1024
    ds_write_b128 v98, v[36:39] offset:2048
    ds_write_b128 v98, v[40:43] offset:3072
    ds_write_b128 v98, v[44:47] offset:4096
    ds_write_b128 v98, v[48:51] offset:5120
    ds_write_b128 v98, v[52:55] offset:6144
    ds_write_b128 v98, v[56:59] offset:7168
    ds_write_b128 v98, v[60:63] offset:8192
    ds_write_b128 v98, v[64:67] offset:9216
    ds_write_b128 v98, v[68:71] offset:10240
    ds_write_b128 v98, v[72:75] offset:11264
    ds_write_b128 v98, v[76:79] offset:12288
    ds_write_b128 v98, v[80:83] offset:13312
    ds_write_b128 v98, v[84:87] offset:14336
    ds_write_b128 v98, v[88:91] offset:15360
    s_waitcnt lgkmcnt(0)
    s_waitcnt vmcnt(0)
    s_barrier
    s_xor_b32 s11, s9, 0
    s_lshl_b32 s11, s11, 14
    s_add_u32 s11, s11, 0
    v_add_u32 v98, s11, v104
    v_add_u32 v99, s11, v105
    ds_read_b64_tr_b16 v[28:29], v98 offset:0
    ds_read_b64_tr_b16 v[30:31], v98 offset:512
    ds_read_b64_tr_b16 v[32:33], v98 offset:8192
    ds_read_b64_tr_b16 v[34:35], v98 offset:8704
    ds_read_b64_tr_b16 v[36:37], v99 offset:0
    ds_read_b64_tr_b16 v[38:39], v99 offset:512
    ds_read_b64_tr_b16 v[40:41], v99 offset:8192
    ds_read_b64_tr_b16 v[42:43], v99 offset:8704
    s_waitcnt lgkmcnt(0)
    s_xor_b32 s11, s9, 1
    s_lshl_b32 s11, s11, 14
    s_add_u32 s11, s11, 0
    v_add_u32 v98, s11, v104
    v_add_u32 v99, s11, v105
    ds_read_b64_tr_b16 v[128:129], v98 offset:0
    ds_read_b64_tr_b16 v[130:131], v98 offset:512
    ds_read_b64_tr_b16 v[132:133], v98 offset:8192
    ds_read_b64_tr_b16 v[134:135], v98 offset:8704
    ds_read_b64_tr_b16 v[136:137], v99 offset:0
    ds_read_b64_tr_b16 v[138:139], v99 offset:512
    ds_read_b64_tr_b16 v[140:141], v99 offset:8192
    ds_read_b64_tr_b16 v[142:143], v99 offset:8704
    s_waitcnt lgkmcnt(0)
    s_xor_b32 s11, s9, 2
    s_lshl_b32 s11, s11, 14
    s_add_u32 s11, s11, 0
    v_add_u32 v98, s11, v104
    v_add_u32 v99, s11, v105
    ds_read_b64_tr_b16 v[144:145], v98 offset:0
    ds_read_b64_tr_b16 v[146:147], v98 offset:512
    ds_read_b64_tr_b16 v[148:149], v98 offset:8192
    ds_read_b64_tr_b16 v[150:151], v98 offset:8704
    ds_read_b64_tr_b16 v[152:153], v99 offset:0
    ds_read_b64_tr_b16 v[154:155], v99 offset:512
    ds_read_b64_tr_b16 v[156:157], v99 offset:8192
    ds_read_b64_tr_b16 v[158:159], v99 offset:8704
    s_waitcnt lgkmcnt(0)
    s_xor_b32 s11, s9, 3
    s_lshl_b32 s11, s11, 14
    s_add_u32 s11, s11, 0
    v_add_u32 v98, s11, v104
    v_add_u32 v99, s11, v105
    ds_read_b64_tr_b16 v[160:161], v98 offset:0
    ds_read_b64_tr_b16 v[162:163], v98 offset:512
    ds_read_b64_tr_b16 v[164:165], v98 offset:8192
    ds_read_b64_tr_b16 v[166:167], v98 offset:8704
    ds_read_b64_tr_b16 v[168:169], v99 offset:0
    ds_read_b64_tr_b16 v[170:171], v99 offset:512
    ds_read_b64_tr_b16 v[172:173], v99 offset:8192
    ds_read_b64_tr_b16 v[174:175], v99 offset:8704
    s_waitcnt lgkmcnt(0)
    s_barrier
    s_lshl_b32 s11, s9, 15
    s_add_u32 s11, s11, 2097152
    s_add_u32 s12, s68, s11
    s_addc_u32 s13, s69, 0
    s_lshl_b32 s54, s9, 10
    s_add_u32 s54, s54, 32768
    s_mov_b32 m0, s54
    s_nop 0
    global_load_lds_dwordx4 v102, s[12:13]
    s_add_u32 s12, s12, 131072
    s_addc_u32 s13, s13, 0
    s_add_u32 s54, s54, 4096
    s_mov_b32 m0, s54
    s_nop 0
    global_load_lds_dwordx4 v102, s[12:13]
    s_add_u32 s12, s12, 131072
    s_addc_u32 s13, s13, 0
    s_add_u32 s54, s54, 4096
    s_mov_b32 m0, s54
    s_nop 0
    global_load_lds_dwordx4 v102, s[12:13]
    s_add_u32 s12, s12, 131072
    s_addc_u32 s13, s13, 0
    s_add_u32 s54, s54, 4096
    s_mov_b32 m0, s54
    s_nop 0
    global_load_lds_dwordx4 v102, s[12:13]
    s_add_u32 s12, s12, 131072
    s_addc_u32 s13, s13, 0
    s_add_u32 s54, s54, 4096
    s_mov_b32 m0, s54
    s_nop 0
    global_load_lds_dwordx4 v102, s[12:13]
    s_add_u32 s12, s12, 131072
    s_addc_u32 s13, s13, 0
    s_add_u32 s54, s54, 4096
    s_mov_b32 m0, s54
    s_nop 0
    global_load_lds_dwordx4 v102, s[12:13]
    s_add_u32 s12, s12, 131072
    s_addc_u32 s13, s13, 0
    s_add_u32 s54, s54, 4096
    s_mov_b32 m0, s54
    s_nop 0
    global_load_lds_dwordx4 v102, s[12:13]
    s_add_u32 s12, s12, 131072
    s_addc_u32 s13, s13, 0
    s_add_u32 s54, s54, 4096
    s_mov_b32 m0, s54
    s_nop 0
    global_load_lds_dwordx4 v102, s[12:13]
    s_add_u32 s12, s12, 131072
    s_addc_u32 s13, s13, 0
    s_add_u32 s54, s54, 4096
    s_mov_b32 m0, s54
    s_nop 0
    global_load_lds_dwordx4 v102, s[12:13]
    s_add_u32 s12, s12, 131072
    s_addc_u32 s13, s13, 0
    s_add_u32 s54, s54, 4096
    s_mov_b32 m0, s54
    s_nop 0
    global_load_lds_dwordx4 v102, s[12:13]
    s_add_u32 s12, s12, 131072
    s_addc_u32 s13, s13, 0
    s_add_u32 s54, s54, 4096
    s_mov_b32 m0, s54
    s_nop 0
    global_load_lds_dwordx4 v102, s[12:13]
    s_add_u32 s12, s12, 131072
    s_addc_u32 s13, s13, 0
    s_add_u32 s54, s54, 4096
    s_mov_b32 m0, s54
    s_nop 0
    global_load_lds_dwordx4 v102, s[12:13]
    s_add_u32 s12, s12, 131072
    s_addc_u32 s13, s13, 0
    s_add_u32 s54, s54, 4096
    s_mov_b32 m0, s54
    s_nop 0
    global_load_lds_dwordx4 v102, s[12:13]
    s_add_u32 s12, s12, 131072
    s_addc_u32 s13, s13, 0
    s_add_u32 s54, s54, 4096
    s_mov_b32 m0, s54
    s_nop 0
    global_load_lds_dwordx4 v102, s[12:13]
    s_add_u32 s12, s12, 131072
    s_addc_u32 s13, s13, 0
    s_add_u32 s54, s54, 4096
    s_mov_b32 m0, s54
    s_nop 0
    global_load_lds_dwordx4 v102, s[12:13]
    s_add_u32 s12, s12, 131072
    s_addc_u32 s13, s13, 0
    s_add_u32 s54, s54, 4096
    s_mov_b32 m0, s54
    s_nop 0
    global_load_lds_dwordx4 v102, s[12:13]
    s_waitcnt vmcnt(0)
    s_barrier
    s_xor_b32 s11, s9, 0
    s_lshl_b32 s11, s11, 14
    s_add_u32 s11, s11, 0
    v_add_u32 v98, s11, v104
    v_add_u32 v99, s11, v105
    ds_read_b64_tr_b16 v[44:45], v98 offset:0
    ds_read_b64_tr_b16 v[46:47], v98 offset:512
    ds_read_b64_tr_b16 v[48:49], v98 offset:8192
    ds_read_b64_tr_b16 v[50:51], v98 offset:8704
    ds_read_b64_tr_b16 v[52:53], v99 offset:0
    ds_read_b64_tr_b16 v[54:55], v99 offset:512
    ds_read_b64_tr_b16 v[56:57], v99 offset:8192
    ds_read_b64_tr_b16 v[58:59], v99 offset:8704
    s_waitcnt lgkmcnt(0)
    s_xor_b32 s11, s9, 1
    s_lshl_b32 s11, s11, 14
    s_add_u32 s11, s11, 0
    v_add_u32 v98, s11, v104
    v_add_u32 v99, s11, v105
    ds_read_b64_tr_b16 v[176:177], v98 offset:0
    ds_read_b64_tr_b16 v[178:179], v98 offset:512
    ds_read_b64_tr_b16 v[180:181], v98 offset:8192
    ds_read_b64_tr_b16 v[182:183], v98 offset:8704
    ds_read_b64_tr_b16 v[184:185], v99 offset:0
    ds_read_b64_tr_b16 v[186:187], v99 offset:512
    ds_read_b64_tr_b16 v[188:189], v99 offset:8192
    ds_read_b64_tr_b16 v[190:191], v99 offset:8704
    s_waitcnt lgkmcnt(0)
    s_xor_b32 s11, s9, 2
    s_lshl_b32 s11, s11, 14
    s_add_u32 s11, s11, 0
    v_add_u32 v98, s11, v104
    v_add_u32 v99, s11, v105
    ds_read_b64_tr_b16 v[60:61], v98 offset:0
    ds_read_b64_tr_b16 v[62:63], v98 offset:512
    ds_read_b64_tr_b16 v[64:65], v98 offset:8192
    ds_read_b64_tr_b16 v[66:67], v98 offset:8704
    ds_read_b64_tr_b16 v[68:69], v99 offset:0
    ds_read_b64_tr_b16 v[70:71], v99 offset:512
    ds_read_b64_tr_b16 v[72:73], v99 offset:8192
    ds_read_b64_tr_b16 v[74:75], v99 offset:8704
    s_waitcnt lgkmcnt(0)
    s_xor_b32 s11, s9, 3
    s_lshl_b32 s11, s11, 14
    s_add_u32 s11, s11, 0
    v_add_u32 v98, s11, v104
    v_add_u32 v99, s11, v105
    ds_read_b64_tr_b16 v[76:77], v98 offset:0
    ds_read_b64_tr_b16 v[78:79], v98 offset:512
    ds_read_b64_tr_b16 v[80:81], v98 offset:8192
    ds_read_b64_tr_b16 v[82:83], v98 offset:8704
    ds_read_b64_tr_b16 v[84:85], v99 offset:0
    ds_read_b64_tr_b16 v[86:87], v99 offset:512
    ds_read_b64_tr_b16 v[88:89], v99 offset:8192
    ds_read_b64_tr_b16 v[90:91], v99 offset:8704
    s_waitcnt lgkmcnt(0)
    s_barrier
    s_lshl_b32 s11, s9, 14
    s_add_u32 s11, s11, 32768
    v_add_u32 v98, s11, v5
    ds_write_b128 v98, v[28:31] offset:0
    ds_write_b128 v98, v[32:35] offset:1024
    ds_write_b128 v98, v[36:39] offset:2048
    ds_write_b128 v98, v[40:43] offset:3072
    ds_write_b128 v98, v[44:47] offset:4096
    ds_write_b128 v98, v[48:51] offset:5120
    ds_write_b128 v98, v[52:55] offset:6144
    ds_write_b128 v98, v[56:59] offset:7168
    ds_write_b128 v98, v[60:63] offset:8192
    ds_write_b128 v98, v[64:67] offset:9216
    ds_write_b128 v98, v[68:71] offset:10240
    ds_write_b128 v98, v[72:75] offset:11264
    ds_write_b128 v98, v[76:79] offset:12288
    ds_write_b128 v98, v[80:83] offset:13312
    ds_write_b128 v98, v[84:87] offset:14336
    ds_write_b128 v98, v[88:91] offset:15360
    s_waitcnt lgkmcnt(0)
    s_cmp_eq_u32 s9, 0
    s_cbranch_scc0 L_mode_b
    s_mov_b32 s52, 0
    s_add_u32 s72, s4, 89141248
    s_addc_u32 s73, s5, 0
L_mode_poll:
    v_mov_b32 v124, 0
    v_mov_b32 v125, 192
    v_mov_b32 v120, 128
    global_load_dword v126, v124, s[6:7] sc1
    global_load_dword v127, v125, s[6:7] sc1
    global_load_dword v121, v120, s[6:7] sc1
    global_load_dword v122, v124, s[72:73] sc1
    s_waitcnt vmcnt(0)
    v_readfirstlane_b32 s11, v126
    v_readfirstlane_b32 s54, v127
    v_readfirstlane_b32 s74, v121
    v_readfirstlane_b32 s75, v122
    s_add_u32 s52, s52, 1
    s_min_u32 s11, s11, 32
    s_cmp_ge_u32 s11, 32
    s_cselect_b32 s76, 1, 2
    s_cmp_gt_u32 s52, 400000
    s_cbranch_scc1 L_mode_dec
    s_cmp_lt_u32 s74, 32
    s_cbranch_scc1 L_mode_sleep
    s_cmp_lg_u32 s75, 64
    s_cbranch_scc1 L_mode_sleep
    s_cmp_eq_u32 s76, 1
    s_cbranch_scc1 L_mode_dec
    s_cmp_ge_u32 s54, 256
    s_cbranch_scc1 L_mode_dec
L_mode_sleep:
    s_sleep 2
    s_branch L_mode_poll
L_mode_dec:
    v_mov_b32 v124, 14336
    v_mov_b32 v125, s76
    ds_write_b32 v124, v125
    s_waitcnt lgkmcnt(0)
L_mode_b:
    s_barrier
    v_mov_b32 v124, 14336
    ds_read_b32 v125, v124
    s_waitcnt lgkmcnt(0)
    v_readfirstlane_b32 s76, v125
    s_barrier
    s_lshl_b32 s55, s9, 11
    s_add_u32 m0, s55, 16384
    s_nop 0
    global_load_lds_dwordx4 v16, s[40:41] sc1
    global_load_lds_dwordx4 v16, s[40:41] offset:1024 sc1
    v_lshlrev_b32 v98, 7, v92
    s_lshl_b32 s11, s9, 18
    v_add_u32 v98, s11, v98
    v_add_u32 v99, 262144, v98
    global_load_dword v29, v98, s[42:43]
    global_load_dword v28, v99, s[40:41]
    s_cmp_eq_u32 s76, 1
    s_cbranch_scc0 L_mode_slow
L_mode_fast:
    s_mov_b32 s10, 0
    s_mov_b32 s53, 0
    s_mov_b32 s86, 16384
    s_mov_b32 s87, 24576
    s_mov_b32 s90, s48
    s_mov_b32 s91, s48
    v_mov_b64 v[126:127], 0
    s_add_u32 s16, s50, 2048
    s_addc_u32 s17, s51, 0
    s_lshl_b32 s94, s9, 11
    v_xor_b32 v14, 0x40000, v14
    s_mov_b32 s3, 64
    s_lshl_b32 s11, s8, 7
    s_add_u32 s98, s4, s11
    s_addc_u32 s99, s5, 0
    s_add_u32 s98, s98, 89137152
    s_addc_u32 s99, s99, 0
    s_add_u32 s96, s4, 89141248
    s_addc_u32 s97, s5, 0
.p2align 6
L_step:
    v_mov_b64 v[68:69], 0
    v_mov_b64 v[70:71], 0
    v_mov_b64 v[72:73], 0
    v_mov_b64 v[74:75], 0
    v_mov_b64 v[76:77], 0
    v_mov_b64 v[78:79], 0
    v_mov_b64 v[80:81], 0
    v_mov_b64 v[82:83], 0
    v_mov_b64 v[84:85], 0
    v_mov_b64 v[86:87], 0
    v_mov_b64 v[88:89], 0
    v_mov_b64 v[90:91], 0
    s_nop 15
    s_nop 7
    global_load_dwordx4 v[36:39], v1, s[16:17] offset:-2048 sc1
    global_load_dwordx4 v[52:55], v1, s[16:17] offset:2048 sc1
    s_add_u32 s11, s10, 1
    s_and_b32 s11, s11, 3
    s_lshl_b32 s11, s11, 13
    s_add_u32 s18, s50, s11
    s_addc_u32 s19, s51, 0
    s_add_u32 s11, s10, 3
    s_and_b32 s11, s11, 3
    s_lshl_b32 s11, s11, 13
    s_add_u32 s20, s50, s11
    s_addc_u32 s21, s51, 0
    s_cmp_lt_u32 s10, 63
    s_cselect_b32 s11, 262144, 0
    s_add_u32 s40, s40, s11
    s_addc_u32 s41, s41, 0
    s_lshl_b32 s55, s9, 11
    s_add_u32 s88, s55, s87
    s_mov_b32 m0, s88
    s_add_u32 s11, s10, 1
    s_and_b32 s11, s11, 7
    s_cmp_eq_u32 s11, 0
    s_cbranch_scc0 L_kvok
    s_cmp_eq_u32 s3, 64
    s_cbranch_scc0 L_kvwait
L_kvok:
    s_add_u32 s11, s10, 2
    s_and_b32 s2, s11, 7
    s_cmp_eq_u32 s2, 0
    s_cselect_b32 s2, 1, 0
    s_lshr_b32 s11, s11, 3
    s_min_u32 s11, s11, 7
    s_lshl_b32 s11, s11, 9
    s_add_u32 s11, s11, 89141248
    s_add_u32 s96, s4, s11
    s_addc_u32 s97, s5, 0
    ds_read_b128 v[92:95], v10 offset:0
    ds_read_b128 v[96:99], v10 offset:1024
    ds_read_b128 v[100:103], v10 offset:2048
    ds_read_b128 v[104:107], v10 offset:3072
    ds_read_b128 v[108:111], v10 offset:4096
    ds_read_b128 v[112:115], v10 offset:5120
    ds_read_b128 v[116:119], v10 offset:6144
    ds_read_b128 v[120:123], v10 offset:7168
    s_nop 9
    global_load_dwordx4 v[36:39], v1, s[16:17] offset:-2048 sc1
    global_load_dwordx4 v[52:55], v1, s[16:17] offset:2048 sc1
    s_mov_b32 s52, 0
    s_waitcnt vmcnt(2)
    v_max3_u32 v124, v36, v37, v38
    v_max3_u32 v125, v39, v52, v53
    v_max3_u32 v124, v124, v54, v55
    v_max_u32 v124, v124, v125
    v_cmp_eq_u32 vcc, -1, v124
    s_cbranch_vccz L_p2ok
    s_mov_b64 exec, vcc
    global_load_dwordx4 v[36:39], v1, s[16:17] offset:-2048 sc1
    global_load_dwordx4 v[52:55], v1, s[16:17] offset:2048 sc1
    s_mov_b64 exec, -1
    s_waitcnt vmcnt(2)
    v_max3_u32 v124, v36, v37, v38
    v_max3_u32 v125, v39, v52, v53
    v_max3_u32 v124, v124, v54, v55
    v_max_u32 v124, v124, v125
    v_cmp_eq_u32 vcc, -1, v124
    s_cbranch_vccz L_p2ok
    s_add_u32 s52, s52, 1
L_p2:
    s_mov_b64 exec, vcc
    global_load_dwordx4 v[36:39], v1, s[16:17] offset:-2048 sc1
    global_load_dwordx4 v[52:55], v1, s[16:17] offset:2048 sc1
    s_mov_b64 exec, -1
    s_waitcnt vmcnt(2)
    v_max3_u32 v124, v36, v37, v38
    v_max3_u32 v125, v39, v52, v53
    v_max3_u32 v124, v124, v54, v55
    v_max_u32 v124, v124, v125
    v_cmp_eq_u32 vcc, -1, v124
    s_cbranch_vccz L_p2ok
    s_add_u32 s52, s52, 1
    s_cmp_lt_u32 s52, 200000
    s_cbranch_scc1 L_p2
    s_mov_b32 s53, 2
L_p2ok:
    ds_write_b128 v1, v[36:39]
    s_waitcnt lgkmcnt(1)
    v_smfmac_f32_16x16x64_bf16 v[68:71], v[36:39], a[0:7], v0
    ds_write_b128 v1, v[52:55] offset:4096
    v_smfmac_f32_16x16x64_bf16 v[72:75], v[36:39], a[8:15], v0
    v_smfmac_f32_16x16x64_bf16 v[76:79], v[36:39], a[128:135], v0
    v_smfmac_f32_16x16x64_bf16 v[80:83], v[36:39], a[136:143], v0
    v_smfmac_f32_16x16x64_bf16 v[84:87], v[36:39], v[92:99], v0
    s_waitcnt lgkmcnt(0)
    s_barrier
    v_smfmac_f32_16x16x64_bf16 v[88:91], v[36:39], v[100:107], v0
    ds_read_b128 v[40:43], v2 offset:0
    v_smfmac_f32_16x16x64_bf16 v[68:71], v[52:55], a[64:71], v0
    ds_read_b128 v[44:47], v3 offset:0
    v_smfmac_f32_16x16x64_bf16 v[72:75], v[52:55], a[72:79], v0
    ds_read_b128 v[48:51], v4 offset:0
    v_smfmac_f32_16x16x64_bf16 v[76:79], v[52:55], a[192:199], v0
    ds_read_b128 v[56:59], v2 offset:4096
    v_smfmac_f32_16x16x64_bf16 v[80:83], v[52:55], a[200:207], v0
    ds_read_b128 v[60:63], v3 offset:4096
    v_smfmac_f32_16x16x64_bf16 v[84:87], v[52:55], v[108:115], v0
    ds_read_b128 v[64:67], v4 offset:4096
    v_smfmac_f32_16x16x64_bf16 v[88:91], v[52:55], v[116:123], v0
    s_waitcnt lgkmcnt(3)
    v_smfmac_f32_16x16x64_bf16 v[68:71], v[40:43], a[16:23], v0
    global_load_dwordx4 v[28:31], v17, s[42:43] sc1
    v_smfmac_f32_16x16x64_bf16 v[72:75], v[40:43], a[24:31], v0
    global_load_dwordx4 v[32:35], v17, s[42:43] offset:1024 sc1
    v_smfmac_f32_16x16x64_bf16 v[68:71], v[44:47], a[32:39], v0
    global_load_lds_dwordx4 v16, s[40:41] sc1
    v_smfmac_f32_16x16x64_bf16 v[72:75], v[44:47], a[40:47], v0
    v_smfmac_f32_16x16x64_bf16 v[68:71], v[48:51], a[48:55], v0
    global_load_lds_dwordx4 v16, s[40:41] offset:1024 sc1
    v_smfmac_f32_16x16x64_bf16 v[72:75], v[48:51], a[56:63], v0
    v_add_u32 v124, s86, v5
    s_waitcnt vmcnt(4)
    s_waitcnt lgkmcnt(0)
    v_smfmac_f32_16x16x64_bf16 v[68:71], v[56:59], a[80:87], v0
    s_cmp_eq_u32 s2, 0
    s_cbranch_scc1 L_noflg
    global_load_dword v19, v126, s[96:97] sc1
L_noflg:
    v_smfmac_f32_16x16x64_bf16 v[72:75], v[56:59], a[88:95], v0
    ds_read_b128 v[108:111], v124 offset:0
    v_smfmac_f32_16x16x64_bf16 v[68:71], v[60:63], a[96:103], v0
    s_cmp_eq_u32 s9, 0
    s_cbranch_scc0 L_noprg
    v_mov_b32 v125, s10
    global_store_dword v126, v125, s[98:99] sc1
L_noprg:
    ds_read_b128 v[112:115], v124 offset:1024
    v_smfmac_f32_16x16x64_bf16 v[72:75], v[60:63], a[104:111], v0
    ds_read_b128 v[116:119], v124 offset:2048
    v_smfmac_f32_16x16x64_bf16 v[68:71], v[64:67], a[112:119], v0
    ds_read_b128 v[120:123], v124 offset:3072
    v_smfmac_f32_16x16x64_bf16 v[72:75], v[64:67], a[120:127], v0
    ds_read_b128 v[36:39], v124 offset:4096
    v_smfmac_f32_16x16x64_bf16 v[76:79], v[40:43], a[144:151], v0
    ds_read_b128 v[52:55], v124 offset:5120
    global_store_dword v14, v18, s[22:23] offset:0
    v_smfmac_f32_16x16x64_bf16 v[80:83], v[40:43], a[152:159], v0
    global_store_dword v14, v18, s[22:23] offset:256
    global_store_dword v14, v18, s[22:23] offset:512
    v_smfmac_f32_16x16x64_bf16 v[76:79], v[44:47], a[160:167], v0
    v_add_f32 v68, v68, v69
    v_smfmac_f32_16x16x64_bf16 v[80:83], v[44:47], a[168:175], v0
    v_add_f32 v70, v70, v71
    v_smfmac_f32_16x16x64_bf16 v[76:79], v[48:51], a[176:183], v0
    v_add_f32 v72, v72, v73
    v_smfmac_f32_16x16x64_bf16 v[80:83], v[48:51], a[184:191], v0
    v_add_f32 v74, v74, v75
    v_smfmac_f32_16x16x64_bf16 v[76:79], v[56:59], a[208:215], v0
    v_cvt_pk_bf16_f32 v68, v68, v70
    v_smfmac_f32_16x16x64_bf16 v[80:83], v[56:59], a[216:223], v0
    v_cvt_pk_bf16_f32 v72, v72, v74
    v_smfmac_f32_16x16x64_bf16 v[76:79], v[60:63], a[224:231], v0
    ds_write_b32 v6, v68
    global_store_dword v14, v18, s[22:23] offset:768
    v_smfmac_f32_16x16x64_bf16 v[80:83], v[60:63], a[232:239], v0
    ds_write_b32 v6, v72 offset:256
    global_store_dword v14, v18, s[22:23] offset:1024
    v_smfmac_f32_16x16x64_bf16 v[76:79], v[64:67], a[240:247], v0
    global_store_dword v14, v18, s[22:23] offset:1280
    global_store_dword v14, v18, s[22:23] offset:1536
    v_smfmac_f32_16x16x64_bf16 v[80:83], v[64:67], a[248:255], v0
    global_store_dword v14, v18, s[22:23] offset:1792
    v_xor_b32 v14, 0x40000, v14
    v_smfmac_f32_16x16x64_bf16 v[84:87], v[40:43], v[128:135], v0
    v_smfmac_f32_16x16x64_bf16 v[88:91], v[40:43], v[136:143], v0
    v_add_f32 v76, v76, v77
    v_add_f32 v78, v78, v79
    v_add_f32 v80, v80, v81
    v_add_f32 v82, v82, v83
    v_cvt_pk_bf16_f32 v76, v76, v78
    v_cvt_pk_bf16_f32 v80, v80, v82
    ds_write_b32 v7, v76
    ds_write_b32 v7, v80 offset:512
    v_smfmac_f32_16x16x64_bf16 v[84:87], v[44:47], v[144:151], v0
    global_store_dword v6, v76, s[44:45] sc1
    v_smfmac_f32_16x16x64_bf16 v[88:91], v[44:47], v[152:159], v0
    global_store_dword v6, v80, s[44:45] offset:256 sc1
    v_smfmac_f32_16x16x64_bf16 v[84:87], v[48:51], v[160:167], v0
    v_smfmac_f32_16x16x64_bf16 v[88:91], v[48:51], v[168:175], v0
    s_waitcnt lgkmcnt(0)
    s_barrier
    ds_read_b64_tr_b16 v[92:93], v8 offset:0
    ds_read_b64_tr_b16 v[94:95], v8 offset:64
    ds_read_b64_tr_b16 v[96:97], v8 offset:512
    ds_read_b64_tr_b16 v[98:99], v8 offset:576
    v_smfmac_f32_16x16x64_bf16 v[84:87], v[56:59], v[176:183], v0
    ds_read_b64_tr_b16 v[100:101], v8 offset:1024
    ds_read_b64_tr_b16 v[102:103], v8 offset:1088
    ds_read_b64_tr_b16 v[104:105], v8 offset:1536
    ds_read_b64_tr_b16 v[106:107], v8 offset:1600
    ds_read_b64_tr_b16 v[40:41], v9 offset:0
    ds_read_b64_tr_b16 v[42:43], v9 offset:128
    v_smfmac_f32_16x16x64_bf16 v[88:91], v[56:59], v[184:191], v0
    ds_read_b64_tr_b16 v[44:45], v9 offset:1024
    ds_read_b64_tr_b16 v[46:47], v9 offset:1152
    ds_read_b64_tr_b16 v[48:49], v9 offset:2048
    ds_read_b64_tr_b16 v[50:51], v9 offset:2176
    ds_read_b64_tr_b16 v[80:81], v9 offset:3072
    ds_read_b64_tr_b16 v[82:83], v9 offset:3200
    s_waitcnt lgkmcnt(12)
    v_mfma_f32_16x16x32_bf16 v[68:71], v[108:111], v[92:95], 0
    v_mfma_f32_16x16x32_bf16 v[68:71], v[112:115], v[96:99], v[68:71]
    ds_read_b128 v[108:111], v124 offset:6144
    ds_read_b128 v[112:115], v124 offset:7168
    s_waitcnt lgkmcnt(10)
    v_mfma_f32_16x16x32_bf16 v[68:71], v[116:119], v[100:103], v[68:71]
    v_mfma_f32_16x16x32_bf16 v[68:71], v[120:123], v[104:107], v[68:71]
    ds_read_b128 v[116:119], v10 offset:8192
    ds_read_b128 v[120:123], v10 offset:9216
    v_mfma_f32_16x16x32_bf16 v[72:75], v[36:39], v[92:95], 0
    v_mfma_f32_16x16x32_bf16 v[72:75], v[52:55], v[96:99], v[72:75]
    s_waitcnt lgkmcnt(2)
    v_mfma_f32_16x16x32_bf16 v[72:75], v[108:111], v[100:103], v[72:75]
    v_mfma_f32_16x16x32_bf16 v[72:75], v[112:115], v[104:107], v[72:75]
    ds_read_b128 v[108:111], v10 offset:10240
    ds_read_b128 v[112:115], v10 offset:11264
    v_mfma_f32_16x16x32_bf16 v[76:79], v[40:43], v[92:95], 0
    v_mfma_f32_16x16x32_bf16 v[76:79], v[44:47], v[96:99], v[76:79]
    v_mfma_f32_16x16x32_bf16 v[76:79], v[48:51], v[100:103], v[76:79]
    v_max3_f32 v124, v68, v69, v70
    v_max3_f32 v124, v124, v71, v72
    v_mfma_f32_16x16x32_bf16 v[76:79], v[80:83], v[104:107], v[76:79]
    v_max3_f32 v124, v124, v73, v74
    v_max_f32 v124, v124, v75
    ds_read_b128 v[92:95], v10 offset:12288
    ds_read_b128 v[96:99], v10 offset:13312
    ds_read_b128 v[100:103], v10 offset:14336
    ds_read_b128 v[104:107], v10 offset:15360
    s_waitcnt lgkmcnt(4)
    v_smfmac_f32_16x16x64_bf16 v[84:87], v[60:63], v[116:123], v0
    ds_read_b128 v[36:39], v11 offset:0
    v_smfmac_f32_16x16x64_bf16 v[88:91], v[60:63], v[108:115], v0
    ds_read_b128 v[40:43], v11 offset:1024
    ds_read_b128 v[44:47], v11 offset:2048
    ds_read_b128 v[48:51], v11 offset:3072
    ds_read_b128 v[52:55], v11 offset:4096
    ds_read_b128 v[56:59], v11 offset:5120
    v_max3_f32 v124, v124, v76, v77
    v_mov_b32 v125, v124
    s_cmp_eq_u32 s10, 63
    s_nop 0
    v_permlane32_swap_b32 v124, v125
    v_max_f32 v124, v124, v125
    v_mov_b32 v125, v124
    s_waitcnt lgkmcnt(6)
    v_smfmac_f32_16x16x64_bf16 v[84:87], v[64:67], v[92:99], v0
    v_permlane16_swap_b32 v124, v125
    v_smfmac_f32_16x16x64_bf16 v[88:91], v[64:67], v[100:107], v0
    v_max_f32 v124, v124, v125
    v_mul_f32 v124, s49, v124
    ds_read_b128 v[60:63], v11 offset:6144
    ds_read_b128 v[64:67], v11 offset:7168
    v_pk_fma_f32 v[68:69], v[68:69], s[90:91], v[124:125] op_sel_hi:[1,1,0]
    v_pk_fma_f32 v[70:71], v[70:71], s[90:91], v[124:125] op_sel_hi:[1,1,0]
    v_pk_fma_f32 v[72:73], v[72:73], s[90:91], v[124:125] op_sel_hi:[1,1,0]
    v_pk_fma_f32 v[74:75], v[74:75], s[90:91], v[124:125] op_sel_hi:[1,1,0]
    v_pk_fma_f32 v[76:77], v[76:77], s[90:91], v[124:125] op_sel_hi:[1,1,0]
    v_exp_f32 v68, v68
    v_exp_f32 v69, v69
    v_exp_f32 v70, v70
    v_exp_f32 v71, v71
    v_exp_f32 v72, v72
    v_cvt_pk_bf16_f32 v92, v68, v69
    v_exp_f32 v73, v73
    v_cvt_pk_bf16_f32 v93, v70, v71
    v_exp_f32 v74, v74
    v_exp_f32 v75, v75
    v_cvt_pk_bf16_f32 v94, v72, v73
    v_exp_f32 v76, v76
    v_cvt_pk_bf16_f32 v95, v74, v75
    v_exp_f32 v77, v77
    v_mov_b32 v97, 0
    s_waitcnt vmcnt(12)
    v_mfma_f32_16x16x32_bf16 v[116:119], v[24:27], v[92:95], 0
    v_cvt_pk_bf16_f32 v96, v76, v77
    v_add_f32 v84, v84, v85
    v_mfma_f32_16x16x32_bf16 v[108:111], v[28:31], v[92:95], 0
    v_add_f32 v86, v86, v87
    v_add_f32 v88, v88, v89
    v_mfma_f32_16x16x16_bf16 v[116:119], v[24:25], v[96:97], v[116:119]
    v_add_f32 v90, v90, v91
    v_cvt_pk_bf16_f32 v84, v84, v86
    v_mfma_f32_16x16x32_bf16 v[112:115], v[32:35], v[92:95], 0
    v_mov_b32 v85, 0
    v_cvt_pk_bf16_f32 v86, v88, v90
    v_mov_b32 v87, 0
    s_nop 1
    v_mfma_f32_16x16x16_bf16 v[108:111], v[84:85], v[96:97], v[108:111]
    global_store_dword v6, v84, s[46:47] offset:0 sc1
    v_mfma_f32_16x16x16_bf16 v[112:115], v[86:87], v[96:97], v[112:115]
    global_store_dword v6, v86, s[46:47] offset:256 sc1
    s_cbranch_scc1 L_chain_end
    v_rcp_f32 v124, v116
    s_nop 2
    v_pk_mul_f32 v[108:109], v[108:109], v[124:125] op_sel_hi:[1,0]
    v_pk_mul_f32 v[110:111], v[110:111], v[124:125] op_sel_hi:[1,0]
    v_pk_mul_f32 v[112:113], v[112:113], v[124:125] op_sel_hi:[1,0]
    v_pk_mul_f32 v[114:115], v[114:115], v[124:125] op_sel_hi:[1,0]
    v_cvt_pk_bf16_f32 v100, v108, v109
    v_cvt_pk_bf16_f32 v101, v110, v111
    v_cvt_pk_bf16_f32 v102, v112, v113
    v_cvt_pk_bf16_f32 v103, v114, v115
    ds_write_b64 v12, v[100:101] offset:0
    ds_write_b64 v12, v[102:103] offset:256
    v_mfma_f32_32x32x8_bf16 v[76:91], v[126:127], v[24:25], 0
    v_mfma_f32_16x16x16_bf16 v[28:31], v[126:127], v[24:25], 0
    v_mfma_f32_16x16x16_bf16 v[32:35], v[126:127], v[24:25], 0
    s_waitcnt lgkmcnt(0)
    s_barrier
    ds_read_b128 v[68:71], v5 offset:14336
    ds_read_b128 v[72:75], v5 offset:15360
    s_waitcnt lgkmcnt(0)
    v_smfmac_f32_16x16x64_bf16 v[76:79], v[68:71], v[192:199], v0
    ds_read_b128 v[92:95], v11 offset:8192
    ds_read_b128 v[96:99], v11 offset:9216
    v_smfmac_f32_16x16x64_bf16 v[76:79], v[72:75], v[200:207], v0
    ds_read_b128 v[100:103], v11 offset:10240
    ds_read_b128 v[104:107], v11 offset:11264
    v_smfmac_f32_16x16x64_bf16 v[80:83], v[68:71], v[208:215], v0
    ds_read_b128 v[108:111], v11 offset:12288
    ds_read_b128 v[112:115], v11 offset:13312
    v_smfmac_f32_16x16x64_bf16 v[80:83], v[72:75], v[216:223], v0
    ds_read_b128 v[116:119], v11 offset:14336
    ds_read_b128 v[120:123], v11 offset:15360
    v_add_f32 v76, v76, v77
    v_add_f32 v78, v78, v79
    v_smfmac_f32_16x16x64_bf16 v[28:31], v[68:71], v[224:231], v0
    v_cvt_pk_bf16_f32 v124, v76, v78
    v_smfmac_f32_16x16x64_bf16 v[28:31], v[72:75], v[232:239], v0
    global_store_dword v13, v124, s[32:33]
    v_mov_b64 v[76:77], 0
    v_smfmac_f32_16x16x64_bf16 v[32:35], v[68:71], v[240:247], v0
    v_mov_b64 v[78:79], 0
    v_add_f32 v80, v80, v81
    v_smfmac_f32_16x16x64_bf16 v[32:35], v[72:75], v[248:255], v0
    v_add_f32 v82, v82, v83
    v_cvt_pk_bf16_f32 v125, v80, v82
    v_smfmac_f32_16x16x64_bf16 v[84:87], v[68:71], v[36:43], v0
    global_store_dword v13, v125, s[34:35]
    v_mov_b64 v[80:81], 0
    v_smfmac_f32_16x16x64_bf16 v[84:87], v[72:75], v[44:51], v0
    v_mov_b64 v[82:83], 0
    v_add_f32 v28, v28, v29
    v_smfmac_f32_16x16x64_bf16 v[88:91], v[68:71], v[52:59], v0
    v_add_f32 v30, v30, v31
    v_cvt_pk_bf16_f32 v124, v28, v30
    v_smfmac_f32_16x16x64_bf16 v[88:91], v[72:75], v[60:67], v0
    global_store_dword v13, v124, s[36:37]
    v_add_f32 v32, v32, v33
    s_waitcnt lgkmcnt(0)
    v_smfmac_f32_16x16x64_bf16 v[76:79], v[68:71], v[92:99], v0
    v_add_f32 v34, v34, v35
    v_cvt_pk_bf16_f32 v125, v32, v34
    v_smfmac_f32_16x16x64_bf16 v[76:79], v[72:75], v[100:107], v0
    global_store_dword v13, v125, s[38:39]
    v_add_f32 v84, v84, v85
    v_smfmac_f32_16x16x64_bf16 v[80:83], v[68:71], v[108:115], v0
    v_add_f32 v86, v86, v87
    v_cvt_pk_bf16_f32 v124, v84, v86
    v_smfmac_f32_16x16x64_bf16 v[80:83], v[72:75], v[116:123], v0
    global_store_dword v13, v124, s[24:25]
    v_add_f32 v88, v88, v89
    v_add_f32 v90, v90, v91
    v_cvt_pk_bf16_f32 v125, v88, v90
    global_store_dword v13, v125, s[26:27]
    v_add_f32 v76, v76, v77
    v_add_f32 v78, v78, v79
    v_cvt_pk_bf16_f32 v124, v76, v78
    global_store_dword v13, v124, s[28:29]
    s_nop 3
    v_add_f32 v80, v80, v81
    v_add_f32 v82, v82, v83
    v_cvt_pk_bf16_f32 v125, v80, v82
    s_nop 0
    global_store_dword v13, v125, s[30:31]
    s_nop 15
    s_nop 15
    s_nop 7
    global_load_dword v40, v14, s[22:23] offset:0 sc1
    global_load_dword v41, v14, s[22:23] offset:256 sc1
    global_load_dword v42, v14, s[22:23] offset:512 sc1
    global_load_dword v43, v14, s[22:23] offset:768 sc1
    global_load_dword v44, v14, s[22:23] offset:1024 sc1
    global_load_dword v45, v14, s[22:23] offset:1280 sc1
    global_load_dword v46, v14, s[22:23] offset:1536 sc1
    global_load_dword v47, v14, s[22:23] offset:1792 sc1
    s_add_u32 s42, s42, 262144
    s_addc_u32 s43, s43, 0
    s_add_u32 s44, s44, 65536
    s_addc_u32 s45, s45, 0
    s_add_u32 s46, s46, 65536
    s_addc_u32 s47, s47, 0
    s_xor_b32 s86, s86, 8192
    s_xor_b32 s87, s87, 8192
    v_xor_b32 v13, 0x40000, v13
    s_add_u32 s10, s10, 1
    s_and_b32 s11, s10, 3
    s_lshl_b32 s11, s11, 13
    s_add_u32 s11, s11, 2048
    s_add_u32 s16, s50, s11
    s_addc_u32 s17, s51, 0
    s_mov_b32 s52, 0
    s_nop 14
    global_load_dword v40, v14, s[22:23] offset:0 sc1
    global_load_dword v41, v14, s[22:23] offset:256 sc1
    global_load_dword v42, v14, s[22:23] offset:512 sc1
    global_load_dword v43, v14, s[22:23] offset:768 sc1
    global_load_dword v44, v14, s[22:23] offset:1024 sc1
    global_load_dword v45, v14, s[22:23] offset:1280 sc1
    global_load_dword v46, v14, s[22:23] offset:1536 sc1
    global_load_dword v47, v14, s[22:23] offset:1792 sc1
    s_waitcnt vmcnt(12)
    v_max3_u32 v124, v40, v41, v42
    v_max_u32 v124, v124, v43
    v_mfma_f32_16x16x32_bf16 v[100:103], v[40:43], v[20:23], 0
    s_waitcnt vmcnt(8)
    v_max3_u32 v125, v44, v45, v46
    v_max3_u32 v124, v124, v125, v47
    v_mfma_f32_16x16x32_bf16 v[100:103], v[44:47], v[20:23], v[100:103]
    v_cmp_eq_u32 vcc, -1, v124
    s_cbranch_vccz L_p1ok
L_p1:
    s_mov_b64 exec, vcc
    global_load_dword v40, v14, s[22:23] offset:0 sc1
    global_load_dword v41, v14, s[22:23] offset:256 sc1
    global_load_dword v42, v14, s[22:23] offset:512 sc1
    global_load_dword v43, v14, s[22:23] offset:768 sc1
    global_load_dword v44, v14, s[22:23] offset:1024 sc1
    global_load_dword v45, v14, s[22:23] offset:1280 sc1
    global_load_dword v46, v14, s[22:23] offset:1536 sc1
    global_load_dword v47, v14, s[22:23] offset:1792 sc1
    s_mov_b64 exec, -1
    s_nop 3
    s_waitcnt vmcnt(12)
    v_max3_u32 v124, v40, v41, v42
    v_max_u32 v124, v124, v43
    v_mfma_f32_16x16x32_bf16 v[100:103], v[40:43], v[20:23], 0
    s_waitcnt vmcnt(8)
    v_max3_u32 v125, v44, v45, v46
    v_max3_u32 v124, v124, v125, v47
    v_mfma_f32_16x16x32_bf16 v[100:103], v[44:47], v[20:23], v[100:103]
    v_cmp_eq_u32 vcc, -1, v124
    s_cbranch_vccz L_p1ok
    s_add_u32 s52, s52, 1
    s_cmp_lt_u32 s52, 200000
    s_cbranch_scc1 L_p1
    s_mov_b32 s53, 1
L_p1ok:
    s_mov_b64 exec, s[58:59]
    s_nop 2
    v_cvt_pk_bf16_f32 v104, v100, v101
    v_cvt_pk_bf16_f32 v105, v102, v103
    global_store_dwordx2 v15, v[104:105], s[18:19]
    s_mov_b64 exec, -1
    v_readfirstlane_b32 s3, v19
    v_mov_b32 v19, -1
    s_mov_b64 exec, s[58:59]
    global_store_dwordx2 v15, v[18:19], s[20:21]
    s_mov_b64 exec, -1
    s_cmp_eq_u32 s53, 0
    s_cbranch_scc1 L_step
L_chain_end:
    s_waitcnt vmcnt(0)
    s_barrier
    v_mov_b32 v125, 64
    global_store_dword v126, v125, s[98:99] sc1
    s_branch L_chain_exit
L_kvwait:
    s_mov_b32 s52, 0
L_kvspin:
    global_load_dword v124, v126, s[96:97] sc1
    s_waitcnt vmcnt(0)
    v_readfirstlane_b32 s3, v124
    s_add_u32 s52, s52, 1
    s_cmp_gt_u32 s52, 200000
    s_cbranch_scc1 L_kvok
    s_cmp_eq_u32 s3, 64
    s_cbranch_scc0 L_kvspin
    s_branch L_kvok
L_mode_slow:
    s_mov_b32 s10, 0
    s_mov_b32 s53, 0
    s_mov_b32 s86, 16384
    s_mov_b32 s87, 24576
    s_mov_b32 s90, s48
    s_mov_b32 s91, s48
    v_mov_b64 v[126:127], 0
    s_add_u32 s16, s50, 2048
    s_addc_u32 s17, s51, 0
    s_lshl_b32 s94, s9, 11
    v_xor_b32 v14, 0x40000, v14
    s_mov_b32 s3, 64
    s_lshl_b32 s11, s8, 7
    s_add_u32 s98, s4, s11
    s_addc_u32 s99, s5, 0
    s_add_u32 s98, s98, 89137152
    s_addc_u32 s99, s99, 0
    s_add_u32 s96, s4, 89141248
    s_addc_u32 s97, s5, 0
.p2align 6
L_step_s:
    v_mov_b64 v[68:69], 0
    v_mov_b64 v[70:71], 0
    v_mov_b64 v[72:73], 0
    v_mov_b64 v[74:75], 0
    v_mov_b64 v[76:77], 0
    v_mov_b64 v[78:79], 0
    v_mov_b64 v[80:81], 0
    v_mov_b64 v[82:83], 0
    v_mov_b64 v[84:85], 0
    v_mov_b64 v[86:87], 0
    v_mov_b64 v[88:89], 0
    v_mov_b64 v[90:91], 0
    s_nop 15
    s_nop 7
    global_load_dwordx4 v[36:39], v1, s[16:17] offset:-2048 sc1
    global_load_dwordx4 v[52:55], v1, s[16:17] offset:2048 sc1
    s_add_u32 s11, s10, 1
    s_and_b32 s11, s11, 3
    s_lshl_b32 s11, s11, 13
    s_add_u32 s18, s50, s11
    s_addc_u32 s19, s51, 0
    s_add_u32 s11, s10, 3
    s_and_b32 s11, s11, 3
    s_lshl_b32 s11, s11, 13
    s_add_u32 s20, s50, s11
    s_addc_u32 s21, s51, 0
    s_cmp_lt_u32 s10, 63
    s_cselect_b32 s11, 262144, 0
    s_add_u32 s40, s40, s11
    s_addc_u32 s41, s41, 0
    s_lshl_b32 s55, s9, 11
    s_add_u32 s88, s55, s87
    s_mov_b32 m0, s88
    s_add_u32 s11, s10, 1
    s_and_b32 s11, s11, 7
    s_cmp_eq_u32 s11, 0
    s_cbranch_scc0 L_kvok_s
    s_cmp_eq_u32 s3, 64
    s_cbranch_scc0 L_kvwait_s
L_kvok_s:
    s_add_u32 s11, s10, 2
    s_and_b32 s2, s11, 7
    s_cmp_eq_u32 s2, 0
    s_cselect_b32 s2, 1, 0
    s_lshr_b32 s11, s11, 3
    s_min_u32 s11, s11, 7
    s_lshl_b32 s11, s11, 9
    s_add_u32 s11, s11, 89141248
    s_add_u32 s96, s4, s11
    s_addc_u32 s97, s5, 0
    ds_read_b128 v[92:95], v10 offset:0
    ds_read_b128 v[96:99], v10 offset:1024
    ds_read_b128 v[100:103], v10 offset:2048
    ds_read_b128 v[104:107], v10 offset:3072
    ds_read_b128 v[108:111], v10 offset:4096
    ds_read_b128 v[112:115], v10 offset:5120
    ds_read_b128 v[116:119], v10 offset:6144
    ds_read_b128 v[120:123], v10 offset:7168
    s_nop 9
    global_load_dwordx4 v[36:39], v1, s[16:17] offset:-2048 sc1
    global_load_dwordx4 v[52:55], v1, s[16:17] offset:2048 sc1
    s_mov_b32 s52, 0
    s_waitcnt vmcnt(2)
    v_max3_u32 v124, v36, v37, v38
    v_max3_u32 v125, v39, v52, v53
    v_max3_u32 v124, v124, v54, v55
    v_max_u32 v124, v124, v125
    v_cmp_eq_u32 vcc, -1, v124
    s_cbranch_vccz L_p2ok_s
    s_mov_b64 exec, vcc
    global_load_dwordx4 v[36:39], v1, s[16:17] offset:-2048 sc1
    global_load_dwordx4 v[52:55], v1, s[16:17] offset:2048 sc1
    s_mov_b64 exec, -1
    s_waitcnt vmcnt(2)
    v_max3_u32 v124, v36, v37, v38
    v_max3_u32 v125, v39, v52, v53
    v_max3_u32 v124, v124, v54, v55
    v_max_u32 v124, v124, v125
    v_cmp_eq_u32 vcc, -1, v124
    s_cbranch_vccz L_p2ok_s
    s_add_u32 s52, s52, 1
L_p2_s:
    s_mov_b64 exec, vcc
    global_load_dwordx4 v[36:39], v1, s[16:17] offset:-2048 sc1
    global_load_dwordx4 v[52:55], v1, s[16:17] offset:2048 sc1
    s_mov_b64 exec, -1
    s_waitcnt vmcnt(2)
    v_max3_u32 v124, v36, v37, v38
    v_max3_u32 v125, v39, v52, v53
    v_max3_u32 v124, v124, v54, v55
    v_max_u32 v124, v124, v125
    v_cmp_eq_u32 vcc, -1, v124
    s_cbranch_vccz L_p2ok_s
    s_add_u32 s52, s52, 1
    s_cmp_lt_u32 s52, 200000
    s_cbranch_scc1 L_p2_s
    s_mov_b32 s53, 2
L_p2ok_s:
    ds_write_b128 v1, v[36:39]
    s_waitcnt lgkmcnt(1)
    v_smfmac_f32_16x16x64_bf16 v[68:71], v[36:39], a[0:7], v0
    ds_write_b128 v1, v[52:55] offset:4096
    v_smfmac_f32_16x16x64_bf16 v[72:75], v[36:39], a[8:15], v0
    v_smfmac_f32_16x16x64_bf16 v[76:79], v[36:39], a[128:135], v0
    v_smfmac_f32_16x16x64_bf16 v[80:83], v[36:39], a[136:143], v0
    v_smfmac_f32_16x16x64_bf16 v[84:87], v[36:39], v[92:99], v0
    s_waitcnt lgkmcnt(0)
    s_barrier
    v_smfmac_f32_16x16x64_bf16 v[88:91], v[36:39], v[100:107], v0
    ds_read_b128 v[40:43], v2 offset:0
    v_smfmac_f32_16x16x64_bf16 v[68:71], v[52:55], a[64:71], v0
    ds_read_b128 v[44:47], v3 offset:0
    v_smfmac_f32_16x16x64_bf16 v[72:75], v[52:55], a[72:79], v0
    ds_read_b128 v[48:51], v4 offset:0
    v_smfmac_f32_16x16x64_bf16 v[76:79], v[52:55], a[192:199], v0
    ds_read_b128 v[56:59], v2 offset:4096
    v_smfmac_f32_16x16x64_bf16 v[80:83], v[52:55], a[200:207], v0
    ds_read_b128 v[60:63], v3 offset:4096
    v_smfmac_f32_16x16x64_bf16 v[84:87], v[52:55], v[108:115], v0
    ds_read_b128 v[64:67], v4 offset:4096
    v_smfmac_f32_16x16x64_bf16 v[88:91], v[52:55], v[116:123], v0
    s_waitcnt lgkmcnt(3)
    v_smfmac_f32_16x16x64_bf16 v[68:71], v[40:43], a[16:23], v0
    global_load_dwordx4 v[28:31], v17, s[42:43] sc1
    v_smfmac_f32_16x16x64_bf16 v[72:75], v[40:43], a[24:31], v0
    global_load_dwordx4 v[32:35], v17, s[42:43] offset:1024 sc1
    v_smfmac_f32_16x16x64_bf16 v[68:71], v[44:47], a[32:39], v0
    global_load_lds_dwordx4 v16, s[40:41] sc1
    v_smfmac_f32_16x16x64_bf16 v[72:75], v[44:47], a[40:47], v0
    v_smfmac_f32_16x16x64_bf16 v[68:71], v[48:51], a[48:55], v0
    global_load_lds_dwordx4 v16, s[40:41] offset:1024 sc1
    v_smfmac_f32_16x16x64_bf16 v[72:75], v[48:51], a[56:63], v0
    v_add_u32 v124, s86, v5
    s_waitcnt vmcnt(4)
    s_waitcnt lgkmcnt(0)
    v_smfmac_f32_16x16x64_bf16 v[68:71], v[56:59], a[80:87], v0
    s_cmp_eq_u32 s2, 0
    s_cbranch_scc1 L_noflg_s
    global_load_dword v19, v126, s[96:97] sc1
L_noflg_s:
    v_smfmac_f32_16x16x64_bf16 v[72:75], v[56:59], a[88:95], v0
    ds_read_b128 v[108:111], v124 offset:0
    v_smfmac_f32_16x16x64_bf16 v[68:71], v[60:63], a[96:103], v0
    s_cmp_eq_u32 s9, 0
    s_cbranch_scc0 L_noprg_s
    v_mov_b32 v125, s10
    global_store_dword v126, v125, s[98:99] sc1
L_noprg_s:
    ds_read_b128 v[112:115], v124 offset:1024
    v_smfmac_f32_16x16x64_bf16 v[72:75], v[60:63], a[104:111], v0
    ds_read_b128 v[116:119], v124 offset:2048
    v_smfmac_f32_16x16x64_bf16 v[68:71], v[64:67], a[112:119], v0
    ds_read_b128 v[120:123], v124 offset:3072
    v_smfmac_f32_16x16x64_bf16 v[72:75], v[64:67], a[120:127], v0
    ds_read_b128 v[36:39], v124 offset:4096
    v_smfmac_f32_16x16x64_bf16 v[76:79], v[40:43], a[144:151], v0
    ds_read_b128 v[52:55], v124 offset:5120
    global_store_dword v14, v18, s[22:23] offset:0 sc1
    v_smfmac_f32_16x16x64_bf16 v[80:83], v[40:43], a[152:159], v0
    global_store_dword v14, v18, s[22:23] offset:256 sc1
    global_store_dword v14, v18, s[22:23] offset:512 sc1
    v_smfmac_f32_16x16x64_bf16 v[76:79], v[44:47], a[160:167], v0
    v_add_f32 v68, v68, v69
    v_smfmac_f32_16x16x64_bf16 v[80:83], v[44:47], a[168:175], v0
    v_add_f32 v70, v70, v71
    v_smfmac_f32_16x16x64_bf16 v[76:79], v[48:51], a[176:183], v0
    v_add_f32 v72, v72, v73
    v_smfmac_f32_16x16x64_bf16 v[80:83], v[48:51], a[184:191], v0
    v_add_f32 v74, v74, v75
    v_smfmac_f32_16x16x64_bf16 v[76:79], v[56:59], a[208:215], v0
    v_cvt_pk_bf16_f32 v68, v68, v70
    v_smfmac_f32_16x16x64_bf16 v[80:83], v[56:59], a[216:223], v0
    v_cvt_pk_bf16_f32 v72, v72, v74
    v_smfmac_f32_16x16x64_bf16 v[76:79], v[60:63], a[224:231], v0
    ds_write_b32 v6, v68
    global_store_dword v14, v18, s[22:23] offset:768 sc1
    v_smfmac_f32_16x16x64_bf16 v[80:83], v[60:63], a[232:239], v0
    ds_write_b32 v6, v72 offset:256
    global_store_dword v14, v18, s[22:23] offset:1024 sc1
    v_smfmac_f32_16x16x64_bf16 v[76:79], v[64:67], a[240:247], v0
    global_store_dword v14, v18, s[22:23] offset:1280 sc1
    global_store_dword v14, v18, s[22:23] offset:1536 sc1
    v_smfmac_f32_16x16x64_bf16 v[80:83], v[64:67], a[248:255], v0
    global_store_dword v14, v18, s[22:23] offset:1792 sc1
    v_xor_b32 v14, 0x40000, v14
    v_smfmac_f32_16x16x64_bf16 v[84:87], v[40:43], v[128:135], v0
    v_smfmac_f32_16x16x64_bf16 v[88:91], v[40:43], v[136:143], v0
    v_add_f32 v76, v76, v77
    v_add_f32 v78, v78, v79
    v_add_f32 v80, v80, v81
    v_add_f32 v82, v82, v83
    v_cvt_pk_bf16_f32 v76, v76, v78
    v_cvt_pk_bf16_f32 v80, v80, v82
    ds_write_b32 v7, v76
    ds_write_b32 v7, v80 offset:512
    v_smfmac_f32_16x16x64_bf16 v[84:87], v[44:47], v[144:151], v0
    global_store_dword v6, v76, s[44:45] sc1
    v_smfmac_f32_16x16x64_bf16 v[88:91], v[44:47], v[152:159], v0
    global_store_dword v6, v80, s[44:45] offset:256 sc1
    v_smfmac_f32_16x16x64_bf16 v[84:87], v[48:51], v[160:167], v0
    v_smfmac_f32_16x16x64_bf16 v[88:91], v[48:51], v[168:175], v0
    s_waitcnt lgkmcnt(0)
    s_barrier
    ds_read_b64_tr_b16 v[92:93], v8 offset:0
    ds_read_b64_tr_b16 v[94:95], v8 offset:64
    ds_read_b64_tr_b16 v[96:97], v8 offset:512
    ds_read_b64_tr_b16 v[98:99], v8 offset:576
    v_smfmac_f32_16x16x64_bf16 v[84:87], v[56:59], v[176:183], v0
    ds_read_b64_tr_b16 v[100:101], v8 offset:1024
    ds_read_b64_tr_b16 v[102:103], v8 offset:1088
    ds_read_b64_tr_b16 v[104:105], v8 offset:1536
    ds_read_b64_tr_b16 v[106:107], v8 offset:1600
    ds_read_b64_tr_b16 v[40:41], v9 offset:0
    ds_read_b64_tr_b16 v[42:43], v9 offset:128
    v_smfmac_f32_16x16x64_bf16 v[88:91], v[56:59], v[184:191], v0
    ds_read_b64_tr_b16 v[44:45], v9 offset:1024
    ds_read_b64_tr_b16 v[46:47], v9 offset:1152
    ds_read_b64_tr_b16 v[48:49], v9 offset:2048
    ds_read_b64_tr_b16 v[50:51], v9 offset:2176
    ds_read_b64_tr_b16 v[80:81], v9 offset:3072
    ds_read_b64_tr_b16 v[82:83], v9 offset:3200
    s_waitcnt lgkmcnt(12)
    v_mfma_f32_16x16x32_bf16 v[68:71], v[108:111], v[92:95], 0
    v_mfma_f32_16x16x32_bf16 v[68:71], v[112:115], v[96:99], v[68:71]
    ds_read_b128 v[108:111], v124 offset:6144
    ds_read_b128 v[112:115], v124 offset:7168
    s_waitcnt lgkmcnt(10)
    v_mfma_f32_16x16x32_bf16 v[68:71], v[116:119], v[100:103], v[68:71]
    v_mfma_f32_16x16x32_bf16 v[68:71], v[120:123], v[104:107], v[68:71]
    ds_read_b128 v[116:119], v10 offset:8192
    ds_read_b128 v[120:123], v10 offset:9216
    v_mfma_f32_16x16x32_bf16 v[72:75], v[36:39], v[92:95], 0
    v_mfma_f32_16x16x32_bf16 v[72:75], v[52:55], v[96:99], v[72:75]
    s_waitcnt lgkmcnt(2)
    v_mfma_f32_16x16x32_bf16 v[72:75], v[108:111], v[100:103], v[72:75]
    v_mfma_f32_16x16x32_bf16 v[72:75], v[112:115], v[104:107], v[72:75]
    ds_read_b128 v[108:111], v10 offset:10240
    ds_read_b128 v[112:115], v10 offset:11264
    v_mfma_f32_16x16x32_bf16 v[76:79], v[40:43], v[92:95], 0
    v_mfma_f32_16x16x32_bf16 v[76:79], v[44:47], v[96:99], v[76:79]
    v_mfma_f32_16x16x32_bf16 v[76:79], v[48:51], v[100:103], v[76:79]
    v_max3_f32 v124, v68, v69, v70
    v_max3_f32 v124, v124, v71, v72
    v_mfma_f32_16x16x32_bf16 v[76:79], v[80:83], v[104:107], v[76:79]
    v_max3_f32 v124, v124, v73, v74
    v_max_f32 v124, v124, v75
    ds_read_b128 v[92:95], v10 offset:12288
    ds_read_b128 v[96:99], v10 offset:13312
    ds_read_b128 v[100:103], v10 offset:14336
    ds_read_b128 v[104:107], v10 offset:15360
    s_waitcnt lgkmcnt(4)
    v_smfmac_f32_16x16x64_bf16 v[84:87], v[60:63], v[116:123], v0
    ds_read_b128 v[36:39], v11 offset:0
    v_smfmac_f32_16x16x64_bf16 v[88:91], v[60:63], v[108:115], v0
    ds_read_b128 v[40:43], v11 offset:1024
    ds_read_b128 v[44:47], v11 offset:2048
    ds_read_b128 v[48:51], v11 offset:3072
    ds_read_b128 v[52:55], v11 offset:4096
    ds_read_b128 v[56:59], v11 offset:5120
    v_max3_f32 v124, v124, v76, v77
    v_mov_b32 v125, v124
    s_cmp_eq_u32 s10, 63
    s_nop 0
    v_permlane32_swap_b32 v124, v125
    v_max_f32 v124, v124, v125
    v_mov_b32 v125, v124
    s_waitcnt lgkmcnt(6)
    v_smfmac_f32_16x16x64_bf16 v[84:87], v[64:67], v[92:99], v0
    v_permlane16_swap_b32 v124, v125
    v_smfmac_f32_16x16x64_bf16 v[88:91], v[64:67], v[100:107], v0
    v_max_f32 v124, v124, v125
    v_mul_f32 v124, s49, v124
    ds_read_b128 v[60:63], v11 offset:6144
    ds_read_b128 v[64:67], v11 offset:7168
    v_pk_fma_f32 v[68:69], v[68:69], s[90:91], v[124:125] op_sel_hi:[1,1,0]
    v_pk_fma_f32 v[70:71], v[70:71], s[90:91], v[124:125] op_sel_hi:[1,1,0]
    v_pk_fma_f32 v[72:73], v[72:73], s[90:91], v[124:125] op_sel_hi:[1,1,0]
    v_pk_fma_f32 v[74:75], v[74:75], s[90:91], v[124:125] op_sel_hi:[1,1,0]
    v_pk_fma_f32 v[76:77], v[76:77], s[90:91], v[124:125] op_sel_hi:[1,1,0]
    v_exp_f32 v68, v68
    v_exp_f32 v69, v69
    v_exp_f32 v70, v70
    v_exp_f32 v71, v71
    v_exp_f32 v72, v72
    v_cvt_pk_bf16_f32 v92, v68, v69
    v_exp_f32 v73, v73
    v_cvt_pk_bf16_f32 v93, v70, v71
    v_exp_f32 v74, v74
    v_exp_f32 v75, v75
    v_cvt_pk_bf16_f32 v94, v72, v73
    v_exp_f32 v76, v76
    v_cvt_pk_bf16_f32 v95, v74, v75
    v_exp_f32 v77, v77
    v_mov_b32 v97, 0
    s_waitcnt vmcnt(12)
    v_mfma_f32_16x16x32_bf16 v[116:119], v[24:27], v[92:95], 0
    v_cvt_pk_bf16_f32 v96, v76, v77
    v_add_f32 v84, v84, v85
    v_mfma_f32_16x16x32_bf16 v[108:111], v[28:31], v[92:95], 0
    v_add_f32 v86, v86, v87
    v_add_f32 v88, v88, v89
    v_mfma_f32_16x16x16_bf16 v[116:119], v[24:25], v[96:97], v[116:119]
    v_add_f32 v90, v90, v91
    v_cvt_pk_bf16_f32 v84, v84, v86
    v_mfma_f32_16x16x32_bf16 v[112:115], v[32:35], v[92:95], 0
    v_mov_b32 v85, 0
    v_cvt_pk_bf16_f32 v86, v88, v90
    v_mov_b32 v87, 0
    s_nop 1
    v_mfma_f32_16x16x16_bf16 v[108:111], v[84:85], v[96:97], v[108:111]
    global_store_dword v6, v84, s[46:47] offset:0 sc1
    v_mfma_f32_16x16x16_bf16 v[112:115], v[86:87], v[96:97], v[112:115]
    global_store_dword v6, v86, s[46:47] offset:256 sc1
    s_cbranch_scc1 L_chain_end_s
    v_rcp_f32 v124, v116
    s_nop 2
    v_pk_mul_f32 v[108:109], v[108:109], v[124:125] op_sel_hi:[1,0]
    v_pk_mul_f32 v[110:111], v[110:111], v[124:125] op_sel_hi:[1,0]
    v_pk_mul_f32 v[112:113], v[112:113], v[124:125] op_sel_hi:[1,0]
    v_pk_mul_f32 v[114:115], v[114:115], v[124:125] op_sel_hi:[1,0]
    v_cvt_pk_bf16_f32 v100, v108, v109
    v_cvt_pk_bf16_f32 v101, v110, v111
    v_cvt_pk_bf16_f32 v102, v112, v113
    v_cvt_pk_bf16_f32 v103, v114, v115
    ds_write_b64 v12, v[100:101] offset:0
    ds_write_b64 v12, v[102:103] offset:256
    v_mfma_f32_32x32x8_bf16 v[76:91], v[126:127], v[24:25], 0
    v_mfma_f32_16x16x16_bf16 v[28:31], v[126:127], v[24:25], 0
    v_mfma_f32_16x16x16_bf16 v[32:35], v[126:127], v[24:25], 0
    s_waitcnt lgkmcnt(0)
    s_barrier
    ds_read_b128 v[68:71], v5 offset:14336
    ds_read_b128 v[72:75], v5 offset:15360
    s_waitcnt lgkmcnt(0)
    v_smfmac_f32_16x16x64_bf16 v[76:79], v[68:71], v[192:199], v0
    ds_read_b128 v[92:95], v11 offset:8192
    ds_read_b128 v[96:99], v11 offset:9216
    v_smfmac_f32_16x16x64_bf16 v[76:79], v[72:75], v[200:207], v0
    ds_read_b128 v[100:103], v11 offset:10240
    ds_read_b128 v[104:107], v11 offset:11264
    v_smfmac_f32_16x16x64_bf16 v[80:83], v[68:71], v[208:215], v0
    ds_read_b128 v[108:111], v11 offset:12288
    ds_read_b128 v[112:115], v11 offset:13312
    v_smfmac_f32_16x16x64_bf16 v[80:83], v[72:75], v[216:223], v0
    ds_read_b128 v[116:119], v11 offset:14336
    ds_read_b128 v[120:123], v11 offset:15360
    v_add_f32 v76, v76, v77
    v_add_f32 v78, v78, v79
    v_smfmac_f32_16x16x64_bf16 v[28:31], v[68:71], v[224:231], v0
    v_cvt_pk_bf16_f32 v124, v76, v78
    v_smfmac_f32_16x16x64_bf16 v[28:31], v[72:75], v[232:239], v0
    global_store_dword v13, v124, s[32:33] sc1
    v_mov_b64 v[76:77], 0
    v_smfmac_f32_16x16x64_bf16 v[32:35], v[68:71], v[240:247], v0
    v_mov_b64 v[78:79], 0
    v_add_f32 v80, v80, v81
    v_smfmac_f32_16x16x64_bf16 v[32:35], v[72:75], v[248:255], v0
    v_add_f32 v82, v82, v83
    v_cvt_pk_bf16_f32 v125, v80, v82
    v_smfmac_f32_16x16x64_bf16 v[84:87], v[68:71], v[36:43], v0
    global_store_dword v13, v125, s[34:35] sc1
    v_mov_b64 v[80:81], 0
    v_smfmac_f32_16x16x64_bf16 v[84:87], v[72:75], v[44:51], v0
    v_mov_b64 v[82:83], 0
    v_add_f32 v28, v28, v29
    v_smfmac_f32_16x16x64_bf16 v[88:91], v[68:71], v[52:59], v0
    v_add_f32 v30, v30, v31
    v_cvt_pk_bf16_f32 v124, v28, v30
    v_smfmac_f32_16x16x64_bf16 v[88:91], v[72:75], v[60:67], v0
    global_store_dword v13, v124, s[36:37] sc1
    v_add_f32 v32, v32, v33
    s_waitcnt lgkmcnt(0)
    v_smfmac_f32_16x16x64_bf16 v[76:79], v[68:71], v[92:99], v0
    v_add_f32 v34, v34, v35
    v_cvt_pk_bf16_f32 v125, v32, v34
    v_smfmac_f32_16x16x64_bf16 v[76:79], v[72:75], v[100:107], v0
    global_store_dword v13, v125, s[38:39] sc1
    v_add_f32 v84, v84, v85
    v_smfmac_f32_16x16x64_bf16 v[80:83], v[68:71], v[108:115], v0
    v_add_f32 v86, v86, v87
    v_cvt_pk_bf16_f32 v124, v84, v86
    v_smfmac_f32_16x16x64_bf16 v[80:83], v[72:75], v[116:123], v0
    global_store_dword v13, v124, s[24:25] sc1
    v_add_f32 v88, v88, v89
    v_add_f32 v90, v90, v91
    v_cvt_pk_bf16_f32 v125, v88, v90
    global_store_dword v13, v125, s[26:27] sc1
    v_add_f32 v76, v76, v77
    v_add_f32 v78, v78, v79
    v_cvt_pk_bf16_f32 v124, v76, v78
    global_store_dword v13, v124, s[28:29] sc1
    s_nop 3
    v_add_f32 v80, v80, v81
    v_add_f32 v82, v82, v83
    v_cvt_pk_bf16_f32 v125, v80, v82
    s_nop 0
    global_store_dword v13, v125, s[30:31] sc1
    s_nop 15
    s_nop 15
    s_nop 7
    global_load_dword v40, v14, s[22:23] offset:0 sc1
    global_load_dword v41, v14, s[22:23] offset:256 sc1
    global_load_dword v42, v14, s[22:23] offset:512 sc1
    global_load_dword v43, v14, s[22:23] offset:768 sc1
    global_load_dword v44, v14, s[22:23] offset:1024 sc1
    global_load_dword v45, v14, s[22:23] offset:1280 sc1
    global_load_dword v46, v14, s[22:23] offset:1536 sc1
    global_load_dword v47, v14, s[22:23] offset:1792 sc1
    s_add_u32 s42, s42, 262144
    s_addc_u32 s43, s43, 0
    s_add_u32 s44, s44, 65536
    s_addc_u32 s45, s45, 0
    s_add_u32 s46, s46, 65536
    s_addc_u32 s47, s47, 0
    s_xor_b32 s86, s86, 8192
    s_xor_b32 s87, s87, 8192
    v_xor_b32 v13, 0x40000, v13
    s_add_u32 s10, s10, 1
    s_and_b32 s11, s10, 3
    s_lshl_b32 s11, s11, 13
    s_add_u32 s11, s11, 2048
    s_add_u32 s16, s50, s11
    s_addc_u32 s17, s51, 0
    s_mov_b32 s52, 0
    s_nop 14
    global_load_dword v40, v14, s[22:23] offset:0 sc1
    global_load_dword v41, v14, s[22:23] offset:256 sc1
    global_load_dword v42, v14, s[22:23] offset:512 sc1
    global_load_dword v43, v14, s[22:23] offset:768 sc1
    global_load_dword v44, v14, s[22:23] offset:1024 sc1
    global_load_dword v45, v14, s[22:23] offset:1280 sc1
    global_load_dword v46, v14, s[22:23] offset:1536 sc1
    global_load_dword v47, v14, s[22:23] offset:1792 sc1
    s_waitcnt vmcnt(12)
    v_max3_u32 v124, v40, v41, v42
    v_max_u32 v124, v124, v43
    v_mfma_f32_16x16x32_bf16 v[100:103], v[40:43], v[20:23], 0
    s_waitcnt vmcnt(8)
    v_max3_u32 v125, v44, v45, v46
    v_max3_u32 v124, v124, v125, v47
    v_mfma_f32_16x16x32_bf16 v[100:103], v[44:47], v[20:23], v[100:103]
    v_cmp_eq_u32 vcc, -1, v124
    s_cbranch_vccz L_p1ok_s
L_p1_s:
    s_mov_b64 exec, vcc
    global_load_dword v40, v14, s[22:23] offset:0 sc1
    global_load_dword v41, v14, s[22:23] offset:256 sc1
    global_load_dword v42, v14, s[22:23] offset:512 sc1
    global_load_dword v43, v14, s[22:23] offset:768 sc1
    global_load_dword v44, v14, s[22:23] offset:1024 sc1
    global_load_dword v45, v14, s[22:23] offset:1280 sc1
    global_load_dword v46, v14, s[22:23] offset:1536 sc1
    global_load_dword v47, v14, s[22:23] offset:1792 sc1
    s_mov_b64 exec, -1
    s_nop 3
    s_waitcnt vmcnt(12)
    v_max3_u32 v124, v40, v41, v42
    v_max_u32 v124, v124, v43
    v_mfma_f32_16x16x32_bf16 v[100:103], v[40:43], v[20:23], 0
    s_waitcnt vmcnt(8)
    v_max3_u32 v125, v44, v45, v46
    v_max3_u32 v124, v124, v125, v47
    v_mfma_f32_16x16x32_bf16 v[100:103], v[44:47], v[20:23], v[100:103]
    v_cmp_eq_u32 vcc, -1, v124
    s_cbranch_vccz L_p1ok_s
    s_add_u32 s52, s52, 1
    s_cmp_lt_u32 s52, 200000
    s_cbranch_scc1 L_p1_s
    s_mov_b32 s53, 1
L_p1ok_s:
    s_mov_b64 exec, s[58:59]
    s_nop 2
    v_cvt_pk_bf16_f32 v104, v100, v101
    v_cvt_pk_bf16_f32 v105, v102, v103
    global_store_dwordx2 v15, v[104:105], s[18:19] sc1
    s_mov_b64 exec, -1
    v_readfirstlane_b32 s3, v19
    v_mov_b32 v19, -1
    s_mov_b64 exec, s[58:59]
    global_store_dwordx2 v15, v[18:19], s[20:21] sc1
    s_mov_b64 exec, -1
    s_cmp_eq_u32 s53, 0
    s_cbranch_scc1 L_step_s
L_chain_end_s:
    s_waitcnt vmcnt(0)
    s_barrier
    v_mov_b32 v125, 64
    global_store_dword v126, v125, s[98:99] sc1
    s_branch L_chain_exit
L_kvwait_s:
    s_mov_b32 s52, 0
L_kvspin_s:
    global_load_dword v124, v126, s[96:97] sc1
    s_waitcnt vmcnt(0)
    v_readfirstlane_b32 s3, v124
    s_add_u32 s52, s52, 1
    s_cmp_gt_u32 s52, 200000
    s_cbranch_scc1 L_kvok_s
    s_cmp_eq_u32 s3, 64
    s_cbranch_scc0 L_kvspin_s
    s_branch L_kvok_s
L_chain_exit:
    s_branch L_done
L_done:
    s_waitcnt vmcnt(0)
    s_endpgm
.section .rodata,"a"
.p2align 6
.amdhsa_kernel gated_mix__memory_aug_recurrent_mem_tr__dense_activation_relu__prompt_kernel
  .amdhsa_next_free_vgpr 512
  .amdhsa_next_free_sgpr 102
  .amdhsa_accum_offset 256
  .amdhsa_group_segment_fixed_size 0
  .amdhsa_kernarg_size 112
  .amdhsa_user_sgpr_count 2
  .amdhsa_user_sgpr_kernarg_segment_ptr 1
  .amdhsa_system_sgpr_workgroup_id_x 1
.end_amdhsa_kernel
```
